```python
import torch

def _softmax(x, axis=-1):
    return torch.softmax(x, dim=axis)
def _gelu(x):
    return torch.nn.functional.gelu(x, approximate="tanh")
def _silu(x):
    return torch.nn.functional.silu(x)
def _sigmoid(x):
    return torch.sigmoid(x)
def _layernorm(x, axis=-1, eps=1e-5):
    m = x.mean(dim=axis, keepdim=True)
    v = x.var(dim=axis, keepdim=True, unbiased=False)
    return (x - m) / torch.sqrt(v + eps)
def _scatter_add(tgt, idx, src, axis=0):
    return tgt.clone().index_add_(axis, idx, src)
def _segment_sum(src, seg, n):
    out = torch.zeros((n,) + src.shape[1:], dtype=src.dtype)
    return out.index_add_(0, seg, src)
def _pad(x, pw):
    flat = tuple(v for pair in reversed(pw) for v in pair)
    return torch.nn.functional.pad(x, flat)

kernel_name = 'parallel_sum__ssm_conv_h3__glu_gated_swiglu__prompt'

def setup_inputs():

    _w = (lambda a: (lambda t: t.to(torch.bfloat16) if t.is_floating_point() else t)(torch.as_tensor(a)))
    def _A_setup():
        B, S, D = 1, 2048, 576
        ks = 4
        return {
            "q": _w((lambda *s: torch.randn(*s, dtype=torch.bfloat16) * 0.05)(B, S, D)),
            "k": _w((lambda *s: torch.randn(*s, dtype=torch.bfloat16) * 0.2)(B, S, D)),
            "v": _w((lambda *s: torch.randn(*s, dtype=torch.bfloat16) * 0.2)(B, S, D)),
            "shift_k": _w((lambda *s: torch.randn(*s, dtype=torch.bfloat16) * 0.2)(D, ks) * 0.5),
            "ssm_k": _w((lambda *s: torch.randn(*s, dtype=torch.bfloat16) * 0.4)(D, S) * (1.0 / S ** 0.5)),
            "ssm_D": _w((lambda *s: torch.randn(*s, dtype=torch.bfloat16) * 0.2)(D)),
        }
    _A_in = _A_setup()

    def _B_setup():
        B, S, D, F = 1, 2048, 576, 4608
        return {
            "x": _w((lambda *s: torch.randn(*s, dtype=torch.bfloat16) * 0.05)(B, S, D)),
            "w1": _w((lambda *s: torch.randn(*s, dtype=torch.bfloat16) * 0.2)(D, F) * (2.0 / D) ** 0.5),
            "w3": _w((lambda *s: torch.randn(*s, dtype=torch.bfloat16) * 0.2)(D, F) * (2.0 / D) ** 0.5),
            "w2": _w((lambda *s: torch.randn(*s, dtype=torch.bfloat16) * 0.2)(F, D) * (2.0 / F) ** 0.5),
        }
    _B_in = _B_setup()

    return {
        "A_q": _A_in["q"],
        "A_k": _A_in["k"],
        "A_v": _A_in["v"],
        "A_shift_k": _A_in["shift_k"],
        "A_ssm_k": _A_in["ssm_k"],
        "A_ssm_D": _A_in["ssm_D"],
        "B_x": _B_in["x"],
        "B_w1": _B_in["w1"],
        "B_w3": _B_in["w3"],
        "B_w2": _B_in["w2"],
    }

def reference(A_q, A_k, A_v, A_shift_k, A_ssm_k, A_ssm_D, B_x, B_w1, B_w3, B_w2):
    def _A_ref(q, k, v, shift_k, ssm_k, ssm_D):
        B, S, D = q.shape
        ks = shift_k.shape[-1]
        k_pad = _pad(k, ((0, 0), (ks - 1, 0), (0, 0)))
        k_shift = torch.zeros_like(k)
        for t in range(ks):
            k_shift = k_shift + k_pad[:, t:t + S, :] * shift_k[:, ks - 1 - t][None, None, :]
        kv = k_shift * v
        L = 2 * S
        kv_pad = _pad(kv, ((0, 0), (0, S), (0, 0)))
        kf_pad = _pad(ssm_k, ((0, 0), (0, S)))
        kv_f = (lambda x, axes=(-2,-1): torch.fft.rfft2(x.float(), dim=axes))(kv_pad[:, None, :, :], axes=(1, 2))
        kf_f = (lambda x, axes=(-2,-1): torch.fft.rfft2(x.float(), dim=axes))(kf_pad[:, None, :], axes=(1, 2))
        kf_f = (lambda x, *d: x.permute(*d))(kf_f, 1, 2, 0)
        y_f = kv_f * kf_f[None, :, :, :]
        y = (lambda x, s, axes=(-2,-1): torch.fft.irfft2(x, s=s, dim=axes).to(torch.bfloat16))(y_f, (1, L), axes=(1, 2))[:, 0, :S, :]
        y = y + kv * ssm_D[None, None, :]
        return q * y

    def _B_ref(x, w1, w3, w2):
        gate = torch.einsum("bsd,df->bsf", x, w1)
        up = torch.einsum("bsd,df->bsf", x, w3)
        h = _silu(gate) * up
        out = torch.einsum("bsf,fd->bsd", h, w2)
        return out

    x = A_q
    xn = _layernorm(x, axis=-1)
    return x + _A_ref(xn, A_k, A_v, A_shift_k, A_ssm_k, A_ssm_D) + _B_ref(xn, B_w1, B_w3, B_w2)
```

```asm
; @launch kernel=front_kernel grid=(480,1,1) block=(256,1,1) lds=8704
; @launch kernel=gemm1_kernel grid=(256,1,1) block=(512,1,1) lds=147456
; @launch kernel=gemm2_kernel grid=(256,1,1) block=(512,1,1) lds=147456
.amdgcn_target "amdgcn-amd-amdhsa--gfx950"
.text
.globl front_kernel
.p2align 8
.type front_kernel,@function
front_kernel:
    s_cmp_ge_u32 s2, 480
    s_cbranch_scc1 L_fr_end
    s_cmp_lt_u32 s2, 64
    s_cbranch_scc1 L_fr_pf
    s_cmp_ge_u32 s2, 192
    s_cbranch_scc1 L_fr_kv
    s_load_dwordx2 s[4:5], s[0:1], 0
    s_load_dwordx2 s[14:15], s[0:1], 96
    s_waitcnt lgkmcnt(0)
    s_mov_b32 s16, s4
    s_mov_b32 s17, s5
    s_mov_b32 s18, 2359296
    s_mov_b32 s19, 0x00020000
    s_mov_b32 s20, s14
    s_mov_b32 s21, s15
    s_mov_b32 s22, 2359296
    s_mov_b32 s23, 0x00020000
    s_sub_u32 s3, s2, 64
    s_lshl_b32 s3, s3, 4
    v_lshrrev_b32 v1, 4, v0
    v_add_u32 v1, s3, v1
    v_and_b32 v2, 15, v0
    v_mul_u32_u24 v3, 1152, v1
    v_lshlrev_b32 v4, 3, v2
    v_add_u32 v3, v3, v4
    buffer_load_dwordx2 v[8:9], v3, s[16:19], 0 offen offset:0
    buffer_load_dwordx2 v[10:11], v3, s[16:19], 0 offen offset:128
    buffer_load_dwordx2 v[12:13], v3, s[16:19], 0 offen offset:256
    buffer_load_dwordx2 v[14:15], v3, s[16:19], 0 offen offset:384
    buffer_load_dwordx2 v[16:17], v3, s[16:19], 0 offen offset:512
    buffer_load_dwordx2 v[18:19], v3, s[16:19], 0 offen offset:640
    buffer_load_dwordx2 v[20:21], v3, s[16:19], 0 offen offset:768
    buffer_load_dwordx2 v[22:23], v3, s[16:19], 0 offen offset:896
    buffer_load_dwordx2 v[24:25], v3, s[16:19], 0 offen offset:1024
    v_lshrrev_b32 v4, 4, v1
    v_mul_u32_u24 v4, 18432, v4
    v_and_b32 v5, 15, v1
    v_lshlrev_b32 v5, 4, v5
    v_add_u32 v4, v4, v5
    v_lshrrev_b32 v5, 2, v2
    v_lshlrev_b32 v5, 8, v5
    v_add_u32 v4, v4, v5
    v_lshrrev_b32 v5, 1, v2
    v_and_b32 v5, 1, v5
    v_lshlrev_b32 v5, 10, v5
    v_add_u32 v4, v4, v5
    v_and_b32 v5, 1, v2
    v_lshlrev_b32 v5, 3, v5
    v_add_u32 v1, v4, v5
    s_waitcnt vmcnt(0)
    v_lshlrev_b32 v32, 16, v8
    v_and_b32 v33, 0xffff0000, v8
    v_lshlrev_b32 v34, 16, v9
    v_and_b32 v35, 0xffff0000, v9
    v_lshlrev_b32 v36, 16, v10
    v_and_b32 v37, 0xffff0000, v10
    v_lshlrev_b32 v38, 16, v11
    v_and_b32 v39, 0xffff0000, v11
    v_lshlrev_b32 v40, 16, v12
    v_and_b32 v41, 0xffff0000, v12
    v_lshlrev_b32 v42, 16, v13
    v_and_b32 v43, 0xffff0000, v13
    v_lshlrev_b32 v44, 16, v14
    v_and_b32 v45, 0xffff0000, v14
    v_lshlrev_b32 v46, 16, v15
    v_and_b32 v47, 0xffff0000, v15
    v_lshlrev_b32 v48, 16, v16
    v_and_b32 v49, 0xffff0000, v16
    v_lshlrev_b32 v50, 16, v17
    v_and_b32 v51, 0xffff0000, v17
    v_lshlrev_b32 v52, 16, v18
    v_and_b32 v53, 0xffff0000, v18
    v_lshlrev_b32 v54, 16, v19
    v_and_b32 v55, 0xffff0000, v19
    v_lshlrev_b32 v56, 16, v20
    v_and_b32 v57, 0xffff0000, v20
    v_lshlrev_b32 v58, 16, v21
    v_and_b32 v59, 0xffff0000, v21
    v_lshlrev_b32 v60, 16, v22
    v_and_b32 v61, 0xffff0000, v22
    v_lshlrev_b32 v62, 16, v23
    v_and_b32 v63, 0xffff0000, v23
    v_lshlrev_b32 v64, 16, v24
    v_and_b32 v65, 0xffff0000, v24
    v_lshlrev_b32 v66, 16, v25
    v_and_b32 v67, 0xffff0000, v25
    v_mov_b32 v72, v8
    v_mov_b32 v73, v9
    v_mov_b32 v76, v10
    v_mov_b32 v77, v11
    v_mov_b32 v80, v12
    v_mov_b32 v81, v13
    v_mov_b32 v84, v14
    v_mov_b32 v85, v15
    v_mov_b32 v88, v16
    v_mov_b32 v89, v17
    v_mov_b32 v92, v18
    v_mov_b32 v93, v19
    v_mov_b32 v96, v20
    v_mov_b32 v97, v21
    v_mov_b32 v100, v22
    v_mov_b32 v101, v23
    v_mov_b32 v104, v24
    v_mov_b32 v105, v25
    v_add_f32 v2, v32, v33
    v_add_f32 v3, v34, v35
    v_add_f32 v2, v2, v36
    v_add_f32 v3, v3, v37
    v_add_f32 v2, v2, v38
    v_add_f32 v3, v3, v39
    v_add_f32 v2, v2, v40
    v_add_f32 v3, v3, v41
    v_add_f32 v2, v2, v42
    v_add_f32 v3, v3, v43
    v_add_f32 v2, v2, v44
    v_add_f32 v3, v3, v45
    v_add_f32 v2, v2, v46
    v_add_f32 v3, v3, v47
    v_add_f32 v2, v2, v48
    v_add_f32 v3, v3, v49
    v_add_f32 v2, v2, v50
    v_add_f32 v3, v3, v51
    v_add_f32 v2, v2, v52
    v_add_f32 v3, v3, v53
    v_add_f32 v2, v2, v54
    v_add_f32 v3, v3, v55
    v_add_f32 v2, v2, v56
    v_add_f32 v3, v3, v57
    v_add_f32 v2, v2, v58
    v_add_f32 v3, v3, v59
    v_add_f32 v2, v2, v60
    v_add_f32 v3, v3, v61
    v_add_f32 v2, v2, v62
    v_add_f32 v3, v3, v63
    v_add_f32 v2, v2, v64
    v_add_f32 v3, v3, v65
    v_add_f32 v2, v2, v66
    v_add_f32 v3, v3, v67
    v_add_f32 v2, v2, v3
    s_nop 1
    v_add_f32_dpp v3, v2, v2 quad_perm:[1,0,3,2] row_mask:0xf bank_mask:0xf
    s_nop 1
    v_add_f32_dpp v2, v3, v3 quad_perm:[2,3,0,1] row_mask:0xf bank_mask:0xf
    s_nop 1
    v_add_f32_dpp v3, v2, v2 row_half_mirror row_mask:0xf bank_mask:0xf
    s_nop 1
    v_add_f32_dpp v2, v3, v3 row_mirror row_mask:0xf bank_mask:0xf
    s_mov_b32 s24, 0x3ae38e39
    v_mul_f32 v2, s24, v2
    v_mov_b32 v4, 0
    v_mov_b32 v5, 0
    v_sub_f32 v6, v32, v2
    v_sub_f32 v7, v33, v2
    v_fmac_f32 v4, v6, v6
    v_fmac_f32 v5, v7, v7
    v_sub_f32 v6, v34, v2
    v_sub_f32 v7, v35, v2
    v_fmac_f32 v4, v6, v6
    v_fmac_f32 v5, v7, v7
    v_sub_f32 v6, v36, v2
    v_sub_f32 v7, v37, v2
    v_fmac_f32 v4, v6, v6
    v_fmac_f32 v5, v7, v7
    v_sub_f32 v6, v38, v2
    v_sub_f32 v7, v39, v2
    v_fmac_f32 v4, v6, v6
    v_fmac_f32 v5, v7, v7
    v_sub_f32 v6, v40, v2
    v_sub_f32 v7, v41, v2
    v_fmac_f32 v4, v6, v6
    v_fmac_f32 v5, v7, v7
    v_sub_f32 v6, v42, v2
    v_sub_f32 v7, v43, v2
    v_fmac_f32 v4, v6, v6
    v_fmac_f32 v5, v7, v7
    v_sub_f32 v6, v44, v2
    v_sub_f32 v7, v45, v2
    v_fmac_f32 v4, v6, v6
    v_fmac_f32 v5, v7, v7
    v_sub_f32 v6, v46, v2
    v_sub_f32 v7, v47, v2
    v_fmac_f32 v4, v6, v6
    v_fmac_f32 v5, v7, v7
    v_sub_f32 v6, v48, v2
    v_sub_f32 v7, v49, v2
    v_fmac_f32 v4, v6, v6
    v_fmac_f32 v5, v7, v7
    v_sub_f32 v6, v50, v2
    v_sub_f32 v7, v51, v2
    v_fmac_f32 v4, v6, v6
    v_fmac_f32 v5, v7, v7
    v_sub_f32 v6, v52, v2
    v_sub_f32 v7, v53, v2
    v_fmac_f32 v4, v6, v6
    v_fmac_f32 v5, v7, v7
    v_sub_f32 v6, v54, v2
    v_sub_f32 v7, v55, v2
    v_fmac_f32 v4, v6, v6
    v_fmac_f32 v5, v7, v7
    v_sub_f32 v6, v56, v2
    v_sub_f32 v7, v57, v2
    v_fmac_f32 v4, v6, v6
    v_fmac_f32 v5, v7, v7
    v_sub_f32 v6, v58, v2
    v_sub_f32 v7, v59, v2
    v_fmac_f32 v4, v6, v6
    v_fmac_f32 v5, v7, v7
    v_sub_f32 v6, v60, v2
    v_sub_f32 v7, v61, v2
    v_fmac_f32 v4, v6, v6
    v_fmac_f32 v5, v7, v7
    v_sub_f32 v6, v62, v2
    v_sub_f32 v7, v63, v2
    v_fmac_f32 v4, v6, v6
    v_fmac_f32 v5, v7, v7
    v_sub_f32 v6, v64, v2
    v_sub_f32 v7, v65, v2
    v_fmac_f32 v4, v6, v6
    v_fmac_f32 v5, v7, v7
    v_sub_f32 v6, v66, v2
    v_sub_f32 v7, v67, v2
    v_fmac_f32 v4, v6, v6
    v_fmac_f32 v5, v7, v7
    v_add_f32 v4, v4, v5
    s_nop 1
    v_add_f32_dpp v5, v4, v4 quad_perm:[1,0,3,2] row_mask:0xf bank_mask:0xf
    s_nop 1
    v_add_f32_dpp v4, v5, v5 quad_perm:[2,3,0,1] row_mask:0xf bank_mask:0xf
    s_nop 1
    v_add_f32_dpp v5, v4, v4 row_half_mirror row_mask:0xf bank_mask:0xf
    s_nop 1
    v_add_f32_dpp v4, v5, v5 row_mirror row_mask:0xf bank_mask:0xf
    v_mul_f32 v4, s24, v4
    v_cvt_pk_bf16_f32 v5, v2, v4
    v_lshlrev_b32 v2, 16, v5
    v_and_b32 v4, 0xffff0000, v5
    v_add_f32 v4, 0x3727c5ac, v4
    v_cvt_pk_bf16_f32 v4, v4, v4
    v_and_b32 v4, 0xffff0000, v4
    v_sqrt_f32 v4, v4
    s_nop 0
    v_cvt_pk_bf16_f32 v4, v4, v4
    v_and_b32 v4, 0xffff0000, v4
    v_rcp_f32 v5, v4
    s_nop 0
    v_sub_f32 v32, v32, v2
    v_sub_f32 v33, v33, v2
    v_cvt_pk_bf16_f32 v6, v32, v33
    v_lshlrev_b32 v32, 16, v6
    v_and_b32 v33, 0xffff0000, v6
    v_mul_f32 v6, v32, v5
    v_mul_f32 v7, v33, v5
    v_fma_f32 v32, -v6, v4, v32
    v_fma_f32 v33, -v7, v4, v33
    v_fma_f32 v6, v32, v5, v6
    v_fma_f32 v7, v33, v5, v7
    v_cvt_pk_bf16_f32 v8, v6, v7
    v_sub_f32 v34, v34, v2
    v_sub_f32 v35, v35, v2
    v_cvt_pk_bf16_f32 v6, v34, v35
    v_lshlrev_b32 v34, 16, v6
    v_and_b32 v35, 0xffff0000, v6
    v_mul_f32 v6, v34, v5
    v_mul_f32 v7, v35, v5
    v_fma_f32 v34, -v6, v4, v34
    v_fma_f32 v35, -v7, v4, v35
    v_fma_f32 v6, v34, v5, v6
    v_fma_f32 v7, v35, v5, v7
    v_cvt_pk_bf16_f32 v9, v6, v7
    v_sub_f32 v36, v36, v2
    v_sub_f32 v37, v37, v2
    v_cvt_pk_bf16_f32 v6, v36, v37
    v_lshlrev_b32 v36, 16, v6
    v_and_b32 v37, 0xffff0000, v6
    v_mul_f32 v6, v36, v5
    v_mul_f32 v7, v37, v5
    v_fma_f32 v36, -v6, v4, v36
    v_fma_f32 v37, -v7, v4, v37
    v_fma_f32 v6, v36, v5, v6
    v_fma_f32 v7, v37, v5, v7
    v_cvt_pk_bf16_f32 v10, v6, v7
    v_sub_f32 v38, v38, v2
    v_sub_f32 v39, v39, v2
    v_cvt_pk_bf16_f32 v6, v38, v39
    v_lshlrev_b32 v38, 16, v6
    v_and_b32 v39, 0xffff0000, v6
    v_mul_f32 v6, v38, v5
    v_mul_f32 v7, v39, v5
    v_fma_f32 v38, -v6, v4, v38
    v_fma_f32 v39, -v7, v4, v39
    v_fma_f32 v6, v38, v5, v6
    v_fma_f32 v7, v39, v5, v7
    v_cvt_pk_bf16_f32 v11, v6, v7
    v_sub_f32 v40, v40, v2
    v_sub_f32 v41, v41, v2
    v_cvt_pk_bf16_f32 v6, v40, v41
    v_lshlrev_b32 v40, 16, v6
    v_and_b32 v41, 0xffff0000, v6
    v_mul_f32 v6, v40, v5
    v_mul_f32 v7, v41, v5
    v_fma_f32 v40, -v6, v4, v40
    v_fma_f32 v41, -v7, v4, v41
    v_fma_f32 v6, v40, v5, v6
    v_fma_f32 v7, v41, v5, v7
    v_cvt_pk_bf16_f32 v12, v6, v7
    v_sub_f32 v42, v42, v2
    v_sub_f32 v43, v43, v2
    v_cvt_pk_bf16_f32 v6, v42, v43
    v_lshlrev_b32 v42, 16, v6
    v_and_b32 v43, 0xffff0000, v6
    v_mul_f32 v6, v42, v5
    v_mul_f32 v7, v43, v5
    v_fma_f32 v42, -v6, v4, v42
    v_fma_f32 v43, -v7, v4, v43
    v_fma_f32 v6, v42, v5, v6
    v_fma_f32 v7, v43, v5, v7
    v_cvt_pk_bf16_f32 v13, v6, v7
    v_sub_f32 v44, v44, v2
    v_sub_f32 v45, v45, v2
    v_cvt_pk_bf16_f32 v6, v44, v45
    v_lshlrev_b32 v44, 16, v6
    v_and_b32 v45, 0xffff0000, v6
    v_mul_f32 v6, v44, v5
    v_mul_f32 v7, v45, v5
    v_fma_f32 v44, -v6, v4, v44
    v_fma_f32 v45, -v7, v4, v45
    v_fma_f32 v6, v44, v5, v6
    v_fma_f32 v7, v45, v5, v7
    v_cvt_pk_bf16_f32 v14, v6, v7
    v_sub_f32 v46, v46, v2
    v_sub_f32 v47, v47, v2
    v_cvt_pk_bf16_f32 v6, v46, v47
    v_lshlrev_b32 v46, 16, v6
    v_and_b32 v47, 0xffff0000, v6
    v_mul_f32 v6, v46, v5
    v_mul_f32 v7, v47, v5
    v_fma_f32 v46, -v6, v4, v46
    v_fma_f32 v47, -v7, v4, v47
    v_fma_f32 v6, v46, v5, v6
    v_fma_f32 v7, v47, v5, v7
    v_cvt_pk_bf16_f32 v15, v6, v7
    v_sub_f32 v48, v48, v2
    v_sub_f32 v49, v49, v2
    v_cvt_pk_bf16_f32 v6, v48, v49
    v_lshlrev_b32 v48, 16, v6
    v_and_b32 v49, 0xffff0000, v6
    v_mul_f32 v6, v48, v5
    v_mul_f32 v7, v49, v5
    v_fma_f32 v48, -v6, v4, v48
    v_fma_f32 v49, -v7, v4, v49
    v_fma_f32 v6, v48, v5, v6
    v_fma_f32 v7, v49, v5, v7
    v_cvt_pk_bf16_f32 v16, v6, v7
    v_sub_f32 v50, v50, v2
    v_sub_f32 v51, v51, v2
    v_cvt_pk_bf16_f32 v6, v50, v51
    v_lshlrev_b32 v50, 16, v6
    v_and_b32 v51, 0xffff0000, v6
    v_mul_f32 v6, v50, v5
    v_mul_f32 v7, v51, v5
    v_fma_f32 v50, -v6, v4, v50
    v_fma_f32 v51, -v7, v4, v51
    v_fma_f32 v6, v50, v5, v6
    v_fma_f32 v7, v51, v5, v7
    v_cvt_pk_bf16_f32 v17, v6, v7
    v_sub_f32 v52, v52, v2
    v_sub_f32 v53, v53, v2
    v_cvt_pk_bf16_f32 v6, v52, v53
    v_lshlrev_b32 v52, 16, v6
    v_and_b32 v53, 0xffff0000, v6
    v_mul_f32 v6, v52, v5
    v_mul_f32 v7, v53, v5
    v_fma_f32 v52, -v6, v4, v52
    v_fma_f32 v53, -v7, v4, v53
    v_fma_f32 v6, v52, v5, v6
    v_fma_f32 v7, v53, v5, v7
    v_cvt_pk_bf16_f32 v18, v6, v7
    v_sub_f32 v54, v54, v2
    v_sub_f32 v55, v55, v2
    v_cvt_pk_bf16_f32 v6, v54, v55
    v_lshlrev_b32 v54, 16, v6
    v_and_b32 v55, 0xffff0000, v6
    v_mul_f32 v6, v54, v5
    v_mul_f32 v7, v55, v5
    v_fma_f32 v54, -v6, v4, v54
    v_fma_f32 v55, -v7, v4, v55
    v_fma_f32 v6, v54, v5, v6
    v_fma_f32 v7, v55, v5, v7
    v_cvt_pk_bf16_f32 v19, v6, v7
    v_sub_f32 v56, v56, v2
    v_sub_f32 v57, v57, v2
    v_cvt_pk_bf16_f32 v6, v56, v57
    v_lshlrev_b32 v56, 16, v6
    v_and_b32 v57, 0xffff0000, v6
    v_mul_f32 v6, v56, v5
    v_mul_f32 v7, v57, v5
    v_fma_f32 v56, -v6, v4, v56
    v_fma_f32 v57, -v7, v4, v57
    v_fma_f32 v6, v56, v5, v6
    v_fma_f32 v7, v57, v5, v7
    v_cvt_pk_bf16_f32 v20, v6, v7
    v_sub_f32 v58, v58, v2
    v_sub_f32 v59, v59, v2
    v_cvt_pk_bf16_f32 v6, v58, v59
    v_lshlrev_b32 v58, 16, v6
    v_and_b32 v59, 0xffff0000, v6
    v_mul_f32 v6, v58, v5
    v_mul_f32 v7, v59, v5
    v_fma_f32 v58, -v6, v4, v58
    v_fma_f32 v59, -v7, v4, v59
    v_fma_f32 v6, v58, v5, v6
    v_fma_f32 v7, v59, v5, v7
    v_cvt_pk_bf16_f32 v21, v6, v7
    v_sub_f32 v60, v60, v2
    v_sub_f32 v61, v61, v2
    v_cvt_pk_bf16_f32 v6, v60, v61
    v_lshlrev_b32 v60, 16, v6
    v_and_b32 v61, 0xffff0000, v6
    v_mul_f32 v6, v60, v5
    v_mul_f32 v7, v61, v5
    v_fma_f32 v60, -v6, v4, v60
    v_fma_f32 v61, -v7, v4, v61
    v_fma_f32 v6, v60, v5, v6
    v_fma_f32 v7, v61, v5, v7
    v_cvt_pk_bf16_f32 v22, v6, v7
    v_sub_f32 v62, v62, v2
    v_sub_f32 v63, v63, v2
    v_cvt_pk_bf16_f32 v6, v62, v63
    v_lshlrev_b32 v62, 16, v6
    v_and_b32 v63, 0xffff0000, v6
    v_mul_f32 v6, v62, v5
    v_mul_f32 v7, v63, v5
    v_fma_f32 v62, -v6, v4, v62
    v_fma_f32 v63, -v7, v4, v63
    v_fma_f32 v6, v62, v5, v6
    v_fma_f32 v7, v63, v5, v7
    v_cvt_pk_bf16_f32 v23, v6, v7
    v_sub_f32 v64, v64, v2
    v_sub_f32 v65, v65, v2
    v_cvt_pk_bf16_f32 v6, v64, v65
    v_lshlrev_b32 v64, 16, v6
    v_and_b32 v65, 0xffff0000, v6
    v_mul_f32 v6, v64, v5
    v_mul_f32 v7, v65, v5
    v_fma_f32 v64, -v6, v4, v64
    v_fma_f32 v65, -v7, v4, v65
    v_fma_f32 v6, v64, v5, v6
    v_fma_f32 v7, v65, v5, v7
    v_cvt_pk_bf16_f32 v24, v6, v7
    v_sub_f32 v66, v66, v2
    v_sub_f32 v67, v67, v2
    v_cvt_pk_bf16_f32 v6, v66, v67
    v_lshlrev_b32 v66, 16, v6
    v_and_b32 v67, 0xffff0000, v6
    v_mul_f32 v6, v66, v5
    v_mul_f32 v7, v67, v5
    v_fma_f32 v66, -v6, v4, v66
    v_fma_f32 v67, -v7, v4, v67
    v_fma_f32 v6, v66, v5, v6
    v_fma_f32 v7, v67, v5, v7
    v_cvt_pk_bf16_f32 v25, v6, v7
    s_mov_b32 s25, 0
    buffer_store_dwordx2 v[8:9], v1, s[20:23], s25 offen
    s_mov_b32 s25, 2048
    buffer_store_dwordx2 v[10:11], v1, s[20:23], s25 offen
    s_mov_b32 s25, 4096
    buffer_store_dwordx2 v[12:13], v1, s[20:23], s25 offen
    s_mov_b32 s25, 6144
    buffer_store_dwordx2 v[14:15], v1, s[20:23], s25 offen
    s_mov_b32 s25, 8192
    buffer_store_dwordx2 v[16:17], v1, s[20:23], s25 offen
    s_mov_b32 s25, 10240
    buffer_store_dwordx2 v[18:19], v1, s[20:23], s25 offen
    s_mov_b32 s25, 12288
    buffer_store_dwordx2 v[20:21], v1, s[20:23], s25 offen
    s_mov_b32 s25, 14336
    buffer_store_dwordx2 v[22:23], v1, s[20:23], s25 offen
    s_mov_b32 s25, 16384
    buffer_store_dwordx2 v[24:25], v1, s[20:23], s25 offen
    s_add_u32 s28, s14, 37748736
    s_addc_u32 s29, s15, 0
    s_mov_b32 s30, 4718592
    s_mov_b32 s31, 0x00020000
    v_lshrrev_b32 v2, 4, v0
    v_add_u32 v2, s3, v2
    v_lshrrev_b32 v3, 4, v2
    v_mul_u32_u24 v3, 36864, v3
    v_and_b32 v2, 15, v2
    v_lshlrev_b32 v2, 4, v2
    v_add_u32 v3, v3, v2
    v_bfe_u32 v2, v0, 2, 2
    v_lshlrev_b32 v2, 10, v2
    v_add_u32 v3, v3, v2
    v_and_b32 v2, 3, v0
    v_lshlrev_b32 v2, 8, v2
    v_add_u32 v3, v3, v2
    v_mov_b32 v74, v8
    v_mov_b32 v75, v9
    s_mov_b32 s25, 0
    buffer_store_dwordx4 v[72:75], v3, s[28:31], s25 offen
    v_mov_b32 v78, v10
    v_mov_b32 v79, v11
    s_mov_b32 s25, 4096
    buffer_store_dwordx4 v[76:79], v3, s[28:31], s25 offen
    v_mov_b32 v82, v12
    v_mov_b32 v83, v13
    s_mov_b32 s25, 8192
    buffer_store_dwordx4 v[80:83], v3, s[28:31], s25 offen
    v_mov_b32 v86, v14
    v_mov_b32 v87, v15
    s_mov_b32 s25, 12288
    buffer_store_dwordx4 v[84:87], v3, s[28:31], s25 offen
    v_mov_b32 v90, v16
    v_mov_b32 v91, v17
    s_mov_b32 s25, 16384
    buffer_store_dwordx4 v[88:91], v3, s[28:31], s25 offen
    v_mov_b32 v94, v18
    v_mov_b32 v95, v19
    s_mov_b32 s25, 20480
    buffer_store_dwordx4 v[92:95], v3, s[28:31], s25 offen
    v_mov_b32 v98, v20
    v_mov_b32 v99, v21
    s_mov_b32 s25, 24576
    buffer_store_dwordx4 v[96:99], v3, s[28:31], s25 offen
    v_mov_b32 v102, v22
    v_mov_b32 v103, v23
    s_mov_b32 s25, 28672
    buffer_store_dwordx4 v[100:103], v3, s[28:31], s25 offen
    v_mov_b32 v106, v24
    v_mov_b32 v107, v25
    s_mov_b32 s25, 32768
    buffer_store_dwordx4 v[104:107], v3, s[28:31], s25 offen
    s_endpgm
L_fr_pf:
    s_load_dwordx4 s[4:7], s[0:1], 56
    s_load_dwordx2 s[8:9], s[0:1], 32
    s_load_dwordx2 s[10:11], s[0:1], 96
    v_and_b32 v1, 63, v0
    v_lshrrev_b32 v2, 6, v0
    s_nop 0
    v_readfirstlane_b32 s40, v2
    s_and_b32 s30, s2, 7
    s_mul_i32 s30, s30, 1152
    s_mov_b32 s31, s2
    s_lshr_b32 s31, s31, 3
    s_lshl_b32 s31, s31, 2
    s_add_u32 s31, s31, s40
    s_mul_i32 s31, s31, 64512
    v_mul_u32_u24 v2, 57, v1
    v_lshrrev_b32 v2, 9, v2
    v_mul_u32_u24 v3, 9, v2
    v_sub_u32 v3, v1, v3
    v_mul_u32_u24 v2, 9216, v2
    v_lshlrev_b32 v3, 7, v3
    v_add_u32 v2, v2, v3
    s_waitcnt lgkmcnt(0)
    s_add_u32 s24, s10, 58720256
    s_addc_u32 s25, s11, 0
    s_mov_b32 s26, 16384
    s_mov_b32 s27, 0x00020000
    s_cmp_lg_u32 s2, 0
    s_cbranch_scc1 L_fr_pf1
    v_lshlrev_b32 v4, 7, v0
    v_mov_b32 v5, 0
    buffer_store_dword v5, v4, s[24:27], 0 offen
L_fr_pf1:
    s_add_u32 s12, s4, s30
    s_addc_u32 s13, s5, 0
    s_sub_u32 s14, 5308416, s30
    s_mov_b32 s15, 0x00020000
    s_add_u32 s16, s6, s30
    s_addc_u32 s17, s7, 0
    s_sub_u32 s18, 5308416, s30
    s_mov_b32 s19, 0x00020000
    buffer_load_dword v8, v2, s[12:15], s31 offen
    buffer_load_dword v9, v2, s[16:19], s31 offen
    s_add_u32 s31, s31, 2064384
    s_endpgm
L_fr_kv:
    s_load_dwordx4 s[8:11], s[0:1], 8
    s_load_dwordx2 s[12:13], s[0:1], 24
    s_load_dwordx2 s[14:15], s[0:1], 96
    s_waitcnt lgkmcnt(0)
    s_mov_b32 s16, s8
    s_mov_b32 s17, s9
    s_mov_b32 s18, 2359296
    s_mov_b32 s19, 0x00020000
    s_mov_b32 s20, s10
    s_mov_b32 s21, s11
    s_mov_b32 s22, 2359296
    s_mov_b32 s23, 0x00020000
    s_mov_b32 s24, s12
    s_mov_b32 s25, s13
    s_mov_b32 s26, 4608
    s_mov_b32 s27, 0x00020000
    s_add_u32 s28, s14, 4194304
    s_addc_u32 s29, s15, 0
    s_mov_b32 s30, 2359296
    s_mov_b32 s31, 0x00020000
    s_sub_u32 s3, s2, 192
    s_and_b32 s32, s3, 31
    s_lshr_b32 s33, s3, 5
    v_lshrrev_b32 v1, 3, v0
    v_and_b32 v2, 7, v0
    s_lshl_b32 s34, s32, 6
    v_lshlrev_b32 v3, 1, v1
    v_add_u32 v3, s34, v3
    s_lshl_b32 s35, s33, 7
    v_lshlrev_b32 v4, 4, v2
    v_add_u32 v4, s35, v4
    v_mul_u32_u24 v5, 1152, v3
    v_add_u32 v5, v5, v4
    v_add_u32 v6, 4294963840, v5
    v_add_u32 v7, 4294964992, v5
    v_add_u32 v8, 4294966144, v5
    v_add_u32 v9, 0, v5
    v_add_u32 v10, 1152, v5
    buffer_load_dwordx4 v[12:15], v6, s[16:19], 0 offen
    buffer_load_dwordx4 v[16:19], v7, s[16:19], 0 offen
    buffer_load_dwordx4 v[20:23], v8, s[16:19], 0 offen
    buffer_load_dwordx4 v[24:27], v9, s[16:19], 0 offen
    buffer_load_dwordx4 v[28:31], v10, s[16:19], 0 offen
    buffer_load_dwordx4 v[32:35], v5, s[20:23], 0 offen
    buffer_load_dwordx4 v[36:39], v5, s[20:23], 0 offen offset:1152
    v_lshlrev_b32 v11, 2, v4
    buffer_load_dwordx4 v[40:43], v11, s[24:27], 0 offen offset:0
    buffer_load_dwordx4 v[44:47], v11, s[24:27], 0 offen offset:16
    buffer_load_dwordx4 v[48:51], v11, s[24:27], 0 offen offset:32
    buffer_load_dwordx4 v[52:55], v11, s[24:27], 0 offen offset:48
    v_mul_u32_u24 v56, 1088, v2
    v_sub_u32 v57, 31, v1
    v_lshlrev_b32 v57, 2, v57
    v_add_u32 v56, v56, v57
    s_waitcnt vmcnt(0)
    v_lshlrev_b32 v60, 16, v12
    v_lshlrev_b32 v61, 16, v16
    v_lshlrev_b32 v62, 16, v20
    v_lshlrev_b32 v63, 16, v24
    v_lshlrev_b32 v64, 16, v28
    v_lshlrev_b32 v65, 16, v32
    v_lshlrev_b32 v66, 16, v36
    v_lshlrev_b32 v67, 16, v40
    v_and_b32 v68, 0xffff0000, v40
    v_lshlrev_b32 v69, 16, v41
    v_and_b32 v70, 0xffff0000, v41
    v_mul_f32 v71, v60, v70
    v_mul_f32 v72, v61, v70
    v_cvt_pk_bf16_f32 v73, v71, v72
    v_lshlrev_b32 v74, 16, v73
    v_and_b32 v75, 0xffff0000, v73
    v_mul_f32 v71, v61, v69
    v_mul_f32 v72, v62, v69
    v_cvt_pk_bf16_f32 v73, v71, v72
    v_lshlrev_b32 v71, 16, v73
    v_and_b32 v72, 0xffff0000, v73
    v_add_f32 v74, v74, v71
    v_add_f32 v75, v75, v72
    v_cvt_pk_bf16_f32 v73, v74, v75
    v_lshlrev_b32 v74, 16, v73
    v_and_b32 v75, 0xffff0000, v73
    v_mul_f32 v71, v62, v68
    v_mul_f32 v72, v63, v68
    v_cvt_pk_bf16_f32 v73, v71, v72
    v_lshlrev_b32 v71, 16, v73
    v_and_b32 v72, 0xffff0000, v73
    v_add_f32 v74, v74, v71
    v_add_f32 v75, v75, v72
    v_cvt_pk_bf16_f32 v73, v74, v75
    v_lshlrev_b32 v74, 16, v73
    v_and_b32 v75, 0xffff0000, v73
    v_mul_f32 v71, v63, v67
    v_mul_f32 v72, v64, v67
    v_cvt_pk_bf16_f32 v73, v71, v72
    v_lshlrev_b32 v71, 16, v73
    v_and_b32 v72, 0xffff0000, v73
    v_add_f32 v74, v74, v71
    v_add_f32 v75, v75, v72
    v_cvt_pk_bf16_f32 v73, v74, v75
    v_lshlrev_b32 v74, 16, v73
    v_and_b32 v75, 0xffff0000, v73
    v_mul_f32 v74, v74, v65
    v_mul_f32 v75, v75, v66
    v_cvt_pk_bf16_f32 v73, v75, v74
    ds_write_b32 v56, v73 offset:0
    v_and_b32 v60, 0xffff0000, v12
    v_and_b32 v61, 0xffff0000, v16
    v_and_b32 v62, 0xffff0000, v20
    v_and_b32 v63, 0xffff0000, v24
    v_and_b32 v64, 0xffff0000, v28
    v_and_b32 v65, 0xffff0000, v32
    v_and_b32 v66, 0xffff0000, v36
    v_lshlrev_b32 v67, 16, v42
    v_and_b32 v68, 0xffff0000, v42
    v_lshlrev_b32 v69, 16, v43
    v_and_b32 v70, 0xffff0000, v43
    v_mul_f32 v71, v60, v70
    v_mul_f32 v72, v61, v70
    v_cvt_pk_bf16_f32 v73, v71, v72
    v_lshlrev_b32 v74, 16, v73
    v_and_b32 v75, 0xffff0000, v73
    v_mul_f32 v71, v61, v69
    v_mul_f32 v72, v62, v69
    v_cvt_pk_bf16_f32 v73, v71, v72
    v_lshlrev_b32 v71, 16, v73
    v_and_b32 v72, 0xffff0000, v73
    v_add_f32 v74, v74, v71
    v_add_f32 v75, v75, v72
    v_cvt_pk_bf16_f32 v73, v74, v75
    v_lshlrev_b32 v74, 16, v73
    v_and_b32 v75, 0xffff0000, v73
    v_mul_f32 v71, v62, v68
    v_mul_f32 v72, v63, v68
    v_cvt_pk_bf16_f32 v73, v71, v72
    v_lshlrev_b32 v71, 16, v73
    v_and_b32 v72, 0xffff0000, v73
    v_add_f32 v74, v74, v71
    v_add_f32 v75, v75, v72
    v_cvt_pk_bf16_f32 v73, v74, v75
    v_lshlrev_b32 v74, 16, v73
    v_and_b32 v75, 0xffff0000, v73
    v_mul_f32 v71, v63, v67
    v_mul_f32 v72, v64, v67
    v_cvt_pk_bf16_f32 v73, v71, v72
    v_lshlrev_b32 v71, 16, v73
    v_and_b32 v72, 0xffff0000, v73
    v_add_f32 v74, v74, v71
    v_add_f32 v75, v75, v72
    v_cvt_pk_bf16_f32 v73, v74, v75
    v_lshlrev_b32 v74, 16, v73
    v_and_b32 v75, 0xffff0000, v73
    v_mul_f32 v74, v74, v65
    v_mul_f32 v75, v75, v66
    v_cvt_pk_bf16_f32 v73, v75, v74
    ds_write_b32 v56, v73 offset:136
    v_lshlrev_b32 v60, 16, v13
    v_lshlrev_b32 v61, 16, v17
    v_lshlrev_b32 v62, 16, v21
    v_lshlrev_b32 v63, 16, v25
    v_lshlrev_b32 v64, 16, v29
    v_lshlrev_b32 v65, 16, v33
    v_lshlrev_b32 v66, 16, v37
    v_lshlrev_b32 v67, 16, v44
    v_and_b32 v68, 0xffff0000, v44
    v_lshlrev_b32 v69, 16, v45
    v_and_b32 v70, 0xffff0000, v45
    v_mul_f32 v71, v60, v70
    v_mul_f32 v72, v61, v70
    v_cvt_pk_bf16_f32 v73, v71, v72
    v_lshlrev_b32 v74, 16, v73
    v_and_b32 v75, 0xffff0000, v73
    v_mul_f32 v71, v61, v69
    v_mul_f32 v72, v62, v69
    v_cvt_pk_bf16_f32 v73, v71, v72
    v_lshlrev_b32 v71, 16, v73
    v_and_b32 v72, 0xffff0000, v73
    v_add_f32 v74, v74, v71
    v_add_f32 v75, v75, v72
    v_cvt_pk_bf16_f32 v73, v74, v75
    v_lshlrev_b32 v74, 16, v73
    v_and_b32 v75, 0xffff0000, v73
    v_mul_f32 v71, v62, v68
    v_mul_f32 v72, v63, v68
    v_cvt_pk_bf16_f32 v73, v71, v72
    v_lshlrev_b32 v71, 16, v73
    v_and_b32 v72, 0xffff0000, v73
    v_add_f32 v74, v74, v71
    v_add_f32 v75, v75, v72
    v_cvt_pk_bf16_f32 v73, v74, v75
    v_lshlrev_b32 v74, 16, v73
    v_and_b32 v75, 0xffff0000, v73
    v_mul_f32 v71, v63, v67
    v_mul_f32 v72, v64, v67
    v_cvt_pk_bf16_f32 v73, v71, v72
    v_lshlrev_b32 v71, 16, v73
    v_and_b32 v72, 0xffff0000, v73
    v_add_f32 v74, v74, v71
    v_add_f32 v75, v75, v72
    v_cvt_pk_bf16_f32 v73, v74, v75
    v_lshlrev_b32 v74, 16, v73
    v_and_b32 v75, 0xffff0000, v73
    v_mul_f32 v74, v74, v65
    v_mul_f32 v75, v75, v66
    v_cvt_pk_bf16_f32 v73, v75, v74
    ds_write_b32 v56, v73 offset:272
    v_and_b32 v60, 0xffff0000, v13
    v_and_b32 v61, 0xffff0000, v17
    v_and_b32 v62, 0xffff0000, v21
    v_and_b32 v63, 0xffff0000, v25
    v_and_b32 v64, 0xffff0000, v29
    v_and_b32 v65, 0xffff0000, v33
    v_and_b32 v66, 0xffff0000, v37
    v_lshlrev_b32 v67, 16, v46
    v_and_b32 v68, 0xffff0000, v46
    v_lshlrev_b32 v69, 16, v47
    v_and_b32 v70, 0xffff0000, v47
    v_mul_f32 v71, v60, v70
    v_mul_f32 v72, v61, v70
    v_cvt_pk_bf16_f32 v73, v71, v72
    v_lshlrev_b32 v74, 16, v73
    v_and_b32 v75, 0xffff0000, v73
    v_mul_f32 v71, v61, v69
    v_mul_f32 v72, v62, v69
    v_cvt_pk_bf16_f32 v73, v71, v72
    v_lshlrev_b32 v71, 16, v73
    v_and_b32 v72, 0xffff0000, v73
    v_add_f32 v74, v74, v71
    v_add_f32 v75, v75, v72
    v_cvt_pk_bf16_f32 v73, v74, v75
    v_lshlrev_b32 v74, 16, v73
    v_and_b32 v75, 0xffff0000, v73
    v_mul_f32 v71, v62, v68
    v_mul_f32 v72, v63, v68
    v_cvt_pk_bf16_f32 v73, v71, v72
    v_lshlrev_b32 v71, 16, v73
    v_and_b32 v72, 0xffff0000, v73
    v_add_f32 v74, v74, v71
    v_add_f32 v75, v75, v72
    v_cvt_pk_bf16_f32 v73, v74, v75
    v_lshlrev_b32 v74, 16, v73
    v_and_b32 v75, 0xffff0000, v73
    v_mul_f32 v71, v63, v67
    v_mul_f32 v72, v64, v67
    v_cvt_pk_bf16_f32 v73, v71, v72
    v_lshlrev_b32 v71, 16, v73
    v_and_b32 v72, 0xffff0000, v73
    v_add_f32 v74, v74, v71
    v_add_f32 v75, v75, v72
    v_cvt_pk_bf16_f32 v73, v74, v75
    v_lshlrev_b32 v74, 16, v73
    v_and_b32 v75, 0xffff0000, v73
    v_mul_f32 v74, v74, v65
    v_mul_f32 v75, v75, v66
    v_cvt_pk_bf16_f32 v73, v75, v74
    ds_write_b32 v56, v73 offset:408
    v_lshlrev_b32 v60, 16, v14
    v_lshlrev_b32 v61, 16, v18
    v_lshlrev_b32 v62, 16, v22
    v_lshlrev_b32 v63, 16, v26
    v_lshlrev_b32 v64, 16, v30
    v_lshlrev_b32 v65, 16, v34
    v_lshlrev_b32 v66, 16, v38
    v_lshlrev_b32 v67, 16, v48
    v_and_b32 v68, 0xffff0000, v48
    v_lshlrev_b32 v69, 16, v49
    v_and_b32 v70, 0xffff0000, v49
    v_mul_f32 v71, v60, v70
    v_mul_f32 v72, v61, v70
    v_cvt_pk_bf16_f32 v73, v71, v72
    v_lshlrev_b32 v74, 16, v73
    v_and_b32 v75, 0xffff0000, v73
    v_mul_f32 v71, v61, v69
    v_mul_f32 v72, v62, v69
    v_cvt_pk_bf16_f32 v73, v71, v72
    v_lshlrev_b32 v71, 16, v73
    v_and_b32 v72, 0xffff0000, v73
    v_add_f32 v74, v74, v71
    v_add_f32 v75, v75, v72
    v_cvt_pk_bf16_f32 v73, v74, v75
    v_lshlrev_b32 v74, 16, v73
    v_and_b32 v75, 0xffff0000, v73
    v_mul_f32 v71, v62, v68
    v_mul_f32 v72, v63, v68
    v_cvt_pk_bf16_f32 v73, v71, v72
    v_lshlrev_b32 v71, 16, v73
    v_and_b32 v72, 0xffff0000, v73
    v_add_f32 v74, v74, v71
    v_add_f32 v75, v75, v72
    v_cvt_pk_bf16_f32 v73, v74, v75
    v_lshlrev_b32 v74, 16, v73
    v_and_b32 v75, 0xffff0000, v73
    v_mul_f32 v71, v63, v67
    v_mul_f32 v72, v64, v67
    v_cvt_pk_bf16_f32 v73, v71, v72
    v_lshlrev_b32 v71, 16, v73
    v_and_b32 v72, 0xffff0000, v73
    v_add_f32 v74, v74, v71
    v_add_f32 v75, v75, v72
    v_cvt_pk_bf16_f32 v73, v74, v75
    v_lshlrev_b32 v74, 16, v73
    v_and_b32 v75, 0xffff0000, v73
    v_mul_f32 v74, v74, v65
    v_mul_f32 v75, v75, v66
    v_cvt_pk_bf16_f32 v73, v75, v74
    ds_write_b32 v56, v73 offset:544
    v_and_b32 v60, 0xffff0000, v14
    v_and_b32 v61, 0xffff0000, v18
    v_and_b32 v62, 0xffff0000, v22
    v_and_b32 v63, 0xffff0000, v26
    v_and_b32 v64, 0xffff0000, v30
    v_and_b32 v65, 0xffff0000, v34
    v_and_b32 v66, 0xffff0000, v38
    v_lshlrev_b32 v67, 16, v50
    v_and_b32 v68, 0xffff0000, v50
    v_lshlrev_b32 v69, 16, v51
    v_and_b32 v70, 0xffff0000, v51
    v_mul_f32 v71, v60, v70
    v_mul_f32 v72, v61, v70
    v_cvt_pk_bf16_f32 v73, v71, v72
    v_lshlrev_b32 v74, 16, v73
    v_and_b32 v75, 0xffff0000, v73
    v_mul_f32 v71, v61, v69
    v_mul_f32 v72, v62, v69
    v_cvt_pk_bf16_f32 v73, v71, v72
    v_lshlrev_b32 v71, 16, v73
    v_and_b32 v72, 0xffff0000, v73
    v_add_f32 v74, v74, v71
    v_add_f32 v75, v75, v72
    v_cvt_pk_bf16_f32 v73, v74, v75
    v_lshlrev_b32 v74, 16, v73
    v_and_b32 v75, 0xffff0000, v73
    v_mul_f32 v71, v62, v68
    v_mul_f32 v72, v63, v68
    v_cvt_pk_bf16_f32 v73, v71, v72
    v_lshlrev_b32 v71, 16, v73
    v_and_b32 v72, 0xffff0000, v73
    v_add_f32 v74, v74, v71
    v_add_f32 v75, v75, v72
    v_cvt_pk_bf16_f32 v73, v74, v75
    v_lshlrev_b32 v74, 16, v73
    v_and_b32 v75, 0xffff0000, v73
    v_mul_f32 v71, v63, v67
    v_mul_f32 v72, v64, v67
    v_cvt_pk_bf16_f32 v73, v71, v72
    v_lshlrev_b32 v71, 16, v73
    v_and_b32 v72, 0xffff0000, v73
    v_add_f32 v74, v74, v71
    v_add_f32 v75, v75, v72
    v_cvt_pk_bf16_f32 v73, v74, v75
    v_lshlrev_b32 v74, 16, v73
    v_and_b32 v75, 0xffff0000, v73
    v_mul_f32 v74, v74, v65
    v_mul_f32 v75, v75, v66
    v_cvt_pk_bf16_f32 v73, v75, v74
    ds_write_b32 v56, v73 offset:680
    v_lshlrev_b32 v60, 16, v15
    v_lshlrev_b32 v61, 16, v19
    v_lshlrev_b32 v62, 16, v23
    v_lshlrev_b32 v63, 16, v27
    v_lshlrev_b32 v64, 16, v31
    v_lshlrev_b32 v65, 16, v35
    v_lshlrev_b32 v66, 16, v39
    v_lshlrev_b32 v67, 16, v52
    v_and_b32 v68, 0xffff0000, v52
    v_lshlrev_b32 v69, 16, v53
    v_and_b32 v70, 0xffff0000, v53
    v_mul_f32 v71, v60, v70
    v_mul_f32 v72, v61, v70
    v_cvt_pk_bf16_f32 v73, v71, v72
    v_lshlrev_b32 v74, 16, v73
    v_and_b32 v75, 0xffff0000, v73
    v_mul_f32 v71, v61, v69
    v_mul_f32 v72, v62, v69
    v_cvt_pk_bf16_f32 v73, v71, v72
    v_lshlrev_b32 v71, 16, v73
    v_and_b32 v72, 0xffff0000, v73
    v_add_f32 v74, v74, v71
    v_add_f32 v75, v75, v72
    v_cvt_pk_bf16_f32 v73, v74, v75
    v_lshlrev_b32 v74, 16, v73
    v_and_b32 v75, 0xffff0000, v73
    v_mul_f32 v71, v62, v68
    v_mul_f32 v72, v63, v68
    v_cvt_pk_bf16_f32 v73, v71, v72
    v_lshlrev_b32 v71, 16, v73
    v_and_b32 v72, 0xffff0000, v73
    v_add_f32 v74, v74, v71
    v_add_f32 v75, v75, v72
    v_cvt_pk_bf16_f32 v73, v74, v75
    v_lshlrev_b32 v74, 16, v73
    v_and_b32 v75, 0xffff0000, v73
    v_mul_f32 v71, v63, v67
    v_mul_f32 v72, v64, v67
    v_cvt_pk_bf16_f32 v73, v71, v72
    v_lshlrev_b32 v71, 16, v73
    v_and_b32 v72, 0xffff0000, v73
    v_add_f32 v74, v74, v71
    v_add_f32 v75, v75, v72
    v_cvt_pk_bf16_f32 v73, v74, v75
    v_lshlrev_b32 v74, 16, v73
    v_and_b32 v75, 0xffff0000, v73
    v_mul_f32 v74, v74, v65
    v_mul_f32 v75, v75, v66
    v_cvt_pk_bf16_f32 v73, v75, v74
    ds_write_b32 v56, v73 offset:816
    v_and_b32 v60, 0xffff0000, v15
    v_and_b32 v61, 0xffff0000, v19
    v_and_b32 v62, 0xffff0000, v23
    v_and_b32 v63, 0xffff0000, v27
    v_and_b32 v64, 0xffff0000, v31
    v_and_b32 v65, 0xffff0000, v35
    v_and_b32 v66, 0xffff0000, v39
    v_lshlrev_b32 v67, 16, v54
    v_and_b32 v68, 0xffff0000, v54
    v_lshlrev_b32 v69, 16, v55
    v_and_b32 v70, 0xffff0000, v55
    v_mul_f32 v71, v60, v70
    v_mul_f32 v72, v61, v70
    v_cvt_pk_bf16_f32 v73, v71, v72
    v_lshlrev_b32 v74, 16, v73
    v_and_b32 v75, 0xffff0000, v73
    v_mul_f32 v71, v61, v69
    v_mul_f32 v72, v62, v69
    v_cvt_pk_bf16_f32 v73, v71, v72
    v_lshlrev_b32 v71, 16, v73
    v_and_b32 v72, 0xffff0000, v73
    v_add_f32 v74, v74, v71
    v_add_f32 v75, v75, v72
    v_cvt_pk_bf16_f32 v73, v74, v75
    v_lshlrev_b32 v74, 16, v73
    v_and_b32 v75, 0xffff0000, v73
    v_mul_f32 v71, v62, v68
    v_mul_f32 v72, v63, v68
    v_cvt_pk_bf16_f32 v73, v71, v72
    v_lshlrev_b32 v71, 16, v73
    v_and_b32 v72, 0xffff0000, v73
    v_add_f32 v74, v74, v71
    v_add_f32 v75, v75, v72
    v_cvt_pk_bf16_f32 v73, v74, v75
    v_lshlrev_b32 v74, 16, v73
    v_and_b32 v75, 0xffff0000, v73
    v_mul_f32 v71, v63, v67
    v_mul_f32 v72, v64, v67
    v_cvt_pk_bf16_f32 v73, v71, v72
    v_lshlrev_b32 v71, 16, v73
    v_and_b32 v72, 0xffff0000, v73
    v_add_f32 v74, v74, v71
    v_add_f32 v75, v75, v72
    v_cvt_pk_bf16_f32 v73, v74, v75
    v_lshlrev_b32 v74, 16, v73
    v_and_b32 v75, 0xffff0000, v73
    v_mul_f32 v74, v74, v65
    v_mul_f32 v75, v75, v66
    v_cvt_pk_bf16_f32 v73, v75, v74
    ds_write_b32 v56, v73 offset:952
    s_waitcnt lgkmcnt(0)
    s_barrier
    v_lshrrev_b32 v1, 2, v0
    v_and_b32 v2, 3, v0
    v_mul_u32_u24 v3, 136, v1
    v_lshlrev_b32 v4, 5, v2
    v_add_u32 v3, v3, v4
    ds_read_b64 v[8:9], v3 offset:0
    ds_read_b64 v[10:11], v3 offset:8
    ds_read_b64 v[12:13], v3 offset:16
    ds_read_b64 v[14:15], v3 offset:24
    s_lshl_b32 s36, s33, 18
    s_lshl_b32 s37, s32, 7
    s_sub_u32 s36, s36, s37
    s_add_u32 s36, s36, 3968
    v_lshlrev_b32 v5, 12, v1
    v_add_u32 v5, v5, v4
    v_add_u32 v5, s36, v5
    s_waitcnt lgkmcnt(0)
    buffer_store_dwordx4 v[8:11], v5, s[28:31], 0 offen
    buffer_store_dwordx4 v[12:15], v5, s[28:31], 0 offen offset:16
L_fr_end:
    s_endpgm
.globl gemm1_kernel
.p2align 8
.type gemm1_kernel,@function
gemm1_kernel:
    s_cmp_ge_u32 s2, 256
    s_cbranch_scc1 L_g1_end
    s_load_dwordx4 s[4:7], s[0:1], 56
    s_load_dwordx2 s[8:9], s[0:1], 96
    s_load_dwordx4 s[72:75], s[0:1], 32
    s_load_dwordx2 s[86:87], s[0:1], 72
    v_and_b32 v1, 63, v0
    v_lshrrev_b32 v2, 6, v0
    s_nop 0
    v_readfirstlane_b32 s40, v2
    s_and_b32 s30, s2, 7
    s_lshr_b32 s31, s2, 3
    s_lshl_b32 s30, s30, 2
    s_and_b32 s32, s31, 3
    s_add_u32 s30, s30, s32
    s_lshr_b32 s31, s31, 2
    s_mul_i32 s33, s30, 288
    s_and_b32 s41, s40, 3
    s_lshr_b32 s42, s40, 2
    s_mul_i32 s43, s42, 18432
    s_lshl_b32 s44, s41, 12
    s_add_u32 s34, s43, s44
    s_lshl_b32 s44, s41, 9
    s_add_u32 s44, s44, 16384
    s_add_u32 s35, s43, s44
    s_movk_i32 s45, 3641
    s_lshl_b32 s44, s41, 8
    s_add_u32 s44, s44, 0
    v_add_u32 v17, s44, v1
    v_mul_lo_u32 v18, v17, s45
    v_lshrrev_b32 v18, 16, v18
    v_mul_u32_u24 v19, 18, v18
    v_sub_u32 v19, v17, v19
    v_lshrrev_b32 v17, 4, v18
    v_and_b32 v17, 1, v17
    v_lshlrev_b32 v17, 2, v17
    v_xor_b32 v18, v18, v17
    v_mul_u32_u24 v18, 9216, v18
    v_lshlrev_b32 v19, 4, v19
    v_add_u32 v2, v18, v19
    s_lshl_b32 s44, s41, 8
    s_add_u32 s44, s44, 64
    v_add_u32 v17, s44, v1
    v_mul_lo_u32 v18, v17, s45
    v_lshrrev_b32 v18, 16, v18
    v_mul_u32_u24 v19, 18, v18
    v_sub_u32 v19, v17, v19
    v_lshrrev_b32 v17, 4, v18
    v_and_b32 v17, 1, v17
    v_lshlrev_b32 v17, 2, v17
    v_xor_b32 v18, v18, v17
    v_mul_u32_u24 v18, 9216, v18
    v_lshlrev_b32 v19, 4, v19
    v_add_u32 v3, v18, v19
    s_lshl_b32 s44, s41, 8
    s_add_u32 s44, s44, 128
    v_add_u32 v17, s44, v1
    v_mul_lo_u32 v18, v17, s45
    v_lshrrev_b32 v18, 16, v18
    v_mul_u32_u24 v19, 18, v18
    v_sub_u32 v19, v17, v19
    v_lshrrev_b32 v17, 4, v18
    v_and_b32 v17, 1, v17
    v_lshlrev_b32 v17, 2, v17
    v_xor_b32 v18, v18, v17
    v_mul_u32_u24 v18, 9216, v18
    v_lshlrev_b32 v19, 4, v19
    v_add_u32 v4, v18, v19
    s_lshl_b32 s44, s41, 8
    s_add_u32 s44, s44, 192
    v_add_u32 v17, s44, v1
    v_mul_lo_u32 v18, v17, s45
    v_lshrrev_b32 v18, 16, v18
    v_mul_u32_u24 v19, 18, v18
    v_sub_u32 v19, v17, v19
    v_lshrrev_b32 v17, 4, v18
    v_and_b32 v17, 1, v17
    v_lshlrev_b32 v17, 2, v17
    v_xor_b32 v18, v18, v17
    v_mul_u32_u24 v18, 9216, v18
    v_lshlrev_b32 v19, 4, v19
    v_add_u32 v5, v18, v19
    s_lshl_b32 s44, s41, 5
    s_add_u32 s44, s44, 1024
    v_add_u32 v17, s44, v1
    v_mul_lo_u32 v18, v17, s45
    v_lshrrev_b32 v18, 16, v18
    v_mul_u32_u24 v19, 18, v18
    v_sub_u32 v19, v17, v19
    v_lshrrev_b32 v17, 4, v18
    v_and_b32 v17, 1, v17
    v_lshlrev_b32 v17, 2, v17
    v_xor_b32 v18, v18, v17
    v_mul_u32_u24 v18, 9216, v18
    v_lshlrev_b32 v19, 4, v19
    v_add_u32 v6, v18, v19
    s_lshl_b32 s36, s31, 4
    s_lshl_b32 s37, s40, 1
    s_add_u32 s36, s36, s37
    s_mul_i32 s37, s36, 18432
    v_lshlrev_b32 v17, 4, v1
    v_add_u32 v7, s37, v17
    v_add_u32 v8, 18432, v7
    s_waitcnt lgkmcnt(0)
    s_cmp_ge_u32 s40, 4
    s_cselect_b32 s10, s6, s4
    s_cselect_b32 s11, s7, s5
    s_add_u32 s12, s10, s33
    s_addc_u32 s13, s11, 0
    s_sub_u32 s14, 5308416, s33
    s_mov_b32 s15, 0x00020000
    s_mov_b32 s16, s8
    s_mov_b32 s17, s9
    s_mov_b32 s18, 2359296
    s_mov_b32 s19, 0x00020000
    s_add_u32 s20, s8, 16777216
    s_addc_u32 s21, s9, 0
    s_mov_b32 s22, 18874368
    s_mov_b32 s23, 0x00020000
    s_mov_b32 s46, 0
    s_add_u32 m0, s34, 0
    s_nop 0
    buffer_load_dwordx4 v2, s[12:15], s46 offen lds
    s_add_u32 m0, s34, 1024
    s_nop 0
    buffer_load_dwordx4 v3, s[12:15], s46 offen lds
    s_add_u32 m0, s34, 2048
    s_nop 0
    buffer_load_dwordx4 v4, s[12:15], s46 offen lds
    s_add_u32 m0, s34, 3072
    s_nop 0
    buffer_load_dwordx4 v5, s[12:15], s46 offen lds
    s_add_u32 m0, s35, 0
    s_mov_b32 exec_hi, 0
    buffer_load_dwordx4 v6, s[12:15], s46 offen lds
    s_mov_b32 exec_hi, -1
    s_mov_b32 s47, 0
    buffer_load_dwordx4 v[20:23], v7, s[16:19], s47 offen offset:0
    buffer_load_dwordx4 v[24:27], v7, s[16:19], s47 offen offset:1024
    buffer_load_dwordx4 v[28:31], v8, s[16:19], s47 offen offset:0
    buffer_load_dwordx4 v[32:35], v8, s[16:19], s47 offen offset:1024
    s_mov_b32 s46, 589824
    s_add_u32 m0, s34, 36864
    s_nop 0
    buffer_load_dwordx4 v2, s[12:15], s46 offen lds
    s_add_u32 m0, s34, 37888
    s_nop 0
    buffer_load_dwordx4 v3, s[12:15], s46 offen lds
    s_add_u32 m0, s34, 38912
    s_nop 0
    buffer_load_dwordx4 v4, s[12:15], s46 offen lds
    s_add_u32 m0, s34, 39936
    s_nop 0
    buffer_load_dwordx4 v5, s[12:15], s46 offen lds
    s_add_u32 m0, s35, 36864
    s_mov_b32 exec_hi, 0
    buffer_load_dwordx4 v6, s[12:15], s46 offen lds
    s_mov_b32 exec_hi, -1
    s_mov_b32 s47, 2048
    buffer_load_dwordx4 v[36:39], v7, s[16:19], s47 offen offset:0
    buffer_load_dwordx4 v[40:43], v7, s[16:19], s47 offen offset:1024
    buffer_load_dwordx4 v[44:47], v8, s[16:19], s47 offen offset:0
    buffer_load_dwordx4 v[48:51], v8, s[16:19], s47 offen offset:1024
    v_lshrrev_b32 v17, 4, v1
    v_lshrrev_b32 v18, 2, v1
    v_and_b32 v18, 3, v18
    v_and_b32 v19, 1, v17
    v_lshlrev_b32 v17, 4, v17
    v_add_u32 v17, v17, v18
    v_lshlrev_b32 v19, 2, v19
    v_add_u32 v18, v17, v19
    v_xor_b32 v19, 4, v19
    v_add_u32 v19, v17, v19
    v_mul_u32_u24 v18, 288, v18
    v_mul_u32_u24 v19, 288, v19
    v_and_b32 v17, 3, v1
    v_lshlrev_b32 v17, 3, v17
    v_add_u32 v9, v18, v17
    v_add_u32 v10, v19, v17
    v_add_u32 v11, 36864, v9
    v_add_u32 v12, 36864, v10
    v_add_u32 v13, 73728, v9
    v_add_u32 v14, 73728, v10
    v_add_u32 v15, 110592, v9
    v_add_u32 v16, 110592, v10
    v_mov_b32 v108, 0
    v_mov_b32 v109, 0
    v_mov_b32 v110, 0
    v_mov_b32 v111, 0
    v_mov_b32 v112, 0
    v_mov_b32 v113, 0
    v_mov_b32 v114, 0
    v_mov_b32 v115, 0
    v_mov_b32 v116, 0
    v_mov_b32 v117, 0
    v_mov_b32 v118, 0
    v_mov_b32 v119, 0
    v_mov_b32 v120, 0
    v_mov_b32 v121, 0
    v_mov_b32 v122, 0
    v_mov_b32 v123, 0
    v_mov_b32 v124, 0
    v_mov_b32 v125, 0
    v_mov_b32 v126, 0
    v_mov_b32 v127, 0
    v_mov_b32 v128, 0
    v_mov_b32 v129, 0
    v_mov_b32 v130, 0
    v_mov_b32 v131, 0
    v_mov_b32 v132, 0
    v_mov_b32 v133, 0
    v_mov_b32 v134, 0
    v_mov_b32 v135, 0
    v_mov_b32 v136, 0
    v_mov_b32 v137, 0
    v_mov_b32 v138, 0
    v_mov_b32 v139, 0
    v_mov_b32 v140, 0
    v_mov_b32 v141, 0
    v_mov_b32 v142, 0
    v_mov_b32 v143, 0
    v_mov_b32 v144, 0
    v_mov_b32 v145, 0
    v_mov_b32 v146, 0
    v_mov_b32 v147, 0
    v_mov_b32 v148, 0
    v_mov_b32 v149, 0
    v_mov_b32 v150, 0
    v_mov_b32 v151, 0
    v_mov_b32 v152, 0
    v_mov_b32 v153, 0
    v_mov_b32 v154, 0
    v_mov_b32 v155, 0
    v_mov_b32 v156, 0
    v_mov_b32 v157, 0
    v_mov_b32 v158, 0
    v_mov_b32 v159, 0
    v_mov_b32 v160, 0
    v_mov_b32 v161, 0
    v_mov_b32 v162, 0
    v_mov_b32 v163, 0
    v_mov_b32 v164, 0
    v_mov_b32 v165, 0
    v_mov_b32 v166, 0
    v_mov_b32 v167, 0
    v_mov_b32 v168, 0
    v_mov_b32 v169, 0
    v_mov_b32 v170, 0
    v_mov_b32 v171, 0
    v_mov_b32 v172, 0
    v_mov_b32 v173, 0
    v_mov_b32 v174, 0
    v_mov_b32 v175, 0
    v_mov_b32 v176, 0
    v_mov_b32 v177, 0
    v_mov_b32 v178, 0
    v_mov_b32 v179, 0
    v_mov_b32 v180, 0
    v_mov_b32 v181, 0
    v_mov_b32 v182, 0
    v_mov_b32 v183, 0
    v_mov_b32 v184, 0
    v_mov_b32 v185, 0
    v_mov_b32 v186, 0
    v_mov_b32 v187, 0
    v_mov_b32 v188, 0
    v_mov_b32 v189, 0
    v_mov_b32 v190, 0
    v_mov_b32 v191, 0
    v_mov_b32 v192, 0
    v_mov_b32 v193, 0
    v_mov_b32 v194, 0
    v_mov_b32 v195, 0
    v_mov_b32 v196, 0
    v_mov_b32 v197, 0
    v_mov_b32 v198, 0
    v_mov_b32 v199, 0
    v_mov_b32 v200, 0
    v_mov_b32 v201, 0
    v_mov_b32 v202, 0
    v_mov_b32 v203, 0
    v_mov_b32 v204, 0
    v_mov_b32 v205, 0
    v_mov_b32 v206, 0
    v_mov_b32 v207, 0
    v_mov_b32 v208, 0
    v_mov_b32 v209, 0
    v_mov_b32 v210, 0
    v_mov_b32 v211, 0
    v_mov_b32 v212, 0
    v_mov_b32 v213, 0
    v_mov_b32 v214, 0
    v_mov_b32 v215, 0
    v_mov_b32 v216, 0
    v_mov_b32 v217, 0
    v_mov_b32 v218, 0
    v_mov_b32 v219, 0
    v_mov_b32 v220, 0
    v_mov_b32 v221, 0
    v_mov_b32 v222, 0
    v_mov_b32 v223, 0
    v_mov_b32 v224, 0
    v_mov_b32 v225, 0
    v_mov_b32 v226, 0
    v_mov_b32 v227, 0
    v_mov_b32 v228, 0
    v_mov_b32 v229, 0
    v_mov_b32 v230, 0
    v_mov_b32 v231, 0
    v_mov_b32 v232, 0
    v_mov_b32 v233, 0
    v_mov_b32 v234, 0
    v_mov_b32 v235, 0
    v_mov_b32 v236, 0
    v_mov_b32 v237, 0
    v_mov_b32 v238, 0
    v_mov_b32 v239, 0
    v_mov_b32 v240, 0
    v_mov_b32 v241, 0
    v_mov_b32 v242, 0
    v_mov_b32 v243, 0
    v_mov_b32 v244, 0
    v_mov_b32 v245, 0
    v_mov_b32 v246, 0
    v_mov_b32 v247, 0
    v_mov_b32 v248, 0
    v_mov_b32 v249, 0
    v_mov_b32 v250, 0
    v_mov_b32 v251, 0
    s_waitcnt vmcnt(9)
    s_barrier
    ds_read_b64_tr_b16 v[84:85], v9 offset:0
    ds_read_b64_tr_b16 v[86:87], v10 offset:0
    ds_read_b64_tr_b16 v[88:89], v9 offset:32
    ds_read_b64_tr_b16 v[90:91], v10 offset:32
    ds_read_b64_tr_b16 v[92:93], v9 offset:64
    ds_read_b64_tr_b16 v[94:95], v10 offset:64
    ds_read_b64_tr_b16 v[96:97], v9 offset:96
    ds_read_b64_tr_b16 v[98:99], v10 offset:96
    ds_read_b64_tr_b16 v[100:101], v9 offset:128
    ds_read_b64_tr_b16 v[102:103], v10 offset:128
    ds_read_b64_tr_b16 v[104:105], v9 offset:160
    ds_read_b64_tr_b16 v[106:107], v10 offset:160
    s_waitcnt lgkmcnt(10)
    v_mfma_f32_16x16x32_bf16 v[108:111], v[84:87], v[20:23], v[108:111]
    v_mfma_f32_16x16x32_bf16 v[180:183], v[84:87], v[28:31], v[180:183]
    ds_read_b64_tr_b16 v[84:85], v9 offset:192
    ds_read_b64_tr_b16 v[86:87], v10 offset:192
    s_waitcnt lgkmcnt(10)
    v_mfma_f32_16x16x32_bf16 v[112:115], v[88:91], v[20:23], v[112:115]
    v_mfma_f32_16x16x32_bf16 v[184:187], v[88:91], v[28:31], v[184:187]
    s_mov_b32 s46, 1179648
    s_add_u32 m0, s34, 73728
    s_nop 0
    buffer_load_dwordx4 v2, s[12:15], s46 offen lds
    s_add_u32 m0, s34, 74752
    s_nop 0
    buffer_load_dwordx4 v3, s[12:15], s46 offen lds
    s_add_u32 m0, s34, 75776
    s_nop 0
    buffer_load_dwordx4 v4, s[12:15], s46 offen lds
    s_add_u32 m0, s34, 76800
    s_nop 0
    buffer_load_dwordx4 v5, s[12:15], s46 offen lds
    s_add_u32 m0, s35, 73728
    s_mov_b32 exec_hi, 0
    buffer_load_dwordx4 v6, s[12:15], s46 offen lds
    s_mov_b32 exec_hi, -1
    ds_read_b64_tr_b16 v[88:89], v9 offset:224
    ds_read_b64_tr_b16 v[90:91], v10 offset:224
    s_waitcnt lgkmcnt(10)
    v_mfma_f32_16x16x32_bf16 v[116:119], v[92:95], v[20:23], v[116:119]
    v_mfma_f32_16x16x32_bf16 v[188:191], v[92:95], v[28:31], v[188:191]
    ds_read_b64_tr_b16 v[92:93], v9 offset:256
    ds_read_b64_tr_b16 v[94:95], v10 offset:256
    s_waitcnt lgkmcnt(10)
    v_mfma_f32_16x16x32_bf16 v[120:123], v[96:99], v[20:23], v[120:123]
    v_mfma_f32_16x16x32_bf16 v[192:195], v[96:99], v[28:31], v[192:195]
    ds_read_b64_tr_b16 v[96:97], v9 offset:18432
    ds_read_b64_tr_b16 v[98:99], v10 offset:18432
    s_waitcnt lgkmcnt(10)
    v_mfma_f32_16x16x32_bf16 v[124:127], v[100:103], v[20:23], v[124:127]
    v_mfma_f32_16x16x32_bf16 v[196:199], v[100:103], v[28:31], v[196:199]
    ds_read_b64_tr_b16 v[100:101], v9 offset:18464
    ds_read_b64_tr_b16 v[102:103], v10 offset:18464
    s_waitcnt lgkmcnt(10)
    v_mfma_f32_16x16x32_bf16 v[128:131], v[104:107], v[20:23], v[128:131]
    v_mfma_f32_16x16x32_bf16 v[200:203], v[104:107], v[28:31], v[200:203]
    ds_read_b64_tr_b16 v[104:105], v9 offset:18496
    ds_read_b64_tr_b16 v[106:107], v10 offset:18496
    s_waitcnt lgkmcnt(10)
    v_mfma_f32_16x16x32_bf16 v[132:135], v[84:87], v[20:23], v[132:135]
    v_mfma_f32_16x16x32_bf16 v[204:207], v[84:87], v[28:31], v[204:207]
    ds_read_b64_tr_b16 v[84:85], v9 offset:18528
    ds_read_b64_tr_b16 v[86:87], v10 offset:18528
    s_waitcnt lgkmcnt(10)
    v_mfma_f32_16x16x32_bf16 v[136:139], v[88:91], v[20:23], v[136:139]
    v_mfma_f32_16x16x32_bf16 v[208:211], v[88:91], v[28:31], v[208:211]
    s_mov_b32 s47, 4096
    buffer_load_dwordx4 v[52:55], v7, s[16:19], s47 offen offset:0
    buffer_load_dwordx4 v[56:59], v7, s[16:19], s47 offen offset:1024
    buffer_load_dwordx4 v[60:63], v8, s[16:19], s47 offen offset:0
    buffer_load_dwordx4 v[64:67], v8, s[16:19], s47 offen offset:1024
    ds_read_b64_tr_b16 v[88:89], v9 offset:18560
    ds_read_b64_tr_b16 v[90:91], v10 offset:18560
    s_waitcnt lgkmcnt(10)
    v_mfma_f32_16x16x32_bf16 v[140:143], v[92:95], v[20:23], v[140:143]
    v_mfma_f32_16x16x32_bf16 v[212:215], v[92:95], v[28:31], v[212:215]
    ds_read_b64_tr_b16 v[92:93], v9 offset:18592
    ds_read_b64_tr_b16 v[94:95], v10 offset:18592
    s_waitcnt lgkmcnt(10)
    v_mfma_f32_16x16x32_bf16 v[144:147], v[96:99], v[20:23], v[144:147]
    v_mfma_f32_16x16x32_bf16 v[216:219], v[96:99], v[28:31], v[216:219]
    ds_read_b64_tr_b16 v[96:97], v9 offset:18624
    ds_read_b64_tr_b16 v[98:99], v10 offset:18624
    s_waitcnt lgkmcnt(10)
    v_mfma_f32_16x16x32_bf16 v[148:151], v[100:103], v[20:23], v[148:151]
    v_mfma_f32_16x16x32_bf16 v[220:223], v[100:103], v[28:31], v[220:223]
    ds_read_b64_tr_b16 v[100:101], v9 offset:18656
    ds_read_b64_tr_b16 v[102:103], v10 offset:18656
    s_waitcnt lgkmcnt(10)
    v_mfma_f32_16x16x32_bf16 v[152:155], v[104:107], v[20:23], v[152:155]
    v_mfma_f32_16x16x32_bf16 v[224:227], v[104:107], v[28:31], v[224:227]
    ds_read_b64_tr_b16 v[104:105], v9 offset:18688
    ds_read_b64_tr_b16 v[106:107], v10 offset:18688
    s_waitcnt lgkmcnt(10)
    v_mfma_f32_16x16x32_bf16 v[156:159], v[84:87], v[20:23], v[156:159]
    v_mfma_f32_16x16x32_bf16 v[228:231], v[84:87], v[28:31], v[228:231]
    ds_read_b64_tr_b16 v[84:85], v9 offset:2304
    ds_read_b64_tr_b16 v[86:87], v10 offset:2304
    s_waitcnt lgkmcnt(10)
    v_mfma_f32_16x16x32_bf16 v[160:163], v[88:91], v[20:23], v[160:163]
    v_mfma_f32_16x16x32_bf16 v[232:235], v[88:91], v[28:31], v[232:235]
    ds_read_b64_tr_b16 v[88:89], v9 offset:2336
    ds_read_b64_tr_b16 v[90:91], v10 offset:2336
    s_waitcnt lgkmcnt(10)
    v_mfma_f32_16x16x32_bf16 v[164:167], v[92:95], v[20:23], v[164:167]
    v_mfma_f32_16x16x32_bf16 v[236:239], v[92:95], v[28:31], v[236:239]
    ds_read_b64_tr_b16 v[92:93], v9 offset:2368
    ds_read_b64_tr_b16 v[94:95], v10 offset:2368
    s_waitcnt lgkmcnt(10)
    v_mfma_f32_16x16x32_bf16 v[168:171], v[96:99], v[20:23], v[168:171]
    v_mfma_f32_16x16x32_bf16 v[240:243], v[96:99], v[28:31], v[240:243]
    ds_read_b64_tr_b16 v[96:97], v9 offset:2400
    ds_read_b64_tr_b16 v[98:99], v10 offset:2400
    s_waitcnt lgkmcnt(10)
    v_mfma_f32_16x16x32_bf16 v[172:175], v[100:103], v[20:23], v[172:175]
    v_mfma_f32_16x16x32_bf16 v[244:247], v[100:103], v[28:31], v[244:247]
    ds_read_b64_tr_b16 v[100:101], v9 offset:2432
    ds_read_b64_tr_b16 v[102:103], v10 offset:2432
    s_waitcnt lgkmcnt(10)
    v_mfma_f32_16x16x32_bf16 v[176:179], v[104:107], v[20:23], v[176:179]
    v_mfma_f32_16x16x32_bf16 v[248:251], v[104:107], v[28:31], v[248:251]
    ds_read_b64_tr_b16 v[104:105], v9 offset:2464
    ds_read_b64_tr_b16 v[106:107], v10 offset:2464
    s_waitcnt lgkmcnt(10)
    v_mfma_f32_16x16x32_bf16 v[108:111], v[84:87], v[24:27], v[108:111]
    v_mfma_f32_16x16x32_bf16 v[180:183], v[84:87], v[32:35], v[180:183]
    ds_read_b64_tr_b16 v[84:85], v9 offset:2496
    ds_read_b64_tr_b16 v[86:87], v10 offset:2496
    s_waitcnt lgkmcnt(10)
    v_mfma_f32_16x16x32_bf16 v[112:115], v[88:91], v[24:27], v[112:115]
    v_mfma_f32_16x16x32_bf16 v[184:187], v[88:91], v[32:35], v[184:187]
    ds_read_b64_tr_b16 v[88:89], v9 offset:2528
    ds_read_b64_tr_b16 v[90:91], v10 offset:2528
    s_waitcnt lgkmcnt(10)
    v_mfma_f32_16x16x32_bf16 v[116:119], v[92:95], v[24:27], v[116:119]
    v_mfma_f32_16x16x32_bf16 v[188:191], v[92:95], v[32:35], v[188:191]
    ds_read_b64_tr_b16 v[92:93], v9 offset:2560
    ds_read_b64_tr_b16 v[94:95], v10 offset:2560
    s_waitcnt lgkmcnt(10)
    v_mfma_f32_16x16x32_bf16 v[120:123], v[96:99], v[24:27], v[120:123]
    v_mfma_f32_16x16x32_bf16 v[192:195], v[96:99], v[32:35], v[192:195]
    s_mov_b32 s47, 6144
    buffer_load_dwordx4 v[68:71], v7, s[16:19], s47 offen offset:0
    buffer_load_dwordx4 v[72:75], v7, s[16:19], s47 offen offset:1024
    buffer_load_dwordx4 v[76:79], v8, s[16:19], s47 offen offset:0
    buffer_load_dwordx4 v[80:83], v8, s[16:19], s47 offen offset:1024
    ds_read_b64_tr_b16 v[96:97], v9 offset:20736
    ds_read_b64_tr_b16 v[98:99], v10 offset:20736
    s_waitcnt lgkmcnt(10)
    v_mfma_f32_16x16x32_bf16 v[124:127], v[100:103], v[24:27], v[124:127]
    v_mfma_f32_16x16x32_bf16 v[196:199], v[100:103], v[32:35], v[196:199]
    ds_read_b64_tr_b16 v[100:101], v9 offset:20768
    ds_read_b64_tr_b16 v[102:103], v10 offset:20768
    s_waitcnt lgkmcnt(10)
    v_mfma_f32_16x16x32_bf16 v[128:131], v[104:107], v[24:27], v[128:131]
    v_mfma_f32_16x16x32_bf16 v[200:203], v[104:107], v[32:35], v[200:203]
    ds_read_b64_tr_b16 v[104:105], v9 offset:20800
    ds_read_b64_tr_b16 v[106:107], v10 offset:20800
    s_waitcnt lgkmcnt(10)
    v_mfma_f32_16x16x32_bf16 v[132:135], v[84:87], v[24:27], v[132:135]
    v_mfma_f32_16x16x32_bf16 v[204:207], v[84:87], v[32:35], v[204:207]
    ds_read_b64_tr_b16 v[84:85], v9 offset:20832
    ds_read_b64_tr_b16 v[86:87], v10 offset:20832
    s_waitcnt lgkmcnt(10)
    v_mfma_f32_16x16x32_bf16 v[136:139], v[88:91], v[24:27], v[136:139]
    v_mfma_f32_16x16x32_bf16 v[208:211], v[88:91], v[32:35], v[208:211]
    ds_read_b64_tr_b16 v[88:89], v9 offset:20864
    ds_read_b64_tr_b16 v[90:91], v10 offset:20864
    s_waitcnt lgkmcnt(10)
    v_mfma_f32_16x16x32_bf16 v[140:143], v[92:95], v[24:27], v[140:143]
    v_mfma_f32_16x16x32_bf16 v[212:215], v[92:95], v[32:35], v[212:215]
    ds_read_b64_tr_b16 v[92:93], v9 offset:20896
    ds_read_b64_tr_b16 v[94:95], v10 offset:20896
    s_waitcnt lgkmcnt(10)
    v_mfma_f32_16x16x32_bf16 v[144:147], v[96:99], v[24:27], v[144:147]
    v_mfma_f32_16x16x32_bf16 v[216:219], v[96:99], v[32:35], v[216:219]
    ds_read_b64_tr_b16 v[96:97], v9 offset:20928
    ds_read_b64_tr_b16 v[98:99], v10 offset:20928
    s_waitcnt lgkmcnt(10)
    v_mfma_f32_16x16x32_bf16 v[148:151], v[100:103], v[24:27], v[148:151]
    v_mfma_f32_16x16x32_bf16 v[220:223], v[100:103], v[32:35], v[220:223]
    ds_read_b64_tr_b16 v[100:101], v9 offset:20960
    ds_read_b64_tr_b16 v[102:103], v10 offset:20960
    s_waitcnt lgkmcnt(10)
    v_mfma_f32_16x16x32_bf16 v[152:155], v[104:107], v[24:27], v[152:155]
    v_mfma_f32_16x16x32_bf16 v[224:227], v[104:107], v[32:35], v[224:227]
    ds_read_b64_tr_b16 v[104:105], v9 offset:20992
    ds_read_b64_tr_b16 v[106:107], v10 offset:20992
    s_waitcnt lgkmcnt(10)
    v_mfma_f32_16x16x32_bf16 v[156:159], v[84:87], v[24:27], v[156:159]
    v_mfma_f32_16x16x32_bf16 v[228:231], v[84:87], v[32:35], v[228:231]
    s_waitcnt vmcnt(17)
    s_barrier
    ds_read_b64_tr_b16 v[84:85], v11 offset:0
    ds_read_b64_tr_b16 v[86:87], v12 offset:0
    s_waitcnt lgkmcnt(10)
    v_mfma_f32_16x16x32_bf16 v[160:163], v[88:91], v[24:27], v[160:163]
    v_mfma_f32_16x16x32_bf16 v[232:235], v[88:91], v[32:35], v[232:235]
    s_mov_b32 s46, 1769472
    s_add_u32 m0, s34, 110592
    s_nop 0
    buffer_load_dwordx4 v2, s[12:15], s46 offen lds
    ds_read_b64_tr_b16 v[88:89], v11 offset:32
    ds_read_b64_tr_b16 v[90:91], v12 offset:32
    s_waitcnt lgkmcnt(10)
    v_mfma_f32_16x16x32_bf16 v[164:167], v[92:95], v[24:27], v[164:167]
    v_mfma_f32_16x16x32_bf16 v[236:239], v[92:95], v[32:35], v[236:239]
    ds_read_b64_tr_b16 v[92:93], v11 offset:64
    ds_read_b64_tr_b16 v[94:95], v12 offset:64
    s_waitcnt lgkmcnt(10)
    v_mfma_f32_16x16x32_bf16 v[168:171], v[96:99], v[24:27], v[168:171]
    v_mfma_f32_16x16x32_bf16 v[240:243], v[96:99], v[32:35], v[240:243]
    s_add_u32 m0, s34, 111616
    s_nop 0
    buffer_load_dwordx4 v3, s[12:15], s46 offen lds
    ds_read_b64_tr_b16 v[96:97], v11 offset:96
    ds_read_b64_tr_b16 v[98:99], v12 offset:96
    s_waitcnt lgkmcnt(10)
    v_mfma_f32_16x16x32_bf16 v[172:175], v[100:103], v[24:27], v[172:175]
    v_mfma_f32_16x16x32_bf16 v[244:247], v[100:103], v[32:35], v[244:247]
    ds_read_b64_tr_b16 v[100:101], v11 offset:128
    ds_read_b64_tr_b16 v[102:103], v12 offset:128
    s_waitcnt lgkmcnt(10)
    v_mfma_f32_16x16x32_bf16 v[176:179], v[104:107], v[24:27], v[176:179]
    v_mfma_f32_16x16x32_bf16 v[248:251], v[104:107], v[32:35], v[248:251]
    s_add_u32 m0, s34, 112640
    s_nop 0
    buffer_load_dwordx4 v4, s[12:15], s46 offen lds
    s_waitcnt vmcnt(16)
    ds_read_b64_tr_b16 v[104:105], v11 offset:160
    ds_read_b64_tr_b16 v[106:107], v12 offset:160
    s_waitcnt lgkmcnt(10)
    v_mfma_f32_16x16x32_bf16 v[108:111], v[84:87], v[36:39], v[108:111]
    v_mfma_f32_16x16x32_bf16 v[180:183], v[84:87], v[44:47], v[180:183]
    ds_read_b64_tr_b16 v[84:85], v11 offset:192
    ds_read_b64_tr_b16 v[86:87], v12 offset:192
    s_waitcnt lgkmcnt(10)
    v_mfma_f32_16x16x32_bf16 v[112:115], v[88:91], v[36:39], v[112:115]
    v_mfma_f32_16x16x32_bf16 v[184:187], v[88:91], v[44:47], v[184:187]
    s_add_u32 m0, s34, 113664
    s_nop 0
    buffer_load_dwordx4 v5, s[12:15], s46 offen lds
    ds_read_b64_tr_b16 v[88:89], v11 offset:224
    ds_read_b64_tr_b16 v[90:91], v12 offset:224
    s_waitcnt lgkmcnt(10)
    v_mfma_f32_16x16x32_bf16 v[116:119], v[92:95], v[36:39], v[116:119]
    v_mfma_f32_16x16x32_bf16 v[188:191], v[92:95], v[44:47], v[188:191]
    ds_read_b64_tr_b16 v[92:93], v11 offset:256
    ds_read_b64_tr_b16 v[94:95], v12 offset:256
    s_waitcnt lgkmcnt(10)
    v_mfma_f32_16x16x32_bf16 v[120:123], v[96:99], v[36:39], v[120:123]
    v_mfma_f32_16x16x32_bf16 v[192:195], v[96:99], v[44:47], v[192:195]
    s_add_u32 m0, s35, 110592
    s_mov_b32 exec_hi, 0
    buffer_load_dwordx4 v6, s[12:15], s46 offen lds
    s_mov_b32 exec_hi, -1
    ds_read_b64_tr_b16 v[96:97], v11 offset:18432
    ds_read_b64_tr_b16 v[98:99], v12 offset:18432
    s_waitcnt lgkmcnt(10)
    v_mfma_f32_16x16x32_bf16 v[124:127], v[100:103], v[36:39], v[124:127]
    v_mfma_f32_16x16x32_bf16 v[196:199], v[100:103], v[44:47], v[196:199]
    ds_read_b64_tr_b16 v[100:101], v11 offset:18464
    ds_read_b64_tr_b16 v[102:103], v12 offset:18464
    s_waitcnt lgkmcnt(10)
    v_mfma_f32_16x16x32_bf16 v[128:131], v[104:107], v[36:39], v[128:131]
    v_mfma_f32_16x16x32_bf16 v[200:203], v[104:107], v[44:47], v[200:203]
    s_mov_b32 s47, 8192
    buffer_load_dwordx4 v[20:23], v7, s[16:19], s47 offen offset:0
    ds_read_b64_tr_b16 v[104:105], v11 offset:18496
    ds_read_b64_tr_b16 v[106:107], v12 offset:18496
    s_waitcnt lgkmcnt(10)
    v_mfma_f32_16x16x32_bf16 v[132:135], v[84:87], v[36:39], v[132:135]
    v_mfma_f32_16x16x32_bf16 v[204:207], v[84:87], v[44:47], v[204:207]
    ds_read_b64_tr_b16 v[84:85], v11 offset:18528
    ds_read_b64_tr_b16 v[86:87], v12 offset:18528
    s_waitcnt lgkmcnt(10)
    v_mfma_f32_16x16x32_bf16 v[136:139], v[88:91], v[36:39], v[136:139]
    v_mfma_f32_16x16x32_bf16 v[208:211], v[88:91], v[44:47], v[208:211]
    buffer_load_dwordx4 v[24:27], v7, s[16:19], s47 offen offset:1024
    ds_read_b64_tr_b16 v[88:89], v11 offset:18560
    ds_read_b64_tr_b16 v[90:91], v12 offset:18560
    s_waitcnt lgkmcnt(10)
    v_mfma_f32_16x16x32_bf16 v[140:143], v[92:95], v[36:39], v[140:143]
    v_mfma_f32_16x16x32_bf16 v[212:215], v[92:95], v[44:47], v[212:215]
    ds_read_b64_tr_b16 v[92:93], v11 offset:18592
    ds_read_b64_tr_b16 v[94:95], v12 offset:18592
    s_waitcnt lgkmcnt(10)
    v_mfma_f32_16x16x32_bf16 v[144:147], v[96:99], v[36:39], v[144:147]
    v_mfma_f32_16x16x32_bf16 v[216:219], v[96:99], v[44:47], v[216:219]
    buffer_load_dwordx4 v[28:31], v8, s[16:19], s47 offen offset:0
    ds_read_b64_tr_b16 v[96:97], v11 offset:18624
    ds_read_b64_tr_b16 v[98:99], v12 offset:18624
    s_waitcnt lgkmcnt(10)
    v_mfma_f32_16x16x32_bf16 v[148:151], v[100:103], v[36:39], v[148:151]
    v_mfma_f32_16x16x32_bf16 v[220:223], v[100:103], v[44:47], v[220:223]
    ds_read_b64_tr_b16 v[100:101], v11 offset:18656
    ds_read_b64_tr_b16 v[102:103], v12 offset:18656
    s_waitcnt lgkmcnt(10)
    v_mfma_f32_16x16x32_bf16 v[152:155], v[104:107], v[36:39], v[152:155]
    v_mfma_f32_16x16x32_bf16 v[224:227], v[104:107], v[44:47], v[224:227]
    buffer_load_dwordx4 v[32:35], v8, s[16:19], s47 offen offset:1024
    ds_read_b64_tr_b16 v[104:105], v11 offset:18688
    ds_read_b64_tr_b16 v[106:107], v12 offset:18688
    s_waitcnt lgkmcnt(10)
    v_mfma_f32_16x16x32_bf16 v[156:159], v[84:87], v[36:39], v[156:159]
    v_mfma_f32_16x16x32_bf16 v[228:231], v[84:87], v[44:47], v[228:231]
    ds_read_b64_tr_b16 v[84:85], v11 offset:2304
    ds_read_b64_tr_b16 v[86:87], v12 offset:2304
    s_waitcnt lgkmcnt(10)
    v_mfma_f32_16x16x32_bf16 v[160:163], v[88:91], v[36:39], v[160:163]
    v_mfma_f32_16x16x32_bf16 v[232:235], v[88:91], v[44:47], v[232:235]
    ds_read_b64_tr_b16 v[88:89], v11 offset:2336
    ds_read_b64_tr_b16 v[90:91], v12 offset:2336
    s_waitcnt lgkmcnt(10)
    v_mfma_f32_16x16x32_bf16 v[164:167], v[92:95], v[36:39], v[164:167]
    v_mfma_f32_16x16x32_bf16 v[236:239], v[92:95], v[44:47], v[236:239]
    ds_read_b64_tr_b16 v[92:93], v11 offset:2368
    ds_read_b64_tr_b16 v[94:95], v12 offset:2368
    s_waitcnt lgkmcnt(10)
    v_mfma_f32_16x16x32_bf16 v[168:171], v[96:99], v[36:39], v[168:171]
    v_mfma_f32_16x16x32_bf16 v[240:243], v[96:99], v[44:47], v[240:243]
    ds_read_b64_tr_b16 v[96:97], v11 offset:2400
    ds_read_b64_tr_b16 v[98:99], v12 offset:2400
    s_waitcnt lgkmcnt(10)
    v_mfma_f32_16x16x32_bf16 v[172:175], v[100:103], v[36:39], v[172:175]
    v_mfma_f32_16x16x32_bf16 v[244:247], v[100:103], v[44:47], v[244:247]
    ds_read_b64_tr_b16 v[100:101], v11 offset:2432
    ds_read_b64_tr_b16 v[102:103], v12 offset:2432
    s_waitcnt lgkmcnt(10)
    v_mfma_f32_16x16x32_bf16 v[176:179], v[104:107], v[36:39], v[176:179]
    v_mfma_f32_16x16x32_bf16 v[248:251], v[104:107], v[44:47], v[248:251]
    ds_read_b64_tr_b16 v[104:105], v11 offset:2464
    ds_read_b64_tr_b16 v[106:107], v12 offset:2464
    s_waitcnt lgkmcnt(10)
    v_mfma_f32_16x16x32_bf16 v[108:111], v[84:87], v[40:43], v[108:111]
    v_mfma_f32_16x16x32_bf16 v[180:183], v[84:87], v[48:51], v[180:183]
    ds_read_b64_tr_b16 v[84:85], v11 offset:2496
    ds_read_b64_tr_b16 v[86:87], v12 offset:2496
    s_waitcnt lgkmcnt(10)
    v_mfma_f32_16x16x32_bf16 v[112:115], v[88:91], v[40:43], v[112:115]
    v_mfma_f32_16x16x32_bf16 v[184:187], v[88:91], v[48:51], v[184:187]
    ds_read_b64_tr_b16 v[88:89], v11 offset:2528
    ds_read_b64_tr_b16 v[90:91], v12 offset:2528
    s_waitcnt lgkmcnt(10)
    v_mfma_f32_16x16x32_bf16 v[116:119], v[92:95], v[40:43], v[116:119]
    v_mfma_f32_16x16x32_bf16 v[188:191], v[92:95], v[48:51], v[188:191]
    ds_read_b64_tr_b16 v[92:93], v11 offset:2560
    ds_read_b64_tr_b16 v[94:95], v12 offset:2560
    s_waitcnt lgkmcnt(10)
    v_mfma_f32_16x16x32_bf16 v[120:123], v[96:99], v[40:43], v[120:123]
    v_mfma_f32_16x16x32_bf16 v[192:195], v[96:99], v[48:51], v[192:195]
    ds_read_b64_tr_b16 v[96:97], v11 offset:20736
    ds_read_b64_tr_b16 v[98:99], v12 offset:20736
    s_waitcnt lgkmcnt(10)
    v_mfma_f32_16x16x32_bf16 v[124:127], v[100:103], v[40:43], v[124:127]
    v_mfma_f32_16x16x32_bf16 v[196:199], v[100:103], v[48:51], v[196:199]
    ds_read_b64_tr_b16 v[100:101], v11 offset:20768
    ds_read_b64_tr_b16 v[102:103], v12 offset:20768
    s_waitcnt lgkmcnt(10)
    v_mfma_f32_16x16x32_bf16 v[128:131], v[104:107], v[40:43], v[128:131]
    v_mfma_f32_16x16x32_bf16 v[200:203], v[104:107], v[48:51], v[200:203]
    ds_read_b64_tr_b16 v[104:105], v11 offset:20800
    ds_read_b64_tr_b16 v[106:107], v12 offset:20800
    s_waitcnt lgkmcnt(10)
    v_mfma_f32_16x16x32_bf16 v[132:135], v[84:87], v[40:43], v[132:135]
    v_mfma_f32_16x16x32_bf16 v[204:207], v[84:87], v[48:51], v[204:207]
    ds_read_b64_tr_b16 v[84:85], v11 offset:20832
    ds_read_b64_tr_b16 v[86:87], v12 offset:20832
    s_waitcnt lgkmcnt(10)
    v_mfma_f32_16x16x32_bf16 v[136:139], v[88:91], v[40:43], v[136:139]
    v_mfma_f32_16x16x32_bf16 v[208:211], v[88:91], v[48:51], v[208:211]
    ds_read_b64_tr_b16 v[88:89], v11 offset:20864
    ds_read_b64_tr_b16 v[90:91], v12 offset:20864
    s_waitcnt lgkmcnt(10)
    v_mfma_f32_16x16x32_bf16 v[140:143], v[92:95], v[40:43], v[140:143]
    v_mfma_f32_16x16x32_bf16 v[212:215], v[92:95], v[48:51], v[212:215]
    ds_read_b64_tr_b16 v[92:93], v11 offset:20896
    ds_read_b64_tr_b16 v[94:95], v12 offset:20896
    s_waitcnt lgkmcnt(10)
    v_mfma_f32_16x16x32_bf16 v[144:147], v[96:99], v[40:43], v[144:147]
    v_mfma_f32_16x16x32_bf16 v[216:219], v[96:99], v[48:51], v[216:219]
    ds_read_b64_tr_b16 v[96:97], v11 offset:20928
    ds_read_b64_tr_b16 v[98:99], v12 offset:20928
    s_waitcnt lgkmcnt(10)
    v_mfma_f32_16x16x32_bf16 v[148:151], v[100:103], v[40:43], v[148:151]
    v_mfma_f32_16x16x32_bf16 v[220:223], v[100:103], v[48:51], v[220:223]
    ds_read_b64_tr_b16 v[100:101], v11 offset:20960
    ds_read_b64_tr_b16 v[102:103], v12 offset:20960
    s_waitcnt lgkmcnt(10)
    v_mfma_f32_16x16x32_bf16 v[152:155], v[104:107], v[40:43], v[152:155]
    v_mfma_f32_16x16x32_bf16 v[224:227], v[104:107], v[48:51], v[224:227]
    ds_read_b64_tr_b16 v[104:105], v11 offset:20992
    ds_read_b64_tr_b16 v[106:107], v12 offset:20992
    s_waitcnt lgkmcnt(10)
    v_mfma_f32_16x16x32_bf16 v[156:159], v[84:87], v[40:43], v[156:159]
    v_mfma_f32_16x16x32_bf16 v[228:231], v[84:87], v[48:51], v[228:231]
    s_waitcnt vmcnt(17)
    s_barrier
    ds_read_b64_tr_b16 v[84:85], v13 offset:0
    ds_read_b64_tr_b16 v[86:87], v14 offset:0
    s_waitcnt lgkmcnt(10)
    v_mfma_f32_16x16x32_bf16 v[160:163], v[88:91], v[40:43], v[160:163]
    v_mfma_f32_16x16x32_bf16 v[232:235], v[88:91], v[48:51], v[232:235]
    s_mov_b32 s46, 2359296
    s_add_u32 m0, s34, 0
    s_nop 0
    buffer_load_dwordx4 v2, s[12:15], s46 offen lds
    ds_read_b64_tr_b16 v[88:89], v13 offset:32
    ds_read_b64_tr_b16 v[90:91], v14 offset:32
    s_waitcnt lgkmcnt(10)
    v_mfma_f32_16x16x32_bf16 v[164:167], v[92:95], v[40:43], v[164:167]
    v_mfma_f32_16x16x32_bf16 v[236:239], v[92:95], v[48:51], v[236:239]
    ds_read_b64_tr_b16 v[92:93], v13 offset:64
    ds_read_b64_tr_b16 v[94:95], v14 offset:64
    s_waitcnt lgkmcnt(10)
    v_mfma_f32_16x16x32_bf16 v[168:171], v[96:99], v[40:43], v[168:171]
    v_mfma_f32_16x16x32_bf16 v[240:243], v[96:99], v[48:51], v[240:243]
    s_add_u32 m0, s34, 1024
    s_nop 0
    buffer_load_dwordx4 v3, s[12:15], s46 offen lds
    ds_read_b64_tr_b16 v[96:97], v13 offset:96
    ds_read_b64_tr_b16 v[98:99], v14 offset:96
    s_waitcnt lgkmcnt(10)
    v_mfma_f32_16x16x32_bf16 v[172:175], v[100:103], v[40:43], v[172:175]
    v_mfma_f32_16x16x32_bf16 v[244:247], v[100:103], v[48:51], v[244:247]
    ds_read_b64_tr_b16 v[100:101], v13 offset:128
    ds_read_b64_tr_b16 v[102:103], v14 offset:128
    s_waitcnt lgkmcnt(10)
    v_mfma_f32_16x16x32_bf16 v[176:179], v[104:107], v[40:43], v[176:179]
    v_mfma_f32_16x16x32_bf16 v[248:251], v[104:107], v[48:51], v[248:251]
    s_add_u32 m0, s34, 2048
    s_nop 0
    buffer_load_dwordx4 v4, s[12:15], s46 offen lds
    s_waitcnt vmcnt(16)
    ds_read_b64_tr_b16 v[104:105], v13 offset:160
    ds_read_b64_tr_b16 v[106:107], v14 offset:160
    s_waitcnt lgkmcnt(10)
    v_mfma_f32_16x16x32_bf16 v[108:111], v[84:87], v[52:55], v[108:111]
    v_mfma_f32_16x16x32_bf16 v[180:183], v[84:87], v[60:63], v[180:183]
    ds_read_b64_tr_b16 v[84:85], v13 offset:192
    ds_read_b64_tr_b16 v[86:87], v14 offset:192
    s_waitcnt lgkmcnt(10)
    v_mfma_f32_16x16x32_bf16 v[112:115], v[88:91], v[52:55], v[112:115]
    v_mfma_f32_16x16x32_bf16 v[184:187], v[88:91], v[60:63], v[184:187]
    s_add_u32 m0, s34, 3072
    s_nop 0
    buffer_load_dwordx4 v5, s[12:15], s46 offen lds
    ds_read_b64_tr_b16 v[88:89], v13 offset:224
    ds_read_b64_tr_b16 v[90:91], v14 offset:224
    s_waitcnt lgkmcnt(10)
    v_mfma_f32_16x16x32_bf16 v[116:119], v[92:95], v[52:55], v[116:119]
    v_mfma_f32_16x16x32_bf16 v[188:191], v[92:95], v[60:63], v[188:191]
    ds_read_b64_tr_b16 v[92:93], v13 offset:256
    ds_read_b64_tr_b16 v[94:95], v14 offset:256
    s_waitcnt lgkmcnt(10)
    v_mfma_f32_16x16x32_bf16 v[120:123], v[96:99], v[52:55], v[120:123]
    v_mfma_f32_16x16x32_bf16 v[192:195], v[96:99], v[60:63], v[192:195]
    s_add_u32 m0, s35, 0
    s_mov_b32 exec_hi, 0
    buffer_load_dwordx4 v6, s[12:15], s46 offen lds
    s_mov_b32 exec_hi, -1
    ds_read_b64_tr_b16 v[96:97], v13 offset:18432
    ds_read_b64_tr_b16 v[98:99], v14 offset:18432
    s_waitcnt lgkmcnt(10)
    v_mfma_f32_16x16x32_bf16 v[124:127], v[100:103], v[52:55], v[124:127]
    v_mfma_f32_16x16x32_bf16 v[196:199], v[100:103], v[60:63], v[196:199]
    ds_read_b64_tr_b16 v[100:101], v13 offset:18464
    ds_read_b64_tr_b16 v[102:103], v14 offset:18464
    s_waitcnt lgkmcnt(10)
    v_mfma_f32_16x16x32_bf16 v[128:131], v[104:107], v[52:55], v[128:131]
    v_mfma_f32_16x16x32_bf16 v[200:203], v[104:107], v[60:63], v[200:203]
    s_mov_b32 s47, 10240
    buffer_load_dwordx4 v[36:39], v7, s[16:19], s47 offen offset:0
    ds_read_b64_tr_b16 v[104:105], v13 offset:18496
    ds_read_b64_tr_b16 v[106:107], v14 offset:18496
    s_waitcnt lgkmcnt(10)
    v_mfma_f32_16x16x32_bf16 v[132:135], v[84:87], v[52:55], v[132:135]
    v_mfma_f32_16x16x32_bf16 v[204:207], v[84:87], v[60:63], v[204:207]
    ds_read_b64_tr_b16 v[84:85], v13 offset:18528
    ds_read_b64_tr_b16 v[86:87], v14 offset:18528
    s_waitcnt lgkmcnt(10)
    v_mfma_f32_16x16x32_bf16 v[136:139], v[88:91], v[52:55], v[136:139]
    v_mfma_f32_16x16x32_bf16 v[208:211], v[88:91], v[60:63], v[208:211]
    buffer_load_dwordx4 v[40:43], v7, s[16:19], s47 offen offset:1024
    ds_read_b64_tr_b16 v[88:89], v13 offset:18560
    ds_read_b64_tr_b16 v[90:91], v14 offset:18560
    s_waitcnt lgkmcnt(10)
    v_mfma_f32_16x16x32_bf16 v[140:143], v[92:95], v[52:55], v[140:143]
    v_mfma_f32_16x16x32_bf16 v[212:215], v[92:95], v[60:63], v[212:215]
    ds_read_b64_tr_b16 v[92:93], v13 offset:18592
    ds_read_b64_tr_b16 v[94:95], v14 offset:18592
    s_waitcnt lgkmcnt(10)
    v_mfma_f32_16x16x32_bf16 v[144:147], v[96:99], v[52:55], v[144:147]
    v_mfma_f32_16x16x32_bf16 v[216:219], v[96:99], v[60:63], v[216:219]
    buffer_load_dwordx4 v[44:47], v8, s[16:19], s47 offen offset:0
    ds_read_b64_tr_b16 v[96:97], v13 offset:18624
    ds_read_b64_tr_b16 v[98:99], v14 offset:18624
    s_waitcnt lgkmcnt(10)
    v_mfma_f32_16x16x32_bf16 v[148:151], v[100:103], v[52:55], v[148:151]
    v_mfma_f32_16x16x32_bf16 v[220:223], v[100:103], v[60:63], v[220:223]
    ds_read_b64_tr_b16 v[100:101], v13 offset:18656
    ds_read_b64_tr_b16 v[102:103], v14 offset:18656
    s_waitcnt lgkmcnt(10)
    v_mfma_f32_16x16x32_bf16 v[152:155], v[104:107], v[52:55], v[152:155]
    v_mfma_f32_16x16x32_bf16 v[224:227], v[104:107], v[60:63], v[224:227]
    buffer_load_dwordx4 v[48:51], v8, s[16:19], s47 offen offset:1024
    ds_read_b64_tr_b16 v[104:105], v13 offset:18688
    ds_read_b64_tr_b16 v[106:107], v14 offset:18688
    s_waitcnt lgkmcnt(10)
    v_mfma_f32_16x16x32_bf16 v[156:159], v[84:87], v[52:55], v[156:159]
    v_mfma_f32_16x16x32_bf16 v[228:231], v[84:87], v[60:63], v[228:231]
    ds_read_b64_tr_b16 v[84:85], v13 offset:2304
    ds_read_b64_tr_b16 v[86:87], v14 offset:2304
    s_waitcnt lgkmcnt(10)
    v_mfma_f32_16x16x32_bf16 v[160:163], v[88:91], v[52:55], v[160:163]
    v_mfma_f32_16x16x32_bf16 v[232:235], v[88:91], v[60:63], v[232:235]
    ds_read_b64_tr_b16 v[88:89], v13 offset:2336
    ds_read_b64_tr_b16 v[90:91], v14 offset:2336
    s_waitcnt lgkmcnt(10)
    v_mfma_f32_16x16x32_bf16 v[164:167], v[92:95], v[52:55], v[164:167]
    v_mfma_f32_16x16x32_bf16 v[236:239], v[92:95], v[60:63], v[236:239]
    ds_read_b64_tr_b16 v[92:93], v13 offset:2368
    ds_read_b64_tr_b16 v[94:95], v14 offset:2368
    s_waitcnt lgkmcnt(10)
    v_mfma_f32_16x16x32_bf16 v[168:171], v[96:99], v[52:55], v[168:171]
    v_mfma_f32_16x16x32_bf16 v[240:243], v[96:99], v[60:63], v[240:243]
    ds_read_b64_tr_b16 v[96:97], v13 offset:2400
    ds_read_b64_tr_b16 v[98:99], v14 offset:2400
    s_waitcnt lgkmcnt(10)
    v_mfma_f32_16x16x32_bf16 v[172:175], v[100:103], v[52:55], v[172:175]
    v_mfma_f32_16x16x32_bf16 v[244:247], v[100:103], v[60:63], v[244:247]
    ds_read_b64_tr_b16 v[100:101], v13 offset:2432
    ds_read_b64_tr_b16 v[102:103], v14 offset:2432
    s_waitcnt lgkmcnt(10)
    v_mfma_f32_16x16x32_bf16 v[176:179], v[104:107], v[52:55], v[176:179]
    v_mfma_f32_16x16x32_bf16 v[248:251], v[104:107], v[60:63], v[248:251]
    ds_read_b64_tr_b16 v[104:105], v13 offset:2464
    ds_read_b64_tr_b16 v[106:107], v14 offset:2464
    s_waitcnt lgkmcnt(10)
    v_mfma_f32_16x16x32_bf16 v[108:111], v[84:87], v[56:59], v[108:111]
    v_mfma_f32_16x16x32_bf16 v[180:183], v[84:87], v[64:67], v[180:183]
    ds_read_b64_tr_b16 v[84:85], v13 offset:2496
    ds_read_b64_tr_b16 v[86:87], v14 offset:2496
    s_waitcnt lgkmcnt(10)
    v_mfma_f32_16x16x32_bf16 v[112:115], v[88:91], v[56:59], v[112:115]
    v_mfma_f32_16x16x32_bf16 v[184:187], v[88:91], v[64:67], v[184:187]
    ds_read_b64_tr_b16 v[88:89], v13 offset:2528
    ds_read_b64_tr_b16 v[90:91], v14 offset:2528
    s_waitcnt lgkmcnt(10)
    v_mfma_f32_16x16x32_bf16 v[116:119], v[92:95], v[56:59], v[116:119]
    v_mfma_f32_16x16x32_bf16 v[188:191], v[92:95], v[64:67], v[188:191]
    ds_read_b64_tr_b16 v[92:93], v13 offset:2560
    ds_read_b64_tr_b16 v[94:95], v14 offset:2560
    s_waitcnt lgkmcnt(10)
    v_mfma_f32_16x16x32_bf16 v[120:123], v[96:99], v[56:59], v[120:123]
    v_mfma_f32_16x16x32_bf16 v[192:195], v[96:99], v[64:67], v[192:195]
    ds_read_b64_tr_b16 v[96:97], v13 offset:20736
    ds_read_b64_tr_b16 v[98:99], v14 offset:20736
    s_waitcnt lgkmcnt(10)
    v_mfma_f32_16x16x32_bf16 v[124:127], v[100:103], v[56:59], v[124:127]
    v_mfma_f32_16x16x32_bf16 v[196:199], v[100:103], v[64:67], v[196:199]
    ds_read_b64_tr_b16 v[100:101], v13 offset:20768
    ds_read_b64_tr_b16 v[102:103], v14 offset:20768
    s_waitcnt lgkmcnt(10)
    v_mfma_f32_16x16x32_bf16 v[128:131], v[104:107], v[56:59], v[128:131]
    v_mfma_f32_16x16x32_bf16 v[200:203], v[104:107], v[64:67], v[200:203]
    ds_read_b64_tr_b16 v[104:105], v13 offset:20800
    ds_read_b64_tr_b16 v[106:107], v14 offset:20800
    s_waitcnt lgkmcnt(10)
    v_mfma_f32_16x16x32_bf16 v[132:135], v[84:87], v[56:59], v[132:135]
    v_mfma_f32_16x16x32_bf16 v[204:207], v[84:87], v[64:67], v[204:207]
    ds_read_b64_tr_b16 v[84:85], v13 offset:20832
    ds_read_b64_tr_b16 v[86:87], v14 offset:20832
    s_waitcnt lgkmcnt(10)
    v_mfma_f32_16x16x32_bf16 v[136:139], v[88:91], v[56:59], v[136:139]
    v_mfma_f32_16x16x32_bf16 v[208:211], v[88:91], v[64:67], v[208:211]
    ds_read_b64_tr_b16 v[88:89], v13 offset:20864
    ds_read_b64_tr_b16 v[90:91], v14 offset:20864
    s_waitcnt lgkmcnt(10)
    v_mfma_f32_16x16x32_bf16 v[140:143], v[92:95], v[56:59], v[140:143]
    v_mfma_f32_16x16x32_bf16 v[212:215], v[92:95], v[64:67], v[212:215]
    ds_read_b64_tr_b16 v[92:93], v13 offset:20896
    ds_read_b64_tr_b16 v[94:95], v14 offset:20896
    s_waitcnt lgkmcnt(10)
    v_mfma_f32_16x16x32_bf16 v[144:147], v[96:99], v[56:59], v[144:147]
    v_mfma_f32_16x16x32_bf16 v[216:219], v[96:99], v[64:67], v[216:219]
    ds_read_b64_tr_b16 v[96:97], v13 offset:20928
    ds_read_b64_tr_b16 v[98:99], v14 offset:20928
    s_waitcnt lgkmcnt(10)
    v_mfma_f32_16x16x32_bf16 v[148:151], v[100:103], v[56:59], v[148:151]
    v_mfma_f32_16x16x32_bf16 v[220:223], v[100:103], v[64:67], v[220:223]
    ds_read_b64_tr_b16 v[100:101], v13 offset:20960
    ds_read_b64_tr_b16 v[102:103], v14 offset:20960
    s_waitcnt lgkmcnt(10)
    v_mfma_f32_16x16x32_bf16 v[152:155], v[104:107], v[56:59], v[152:155]
    v_mfma_f32_16x16x32_bf16 v[224:227], v[104:107], v[64:67], v[224:227]
    ds_read_b64_tr_b16 v[104:105], v13 offset:20992
    ds_read_b64_tr_b16 v[106:107], v14 offset:20992
    s_waitcnt lgkmcnt(10)
    v_mfma_f32_16x16x32_bf16 v[156:159], v[84:87], v[56:59], v[156:159]
    v_mfma_f32_16x16x32_bf16 v[228:231], v[84:87], v[64:67], v[228:231]
    s_waitcnt vmcnt(13)
    s_barrier
    ds_read_b64_tr_b16 v[84:85], v15 offset:0
    ds_read_b64_tr_b16 v[86:87], v16 offset:0
    s_waitcnt lgkmcnt(10)
    v_mfma_f32_16x16x32_bf16 v[160:163], v[88:91], v[56:59], v[160:163]
    v_mfma_f32_16x16x32_bf16 v[232:235], v[88:91], v[64:67], v[232:235]
    s_mov_b32 s46, 2949120
    s_add_u32 m0, s34, 36864
    s_nop 0
    buffer_load_dwordx4 v2, s[12:15], s46 offen lds
    ds_read_b64_tr_b16 v[88:89], v15 offset:32
    ds_read_b64_tr_b16 v[90:91], v16 offset:32
    s_waitcnt lgkmcnt(10)
    v_mfma_f32_16x16x32_bf16 v[164:167], v[92:95], v[56:59], v[164:167]
    v_mfma_f32_16x16x32_bf16 v[236:239], v[92:95], v[64:67], v[236:239]
    ds_read_b64_tr_b16 v[92:93], v15 offset:64
    ds_read_b64_tr_b16 v[94:95], v16 offset:64
    s_waitcnt lgkmcnt(10)
    v_mfma_f32_16x16x32_bf16 v[168:171], v[96:99], v[56:59], v[168:171]
    v_mfma_f32_16x16x32_bf16 v[240:243], v[96:99], v[64:67], v[240:243]
    s_add_u32 m0, s34, 37888
    s_nop 0
    buffer_load_dwordx4 v3, s[12:15], s46 offen lds
    ds_read_b64_tr_b16 v[96:97], v15 offset:96
    ds_read_b64_tr_b16 v[98:99], v16 offset:96
    s_waitcnt lgkmcnt(10)
    v_mfma_f32_16x16x32_bf16 v[172:175], v[100:103], v[56:59], v[172:175]
    v_mfma_f32_16x16x32_bf16 v[244:247], v[100:103], v[64:67], v[244:247]
    ds_read_b64_tr_b16 v[100:101], v15 offset:128
    ds_read_b64_tr_b16 v[102:103], v16 offset:128
    s_waitcnt lgkmcnt(10)
    v_mfma_f32_16x16x32_bf16 v[176:179], v[104:107], v[56:59], v[176:179]
    v_mfma_f32_16x16x32_bf16 v[248:251], v[104:107], v[64:67], v[248:251]
    s_add_u32 m0, s34, 38912
    s_nop 0
    buffer_load_dwordx4 v4, s[12:15], s46 offen lds
    ds_read_b64_tr_b16 v[104:105], v15 offset:160
    ds_read_b64_tr_b16 v[106:107], v16 offset:160
    s_waitcnt lgkmcnt(10)
    v_mfma_f32_16x16x32_bf16 v[108:111], v[84:87], v[68:71], v[108:111]
    v_mfma_f32_16x16x32_bf16 v[180:183], v[84:87], v[76:79], v[180:183]
    ds_read_b64_tr_b16 v[84:85], v15 offset:192
    ds_read_b64_tr_b16 v[86:87], v16 offset:192
    s_waitcnt lgkmcnt(10)
    v_mfma_f32_16x16x32_bf16 v[112:115], v[88:91], v[68:71], v[112:115]
    v_mfma_f32_16x16x32_bf16 v[184:187], v[88:91], v[76:79], v[184:187]
    s_add_u32 m0, s34, 39936
    s_nop 0
    buffer_load_dwordx4 v5, s[12:15], s46 offen lds
    ds_read_b64_tr_b16 v[88:89], v15 offset:224
    ds_read_b64_tr_b16 v[90:91], v16 offset:224
    s_waitcnt lgkmcnt(10)
    v_mfma_f32_16x16x32_bf16 v[116:119], v[92:95], v[68:71], v[116:119]
    v_mfma_f32_16x16x32_bf16 v[188:191], v[92:95], v[76:79], v[188:191]
    ds_read_b64_tr_b16 v[92:93], v15 offset:256
    ds_read_b64_tr_b16 v[94:95], v16 offset:256
    s_waitcnt lgkmcnt(10)
    v_mfma_f32_16x16x32_bf16 v[120:123], v[96:99], v[68:71], v[120:123]
    v_mfma_f32_16x16x32_bf16 v[192:195], v[96:99], v[76:79], v[192:195]
    s_add_u32 m0, s35, 36864
    s_mov_b32 exec_hi, 0
    buffer_load_dwordx4 v6, s[12:15], s46 offen lds
    s_mov_b32 exec_hi, -1
    ds_read_b64_tr_b16 v[96:97], v15 offset:18432
    ds_read_b64_tr_b16 v[98:99], v16 offset:18432
    s_waitcnt lgkmcnt(10)
    v_mfma_f32_16x16x32_bf16 v[124:127], v[100:103], v[68:71], v[124:127]
    v_mfma_f32_16x16x32_bf16 v[196:199], v[100:103], v[76:79], v[196:199]
    ds_read_b64_tr_b16 v[100:101], v15 offset:18464
    ds_read_b64_tr_b16 v[102:103], v16 offset:18464
    s_waitcnt lgkmcnt(10)
    v_mfma_f32_16x16x32_bf16 v[128:131], v[104:107], v[68:71], v[128:131]
    v_mfma_f32_16x16x32_bf16 v[200:203], v[104:107], v[76:79], v[200:203]
    s_mov_b32 s47, 12288
    buffer_load_dwordx4 v[52:55], v7, s[16:19], s47 offen offset:0
    ds_read_b64_tr_b16 v[104:105], v15 offset:18496
    ds_read_b64_tr_b16 v[106:107], v16 offset:18496
    s_waitcnt lgkmcnt(10)
    v_mfma_f32_16x16x32_bf16 v[132:135], v[84:87], v[68:71], v[132:135]
    v_mfma_f32_16x16x32_bf16 v[204:207], v[84:87], v[76:79], v[204:207]
    ds_read_b64_tr_b16 v[84:85], v15 offset:18528
    ds_read_b64_tr_b16 v[86:87], v16 offset:18528
    s_waitcnt lgkmcnt(10)
    v_mfma_f32_16x16x32_bf16 v[136:139], v[88:91], v[68:71], v[136:139]
    v_mfma_f32_16x16x32_bf16 v[208:211], v[88:91], v[76:79], v[208:211]
    buffer_load_dwordx4 v[56:59], v7, s[16:19], s47 offen offset:1024
    ds_read_b64_tr_b16 v[88:89], v15 offset:18560
    ds_read_b64_tr_b16 v[90:91], v16 offset:18560
    s_waitcnt lgkmcnt(10)
    v_mfma_f32_16x16x32_bf16 v[140:143], v[92:95], v[68:71], v[140:143]
    v_mfma_f32_16x16x32_bf16 v[212:215], v[92:95], v[76:79], v[212:215]
    ds_read_b64_tr_b16 v[92:93], v15 offset:18592
    ds_read_b64_tr_b16 v[94:95], v16 offset:18592
    s_waitcnt lgkmcnt(10)
    v_mfma_f32_16x16x32_bf16 v[144:147], v[96:99], v[68:71], v[144:147]
    v_mfma_f32_16x16x32_bf16 v[216:219], v[96:99], v[76:79], v[216:219]
    buffer_load_dwordx4 v[60:63], v8, s[16:19], s47 offen offset:0
    ds_read_b64_tr_b16 v[96:97], v15 offset:18624
    ds_read_b64_tr_b16 v[98:99], v16 offset:18624
    s_waitcnt lgkmcnt(10)
    v_mfma_f32_16x16x32_bf16 v[148:151], v[100:103], v[68:71], v[148:151]
    v_mfma_f32_16x16x32_bf16 v[220:223], v[100:103], v[76:79], v[220:223]
    ds_read_b64_tr_b16 v[100:101], v15 offset:18656
    ds_read_b64_tr_b16 v[102:103], v16 offset:18656
    s_waitcnt lgkmcnt(10)
    v_mfma_f32_16x16x32_bf16 v[152:155], v[104:107], v[68:71], v[152:155]
    v_mfma_f32_16x16x32_bf16 v[224:227], v[104:107], v[76:79], v[224:227]
    buffer_load_dwordx4 v[64:67], v8, s[16:19], s47 offen offset:1024
    ds_read_b64_tr_b16 v[104:105], v15 offset:18688
    ds_read_b64_tr_b16 v[106:107], v16 offset:18688
    s_waitcnt lgkmcnt(10)
    v_mfma_f32_16x16x32_bf16 v[156:159], v[84:87], v[68:71], v[156:159]
    v_mfma_f32_16x16x32_bf16 v[228:231], v[84:87], v[76:79], v[228:231]
    ds_read_b64_tr_b16 v[84:85], v15 offset:2304
    ds_read_b64_tr_b16 v[86:87], v16 offset:2304
    s_waitcnt lgkmcnt(10)
    v_mfma_f32_16x16x32_bf16 v[160:163], v[88:91], v[68:71], v[160:163]
    v_mfma_f32_16x16x32_bf16 v[232:235], v[88:91], v[76:79], v[232:235]
    ds_read_b64_tr_b16 v[88:89], v15 offset:2336
    ds_read_b64_tr_b16 v[90:91], v16 offset:2336
    s_waitcnt lgkmcnt(10)
    v_mfma_f32_16x16x32_bf16 v[164:167], v[92:95], v[68:71], v[164:167]
    v_mfma_f32_16x16x32_bf16 v[236:239], v[92:95], v[76:79], v[236:239]
    ds_read_b64_tr_b16 v[92:93], v15 offset:2368
    ds_read_b64_tr_b16 v[94:95], v16 offset:2368
    s_waitcnt lgkmcnt(10)
    v_mfma_f32_16x16x32_bf16 v[168:171], v[96:99], v[68:71], v[168:171]
    v_mfma_f32_16x16x32_bf16 v[240:243], v[96:99], v[76:79], v[240:243]
    ds_read_b64_tr_b16 v[96:97], v15 offset:2400
    ds_read_b64_tr_b16 v[98:99], v16 offset:2400
    s_waitcnt lgkmcnt(10)
    v_mfma_f32_16x16x32_bf16 v[172:175], v[100:103], v[68:71], v[172:175]
    v_mfma_f32_16x16x32_bf16 v[244:247], v[100:103], v[76:79], v[244:247]
    ds_read_b64_tr_b16 v[100:101], v15 offset:2432
    ds_read_b64_tr_b16 v[102:103], v16 offset:2432
    s_waitcnt lgkmcnt(10)
    v_mfma_f32_16x16x32_bf16 v[176:179], v[104:107], v[68:71], v[176:179]
    v_mfma_f32_16x16x32_bf16 v[248:251], v[104:107], v[76:79], v[248:251]
    ds_read_b64_tr_b16 v[104:105], v15 offset:2464
    ds_read_b64_tr_b16 v[106:107], v16 offset:2464
    s_waitcnt lgkmcnt(10)
    v_mfma_f32_16x16x32_bf16 v[108:111], v[84:87], v[72:75], v[108:111]
    v_mfma_f32_16x16x32_bf16 v[180:183], v[84:87], v[80:83], v[180:183]
    ds_read_b64_tr_b16 v[84:85], v15 offset:2496
    ds_read_b64_tr_b16 v[86:87], v16 offset:2496
    s_waitcnt lgkmcnt(10)
    v_mfma_f32_16x16x32_bf16 v[112:115], v[88:91], v[72:75], v[112:115]
    v_mfma_f32_16x16x32_bf16 v[184:187], v[88:91], v[80:83], v[184:187]
    ds_read_b64_tr_b16 v[88:89], v15 offset:2528
    ds_read_b64_tr_b16 v[90:91], v16 offset:2528
    s_waitcnt lgkmcnt(10)
    v_mfma_f32_16x16x32_bf16 v[116:119], v[92:95], v[72:75], v[116:119]
    v_mfma_f32_16x16x32_bf16 v[188:191], v[92:95], v[80:83], v[188:191]
    ds_read_b64_tr_b16 v[92:93], v15 offset:2560
    ds_read_b64_tr_b16 v[94:95], v16 offset:2560
    s_waitcnt lgkmcnt(10)
    v_mfma_f32_16x16x32_bf16 v[120:123], v[96:99], v[72:75], v[120:123]
    v_mfma_f32_16x16x32_bf16 v[192:195], v[96:99], v[80:83], v[192:195]
    ds_read_b64_tr_b16 v[96:97], v15 offset:20736
    ds_read_b64_tr_b16 v[98:99], v16 offset:20736
    s_waitcnt lgkmcnt(10)
    v_mfma_f32_16x16x32_bf16 v[124:127], v[100:103], v[72:75], v[124:127]
    v_mfma_f32_16x16x32_bf16 v[196:199], v[100:103], v[80:83], v[196:199]
    ds_read_b64_tr_b16 v[100:101], v15 offset:20768
    ds_read_b64_tr_b16 v[102:103], v16 offset:20768
    s_waitcnt lgkmcnt(10)
    v_mfma_f32_16x16x32_bf16 v[128:131], v[104:107], v[72:75], v[128:131]
    v_mfma_f32_16x16x32_bf16 v[200:203], v[104:107], v[80:83], v[200:203]
    ds_read_b64_tr_b16 v[104:105], v15 offset:20800
    ds_read_b64_tr_b16 v[106:107], v16 offset:20800
    s_waitcnt lgkmcnt(10)
    v_mfma_f32_16x16x32_bf16 v[132:135], v[84:87], v[72:75], v[132:135]
    v_mfma_f32_16x16x32_bf16 v[204:207], v[84:87], v[80:83], v[204:207]
    ds_read_b64_tr_b16 v[84:85], v15 offset:20832
    ds_read_b64_tr_b16 v[86:87], v16 offset:20832
    s_waitcnt lgkmcnt(10)
    v_mfma_f32_16x16x32_bf16 v[136:139], v[88:91], v[72:75], v[136:139]
    v_mfma_f32_16x16x32_bf16 v[208:211], v[88:91], v[80:83], v[208:211]
    ds_read_b64_tr_b16 v[88:89], v15 offset:20864
    ds_read_b64_tr_b16 v[90:91], v16 offset:20864
    s_waitcnt lgkmcnt(10)
    v_mfma_f32_16x16x32_bf16 v[140:143], v[92:95], v[72:75], v[140:143]
    v_mfma_f32_16x16x32_bf16 v[212:215], v[92:95], v[80:83], v[212:215]
    ds_read_b64_tr_b16 v[92:93], v15 offset:20896
    ds_read_b64_tr_b16 v[94:95], v16 offset:20896
    s_waitcnt lgkmcnt(10)
    v_mfma_f32_16x16x32_bf16 v[144:147], v[96:99], v[72:75], v[144:147]
    v_mfma_f32_16x16x32_bf16 v[216:219], v[96:99], v[80:83], v[216:219]
    ds_read_b64_tr_b16 v[96:97], v15 offset:20928
    ds_read_b64_tr_b16 v[98:99], v16 offset:20928
    s_waitcnt lgkmcnt(10)
    v_mfma_f32_16x16x32_bf16 v[148:151], v[100:103], v[72:75], v[148:151]
    v_mfma_f32_16x16x32_bf16 v[220:223], v[100:103], v[80:83], v[220:223]
    ds_read_b64_tr_b16 v[100:101], v15 offset:20960
    ds_read_b64_tr_b16 v[102:103], v16 offset:20960
    s_waitcnt lgkmcnt(10)
    v_mfma_f32_16x16x32_bf16 v[152:155], v[104:107], v[72:75], v[152:155]
    v_mfma_f32_16x16x32_bf16 v[224:227], v[104:107], v[80:83], v[224:227]
    ds_read_b64_tr_b16 v[104:105], v15 offset:20992
    ds_read_b64_tr_b16 v[106:107], v16 offset:20992
    s_waitcnt lgkmcnt(10)
    v_mfma_f32_16x16x32_bf16 v[156:159], v[84:87], v[72:75], v[156:159]
    v_mfma_f32_16x16x32_bf16 v[228:231], v[84:87], v[80:83], v[228:231]
    s_waitcnt vmcnt(13)
    s_barrier
    ds_read_b64_tr_b16 v[84:85], v9 offset:0
    ds_read_b64_tr_b16 v[86:87], v10 offset:0
    s_waitcnt lgkmcnt(10)
    v_mfma_f32_16x16x32_bf16 v[160:163], v[88:91], v[72:75], v[160:163]
    v_mfma_f32_16x16x32_bf16 v[232:235], v[88:91], v[80:83], v[232:235]
    s_mov_b32 s46, 3538944
    s_add_u32 m0, s34, 73728
    s_nop 0
    buffer_load_dwordx4 v2, s[12:15], s46 offen lds
    ds_read_b64_tr_b16 v[88:89], v9 offset:32
    ds_read_b64_tr_b16 v[90:91], v10 offset:32
    s_waitcnt lgkmcnt(10)
    v_mfma_f32_16x16x32_bf16 v[164:167], v[92:95], v[72:75], v[164:167]
    v_mfma_f32_16x16x32_bf16 v[236:239], v[92:95], v[80:83], v[236:239]
    ds_read_b64_tr_b16 v[92:93], v9 offset:64
    ds_read_b64_tr_b16 v[94:95], v10 offset:64
    s_waitcnt lgkmcnt(10)
    v_mfma_f32_16x16x32_bf16 v[168:171], v[96:99], v[72:75], v[168:171]
    v_mfma_f32_16x16x32_bf16 v[240:243], v[96:99], v[80:83], v[240:243]
    s_add_u32 m0, s34, 74752
    s_nop 0
    buffer_load_dwordx4 v3, s[12:15], s46 offen lds
    ds_read_b64_tr_b16 v[96:97], v9 offset:96
    ds_read_b64_tr_b16 v[98:99], v10 offset:96
    s_waitcnt lgkmcnt(10)
    v_mfma_f32_16x16x32_bf16 v[172:175], v[100:103], v[72:75], v[172:175]
    v_mfma_f32_16x16x32_bf16 v[244:247], v[100:103], v[80:83], v[244:247]
    ds_read_b64_tr_b16 v[100:101], v9 offset:128
    ds_read_b64_tr_b16 v[102:103], v10 offset:128
    s_waitcnt lgkmcnt(10)
    v_mfma_f32_16x16x32_bf16 v[176:179], v[104:107], v[72:75], v[176:179]
    v_mfma_f32_16x16x32_bf16 v[248:251], v[104:107], v[80:83], v[248:251]
    s_add_u32 m0, s34, 75776
    s_nop 0
    buffer_load_dwordx4 v4, s[12:15], s46 offen lds
    ds_read_b64_tr_b16 v[104:105], v9 offset:160
    ds_read_b64_tr_b16 v[106:107], v10 offset:160
    s_waitcnt lgkmcnt(10)
    v_mfma_f32_16x16x32_bf16 v[108:111], v[84:87], v[20:23], v[108:111]
    v_mfma_f32_16x16x32_bf16 v[180:183], v[84:87], v[28:31], v[180:183]
    ds_read_b64_tr_b16 v[84:85], v9 offset:192
    ds_read_b64_tr_b16 v[86:87], v10 offset:192
    s_waitcnt lgkmcnt(10)
    v_mfma_f32_16x16x32_bf16 v[112:115], v[88:91], v[20:23], v[112:115]
    v_mfma_f32_16x16x32_bf16 v[184:187], v[88:91], v[28:31], v[184:187]
    s_add_u32 m0, s34, 76800
    s_nop 0
    buffer_load_dwordx4 v5, s[12:15], s46 offen lds
    ds_read_b64_tr_b16 v[88:89], v9 offset:224
    ds_read_b64_tr_b16 v[90:91], v10 offset:224
    s_waitcnt lgkmcnt(10)
    v_mfma_f32_16x16x32_bf16 v[116:119], v[92:95], v[20:23], v[116:119]
    v_mfma_f32_16x16x32_bf16 v[188:191], v[92:95], v[28:31], v[188:191]
    ds_read_b64_tr_b16 v[92:93], v9 offset:256
    ds_read_b64_tr_b16 v[94:95], v10 offset:256
    s_waitcnt lgkmcnt(10)
    v_mfma_f32_16x16x32_bf16 v[120:123], v[96:99], v[20:23], v[120:123]
    v_mfma_f32_16x16x32_bf16 v[192:195], v[96:99], v[28:31], v[192:195]
    s_add_u32 m0, s35, 73728
    s_mov_b32 exec_hi, 0
    buffer_load_dwordx4 v6, s[12:15], s46 offen lds
    s_mov_b32 exec_hi, -1
    ds_read_b64_tr_b16 v[96:97], v9 offset:18432
    ds_read_b64_tr_b16 v[98:99], v10 offset:18432
    s_waitcnt lgkmcnt(10)
    v_mfma_f32_16x16x32_bf16 v[124:127], v[100:103], v[20:23], v[124:127]
    v_mfma_f32_16x16x32_bf16 v[196:199], v[100:103], v[28:31], v[196:199]
    ds_read_b64_tr_b16 v[100:101], v9 offset:18464
    ds_read_b64_tr_b16 v[102:103], v10 offset:18464
    s_waitcnt lgkmcnt(10)
    v_mfma_f32_16x16x32_bf16 v[128:131], v[104:107], v[20:23], v[128:131]
    v_mfma_f32_16x16x32_bf16 v[200:203], v[104:107], v[28:31], v[200:203]
    s_mov_b32 s47, 14336
    buffer_load_dwordx4 v[68:71], v7, s[16:19], s47 offen offset:0
    ds_read_b64_tr_b16 v[104:105], v9 offset:18496
    ds_read_b64_tr_b16 v[106:107], v10 offset:18496
    s_waitcnt lgkmcnt(10)
    v_mfma_f32_16x16x32_bf16 v[132:135], v[84:87], v[20:23], v[132:135]
    v_mfma_f32_16x16x32_bf16 v[204:207], v[84:87], v[28:31], v[204:207]
    ds_read_b64_tr_b16 v[84:85], v9 offset:18528
    ds_read_b64_tr_b16 v[86:87], v10 offset:18528
    s_waitcnt lgkmcnt(10)
    v_mfma_f32_16x16x32_bf16 v[136:139], v[88:91], v[20:23], v[136:139]
    v_mfma_f32_16x16x32_bf16 v[208:211], v[88:91], v[28:31], v[208:211]
    buffer_load_dwordx4 v[72:75], v7, s[16:19], s47 offen offset:1024
    ds_read_b64_tr_b16 v[88:89], v9 offset:18560
    ds_read_b64_tr_b16 v[90:91], v10 offset:18560
    s_waitcnt lgkmcnt(10)
    v_mfma_f32_16x16x32_bf16 v[140:143], v[92:95], v[20:23], v[140:143]
    v_mfma_f32_16x16x32_bf16 v[212:215], v[92:95], v[28:31], v[212:215]
    ds_read_b64_tr_b16 v[92:93], v9 offset:18592
    ds_read_b64_tr_b16 v[94:95], v10 offset:18592
    s_waitcnt lgkmcnt(10)
    v_mfma_f32_16x16x32_bf16 v[144:147], v[96:99], v[20:23], v[144:147]
    v_mfma_f32_16x16x32_bf16 v[216:219], v[96:99], v[28:31], v[216:219]
    buffer_load_dwordx4 v[76:79], v8, s[16:19], s47 offen offset:0
    ds_read_b64_tr_b16 v[96:97], v9 offset:18624
    ds_read_b64_tr_b16 v[98:99], v10 offset:18624
    s_waitcnt lgkmcnt(10)
    v_mfma_f32_16x16x32_bf16 v[148:151], v[100:103], v[20:23], v[148:151]
    v_mfma_f32_16x16x32_bf16 v[220:223], v[100:103], v[28:31], v[220:223]
    ds_read_b64_tr_b16 v[100:101], v9 offset:18656
    ds_read_b64_tr_b16 v[102:103], v10 offset:18656
    s_waitcnt lgkmcnt(10)
    v_mfma_f32_16x16x32_bf16 v[152:155], v[104:107], v[20:23], v[152:155]
    v_mfma_f32_16x16x32_bf16 v[224:227], v[104:107], v[28:31], v[224:227]
    buffer_load_dwordx4 v[80:83], v8, s[16:19], s47 offen offset:1024
    ds_read_b64_tr_b16 v[104:105], v9 offset:18688
    ds_read_b64_tr_b16 v[106:107], v10 offset:18688
    s_waitcnt lgkmcnt(10)
    v_mfma_f32_16x16x32_bf16 v[156:159], v[84:87], v[20:23], v[156:159]
    v_mfma_f32_16x16x32_bf16 v[228:231], v[84:87], v[28:31], v[228:231]
    ds_read_b64_tr_b16 v[84:85], v9 offset:2304
    ds_read_b64_tr_b16 v[86:87], v10 offset:2304
    s_waitcnt lgkmcnt(10)
    v_mfma_f32_16x16x32_bf16 v[160:163], v[88:91], v[20:23], v[160:163]
    v_mfma_f32_16x16x32_bf16 v[232:235], v[88:91], v[28:31], v[232:235]
    ds_read_b64_tr_b16 v[88:89], v9 offset:2336
    ds_read_b64_tr_b16 v[90:91], v10 offset:2336
    s_waitcnt lgkmcnt(10)
    v_mfma_f32_16x16x32_bf16 v[164:167], v[92:95], v[20:23], v[164:167]
    v_mfma_f32_16x16x32_bf16 v[236:239], v[92:95], v[28:31], v[236:239]
    ds_read_b64_tr_b16 v[92:93], v9 offset:2368
    ds_read_b64_tr_b16 v[94:95], v10 offset:2368
    s_waitcnt lgkmcnt(10)
    v_mfma_f32_16x16x32_bf16 v[168:171], v[96:99], v[20:23], v[168:171]
    v_mfma_f32_16x16x32_bf16 v[240:243], v[96:99], v[28:31], v[240:243]
    ds_read_b64_tr_b16 v[96:97], v9 offset:2400
    ds_read_b64_tr_b16 v[98:99], v10 offset:2400
    s_waitcnt lgkmcnt(10)
    v_mfma_f32_16x16x32_bf16 v[172:175], v[100:103], v[20:23], v[172:175]
    v_mfma_f32_16x16x32_bf16 v[244:247], v[100:103], v[28:31], v[244:247]
    ds_read_b64_tr_b16 v[100:101], v9 offset:2432
    ds_read_b64_tr_b16 v[102:103], v10 offset:2432
    s_waitcnt lgkmcnt(10)
    v_mfma_f32_16x16x32_bf16 v[176:179], v[104:107], v[20:23], v[176:179]
    v_mfma_f32_16x16x32_bf16 v[248:251], v[104:107], v[28:31], v[248:251]
    ds_read_b64_tr_b16 v[104:105], v9 offset:2464
    ds_read_b64_tr_b16 v[106:107], v10 offset:2464
    s_waitcnt lgkmcnt(10)
    v_mfma_f32_16x16x32_bf16 v[108:111], v[84:87], v[24:27], v[108:111]
    v_mfma_f32_16x16x32_bf16 v[180:183], v[84:87], v[32:35], v[180:183]
    ds_read_b64_tr_b16 v[84:85], v9 offset:2496
    ds_read_b64_tr_b16 v[86:87], v10 offset:2496
    s_waitcnt lgkmcnt(10)
    v_mfma_f32_16x16x32_bf16 v[112:115], v[88:91], v[24:27], v[112:115]
    v_mfma_f32_16x16x32_bf16 v[184:187], v[88:91], v[32:35], v[184:187]
    ds_read_b64_tr_b16 v[88:89], v9 offset:2528
    ds_read_b64_tr_b16 v[90:91], v10 offset:2528
    s_waitcnt lgkmcnt(10)
    v_mfma_f32_16x16x32_bf16 v[116:119], v[92:95], v[24:27], v[116:119]
    v_mfma_f32_16x16x32_bf16 v[188:191], v[92:95], v[32:35], v[188:191]
    ds_read_b64_tr_b16 v[92:93], v9 offset:2560
    ds_read_b64_tr_b16 v[94:95], v10 offset:2560
    s_waitcnt lgkmcnt(10)
    v_mfma_f32_16x16x32_bf16 v[120:123], v[96:99], v[24:27], v[120:123]
    v_mfma_f32_16x16x32_bf16 v[192:195], v[96:99], v[32:35], v[192:195]
    ds_read_b64_tr_b16 v[96:97], v9 offset:20736
    ds_read_b64_tr_b16 v[98:99], v10 offset:20736
    s_waitcnt lgkmcnt(10)
    v_mfma_f32_16x16x32_bf16 v[124:127], v[100:103], v[24:27], v[124:127]
    v_mfma_f32_16x16x32_bf16 v[196:199], v[100:103], v[32:35], v[196:199]
    ds_read_b64_tr_b16 v[100:101], v9 offset:20768
    ds_read_b64_tr_b16 v[102:103], v10 offset:20768
    s_waitcnt lgkmcnt(10)
    v_mfma_f32_16x16x32_bf16 v[128:131], v[104:107], v[24:27], v[128:131]
    v_mfma_f32_16x16x32_bf16 v[200:203], v[104:107], v[32:35], v[200:203]
    ds_read_b64_tr_b16 v[104:105], v9 offset:20800
    ds_read_b64_tr_b16 v[106:107], v10 offset:20800
    s_waitcnt lgkmcnt(10)
    v_mfma_f32_16x16x32_bf16 v[132:135], v[84:87], v[24:27], v[132:135]
    v_mfma_f32_16x16x32_bf16 v[204:207], v[84:87], v[32:35], v[204:207]
    ds_read_b64_tr_b16 v[84:85], v9 offset:20832
    ds_read_b64_tr_b16 v[86:87], v10 offset:20832
    s_waitcnt lgkmcnt(10)
    v_mfma_f32_16x16x32_bf16 v[136:139], v[88:91], v[24:27], v[136:139]
    v_mfma_f32_16x16x32_bf16 v[208:211], v[88:91], v[32:35], v[208:211]
    ds_read_b64_tr_b16 v[88:89], v9 offset:20864
    ds_read_b64_tr_b16 v[90:91], v10 offset:20864
    s_waitcnt lgkmcnt(10)
    v_mfma_f32_16x16x32_bf16 v[140:143], v[92:95], v[24:27], v[140:143]
    v_mfma_f32_16x16x32_bf16 v[212:215], v[92:95], v[32:35], v[212:215]
    ds_read_b64_tr_b16 v[92:93], v9 offset:20896
    ds_read_b64_tr_b16 v[94:95], v10 offset:20896
    s_waitcnt lgkmcnt(10)
    v_mfma_f32_16x16x32_bf16 v[144:147], v[96:99], v[24:27], v[144:147]
    v_mfma_f32_16x16x32_bf16 v[216:219], v[96:99], v[32:35], v[216:219]
    ds_read_b64_tr_b16 v[96:97], v9 offset:20928
    ds_read_b64_tr_b16 v[98:99], v10 offset:20928
    s_waitcnt lgkmcnt(10)
    v_mfma_f32_16x16x32_bf16 v[148:151], v[100:103], v[24:27], v[148:151]
    v_mfma_f32_16x16x32_bf16 v[220:223], v[100:103], v[32:35], v[220:223]
    ds_read_b64_tr_b16 v[100:101], v9 offset:20960
    ds_read_b64_tr_b16 v[102:103], v10 offset:20960
    s_waitcnt lgkmcnt(10)
    v_mfma_f32_16x16x32_bf16 v[152:155], v[104:107], v[24:27], v[152:155]
    v_mfma_f32_16x16x32_bf16 v[224:227], v[104:107], v[32:35], v[224:227]
    ds_read_b64_tr_b16 v[104:105], v9 offset:20992
    ds_read_b64_tr_b16 v[106:107], v10 offset:20992
    s_waitcnt lgkmcnt(10)
    v_mfma_f32_16x16x32_bf16 v[156:159], v[84:87], v[24:27], v[156:159]
    v_mfma_f32_16x16x32_bf16 v[228:231], v[84:87], v[32:35], v[228:231]
    s_waitcnt vmcnt(13)
    s_barrier
    ds_read_b64_tr_b16 v[84:85], v11 offset:0
    ds_read_b64_tr_b16 v[86:87], v12 offset:0
    s_waitcnt lgkmcnt(10)
    v_mfma_f32_16x16x32_bf16 v[160:163], v[88:91], v[24:27], v[160:163]
    v_mfma_f32_16x16x32_bf16 v[232:235], v[88:91], v[32:35], v[232:235]
    s_mov_b32 s46, 4128768
    s_add_u32 m0, s34, 110592
    s_nop 0
    buffer_load_dwordx4 v2, s[12:15], s46 offen lds
    ds_read_b64_tr_b16 v[88:89], v11 offset:32
    ds_read_b64_tr_b16 v[90:91], v12 offset:32
    s_waitcnt lgkmcnt(10)
    v_mfma_f32_16x16x32_bf16 v[164:167], v[92:95], v[24:27], v[164:167]
    v_mfma_f32_16x16x32_bf16 v[236:239], v[92:95], v[32:35], v[236:239]
    ds_read_b64_tr_b16 v[92:93], v11 offset:64
    ds_read_b64_tr_b16 v[94:95], v12 offset:64
    s_waitcnt lgkmcnt(10)
    v_mfma_f32_16x16x32_bf16 v[168:171], v[96:99], v[24:27], v[168:171]
    v_mfma_f32_16x16x32_bf16 v[240:243], v[96:99], v[32:35], v[240:243]
    s_add_u32 m0, s34, 111616
    s_nop 0
    buffer_load_dwordx4 v3, s[12:15], s46 offen lds
    ds_read_b64_tr_b16 v[96:97], v11 offset:96
    ds_read_b64_tr_b16 v[98:99], v12 offset:96
    s_waitcnt lgkmcnt(10)
    v_mfma_f32_16x16x32_bf16 v[172:175], v[100:103], v[24:27], v[172:175]
    v_mfma_f32_16x16x32_bf16 v[244:247], v[100:103], v[32:35], v[244:247]
    ds_read_b64_tr_b16 v[100:101], v11 offset:128
    ds_read_b64_tr_b16 v[102:103], v12 offset:128
    s_waitcnt lgkmcnt(10)
    v_mfma_f32_16x16x32_bf16 v[176:179], v[104:107], v[24:27], v[176:179]
    v_mfma_f32_16x16x32_bf16 v[248:251], v[104:107], v[32:35], v[248:251]
    s_add_u32 m0, s34, 112640
    s_nop 0
    buffer_load_dwordx4 v4, s[12:15], s46 offen lds
    ds_read_b64_tr_b16 v[104:105], v11 offset:160
    ds_read_b64_tr_b16 v[106:107], v12 offset:160
    s_waitcnt lgkmcnt(10)
    v_mfma_f32_16x16x32_bf16 v[108:111], v[84:87], v[36:39], v[108:111]
    v_mfma_f32_16x16x32_bf16 v[180:183], v[84:87], v[44:47], v[180:183]
    ds_read_b64_tr_b16 v[84:85], v11 offset:192
    ds_read_b64_tr_b16 v[86:87], v12 offset:192
    s_waitcnt lgkmcnt(10)
    v_mfma_f32_16x16x32_bf16 v[112:115], v[88:91], v[36:39], v[112:115]
    v_mfma_f32_16x16x32_bf16 v[184:187], v[88:91], v[44:47], v[184:187]
    s_add_u32 m0, s34, 113664
    s_nop 0
    buffer_load_dwordx4 v5, s[12:15], s46 offen lds
    ds_read_b64_tr_b16 v[88:89], v11 offset:224
    ds_read_b64_tr_b16 v[90:91], v12 offset:224
    s_waitcnt lgkmcnt(10)
    v_mfma_f32_16x16x32_bf16 v[116:119], v[92:95], v[36:39], v[116:119]
    v_mfma_f32_16x16x32_bf16 v[188:191], v[92:95], v[44:47], v[188:191]
    ds_read_b64_tr_b16 v[92:93], v11 offset:256
    ds_read_b64_tr_b16 v[94:95], v12 offset:256
    s_waitcnt lgkmcnt(10)
    v_mfma_f32_16x16x32_bf16 v[120:123], v[96:99], v[36:39], v[120:123]
    v_mfma_f32_16x16x32_bf16 v[192:195], v[96:99], v[44:47], v[192:195]
    s_add_u32 m0, s35, 110592
    s_mov_b32 exec_hi, 0
    buffer_load_dwordx4 v6, s[12:15], s46 offen lds
    s_mov_b32 exec_hi, -1
    ds_read_b64_tr_b16 v[96:97], v11 offset:18432
    ds_read_b64_tr_b16 v[98:99], v12 offset:18432
    s_waitcnt lgkmcnt(10)
    v_mfma_f32_16x16x32_bf16 v[124:127], v[100:103], v[36:39], v[124:127]
    v_mfma_f32_16x16x32_bf16 v[196:199], v[100:103], v[44:47], v[196:199]
    ds_read_b64_tr_b16 v[100:101], v11 offset:18464
    ds_read_b64_tr_b16 v[102:103], v12 offset:18464
    s_waitcnt lgkmcnt(10)
    v_mfma_f32_16x16x32_bf16 v[128:131], v[104:107], v[36:39], v[128:131]
    v_mfma_f32_16x16x32_bf16 v[200:203], v[104:107], v[44:47], v[200:203]
    s_mov_b32 s47, 16384
    buffer_load_dwordx4 v[20:23], v7, s[16:19], s47 offen offset:0
    ds_read_b64_tr_b16 v[104:105], v11 offset:18496
    ds_read_b64_tr_b16 v[106:107], v12 offset:18496
    s_waitcnt lgkmcnt(10)
    v_mfma_f32_16x16x32_bf16 v[132:135], v[84:87], v[36:39], v[132:135]
    v_mfma_f32_16x16x32_bf16 v[204:207], v[84:87], v[44:47], v[204:207]
    ds_read_b64_tr_b16 v[84:85], v11 offset:18528
    ds_read_b64_tr_b16 v[86:87], v12 offset:18528
    s_waitcnt lgkmcnt(10)
    v_mfma_f32_16x16x32_bf16 v[136:139], v[88:91], v[36:39], v[136:139]
    v_mfma_f32_16x16x32_bf16 v[208:211], v[88:91], v[44:47], v[208:211]
    buffer_load_dwordx4 v[24:27], v7, s[16:19], s47 offen offset:1024
    ds_read_b64_tr_b16 v[88:89], v11 offset:18560
    ds_read_b64_tr_b16 v[90:91], v12 offset:18560
    s_waitcnt lgkmcnt(10)
    v_mfma_f32_16x16x32_bf16 v[140:143], v[92:95], v[36:39], v[140:143]
    v_mfma_f32_16x16x32_bf16 v[212:215], v[92:95], v[44:47], v[212:215]
    ds_read_b64_tr_b16 v[92:93], v11 offset:18592
    ds_read_b64_tr_b16 v[94:95], v12 offset:18592
    s_waitcnt lgkmcnt(10)
    v_mfma_f32_16x16x32_bf16 v[144:147], v[96:99], v[36:39], v[144:147]
    v_mfma_f32_16x16x32_bf16 v[216:219], v[96:99], v[44:47], v[216:219]
    buffer_load_dwordx4 v[28:31], v8, s[16:19], s47 offen offset:0
    ds_read_b64_tr_b16 v[96:97], v11 offset:18624
    ds_read_b64_tr_b16 v[98:99], v12 offset:18624
    s_waitcnt lgkmcnt(10)
    v_mfma_f32_16x16x32_bf16 v[148:151], v[100:103], v[36:39], v[148:151]
    v_mfma_f32_16x16x32_bf16 v[220:223], v[100:103], v[44:47], v[220:223]
    ds_read_b64_tr_b16 v[100:101], v11 offset:18656
    ds_read_b64_tr_b16 v[102:103], v12 offset:18656
    s_waitcnt lgkmcnt(10)
    v_mfma_f32_16x16x32_bf16 v[152:155], v[104:107], v[36:39], v[152:155]
    v_mfma_f32_16x16x32_bf16 v[224:227], v[104:107], v[44:47], v[224:227]
    buffer_load_dwordx4 v[32:35], v8, s[16:19], s47 offen offset:1024
    ds_read_b64_tr_b16 v[104:105], v11 offset:18688
    ds_read_b64_tr_b16 v[106:107], v12 offset:18688
    s_waitcnt lgkmcnt(10)
    v_mfma_f32_16x16x32_bf16 v[156:159], v[84:87], v[36:39], v[156:159]
    v_mfma_f32_16x16x32_bf16 v[228:231], v[84:87], v[44:47], v[228:231]
    ds_read_b64_tr_b16 v[84:85], v11 offset:2304
    ds_read_b64_tr_b16 v[86:87], v12 offset:2304
    s_waitcnt lgkmcnt(10)
    v_mfma_f32_16x16x32_bf16 v[160:163], v[88:91], v[36:39], v[160:163]
    v_mfma_f32_16x16x32_bf16 v[232:235], v[88:91], v[44:47], v[232:235]
    ds_read_b64_tr_b16 v[88:89], v11 offset:2336
    ds_read_b64_tr_b16 v[90:91], v12 offset:2336
    s_waitcnt lgkmcnt(10)
    v_mfma_f32_16x16x32_bf16 v[164:167], v[92:95], v[36:39], v[164:167]
    v_mfma_f32_16x16x32_bf16 v[236:239], v[92:95], v[44:47], v[236:239]
    ds_read_b64_tr_b16 v[92:93], v11 offset:2368
    ds_read_b64_tr_b16 v[94:95], v12 offset:2368
    s_waitcnt lgkmcnt(10)
    v_mfma_f32_16x16x32_bf16 v[168:171], v[96:99], v[36:39], v[168:171]
    v_mfma_f32_16x16x32_bf16 v[240:243], v[96:99], v[44:47], v[240:243]
    ds_read_b64_tr_b16 v[96:97], v11 offset:2400
    ds_read_b64_tr_b16 v[98:99], v12 offset:2400
    s_waitcnt lgkmcnt(10)
    v_mfma_f32_16x16x32_bf16 v[172:175], v[100:103], v[36:39], v[172:175]
    v_mfma_f32_16x16x32_bf16 v[244:247], v[100:103], v[44:47], v[244:247]
    ds_read_b64_tr_b16 v[100:101], v11 offset:2432
    ds_read_b64_tr_b16 v[102:103], v12 offset:2432
    s_waitcnt lgkmcnt(10)
    v_mfma_f32_16x16x32_bf16 v[176:179], v[104:107], v[36:39], v[176:179]
    v_mfma_f32_16x16x32_bf16 v[248:251], v[104:107], v[44:47], v[248:251]
    ds_read_b64_tr_b16 v[104:105], v11 offset:2464
    ds_read_b64_tr_b16 v[106:107], v12 offset:2464
    s_waitcnt lgkmcnt(10)
    v_mfma_f32_16x16x32_bf16 v[108:111], v[84:87], v[40:43], v[108:111]
    v_mfma_f32_16x16x32_bf16 v[180:183], v[84:87], v[48:51], v[180:183]
    ds_read_b64_tr_b16 v[84:85], v11 offset:2496
    ds_read_b64_tr_b16 v[86:87], v12 offset:2496
    s_waitcnt lgkmcnt(10)
    v_mfma_f32_16x16x32_bf16 v[112:115], v[88:91], v[40:43], v[112:115]
    v_mfma_f32_16x16x32_bf16 v[184:187], v[88:91], v[48:51], v[184:187]
    ds_read_b64_tr_b16 v[88:89], v11 offset:2528
    ds_read_b64_tr_b16 v[90:91], v12 offset:2528
    s_waitcnt lgkmcnt(10)
    v_mfma_f32_16x16x32_bf16 v[116:119], v[92:95], v[40:43], v[116:119]
    v_mfma_f32_16x16x32_bf16 v[188:191], v[92:95], v[48:51], v[188:191]
    ds_read_b64_tr_b16 v[92:93], v11 offset:2560
    ds_read_b64_tr_b16 v[94:95], v12 offset:2560
    s_waitcnt lgkmcnt(10)
    v_mfma_f32_16x16x32_bf16 v[120:123], v[96:99], v[40:43], v[120:123]
    v_mfma_f32_16x16x32_bf16 v[192:195], v[96:99], v[48:51], v[192:195]
    ds_read_b64_tr_b16 v[96:97], v11 offset:20736
    ds_read_b64_tr_b16 v[98:99], v12 offset:20736
    s_waitcnt lgkmcnt(10)
    v_mfma_f32_16x16x32_bf16 v[124:127], v[100:103], v[40:43], v[124:127]
    v_mfma_f32_16x16x32_bf16 v[196:199], v[100:103], v[48:51], v[196:199]
    ds_read_b64_tr_b16 v[100:101], v11 offset:20768
    ds_read_b64_tr_b16 v[102:103], v12 offset:20768
    s_waitcnt lgkmcnt(10)
    v_mfma_f32_16x16x32_bf16 v[128:131], v[104:107], v[40:43], v[128:131]
    v_mfma_f32_16x16x32_bf16 v[200:203], v[104:107], v[48:51], v[200:203]
    ds_read_b64_tr_b16 v[104:105], v11 offset:20800
    ds_read_b64_tr_b16 v[106:107], v12 offset:20800
    s_waitcnt lgkmcnt(10)
    v_mfma_f32_16x16x32_bf16 v[132:135], v[84:87], v[40:43], v[132:135]
    v_mfma_f32_16x16x32_bf16 v[204:207], v[84:87], v[48:51], v[204:207]
    ds_read_b64_tr_b16 v[84:85], v11 offset:20832
    ds_read_b64_tr_b16 v[86:87], v12 offset:20832
    s_waitcnt lgkmcnt(10)
    v_mfma_f32_16x16x32_bf16 v[136:139], v[88:91], v[40:43], v[136:139]
    v_mfma_f32_16x16x32_bf16 v[208:211], v[88:91], v[48:51], v[208:211]
    ds_read_b64_tr_b16 v[88:89], v11 offset:20864
    ds_read_b64_tr_b16 v[90:91], v12 offset:20864
    s_waitcnt lgkmcnt(10)
    v_mfma_f32_16x16x32_bf16 v[140:143], v[92:95], v[40:43], v[140:143]
    v_mfma_f32_16x16x32_bf16 v[212:215], v[92:95], v[48:51], v[212:215]
    ds_read_b64_tr_b16 v[92:93], v11 offset:20896
    ds_read_b64_tr_b16 v[94:95], v12 offset:20896
    s_waitcnt lgkmcnt(10)
    v_mfma_f32_16x16x32_bf16 v[144:147], v[96:99], v[40:43], v[144:147]
    v_mfma_f32_16x16x32_bf16 v[216:219], v[96:99], v[48:51], v[216:219]
    ds_read_b64_tr_b16 v[96:97], v11 offset:20928
    ds_read_b64_tr_b16 v[98:99], v12 offset:20928
    s_waitcnt lgkmcnt(10)
    v_mfma_f32_16x16x32_bf16 v[148:151], v[100:103], v[40:43], v[148:151]
    v_mfma_f32_16x16x32_bf16 v[220:223], v[100:103], v[48:51], v[220:223]
    ds_read_b64_tr_b16 v[100:101], v11 offset:20960
    ds_read_b64_tr_b16 v[102:103], v12 offset:20960
    s_waitcnt lgkmcnt(10)
    v_mfma_f32_16x16x32_bf16 v[152:155], v[104:107], v[40:43], v[152:155]
    v_mfma_f32_16x16x32_bf16 v[224:227], v[104:107], v[48:51], v[224:227]
    ds_read_b64_tr_b16 v[104:105], v11 offset:20992
    ds_read_b64_tr_b16 v[106:107], v12 offset:20992
    s_waitcnt lgkmcnt(10)
    v_mfma_f32_16x16x32_bf16 v[156:159], v[84:87], v[40:43], v[156:159]
    v_mfma_f32_16x16x32_bf16 v[228:231], v[84:87], v[48:51], v[228:231]
    s_waitcnt vmcnt(13)
    s_barrier
    ds_read_b64_tr_b16 v[84:85], v13 offset:0
    ds_read_b64_tr_b16 v[86:87], v14 offset:0
    s_waitcnt lgkmcnt(10)
    v_mfma_f32_16x16x32_bf16 v[160:163], v[88:91], v[40:43], v[160:163]
    v_mfma_f32_16x16x32_bf16 v[232:235], v[88:91], v[48:51], v[232:235]
    s_mov_b32 s46, 4718592
    s_add_u32 m0, s34, 0
    s_nop 0
    buffer_load_dwordx4 v2, s[12:15], s46 offen lds
    ds_read_b64_tr_b16 v[88:89], v13 offset:32
    ds_read_b64_tr_b16 v[90:91], v14 offset:32
    s_waitcnt lgkmcnt(10)
    v_mfma_f32_16x16x32_bf16 v[164:167], v[92:95], v[40:43], v[164:167]
    v_mfma_f32_16x16x32_bf16 v[236:239], v[92:95], v[48:51], v[236:239]
    ds_read_b64_tr_b16 v[92:93], v13 offset:64
    ds_read_b64_tr_b16 v[94:95], v14 offset:64
    s_waitcnt lgkmcnt(10)
    v_mfma_f32_16x16x32_bf16 v[168:171], v[96:99], v[40:43], v[168:171]
    v_mfma_f32_16x16x32_bf16 v[240:243], v[96:99], v[48:51], v[240:243]
    s_add_u32 m0, s34, 1024
    s_nop 0
    buffer_load_dwordx4 v3, s[12:15], s46 offen lds
    ds_read_b64_tr_b16 v[96:97], v13 offset:96
    ds_read_b64_tr_b16 v[98:99], v14 offset:96
    s_waitcnt lgkmcnt(10)
    v_mfma_f32_16x16x32_bf16 v[172:175], v[100:103], v[40:43], v[172:175]
    v_mfma_f32_16x16x32_bf16 v[244:247], v[100:103], v[48:51], v[244:247]
    ds_read_b64_tr_b16 v[100:101], v13 offset:128
    ds_read_b64_tr_b16 v[102:103], v14 offset:128
    s_waitcnt lgkmcnt(10)
    v_mfma_f32_16x16x32_bf16 v[176:179], v[104:107], v[40:43], v[176:179]
    v_mfma_f32_16x16x32_bf16 v[248:251], v[104:107], v[48:51], v[248:251]
    s_add_u32 m0, s34, 2048
    s_nop 0
    buffer_load_dwordx4 v4, s[12:15], s46 offen lds
    ds_read_b64_tr_b16 v[104:105], v13 offset:160
    ds_read_b64_tr_b16 v[106:107], v14 offset:160
    s_waitcnt lgkmcnt(10)
    v_mfma_f32_16x16x32_bf16 v[108:111], v[84:87], v[52:55], v[108:111]
    v_mfma_f32_16x16x32_bf16 v[180:183], v[84:87], v[60:63], v[180:183]
    ds_read_b64_tr_b16 v[84:85], v13 offset:192
    ds_read_b64_tr_b16 v[86:87], v14 offset:192
    s_waitcnt lgkmcnt(10)
    v_mfma_f32_16x16x32_bf16 v[112:115], v[88:91], v[52:55], v[112:115]
    v_mfma_f32_16x16x32_bf16 v[184:187], v[88:91], v[60:63], v[184:187]
    s_add_u32 m0, s34, 3072
    s_nop 0
    buffer_load_dwordx4 v5, s[12:15], s46 offen lds
    ds_read_b64_tr_b16 v[88:89], v13 offset:224
    ds_read_b64_tr_b16 v[90:91], v14 offset:224
    s_waitcnt lgkmcnt(10)
    v_mfma_f32_16x16x32_bf16 v[116:119], v[92:95], v[52:55], v[116:119]
    v_mfma_f32_16x16x32_bf16 v[188:191], v[92:95], v[60:63], v[188:191]
    ds_read_b64_tr_b16 v[92:93], v13 offset:256
    ds_read_b64_tr_b16 v[94:95], v14 offset:256
    s_waitcnt lgkmcnt(10)
    v_mfma_f32_16x16x32_bf16 v[120:123], v[96:99], v[52:55], v[120:123]
    v_mfma_f32_16x16x32_bf16 v[192:195], v[96:99], v[60:63], v[192:195]
    s_add_u32 m0, s35, 0
    s_mov_b32 exec_hi, 0
    buffer_load_dwordx4 v6, s[12:15], s46 offen lds
    s_mov_b32 exec_hi, -1
    ds_read_b64_tr_b16 v[96:97], v13 offset:18432
    ds_read_b64_tr_b16 v[98:99], v14 offset:18432
    s_waitcnt lgkmcnt(10)
    v_mfma_f32_16x16x32_bf16 v[124:127], v[100:103], v[52:55], v[124:127]
    v_mfma_f32_16x16x32_bf16 v[196:199], v[100:103], v[60:63], v[196:199]
    ds_read_b64_tr_b16 v[100:101], v13 offset:18464
    ds_read_b64_tr_b16 v[102:103], v14 offset:18464
    s_waitcnt lgkmcnt(10)
    v_mfma_f32_16x16x32_bf16 v[128:131], v[104:107], v[52:55], v[128:131]
    v_mfma_f32_16x16x32_bf16 v[200:203], v[104:107], v[60:63], v[200:203]
    ds_read_b64_tr_b16 v[104:105], v13 offset:18496
    ds_read_b64_tr_b16 v[106:107], v14 offset:18496
    s_waitcnt lgkmcnt(10)
    v_mfma_f32_16x16x32_bf16 v[132:135], v[84:87], v[52:55], v[132:135]
    v_mfma_f32_16x16x32_bf16 v[204:207], v[84:87], v[60:63], v[204:207]
    ds_read_b64_tr_b16 v[84:85], v13 offset:18528
    ds_read_b64_tr_b16 v[86:87], v14 offset:18528
    s_waitcnt lgkmcnt(10)
    v_mfma_f32_16x16x32_bf16 v[136:139], v[88:91], v[52:55], v[136:139]
    v_mfma_f32_16x16x32_bf16 v[208:211], v[88:91], v[60:63], v[208:211]
    ds_read_b64_tr_b16 v[88:89], v13 offset:18560
    ds_read_b64_tr_b16 v[90:91], v14 offset:18560
    s_waitcnt lgkmcnt(10)
    v_mfma_f32_16x16x32_bf16 v[140:143], v[92:95], v[52:55], v[140:143]
    v_mfma_f32_16x16x32_bf16 v[212:215], v[92:95], v[60:63], v[212:215]
    ds_read_b64_tr_b16 v[92:93], v13 offset:18592
    ds_read_b64_tr_b16 v[94:95], v14 offset:18592
    s_waitcnt lgkmcnt(10)
    v_mfma_f32_16x16x32_bf16 v[144:147], v[96:99], v[52:55], v[144:147]
    v_mfma_f32_16x16x32_bf16 v[216:219], v[96:99], v[60:63], v[216:219]
    ds_read_b64_tr_b16 v[96:97], v13 offset:18624
    ds_read_b64_tr_b16 v[98:99], v14 offset:18624
    s_waitcnt lgkmcnt(10)
    v_mfma_f32_16x16x32_bf16 v[148:151], v[100:103], v[52:55], v[148:151]
    v_mfma_f32_16x16x32_bf16 v[220:223], v[100:103], v[60:63], v[220:223]
    ds_read_b64_tr_b16 v[100:101], v13 offset:18656
    ds_read_b64_tr_b16 v[102:103], v14 offset:18656
    s_waitcnt lgkmcnt(10)
    v_mfma_f32_16x16x32_bf16 v[152:155], v[104:107], v[52:55], v[152:155]
    v_mfma_f32_16x16x32_bf16 v[224:227], v[104:107], v[60:63], v[224:227]
    ds_read_b64_tr_b16 v[104:105], v13 offset:18688
    ds_read_b64_tr_b16 v[106:107], v14 offset:18688
    s_waitcnt lgkmcnt(10)
    v_mfma_f32_16x16x32_bf16 v[156:159], v[84:87], v[52:55], v[156:159]
    v_mfma_f32_16x16x32_bf16 v[228:231], v[84:87], v[60:63], v[228:231]
    ds_read_b64_tr_b16 v[84:85], v13 offset:2304
    ds_read_b64_tr_b16 v[86:87], v14 offset:2304
    s_waitcnt lgkmcnt(10)
    v_mfma_f32_16x16x32_bf16 v[160:163], v[88:91], v[52:55], v[160:163]
    v_mfma_f32_16x16x32_bf16 v[232:235], v[88:91], v[60:63], v[232:235]
    ds_read_b64_tr_b16 v[88:89], v13 offset:2336
    ds_read_b64_tr_b16 v[90:91], v14 offset:2336
    s_waitcnt lgkmcnt(10)
    v_mfma_f32_16x16x32_bf16 v[164:167], v[92:95], v[52:55], v[164:167]
    v_mfma_f32_16x16x32_bf16 v[236:239], v[92:95], v[60:63], v[236:239]
    ds_read_b64_tr_b16 v[92:93], v13 offset:2368
    ds_read_b64_tr_b16 v[94:95], v14 offset:2368
    s_waitcnt lgkmcnt(10)
    v_mfma_f32_16x16x32_bf16 v[168:171], v[96:99], v[52:55], v[168:171]
    v_mfma_f32_16x16x32_bf16 v[240:243], v[96:99], v[60:63], v[240:243]
    s_bfe_u32 s41, s2, 0x10002
    s_cmp_eq_u32 s41, 0
    s_cselect_b32 s41, 2211840, 0
    s_mov_b32 s26, 2211840
    s_cselect_b32 s26, 3096576, s26
    s_add_u32 s24, s86, s41
    s_addc_u32 s25, s87, 0
    s_mov_b32 s27, 0x00020000
    s_and_b32 s41, s2, 0xf8
    s_add_u32 s41, s41, s40
    s_lshl_b32 s41, s41, 13
    s_add_u32 s42, s41, 2097152
    v_lshlrev_b32 v17, 7, v1
    buffer_load_dword v0, v17, s[24:27], s41 offen
    buffer_load_dword v0, v17, s[24:27], s42 offen
    s_mov_b32 s76, s72
    s_mov_b32 s77, s73
    s_mov_b32 s78, 2359296
    s_mov_b32 s79, 0x00020000
    s_lshl_b32 s41, s2, 3
    s_add_u32 s41, s41, s40
    s_mul_i32 s41, s41, 1152
    s_mov_b32 exec_lo, 0x1ff
    s_mov_b32 exec_hi, 0
    buffer_load_dword v0, v17, s[76:79], s41 offen
    s_mov_b64 exec, -1
    ds_read_b64_tr_b16 v[96:97], v13 offset:2400
    ds_read_b64_tr_b16 v[98:99], v14 offset:2400
    s_waitcnt lgkmcnt(10)
    v_mfma_f32_16x16x32_bf16 v[172:175], v[100:103], v[52:55], v[172:175]
    v_mfma_f32_16x16x32_bf16 v[244:247], v[100:103], v[60:63], v[244:247]
    ds_read_b64_tr_b16 v[100:101], v13 offset:2432
    ds_read_b64_tr_b16 v[102:103], v14 offset:2432
    s_waitcnt lgkmcnt(10)
    v_mfma_f32_16x16x32_bf16 v[176:179], v[104:107], v[52:55], v[176:179]
    v_mfma_f32_16x16x32_bf16 v[248:251], v[104:107], v[60:63], v[248:251]
    ds_read_b64_tr_b16 v[104:105], v13 offset:2464
    ds_read_b64_tr_b16 v[106:107], v14 offset:2464
    s_waitcnt lgkmcnt(10)
    v_mfma_f32_16x16x32_bf16 v[108:111], v[84:87], v[56:59], v[108:111]
    v_mfma_f32_16x16x32_bf16 v[180:183], v[84:87], v[64:67], v[180:183]
    ds_read_b64_tr_b16 v[84:85], v13 offset:2496
    ds_read_b64_tr_b16 v[86:87], v14 offset:2496
    s_waitcnt lgkmcnt(10)
    v_mfma_f32_16x16x32_bf16 v[112:115], v[88:91], v[56:59], v[112:115]
    v_mfma_f32_16x16x32_bf16 v[184:187], v[88:91], v[64:67], v[184:187]
    ds_read_b64_tr_b16 v[88:89], v13 offset:2528
    ds_read_b64_tr_b16 v[90:91], v14 offset:2528
    s_waitcnt lgkmcnt(10)
    v_mfma_f32_16x16x32_bf16 v[116:119], v[92:95], v[56:59], v[116:119]
    v_mfma_f32_16x16x32_bf16 v[188:191], v[92:95], v[64:67], v[188:191]
    ds_read_b64_tr_b16 v[92:93], v13 offset:2560
    ds_read_b64_tr_b16 v[94:95], v14 offset:2560
    s_waitcnt lgkmcnt(10)
    v_mfma_f32_16x16x32_bf16 v[120:123], v[96:99], v[56:59], v[120:123]
    v_mfma_f32_16x16x32_bf16 v[192:195], v[96:99], v[64:67], v[192:195]
    ds_read_b64_tr_b16 v[96:97], v13 offset:20736
    ds_read_b64_tr_b16 v[98:99], v14 offset:20736
    s_waitcnt lgkmcnt(10)
    v_mfma_f32_16x16x32_bf16 v[124:127], v[100:103], v[56:59], v[124:127]
    v_mfma_f32_16x16x32_bf16 v[196:199], v[100:103], v[64:67], v[196:199]
    ds_read_b64_tr_b16 v[100:101], v13 offset:20768
    ds_read_b64_tr_b16 v[102:103], v14 offset:20768
    s_waitcnt lgkmcnt(10)
    v_mfma_f32_16x16x32_bf16 v[128:131], v[104:107], v[56:59], v[128:131]
    v_mfma_f32_16x16x32_bf16 v[200:203], v[104:107], v[64:67], v[200:203]
    ds_read_b64_tr_b16 v[104:105], v13 offset:20800
    ds_read_b64_tr_b16 v[106:107], v14 offset:20800
    s_waitcnt lgkmcnt(10)
    v_mfma_f32_16x16x32_bf16 v[132:135], v[84:87], v[56:59], v[132:135]
    v_mfma_f32_16x16x32_bf16 v[204:207], v[84:87], v[64:67], v[204:207]
    ds_read_b64_tr_b16 v[84:85], v13 offset:20832
    ds_read_b64_tr_b16 v[86:87], v14 offset:20832
    s_waitcnt lgkmcnt(10)
    v_mfma_f32_16x16x32_bf16 v[136:139], v[88:91], v[56:59], v[136:139]
    v_mfma_f32_16x16x32_bf16 v[208:211], v[88:91], v[64:67], v[208:211]
    ds_read_b64_tr_b16 v[88:89], v13 offset:20864
    ds_read_b64_tr_b16 v[90:91], v14 offset:20864
    s_waitcnt lgkmcnt(10)
    v_mfma_f32_16x16x32_bf16 v[140:143], v[92:95], v[56:59], v[140:143]
    v_mfma_f32_16x16x32_bf16 v[212:215], v[92:95], v[64:67], v[212:215]
    ds_read_b64_tr_b16 v[92:93], v13 offset:20896
    ds_read_b64_tr_b16 v[94:95], v14 offset:20896
    s_waitcnt lgkmcnt(10)
    v_mfma_f32_16x16x32_bf16 v[144:147], v[96:99], v[56:59], v[144:147]
    v_mfma_f32_16x16x32_bf16 v[216:219], v[96:99], v[64:67], v[216:219]
    ds_read_b64_tr_b16 v[96:97], v13 offset:20928
    ds_read_b64_tr_b16 v[98:99], v14 offset:20928
    s_waitcnt lgkmcnt(10)
    v_mfma_f32_16x16x32_bf16 v[148:151], v[100:103], v[56:59], v[148:151]
    v_mfma_f32_16x16x32_bf16 v[220:223], v[100:103], v[64:67], v[220:223]
    ds_read_b64_tr_b16 v[100:101], v13 offset:20960
    ds_read_b64_tr_b16 v[102:103], v14 offset:20960
    s_waitcnt lgkmcnt(10)
    v_mfma_f32_16x16x32_bf16 v[152:155], v[104:107], v[56:59], v[152:155]
    v_mfma_f32_16x16x32_bf16 v[224:227], v[104:107], v[64:67], v[224:227]
    ds_read_b64_tr_b16 v[104:105], v13 offset:20992
    ds_read_b64_tr_b16 v[106:107], v14 offset:20992
    s_waitcnt lgkmcnt(10)
    v_mfma_f32_16x16x32_bf16 v[156:159], v[84:87], v[56:59], v[156:159]
    v_mfma_f32_16x16x32_bf16 v[228:231], v[84:87], v[64:67], v[228:231]
    s_waitcnt vmcnt(12)
    s_barrier
    ds_read_b64_tr_b16 v[84:85], v15 offset:0
    ds_read_b64_tr_b16 v[86:87], v16 offset:0
    s_waitcnt lgkmcnt(10)
    v_mfma_f32_16x16x32_bf16 v[160:163], v[88:91], v[56:59], v[160:163]
    v_mfma_f32_16x16x32_bf16 v[232:235], v[88:91], v[64:67], v[232:235]
    ds_read_b64_tr_b16 v[88:89], v15 offset:32
    ds_read_b64_tr_b16 v[90:91], v16 offset:32
    s_waitcnt lgkmcnt(10)
    v_mfma_f32_16x16x32_bf16 v[164:167], v[92:95], v[56:59], v[164:167]
    v_mfma_f32_16x16x32_bf16 v[236:239], v[92:95], v[64:67], v[236:239]
    ds_read_b64_tr_b16 v[92:93], v15 offset:64
    ds_read_b64_tr_b16 v[94:95], v16 offset:64
    s_waitcnt lgkmcnt(10)
    v_mfma_f32_16x16x32_bf16 v[168:171], v[96:99], v[56:59], v[168:171]
    v_mfma_f32_16x16x32_bf16 v[240:243], v[96:99], v[64:67], v[240:243]
    ds_read_b64_tr_b16 v[96:97], v15 offset:96
    ds_read_b64_tr_b16 v[98:99], v16 offset:96
    s_waitcnt lgkmcnt(10)
    v_mfma_f32_16x16x32_bf16 v[172:175], v[100:103], v[56:59], v[172:175]
    v_mfma_f32_16x16x32_bf16 v[244:247], v[100:103], v[64:67], v[244:247]
    ds_read_b64_tr_b16 v[100:101], v15 offset:128
    ds_read_b64_tr_b16 v[102:103], v16 offset:128
    s_waitcnt lgkmcnt(10)
    v_mfma_f32_16x16x32_bf16 v[176:179], v[104:107], v[56:59], v[176:179]
    v_mfma_f32_16x16x32_bf16 v[248:251], v[104:107], v[64:67], v[248:251]
    ds_read_b64_tr_b16 v[104:105], v15 offset:160
    ds_read_b64_tr_b16 v[106:107], v16 offset:160
    s_waitcnt lgkmcnt(10)
    v_mfma_f32_16x16x32_bf16 v[108:111], v[84:87], v[68:71], v[108:111]
    v_mfma_f32_16x16x32_bf16 v[180:183], v[84:87], v[76:79], v[180:183]
    ds_read_b64_tr_b16 v[84:85], v15 offset:192
    ds_read_b64_tr_b16 v[86:87], v16 offset:192
    s_waitcnt lgkmcnt(10)
    v_mfma_f32_16x16x32_bf16 v[112:115], v[88:91], v[68:71], v[112:115]
    v_mfma_f32_16x16x32_bf16 v[184:187], v[88:91], v[76:79], v[184:187]
    ds_read_b64_tr_b16 v[88:89], v15 offset:224
    ds_read_b64_tr_b16 v[90:91], v16 offset:224
    s_waitcnt lgkmcnt(10)
    v_mfma_f32_16x16x32_bf16 v[116:119], v[92:95], v[68:71], v[116:119]
    v_mfma_f32_16x16x32_bf16 v[188:191], v[92:95], v[76:79], v[188:191]
    ds_read_b64_tr_b16 v[92:93], v15 offset:256
    ds_read_b64_tr_b16 v[94:95], v16 offset:256
    s_waitcnt lgkmcnt(10)
    v_mfma_f32_16x16x32_bf16 v[120:123], v[96:99], v[68:71], v[120:123]
    v_mfma_f32_16x16x32_bf16 v[192:195], v[96:99], v[76:79], v[192:195]
    ds_read_b64_tr_b16 v[96:97], v15 offset:18432
    ds_read_b64_tr_b16 v[98:99], v16 offset:18432
    s_waitcnt lgkmcnt(10)
    v_mfma_f32_16x16x32_bf16 v[124:127], v[100:103], v[68:71], v[124:127]
    v_mfma_f32_16x16x32_bf16 v[196:199], v[100:103], v[76:79], v[196:199]
    ds_read_b64_tr_b16 v[100:101], v15 offset:18464
    ds_read_b64_tr_b16 v[102:103], v16 offset:18464
    s_waitcnt lgkmcnt(10)
    v_mfma_f32_16x16x32_bf16 v[128:131], v[104:107], v[68:71], v[128:131]
    v_mfma_f32_16x16x32_bf16 v[200:203], v[104:107], v[76:79], v[200:203]
    ds_read_b64_tr_b16 v[104:105], v15 offset:18496
    ds_read_b64_tr_b16 v[106:107], v16 offset:18496
    s_waitcnt lgkmcnt(10)
    v_mfma_f32_16x16x32_bf16 v[132:135], v[84:87], v[68:71], v[132:135]
    v_mfma_f32_16x16x32_bf16 v[204:207], v[84:87], v[76:79], v[204:207]
    ds_read_b64_tr_b16 v[84:85], v15 offset:18528
    ds_read_b64_tr_b16 v[86:87], v16 offset:18528
    s_waitcnt lgkmcnt(10)
    v_mfma_f32_16x16x32_bf16 v[136:139], v[88:91], v[68:71], v[136:139]
    v_mfma_f32_16x16x32_bf16 v[208:211], v[88:91], v[76:79], v[208:211]
    ds_read_b64_tr_b16 v[88:89], v15 offset:18560
    ds_read_b64_tr_b16 v[90:91], v16 offset:18560
    s_waitcnt lgkmcnt(10)
    v_mfma_f32_16x16x32_bf16 v[140:143], v[92:95], v[68:71], v[140:143]
    v_mfma_f32_16x16x32_bf16 v[212:215], v[92:95], v[76:79], v[212:215]
    ds_read_b64_tr_b16 v[92:93], v15 offset:18592
    ds_read_b64_tr_b16 v[94:95], v16 offset:18592
    s_waitcnt lgkmcnt(10)
    v_mfma_f32_16x16x32_bf16 v[144:147], v[96:99], v[68:71], v[144:147]
    v_mfma_f32_16x16x32_bf16 v[216:219], v[96:99], v[76:79], v[216:219]
    ds_read_b64_tr_b16 v[96:97], v15 offset:18624
    ds_read_b64_tr_b16 v[98:99], v16 offset:18624
    s_waitcnt lgkmcnt(10)
    v_mfma_f32_16x16x32_bf16 v[148:151], v[100:103], v[68:71], v[148:151]
    v_mfma_f32_16x16x32_bf16 v[220:223], v[100:103], v[76:79], v[220:223]
    ds_read_b64_tr_b16 v[100:101], v15 offset:18656
    ds_read_b64_tr_b16 v[102:103], v16 offset:18656
    s_waitcnt lgkmcnt(10)
    v_mfma_f32_16x16x32_bf16 v[152:155], v[104:107], v[68:71], v[152:155]
    v_mfma_f32_16x16x32_bf16 v[224:227], v[104:107], v[76:79], v[224:227]
    ds_read_b64_tr_b16 v[104:105], v15 offset:18688
    ds_read_b64_tr_b16 v[106:107], v16 offset:18688
    s_waitcnt lgkmcnt(10)
    v_mfma_f32_16x16x32_bf16 v[156:159], v[84:87], v[68:71], v[156:159]
    v_mfma_f32_16x16x32_bf16 v[228:231], v[84:87], v[76:79], v[228:231]
    ds_read_b64_tr_b16 v[84:85], v15 offset:2304
    ds_read_b64_tr_b16 v[86:87], v16 offset:2304
    s_waitcnt lgkmcnt(10)
    v_mfma_f32_16x16x32_bf16 v[160:163], v[88:91], v[68:71], v[160:163]
    v_mfma_f32_16x16x32_bf16 v[232:235], v[88:91], v[76:79], v[232:235]
    ds_read_b64_tr_b16 v[88:89], v15 offset:2336
    ds_read_b64_tr_b16 v[90:91], v16 offset:2336
    s_waitcnt lgkmcnt(10)
    v_mfma_f32_16x16x32_bf16 v[164:167], v[92:95], v[68:71], v[164:167]
    v_mfma_f32_16x16x32_bf16 v[236:239], v[92:95], v[76:79], v[236:239]
    ds_read_b64_tr_b16 v[92:93], v15 offset:2368
    ds_read_b64_tr_b16 v[94:95], v16 offset:2368
    s_waitcnt lgkmcnt(10)
    v_mfma_f32_16x16x32_bf16 v[168:171], v[96:99], v[68:71], v[168:171]
    v_mfma_f32_16x16x32_bf16 v[240:243], v[96:99], v[76:79], v[240:243]
    ds_read_b64_tr_b16 v[96:97], v15 offset:2400
    ds_read_b64_tr_b16 v[98:99], v16 offset:2400
    s_waitcnt lgkmcnt(10)
    v_mfma_f32_16x16x32_bf16 v[172:175], v[100:103], v[68:71], v[172:175]
    v_mfma_f32_16x16x32_bf16 v[244:247], v[100:103], v[76:79], v[244:247]
    ds_read_b64_tr_b16 v[100:101], v15 offset:2432
    ds_read_b64_tr_b16 v[102:103], v16 offset:2432
    s_waitcnt lgkmcnt(10)
    v_mfma_f32_16x16x32_bf16 v[176:179], v[104:107], v[68:71], v[176:179]
    v_mfma_f32_16x16x32_bf16 v[248:251], v[104:107], v[76:79], v[248:251]
    ds_read_b64_tr_b16 v[104:105], v15 offset:2464
    ds_read_b64_tr_b16 v[106:107], v16 offset:2464
    s_waitcnt lgkmcnt(10)
    v_mfma_f32_16x16x32_bf16 v[108:111], v[84:87], v[72:75], v[108:111]
    v_mfma_f32_16x16x32_bf16 v[180:183], v[84:87], v[80:83], v[180:183]
    ds_read_b64_tr_b16 v[84:85], v15 offset:2496
    ds_read_b64_tr_b16 v[86:87], v16 offset:2496
    s_waitcnt lgkmcnt(10)
    v_mfma_f32_16x16x32_bf16 v[112:115], v[88:91], v[72:75], v[112:115]
    v_mfma_f32_16x16x32_bf16 v[184:187], v[88:91], v[80:83], v[184:187]
    ds_read_b64_tr_b16 v[88:89], v15 offset:2528
    ds_read_b64_tr_b16 v[90:91], v16 offset:2528
    s_waitcnt lgkmcnt(10)
    v_mfma_f32_16x16x32_bf16 v[116:119], v[92:95], v[72:75], v[116:119]
    v_mfma_f32_16x16x32_bf16 v[188:191], v[92:95], v[80:83], v[188:191]
    ds_read_b64_tr_b16 v[92:93], v15 offset:2560
    ds_read_b64_tr_b16 v[94:95], v16 offset:2560
    s_waitcnt lgkmcnt(10)
    v_mfma_f32_16x16x32_bf16 v[120:123], v[96:99], v[72:75], v[120:123]
    v_mfma_f32_16x16x32_bf16 v[192:195], v[96:99], v[80:83], v[192:195]
    ds_read_b64_tr_b16 v[96:97], v15 offset:20736
    ds_read_b64_tr_b16 v[98:99], v16 offset:20736
    s_waitcnt lgkmcnt(10)
    v_mfma_f32_16x16x32_bf16 v[124:127], v[100:103], v[72:75], v[124:127]
    v_mfma_f32_16x16x32_bf16 v[196:199], v[100:103], v[80:83], v[196:199]
    ds_read_b64_tr_b16 v[100:101], v15 offset:20768
    ds_read_b64_tr_b16 v[102:103], v16 offset:20768
    s_waitcnt lgkmcnt(10)
    v_mfma_f32_16x16x32_bf16 v[128:131], v[104:107], v[72:75], v[128:131]
    v_mfma_f32_16x16x32_bf16 v[200:203], v[104:107], v[80:83], v[200:203]
    ds_read_b64_tr_b16 v[104:105], v15 offset:20800
    ds_read_b64_tr_b16 v[106:107], v16 offset:20800
    s_waitcnt lgkmcnt(10)
    v_mfma_f32_16x16x32_bf16 v[132:135], v[84:87], v[72:75], v[132:135]
    v_mfma_f32_16x16x32_bf16 v[204:207], v[84:87], v[80:83], v[204:207]
    ds_read_b64_tr_b16 v[84:85], v15 offset:20832
    ds_read_b64_tr_b16 v[86:87], v16 offset:20832
    s_waitcnt lgkmcnt(10)
    v_mfma_f32_16x16x32_bf16 v[136:139], v[88:91], v[72:75], v[136:139]
    v_mfma_f32_16x16x32_bf16 v[208:211], v[88:91], v[80:83], v[208:211]
    ds_read_b64_tr_b16 v[88:89], v15 offset:20864
    ds_read_b64_tr_b16 v[90:91], v16 offset:20864
    s_waitcnt lgkmcnt(10)
    v_mfma_f32_16x16x32_bf16 v[140:143], v[92:95], v[72:75], v[140:143]
    v_mfma_f32_16x16x32_bf16 v[212:215], v[92:95], v[80:83], v[212:215]
    ds_read_b64_tr_b16 v[92:93], v15 offset:20896
    ds_read_b64_tr_b16 v[94:95], v16 offset:20896
    s_waitcnt lgkmcnt(10)
    v_mfma_f32_16x16x32_bf16 v[144:147], v[96:99], v[72:75], v[144:147]
    v_mfma_f32_16x16x32_bf16 v[216:219], v[96:99], v[80:83], v[216:219]
    ds_read_b64_tr_b16 v[96:97], v15 offset:20928
    ds_read_b64_tr_b16 v[98:99], v16 offset:20928
    s_waitcnt lgkmcnt(10)
    v_mfma_f32_16x16x32_bf16 v[148:151], v[100:103], v[72:75], v[148:151]
    v_mfma_f32_16x16x32_bf16 v[220:223], v[100:103], v[80:83], v[220:223]
    ds_read_b64_tr_b16 v[100:101], v15 offset:20960
    ds_read_b64_tr_b16 v[102:103], v16 offset:20960
    s_waitcnt lgkmcnt(10)
    v_mfma_f32_16x16x32_bf16 v[152:155], v[104:107], v[72:75], v[152:155]
    v_mfma_f32_16x16x32_bf16 v[224:227], v[104:107], v[80:83], v[224:227]
    ds_read_b64_tr_b16 v[104:105], v15 offset:20992
    ds_read_b64_tr_b16 v[106:107], v16 offset:20992
    s_waitcnt lgkmcnt(10)
    v_mfma_f32_16x16x32_bf16 v[156:159], v[84:87], v[72:75], v[156:159]
    v_mfma_f32_16x16x32_bf16 v[228:231], v[84:87], v[80:83], v[228:231]
    s_waitcnt vmcnt(3)
    s_barrier
    ds_read_b64_tr_b16 v[84:85], v9 offset:0
    ds_read_b64_tr_b16 v[86:87], v10 offset:0
    s_waitcnt lgkmcnt(10)
    v_mfma_f32_16x16x32_bf16 v[160:163], v[88:91], v[72:75], v[160:163]
    v_mfma_f32_16x16x32_bf16 v[232:235], v[88:91], v[80:83], v[232:235]
    ds_read_b64_tr_b16 v[88:89], v9 offset:32
    ds_read_b64_tr_b16 v[90:91], v10 offset:32
    s_waitcnt lgkmcnt(10)
    v_mfma_f32_16x16x32_bf16 v[164:167], v[92:95], v[72:75], v[164:167]
    v_mfma_f32_16x16x32_bf16 v[236:239], v[92:95], v[80:83], v[236:239]
    ds_read_b64_tr_b16 v[92:93], v9 offset:64
    ds_read_b64_tr_b16 v[94:95], v10 offset:64
    s_waitcnt lgkmcnt(10)
    v_mfma_f32_16x16x32_bf16 v[168:171], v[96:99], v[72:75], v[168:171]
    v_mfma_f32_16x16x32_bf16 v[240:243], v[96:99], v[80:83], v[240:243]
    ds_read_b64_tr_b16 v[96:97], v9 offset:96
    ds_read_b64_tr_b16 v[98:99], v10 offset:96
    s_waitcnt lgkmcnt(10)
    v_mfma_f32_16x16x32_bf16 v[172:175], v[100:103], v[72:75], v[172:175]
    v_mfma_f32_16x16x32_bf16 v[244:247], v[100:103], v[80:83], v[244:247]
    ds_read_b64_tr_b16 v[100:101], v9 offset:128
    ds_read_b64_tr_b16 v[102:103], v10 offset:128
    s_waitcnt lgkmcnt(10)
    v_mfma_f32_16x16x32_bf16 v[176:179], v[104:107], v[72:75], v[176:179]
    v_mfma_f32_16x16x32_bf16 v[248:251], v[104:107], v[80:83], v[248:251]
    ds_read_b64_tr_b16 v[104:105], v9 offset:160
    ds_read_b64_tr_b16 v[106:107], v10 offset:160
    s_waitcnt lgkmcnt(10)
    v_mfma_f32_16x16x32_bf16 v[108:111], v[84:87], v[20:23], v[108:111]
    v_mfma_f32_16x16x32_bf16 v[180:183], v[84:87], v[28:31], v[180:183]
    ds_read_b64_tr_b16 v[84:85], v9 offset:192
    ds_read_b64_tr_b16 v[86:87], v10 offset:192
    s_waitcnt lgkmcnt(10)
    v_mfma_f32_16x16x32_bf16 v[112:115], v[88:91], v[20:23], v[112:115]
    v_mfma_f32_16x16x32_bf16 v[184:187], v[88:91], v[28:31], v[184:187]
    ds_read_b64_tr_b16 v[88:89], v9 offset:224
    ds_read_b64_tr_b16 v[90:91], v10 offset:224
    s_waitcnt lgkmcnt(10)
    v_mfma_f32_16x16x32_bf16 v[116:119], v[92:95], v[20:23], v[116:119]
    v_mfma_f32_16x16x32_bf16 v[188:191], v[92:95], v[28:31], v[188:191]
    ds_read_b64_tr_b16 v[92:93], v9 offset:256
    ds_read_b64_tr_b16 v[94:95], v10 offset:256
    s_waitcnt lgkmcnt(10)
    v_mfma_f32_16x16x32_bf16 v[120:123], v[96:99], v[20:23], v[120:123]
    v_mfma_f32_16x16x32_bf16 v[192:195], v[96:99], v[28:31], v[192:195]
    ds_read_b64_tr_b16 v[96:97], v9 offset:18432
    ds_read_b64_tr_b16 v[98:99], v10 offset:18432
    s_waitcnt lgkmcnt(10)
    v_mfma_f32_16x16x32_bf16 v[124:127], v[100:103], v[20:23], v[124:127]
    v_mfma_f32_16x16x32_bf16 v[196:199], v[100:103], v[28:31], v[196:199]
    ds_read_b64_tr_b16 v[100:101], v9 offset:18464
    ds_read_b64_tr_b16 v[102:103], v10 offset:18464
    s_waitcnt lgkmcnt(10)
    v_mfma_f32_16x16x32_bf16 v[128:131], v[104:107], v[20:23], v[128:131]
    v_mfma_f32_16x16x32_bf16 v[200:203], v[104:107], v[28:31], v[200:203]
    ds_read_b64_tr_b16 v[104:105], v9 offset:18496
    ds_read_b64_tr_b16 v[106:107], v10 offset:18496
    s_waitcnt lgkmcnt(10)
    v_mfma_f32_16x16x32_bf16 v[132:135], v[84:87], v[20:23], v[132:135]
    v_mfma_f32_16x16x32_bf16 v[204:207], v[84:87], v[28:31], v[204:207]
    ds_read_b64_tr_b16 v[84:85], v9 offset:18528
    ds_read_b64_tr_b16 v[86:87], v10 offset:18528
    s_waitcnt lgkmcnt(10)
    v_mfma_f32_16x16x32_bf16 v[136:139], v[88:91], v[20:23], v[136:139]
    v_mfma_f32_16x16x32_bf16 v[208:211], v[88:91], v[28:31], v[208:211]
    ds_read_b64_tr_b16 v[88:89], v9 offset:18560
    ds_read_b64_tr_b16 v[90:91], v10 offset:18560
    s_waitcnt lgkmcnt(10)
    v_mfma_f32_16x16x32_bf16 v[140:143], v[92:95], v[20:23], v[140:143]
    v_mfma_f32_16x16x32_bf16 v[212:215], v[92:95], v[28:31], v[212:215]
    ds_read_b64_tr_b16 v[92:93], v9 offset:18592
    ds_read_b64_tr_b16 v[94:95], v10 offset:18592
    s_waitcnt lgkmcnt(10)
    v_mfma_f32_16x16x32_bf16 v[144:147], v[96:99], v[20:23], v[144:147]
    v_mfma_f32_16x16x32_bf16 v[216:219], v[96:99], v[28:31], v[216:219]
    ds_read_b64_tr_b16 v[96:97], v9 offset:18624
    ds_read_b64_tr_b16 v[98:99], v10 offset:18624
    s_waitcnt lgkmcnt(10)
    v_mfma_f32_16x16x32_bf16 v[148:151], v[100:103], v[20:23], v[148:151]
    v_mfma_f32_16x16x32_bf16 v[220:223], v[100:103], v[28:31], v[220:223]
    ds_read_b64_tr_b16 v[100:101], v9 offset:18656
    ds_read_b64_tr_b16 v[102:103], v10 offset:18656
    s_waitcnt lgkmcnt(10)
    v_mfma_f32_16x16x32_bf16 v[152:155], v[104:107], v[20:23], v[152:155]
    v_mfma_f32_16x16x32_bf16 v[224:227], v[104:107], v[28:31], v[224:227]
    ds_read_b64_tr_b16 v[104:105], v9 offset:18688
    ds_read_b64_tr_b16 v[106:107], v10 offset:18688
    s_waitcnt lgkmcnt(10)
    v_mfma_f32_16x16x32_bf16 v[156:159], v[84:87], v[20:23], v[156:159]
    v_mfma_f32_16x16x32_bf16 v[228:231], v[84:87], v[28:31], v[228:231]
    ds_read_b64_tr_b16 v[84:85], v9 offset:2304
    ds_read_b64_tr_b16 v[86:87], v10 offset:2304
    s_waitcnt lgkmcnt(10)
    v_mfma_f32_16x16x32_bf16 v[160:163], v[88:91], v[20:23], v[160:163]
    v_mfma_f32_16x16x32_bf16 v[232:235], v[88:91], v[28:31], v[232:235]
    ds_read_b64_tr_b16 v[88:89], v9 offset:2336
    ds_read_b64_tr_b16 v[90:91], v10 offset:2336
    s_waitcnt lgkmcnt(10)
    v_mfma_f32_16x16x32_bf16 v[164:167], v[92:95], v[20:23], v[164:167]
    v_mfma_f32_16x16x32_bf16 v[236:239], v[92:95], v[28:31], v[236:239]
    ds_read_b64_tr_b16 v[92:93], v9 offset:2368
    ds_read_b64_tr_b16 v[94:95], v10 offset:2368
    s_waitcnt lgkmcnt(10)
    v_mfma_f32_16x16x32_bf16 v[168:171], v[96:99], v[20:23], v[168:171]
    v_mfma_f32_16x16x32_bf16 v[240:243], v[96:99], v[28:31], v[240:243]
    ds_read_b64_tr_b16 v[96:97], v9 offset:2400
    ds_read_b64_tr_b16 v[98:99], v10 offset:2400
    s_waitcnt lgkmcnt(10)
    v_mfma_f32_16x16x32_bf16 v[172:175], v[100:103], v[20:23], v[172:175]
    v_mfma_f32_16x16x32_bf16 v[244:247], v[100:103], v[28:31], v[244:247]
    ds_read_b64_tr_b16 v[100:101], v9 offset:2432
    ds_read_b64_tr_b16 v[102:103], v10 offset:2432
    s_waitcnt lgkmcnt(10)
    v_mfma_f32_16x16x32_bf16 v[176:179], v[104:107], v[20:23], v[176:179]
    v_mfma_f32_16x16x32_bf16 v[248:251], v[104:107], v[28:31], v[248:251]
    ds_read_b64_tr_b16 v[104:105], v9 offset:2464
    ds_read_b64_tr_b16 v[106:107], v10 offset:2464
    s_waitcnt lgkmcnt(10)
    v_mfma_f32_16x16x32_bf16 v[108:111], v[84:87], v[24:27], v[108:111]
    v_mfma_f32_16x16x32_bf16 v[180:183], v[84:87], v[32:35], v[180:183]
    ds_read_b64_tr_b16 v[84:85], v9 offset:2496
    ds_read_b64_tr_b16 v[86:87], v10 offset:2496
    s_waitcnt lgkmcnt(10)
    v_mfma_f32_16x16x32_bf16 v[112:115], v[88:91], v[24:27], v[112:115]
    v_mfma_f32_16x16x32_bf16 v[184:187], v[88:91], v[32:35], v[184:187]
    ds_read_b64_tr_b16 v[88:89], v9 offset:2528
    ds_read_b64_tr_b16 v[90:91], v10 offset:2528
    s_waitcnt lgkmcnt(10)
    v_mfma_f32_16x16x32_bf16 v[116:119], v[92:95], v[24:27], v[116:119]
    v_mfma_f32_16x16x32_bf16 v[188:191], v[92:95], v[32:35], v[188:191]
    ds_read_b64_tr_b16 v[92:93], v9 offset:2560
    ds_read_b64_tr_b16 v[94:95], v10 offset:2560
    s_waitcnt lgkmcnt(10)
    v_mfma_f32_16x16x32_bf16 v[120:123], v[96:99], v[24:27], v[120:123]
    v_mfma_f32_16x16x32_bf16 v[192:195], v[96:99], v[32:35], v[192:195]
    ds_read_b64_tr_b16 v[96:97], v9 offset:20736
    ds_read_b64_tr_b16 v[98:99], v10 offset:20736
    s_waitcnt lgkmcnt(10)
    v_mfma_f32_16x16x32_bf16 v[124:127], v[100:103], v[24:27], v[124:127]
    v_mfma_f32_16x16x32_bf16 v[196:199], v[100:103], v[32:35], v[196:199]
    ds_read_b64_tr_b16 v[100:101], v9 offset:20768
    ds_read_b64_tr_b16 v[102:103], v10 offset:20768
    s_waitcnt lgkmcnt(10)
    v_mfma_f32_16x16x32_bf16 v[128:131], v[104:107], v[24:27], v[128:131]
    v_mfma_f32_16x16x32_bf16 v[200:203], v[104:107], v[32:35], v[200:203]
    ds_read_b64_tr_b16 v[104:105], v9 offset:20800
    ds_read_b64_tr_b16 v[106:107], v10 offset:20800
    s_waitcnt lgkmcnt(10)
    v_mfma_f32_16x16x32_bf16 v[132:135], v[84:87], v[24:27], v[132:135]
    v_mfma_f32_16x16x32_bf16 v[204:207], v[84:87], v[32:35], v[204:207]
    ds_read_b64_tr_b16 v[84:85], v9 offset:20832
    ds_read_b64_tr_b16 v[86:87], v10 offset:20832
    s_waitcnt lgkmcnt(10)
    v_mfma_f32_16x16x32_bf16 v[136:139], v[88:91], v[24:27], v[136:139]
    v_mfma_f32_16x16x32_bf16 v[208:211], v[88:91], v[32:35], v[208:211]
    ds_read_b64_tr_b16 v[88:89], v9 offset:20864
    ds_read_b64_tr_b16 v[90:91], v10 offset:20864
    s_waitcnt lgkmcnt(10)
    v_mfma_f32_16x16x32_bf16 v[140:143], v[92:95], v[24:27], v[140:143]
    v_mfma_f32_16x16x32_bf16 v[212:215], v[92:95], v[32:35], v[212:215]
    ds_read_b64_tr_b16 v[92:93], v9 offset:20896
    ds_read_b64_tr_b16 v[94:95], v10 offset:20896
    s_waitcnt lgkmcnt(10)
    v_mfma_f32_16x16x32_bf16 v[144:147], v[96:99], v[24:27], v[144:147]
    v_mfma_f32_16x16x32_bf16 v[216:219], v[96:99], v[32:35], v[216:219]
    ds_read_b64_tr_b16 v[96:97], v9 offset:20928
    ds_read_b64_tr_b16 v[98:99], v10 offset:20928
    s_waitcnt lgkmcnt(10)
    v_mfma_f32_16x16x32_bf16 v[148:151], v[100:103], v[24:27], v[148:151]
    v_mfma_f32_16x16x32_bf16 v[220:223], v[100:103], v[32:35], v[220:223]
    ds_read_b64_tr_b16 v[100:101], v9 offset:20960
    ds_read_b64_tr_b16 v[102:103], v10 offset:20960
    s_waitcnt lgkmcnt(10)
    v_mfma_f32_16x16x32_bf16 v[152:155], v[104:107], v[24:27], v[152:155]
    v_mfma_f32_16x16x32_bf16 v[224:227], v[104:107], v[32:35], v[224:227]
    ds_read_b64_tr_b16 v[104:105], v9 offset:20992
    ds_read_b64_tr_b16 v[106:107], v10 offset:20992
    s_waitcnt lgkmcnt(10)
    v_mfma_f32_16x16x32_bf16 v[156:159], v[84:87], v[24:27], v[156:159]
    v_mfma_f32_16x16x32_bf16 v[228:231], v[84:87], v[32:35], v[228:231]
    s_waitcnt lgkmcnt(8)
    v_mfma_f32_16x16x32_bf16 v[160:163], v[88:91], v[24:27], v[160:163]
    v_mfma_f32_16x16x32_bf16 v[232:235], v[88:91], v[32:35], v[232:235]
    s_waitcnt lgkmcnt(6)
    v_mfma_f32_16x16x32_bf16 v[164:167], v[92:95], v[24:27], v[164:167]
    v_mfma_f32_16x16x32_bf16 v[236:239], v[92:95], v[32:35], v[236:239]
    s_waitcnt lgkmcnt(4)
    v_mfma_f32_16x16x32_bf16 v[168:171], v[96:99], v[24:27], v[168:171]
    v_mfma_f32_16x16x32_bf16 v[240:243], v[96:99], v[32:35], v[240:243]
    s_waitcnt lgkmcnt(2)
    v_mfma_f32_16x16x32_bf16 v[172:175], v[100:103], v[24:27], v[172:175]
    v_mfma_f32_16x16x32_bf16 v[244:247], v[100:103], v[32:35], v[244:247]
    s_waitcnt lgkmcnt(0)
    v_mfma_f32_16x16x32_bf16 v[176:179], v[104:107], v[24:27], v[176:179]
    v_mfma_f32_16x16x32_bf16 v[248:251], v[104:107], v[32:35], v[248:251]
    s_mul_i32 s37, s36, 147456
    s_mul_i32 s38, s30, 9
    s_and_b32 s39, s38, 1
    s_lshr_b32 s38, s38, 1
    s_lshl_b32 s38, s38, 10
    s_add_u32 s37, s37, s38
    v_lshlrev_b32 v17, 4, v1
    v_add_u32 v2, s37, v17
    v_add_u32 v3, 147456, v2
    s_mov_b32 s46, 0xbfb8aa3b
    s_mov_b32 s47, 0xbfb8aa3b
    s_mov_b32 s48, 1.0
    s_mov_b32 s49, 1.0
    s_movk_i32 s45, 4096
    s_cmp_eq_u32 s39, 0
    s_cbranch_scc0 L_g1_epi_odd
    v_cvt_pk_bf16_f32 v20, v108, v109
    v_cvt_pk_bf16_f32 v21, v110, v111
    v_cvt_pk_bf16_f32 v22, v144, v145
    v_cvt_pk_bf16_f32 v23, v146, v147
    v_lshlrev_b32 v108, 16, v20
    v_and_b32 v109, 0xffff0000, v20
    v_lshlrev_b32 v110, 16, v21
    v_and_b32 v111, 0xffff0000, v21
    v_pk_mul_f32 v[24:25], v[108:109], s[46:47]
    v_pk_mul_f32 v[26:27], v[110:111], s[46:47]
    v_lshlrev_b32 v144, 16, v22
    v_and_b32 v145, 0xffff0000, v22
    v_exp_f32 v24, v24
    v_exp_f32 v25, v25
    v_exp_f32 v26, v26
    v_exp_f32 v27, v27
    v_lshlrev_b32 v146, 16, v23
    v_and_b32 v147, 0xffff0000, v23
    v_pk_add_f32 v[24:25], v[24:25], s[48:49]
    v_pk_add_f32 v[26:27], v[26:27], s[48:49]
    v_rcp_f32 v24, v24
    v_rcp_f32 v25, v25
    v_rcp_f32 v26, v26
    v_rcp_f32 v27, v27
    s_nop 0
    v_pk_mul_f32 v[24:25], v[24:25], v[108:109]
    v_pk_mul_f32 v[26:27], v[26:27], v[110:111]
    v_cvt_pk_bf16_f32 v20, v24, v25
    v_cvt_pk_bf16_f32 v21, v26, v27
    v_lshlrev_b32 v24, 16, v20
    v_and_b32 v25, 0xffff0000, v20
    v_lshlrev_b32 v26, 16, v21
    v_and_b32 v27, 0xffff0000, v21
    v_pk_mul_f32 v[24:25], v[24:25], v[144:145]
    v_pk_mul_f32 v[26:27], v[26:27], v[146:147]
    v_cvt_pk_bf16_f32 v52, v24, v25
    v_cvt_pk_bf16_f32 v53, v26, v27
    v_cvt_pk_bf16_f32 v28, v112, v113
    v_cvt_pk_bf16_f32 v29, v114, v115
    v_cvt_pk_bf16_f32 v30, v148, v149
    v_cvt_pk_bf16_f32 v31, v150, v151
    v_lshlrev_b32 v112, 16, v28
    v_and_b32 v113, 0xffff0000, v28
    v_lshlrev_b32 v114, 16, v29
    v_and_b32 v115, 0xffff0000, v29
    v_pk_mul_f32 v[32:33], v[112:113], s[46:47]
    v_pk_mul_f32 v[34:35], v[114:115], s[46:47]
    v_lshlrev_b32 v148, 16, v30
    v_and_b32 v149, 0xffff0000, v30
    v_exp_f32 v32, v32
    v_exp_f32 v33, v33
    v_exp_f32 v34, v34
    v_exp_f32 v35, v35
    v_lshlrev_b32 v150, 16, v31
    v_and_b32 v151, 0xffff0000, v31
    v_pk_add_f32 v[32:33], v[32:33], s[48:49]
    v_pk_add_f32 v[34:35], v[34:35], s[48:49]
    v_rcp_f32 v32, v32
    v_rcp_f32 v33, v33
    v_rcp_f32 v34, v34
    v_rcp_f32 v35, v35
    s_nop 0
    v_pk_mul_f32 v[32:33], v[32:33], v[112:113]
    v_pk_mul_f32 v[34:35], v[34:35], v[114:115]
    v_cvt_pk_bf16_f32 v28, v32, v33
    v_cvt_pk_bf16_f32 v29, v34, v35
    v_lshlrev_b32 v32, 16, v28
    v_and_b32 v33, 0xffff0000, v28
    v_lshlrev_b32 v34, 16, v29
    v_and_b32 v35, 0xffff0000, v29
    v_pk_mul_f32 v[32:33], v[32:33], v[148:149]
    v_pk_mul_f32 v[34:35], v[34:35], v[150:151]
    v_cvt_pk_bf16_f32 v54, v32, v33
    v_cvt_pk_bf16_f32 v55, v34, v35
    buffer_store_dwordx4 v[52:55], v2, s[20:23], 0 offen offset:0
    v_cvt_pk_bf16_f32 v36, v116, v117
    v_cvt_pk_bf16_f32 v37, v118, v119
    v_cvt_pk_bf16_f32 v38, v152, v153
    v_cvt_pk_bf16_f32 v39, v154, v155
    v_lshlrev_b32 v116, 16, v36
    v_and_b32 v117, 0xffff0000, v36
    v_lshlrev_b32 v118, 16, v37
    v_and_b32 v119, 0xffff0000, v37
    v_pk_mul_f32 v[40:41], v[116:117], s[46:47]
    v_pk_mul_f32 v[42:43], v[118:119], s[46:47]
    v_lshlrev_b32 v152, 16, v38
    v_and_b32 v153, 0xffff0000, v38
    v_exp_f32 v40, v40
    v_exp_f32 v41, v41
    v_exp_f32 v42, v42
    v_exp_f32 v43, v43
    v_lshlrev_b32 v154, 16, v39
    v_and_b32 v155, 0xffff0000, v39
    v_pk_add_f32 v[40:41], v[40:41], s[48:49]
    v_pk_add_f32 v[42:43], v[42:43], s[48:49]
    v_rcp_f32 v40, v40
    v_rcp_f32 v41, v41
    v_rcp_f32 v42, v42
    v_rcp_f32 v43, v43
    s_nop 0
    v_pk_mul_f32 v[40:41], v[40:41], v[116:117]
    v_pk_mul_f32 v[42:43], v[42:43], v[118:119]
    v_cvt_pk_bf16_f32 v36, v40, v41
    v_cvt_pk_bf16_f32 v37, v42, v43
    v_lshlrev_b32 v40, 16, v36
    v_and_b32 v41, 0xffff0000, v36
    v_lshlrev_b32 v42, 16, v37
    v_and_b32 v43, 0xffff0000, v37
    v_pk_mul_f32 v[40:41], v[40:41], v[152:153]
    v_pk_mul_f32 v[42:43], v[42:43], v[154:155]
    v_cvt_pk_bf16_f32 v56, v40, v41
    v_cvt_pk_bf16_f32 v57, v42, v43
    v_cvt_pk_bf16_f32 v44, v120, v121
    v_cvt_pk_bf16_f32 v45, v122, v123
    v_cvt_pk_bf16_f32 v46, v156, v157
    v_cvt_pk_bf16_f32 v47, v158, v159
    v_lshlrev_b32 v120, 16, v44
    v_and_b32 v121, 0xffff0000, v44
    v_lshlrev_b32 v122, 16, v45
    v_and_b32 v123, 0xffff0000, v45
    v_pk_mul_f32 v[48:49], v[120:121], s[46:47]
    v_pk_mul_f32 v[50:51], v[122:123], s[46:47]
    v_lshlrev_b32 v156, 16, v46
    v_and_b32 v157, 0xffff0000, v46
    v_exp_f32 v48, v48
    v_exp_f32 v49, v49
    v_exp_f32 v50, v50
    v_exp_f32 v51, v51
    v_lshlrev_b32 v158, 16, v47
    v_and_b32 v159, 0xffff0000, v47
    v_pk_add_f32 v[48:49], v[48:49], s[48:49]
    v_pk_add_f32 v[50:51], v[50:51], s[48:49]
    v_rcp_f32 v48, v48
    v_rcp_f32 v49, v49
    v_rcp_f32 v50, v50
    v_rcp_f32 v51, v51
    s_nop 0
    v_pk_mul_f32 v[48:49], v[48:49], v[120:121]
    v_pk_mul_f32 v[50:51], v[50:51], v[122:123]
    v_cvt_pk_bf16_f32 v44, v48, v49
    v_cvt_pk_bf16_f32 v45, v50, v51
    v_lshlrev_b32 v48, 16, v44
    v_and_b32 v49, 0xffff0000, v44
    v_lshlrev_b32 v50, 16, v45
    v_and_b32 v51, 0xffff0000, v45
    v_pk_mul_f32 v[48:49], v[48:49], v[156:157]
    v_pk_mul_f32 v[50:51], v[50:51], v[158:159]
    v_cvt_pk_bf16_f32 v58, v48, v49
    v_cvt_pk_bf16_f32 v59, v50, v51
    buffer_store_dwordx4 v[56:59], v2, s[20:23], 0 offen offset:1024
    v_cvt_pk_bf16_f32 v20, v124, v125
    v_cvt_pk_bf16_f32 v21, v126, v127
    v_cvt_pk_bf16_f32 v22, v160, v161
    v_cvt_pk_bf16_f32 v23, v162, v163
    v_lshlrev_b32 v124, 16, v20
    v_and_b32 v125, 0xffff0000, v20
    v_lshlrev_b32 v126, 16, v21
    v_and_b32 v127, 0xffff0000, v21
    v_pk_mul_f32 v[24:25], v[124:125], s[46:47]
    v_pk_mul_f32 v[26:27], v[126:127], s[46:47]
    v_lshlrev_b32 v160, 16, v22
    v_and_b32 v161, 0xffff0000, v22
    v_exp_f32 v24, v24
    v_exp_f32 v25, v25
    v_exp_f32 v26, v26
    v_exp_f32 v27, v27
    v_lshlrev_b32 v162, 16, v23
    v_and_b32 v163, 0xffff0000, v23
    v_pk_add_f32 v[24:25], v[24:25], s[48:49]
    v_pk_add_f32 v[26:27], v[26:27], s[48:49]
    v_rcp_f32 v24, v24
    v_rcp_f32 v25, v25
    v_rcp_f32 v26, v26
    v_rcp_f32 v27, v27
    s_nop 0
    v_pk_mul_f32 v[24:25], v[24:25], v[124:125]
    v_pk_mul_f32 v[26:27], v[26:27], v[126:127]
    v_cvt_pk_bf16_f32 v20, v24, v25
    v_cvt_pk_bf16_f32 v21, v26, v27
    v_lshlrev_b32 v24, 16, v20
    v_and_b32 v25, 0xffff0000, v20
    v_lshlrev_b32 v26, 16, v21
    v_and_b32 v27, 0xffff0000, v21
    v_pk_mul_f32 v[24:25], v[24:25], v[160:161]
    v_pk_mul_f32 v[26:27], v[26:27], v[162:163]
    v_cvt_pk_bf16_f32 v60, v24, v25
    v_cvt_pk_bf16_f32 v61, v26, v27
    v_cvt_pk_bf16_f32 v28, v128, v129
    v_cvt_pk_bf16_f32 v29, v130, v131
    v_cvt_pk_bf16_f32 v30, v164, v165
    v_cvt_pk_bf16_f32 v31, v166, v167
    v_lshlrev_b32 v128, 16, v28
    v_and_b32 v129, 0xffff0000, v28
    v_lshlrev_b32 v130, 16, v29
    v_and_b32 v131, 0xffff0000, v29
    v_pk_mul_f32 v[32:33], v[128:129], s[46:47]
    v_pk_mul_f32 v[34:35], v[130:131], s[46:47]
    v_lshlrev_b32 v164, 16, v30
    v_and_b32 v165, 0xffff0000, v30
    v_exp_f32 v32, v32
    v_exp_f32 v33, v33
    v_exp_f32 v34, v34
    v_exp_f32 v35, v35
    v_lshlrev_b32 v166, 16, v31
    v_and_b32 v167, 0xffff0000, v31
    v_pk_add_f32 v[32:33], v[32:33], s[48:49]
    v_pk_add_f32 v[34:35], v[34:35], s[48:49]
    v_rcp_f32 v32, v32
    v_rcp_f32 v33, v33
    v_rcp_f32 v34, v34
    v_rcp_f32 v35, v35
    s_nop 0
    v_pk_mul_f32 v[32:33], v[32:33], v[128:129]
    v_pk_mul_f32 v[34:35], v[34:35], v[130:131]
    v_cvt_pk_bf16_f32 v28, v32, v33
    v_cvt_pk_bf16_f32 v29, v34, v35
    v_lshlrev_b32 v32, 16, v28
    v_and_b32 v33, 0xffff0000, v28
    v_lshlrev_b32 v34, 16, v29
    v_and_b32 v35, 0xffff0000, v29
    v_pk_mul_f32 v[32:33], v[32:33], v[164:165]
    v_pk_mul_f32 v[34:35], v[34:35], v[166:167]
    v_cvt_pk_bf16_f32 v62, v32, v33
    v_cvt_pk_bf16_f32 v63, v34, v35
    buffer_store_dwordx4 v[60:63], v2, s[20:23], 0 offen offset:2048
    v_cvt_pk_bf16_f32 v36, v132, v133
    v_cvt_pk_bf16_f32 v37, v134, v135
    v_cvt_pk_bf16_f32 v38, v168, v169
    v_cvt_pk_bf16_f32 v39, v170, v171
    v_lshlrev_b32 v132, 16, v36
    v_and_b32 v133, 0xffff0000, v36
    v_lshlrev_b32 v134, 16, v37
    v_and_b32 v135, 0xffff0000, v37
    v_pk_mul_f32 v[40:41], v[132:133], s[46:47]
    v_pk_mul_f32 v[42:43], v[134:135], s[46:47]
    v_lshlrev_b32 v168, 16, v38
    v_and_b32 v169, 0xffff0000, v38
    v_exp_f32 v40, v40
    v_exp_f32 v41, v41
    v_exp_f32 v42, v42
    v_exp_f32 v43, v43
    v_lshlrev_b32 v170, 16, v39
    v_and_b32 v171, 0xffff0000, v39
    v_pk_add_f32 v[40:41], v[40:41], s[48:49]
    v_pk_add_f32 v[42:43], v[42:43], s[48:49]
    v_rcp_f32 v40, v40
    v_rcp_f32 v41, v41
    v_rcp_f32 v42, v42
    v_rcp_f32 v43, v43
    s_nop 0
    v_pk_mul_f32 v[40:41], v[40:41], v[132:133]
    v_pk_mul_f32 v[42:43], v[42:43], v[134:135]
    v_cvt_pk_bf16_f32 v36, v40, v41
    v_cvt_pk_bf16_f32 v37, v42, v43
    v_lshlrev_b32 v40, 16, v36
    v_and_b32 v41, 0xffff0000, v36
    v_lshlrev_b32 v42, 16, v37
    v_and_b32 v43, 0xffff0000, v37
    v_pk_mul_f32 v[40:41], v[40:41], v[168:169]
    v_pk_mul_f32 v[42:43], v[42:43], v[170:171]
    v_cvt_pk_bf16_f32 v64, v40, v41
    v_cvt_pk_bf16_f32 v65, v42, v43
    v_cvt_pk_bf16_f32 v44, v136, v137
    v_cvt_pk_bf16_f32 v45, v138, v139
    v_cvt_pk_bf16_f32 v46, v172, v173
    v_cvt_pk_bf16_f32 v47, v174, v175
    v_lshlrev_b32 v136, 16, v44
    v_and_b32 v137, 0xffff0000, v44
    v_lshlrev_b32 v138, 16, v45
    v_and_b32 v139, 0xffff0000, v45
    v_pk_mul_f32 v[48:49], v[136:137], s[46:47]
    v_pk_mul_f32 v[50:51], v[138:139], s[46:47]
    v_lshlrev_b32 v172, 16, v46
    v_and_b32 v173, 0xffff0000, v46
    v_exp_f32 v48, v48
    v_exp_f32 v49, v49
    v_exp_f32 v50, v50
    v_exp_f32 v51, v51
    v_lshlrev_b32 v174, 16, v47
    v_and_b32 v175, 0xffff0000, v47
    v_pk_add_f32 v[48:49], v[48:49], s[48:49]
    v_pk_add_f32 v[50:51], v[50:51], s[48:49]
    v_rcp_f32 v48, v48
    v_rcp_f32 v49, v49
    v_rcp_f32 v50, v50
    v_rcp_f32 v51, v51
    s_nop 0
    v_pk_mul_f32 v[48:49], v[48:49], v[136:137]
    v_pk_mul_f32 v[50:51], v[50:51], v[138:139]
    v_cvt_pk_bf16_f32 v44, v48, v49
    v_cvt_pk_bf16_f32 v45, v50, v51
    v_lshlrev_b32 v48, 16, v44
    v_and_b32 v49, 0xffff0000, v44
    v_lshlrev_b32 v50, 16, v45
    v_and_b32 v51, 0xffff0000, v45
    v_pk_mul_f32 v[48:49], v[48:49], v[172:173]
    v_pk_mul_f32 v[50:51], v[50:51], v[174:175]
    v_cvt_pk_bf16_f32 v66, v48, v49
    v_cvt_pk_bf16_f32 v67, v50, v51
    buffer_store_dwordx4 v[64:67], v2, s[20:23], 0 offen offset:3072
    v_cvt_pk_bf16_f32 v20, v140, v141
    v_cvt_pk_bf16_f32 v21, v142, v143
    v_cvt_pk_bf16_f32 v22, v176, v177
    v_cvt_pk_bf16_f32 v23, v178, v179
    v_lshlrev_b32 v140, 16, v20
    v_and_b32 v141, 0xffff0000, v20
    v_lshlrev_b32 v142, 16, v21
    v_and_b32 v143, 0xffff0000, v21
    v_pk_mul_f32 v[24:25], v[140:141], s[46:47]
    v_pk_mul_f32 v[26:27], v[142:143], s[46:47]
    v_lshlrev_b32 v176, 16, v22
    v_and_b32 v177, 0xffff0000, v22
    v_exp_f32 v24, v24
    v_exp_f32 v25, v25
    v_exp_f32 v26, v26
    v_exp_f32 v27, v27
    v_lshlrev_b32 v178, 16, v23
    v_and_b32 v179, 0xffff0000, v23
    v_pk_add_f32 v[24:25], v[24:25], s[48:49]
    v_pk_add_f32 v[26:27], v[26:27], s[48:49]
    v_rcp_f32 v24, v24
    v_rcp_f32 v25, v25
    v_rcp_f32 v26, v26
    v_rcp_f32 v27, v27
    s_nop 0
    v_pk_mul_f32 v[24:25], v[24:25], v[140:141]
    v_pk_mul_f32 v[26:27], v[26:27], v[142:143]
    v_cvt_pk_bf16_f32 v20, v24, v25
    v_cvt_pk_bf16_f32 v21, v26, v27
    v_lshlrev_b32 v24, 16, v20
    v_and_b32 v25, 0xffff0000, v20
    v_lshlrev_b32 v26, 16, v21
    v_and_b32 v27, 0xffff0000, v21
    v_pk_mul_f32 v[24:25], v[24:25], v[176:177]
    v_pk_mul_f32 v[26:27], v[26:27], v[178:179]
    v_cvt_pk_bf16_f32 v52, v24, v25
    v_cvt_pk_bf16_f32 v53, v26, v27
    buffer_store_dwordx2 v[52:53], v2, s[20:23], s45 offen offset:0
    v_cvt_pk_bf16_f32 v28, v180, v181
    v_cvt_pk_bf16_f32 v29, v182, v183
    v_cvt_pk_bf16_f32 v30, v216, v217
    v_cvt_pk_bf16_f32 v31, v218, v219
    v_lshlrev_b32 v180, 16, v28
    v_and_b32 v181, 0xffff0000, v28
    v_lshlrev_b32 v182, 16, v29
    v_and_b32 v183, 0xffff0000, v29
    v_pk_mul_f32 v[32:33], v[180:181], s[46:47]
    v_pk_mul_f32 v[34:35], v[182:183], s[46:47]
    v_lshlrev_b32 v216, 16, v30
    v_and_b32 v217, 0xffff0000, v30
    v_exp_f32 v32, v32
    v_exp_f32 v33, v33
    v_exp_f32 v34, v34
    v_exp_f32 v35, v35
    v_lshlrev_b32 v218, 16, v31
    v_and_b32 v219, 0xffff0000, v31
    v_pk_add_f32 v[32:33], v[32:33], s[48:49]
    v_pk_add_f32 v[34:35], v[34:35], s[48:49]
    v_rcp_f32 v32, v32
    v_rcp_f32 v33, v33
    v_rcp_f32 v34, v34
    v_rcp_f32 v35, v35
    s_nop 0
    v_pk_mul_f32 v[32:33], v[32:33], v[180:181]
    v_pk_mul_f32 v[34:35], v[34:35], v[182:183]
    v_cvt_pk_bf16_f32 v28, v32, v33
    v_cvt_pk_bf16_f32 v29, v34, v35
    v_lshlrev_b32 v32, 16, v28
    v_and_b32 v33, 0xffff0000, v28
    v_lshlrev_b32 v34, 16, v29
    v_and_b32 v35, 0xffff0000, v29
    v_pk_mul_f32 v[32:33], v[32:33], v[216:217]
    v_pk_mul_f32 v[34:35], v[34:35], v[218:219]
    v_cvt_pk_bf16_f32 v56, v32, v33
    v_cvt_pk_bf16_f32 v57, v34, v35
    v_cvt_pk_bf16_f32 v36, v184, v185
    v_cvt_pk_bf16_f32 v37, v186, v187
    v_cvt_pk_bf16_f32 v38, v220, v221
    v_cvt_pk_bf16_f32 v39, v222, v223
    v_lshlrev_b32 v184, 16, v36
    v_and_b32 v185, 0xffff0000, v36
    v_lshlrev_b32 v186, 16, v37
    v_and_b32 v187, 0xffff0000, v37
    v_pk_mul_f32 v[40:41], v[184:185], s[46:47]
    v_pk_mul_f32 v[42:43], v[186:187], s[46:47]
    v_lshlrev_b32 v220, 16, v38
    v_and_b32 v221, 0xffff0000, v38
    v_exp_f32 v40, v40
    v_exp_f32 v41, v41
    v_exp_f32 v42, v42
    v_exp_f32 v43, v43
    v_lshlrev_b32 v222, 16, v39
    v_and_b32 v223, 0xffff0000, v39
    v_pk_add_f32 v[40:41], v[40:41], s[48:49]
    v_pk_add_f32 v[42:43], v[42:43], s[48:49]
    v_rcp_f32 v40, v40
    v_rcp_f32 v41, v41
    v_rcp_f32 v42, v42
    v_rcp_f32 v43, v43
    s_nop 0
    v_pk_mul_f32 v[40:41], v[40:41], v[184:185]
    v_pk_mul_f32 v[42:43], v[42:43], v[186:187]
    v_cvt_pk_bf16_f32 v36, v40, v41
    v_cvt_pk_bf16_f32 v37, v42, v43
    v_lshlrev_b32 v40, 16, v36
    v_and_b32 v41, 0xffff0000, v36
    v_lshlrev_b32 v42, 16, v37
    v_and_b32 v43, 0xffff0000, v37
    v_pk_mul_f32 v[40:41], v[40:41], v[220:221]
    v_pk_mul_f32 v[42:43], v[42:43], v[222:223]
    v_cvt_pk_bf16_f32 v58, v40, v41
    v_cvt_pk_bf16_f32 v59, v42, v43
    buffer_store_dwordx4 v[56:59], v3, s[20:23], 0 offen offset:0
    v_cvt_pk_bf16_f32 v44, v188, v189
    v_cvt_pk_bf16_f32 v45, v190, v191
    v_cvt_pk_bf16_f32 v46, v224, v225
    v_cvt_pk_bf16_f32 v47, v226, v227
    v_lshlrev_b32 v188, 16, v44
    v_and_b32 v189, 0xffff0000, v44
    v_lshlrev_b32 v190, 16, v45
    v_and_b32 v191, 0xffff0000, v45
    v_pk_mul_f32 v[48:49], v[188:189], s[46:47]
    v_pk_mul_f32 v[50:51], v[190:191], s[46:47]
    v_lshlrev_b32 v224, 16, v46
    v_and_b32 v225, 0xffff0000, v46
    v_exp_f32 v48, v48
    v_exp_f32 v49, v49
    v_exp_f32 v50, v50
    v_exp_f32 v51, v51
    v_lshlrev_b32 v226, 16, v47
    v_and_b32 v227, 0xffff0000, v47
    v_pk_add_f32 v[48:49], v[48:49], s[48:49]
    v_pk_add_f32 v[50:51], v[50:51], s[48:49]
    v_rcp_f32 v48, v48
    v_rcp_f32 v49, v49
    v_rcp_f32 v50, v50
    v_rcp_f32 v51, v51
    s_nop 0
    v_pk_mul_f32 v[48:49], v[48:49], v[188:189]
    v_pk_mul_f32 v[50:51], v[50:51], v[190:191]
    v_cvt_pk_bf16_f32 v44, v48, v49
    v_cvt_pk_bf16_f32 v45, v50, v51
    v_lshlrev_b32 v48, 16, v44
    v_and_b32 v49, 0xffff0000, v44
    v_lshlrev_b32 v50, 16, v45
    v_and_b32 v51, 0xffff0000, v45
    v_pk_mul_f32 v[48:49], v[48:49], v[224:225]
    v_pk_mul_f32 v[50:51], v[50:51], v[226:227]
    v_cvt_pk_bf16_f32 v60, v48, v49
    v_cvt_pk_bf16_f32 v61, v50, v51
    v_cvt_pk_bf16_f32 v20, v192, v193
    v_cvt_pk_bf16_f32 v21, v194, v195
    v_cvt_pk_bf16_f32 v22, v228, v229
    v_cvt_pk_bf16_f32 v23, v230, v231
    v_lshlrev_b32 v192, 16, v20
    v_and_b32 v193, 0xffff0000, v20
    v_lshlrev_b32 v194, 16, v21
    v_and_b32 v195, 0xffff0000, v21
    v_pk_mul_f32 v[24:25], v[192:193], s[46:47]
    v_pk_mul_f32 v[26:27], v[194:195], s[46:47]
    v_lshlrev_b32 v228, 16, v22
    v_and_b32 v229, 0xffff0000, v22
    v_exp_f32 v24, v24
    v_exp_f32 v25, v25
    v_exp_f32 v26, v26
    v_exp_f32 v27, v27
    v_lshlrev_b32 v230, 16, v23
    v_and_b32 v231, 0xffff0000, v23
    v_pk_add_f32 v[24:25], v[24:25], s[48:49]
    v_pk_add_f32 v[26:27], v[26:27], s[48:49]
    v_rcp_f32 v24, v24
    v_rcp_f32 v25, v25
    v_rcp_f32 v26, v26
    v_rcp_f32 v27, v27
    s_nop 0
    v_pk_mul_f32 v[24:25], v[24:25], v[192:193]
    v_pk_mul_f32 v[26:27], v[26:27], v[194:195]
    v_cvt_pk_bf16_f32 v20, v24, v25
    v_cvt_pk_bf16_f32 v21, v26, v27
    v_lshlrev_b32 v24, 16, v20
    v_and_b32 v25, 0xffff0000, v20
    v_lshlrev_b32 v26, 16, v21
    v_and_b32 v27, 0xffff0000, v21
    v_pk_mul_f32 v[24:25], v[24:25], v[228:229]
    v_pk_mul_f32 v[26:27], v[26:27], v[230:231]
    v_cvt_pk_bf16_f32 v62, v24, v25
    v_cvt_pk_bf16_f32 v63, v26, v27
    buffer_store_dwordx4 v[60:63], v3, s[20:23], 0 offen offset:1024
    v_cvt_pk_bf16_f32 v28, v196, v197
    v_cvt_pk_bf16_f32 v29, v198, v199
    v_cvt_pk_bf16_f32 v30, v232, v233
    v_cvt_pk_bf16_f32 v31, v234, v235
    v_lshlrev_b32 v196, 16, v28
    v_and_b32 v197, 0xffff0000, v28
    v_lshlrev_b32 v198, 16, v29
    v_and_b32 v199, 0xffff0000, v29
    v_pk_mul_f32 v[32:33], v[196:197], s[46:47]
    v_pk_mul_f32 v[34:35], v[198:199], s[46:47]
    v_lshlrev_b32 v232, 16, v30
    v_and_b32 v233, 0xffff0000, v30
    v_exp_f32 v32, v32
    v_exp_f32 v33, v33
    v_exp_f32 v34, v34
    v_exp_f32 v35, v35
    v_lshlrev_b32 v234, 16, v31
    v_and_b32 v235, 0xffff0000, v31
    v_pk_add_f32 v[32:33], v[32:33], s[48:49]
    v_pk_add_f32 v[34:35], v[34:35], s[48:49]
    v_rcp_f32 v32, v32
    v_rcp_f32 v33, v33
    v_rcp_f32 v34, v34
    v_rcp_f32 v35, v35
    s_nop 0
    v_pk_mul_f32 v[32:33], v[32:33], v[196:197]
    v_pk_mul_f32 v[34:35], v[34:35], v[198:199]
    v_cvt_pk_bf16_f32 v28, v32, v33
    v_cvt_pk_bf16_f32 v29, v34, v35
    v_lshlrev_b32 v32, 16, v28
    v_and_b32 v33, 0xffff0000, v28
    v_lshlrev_b32 v34, 16, v29
    v_and_b32 v35, 0xffff0000, v29
    v_pk_mul_f32 v[32:33], v[32:33], v[232:233]
    v_pk_mul_f32 v[34:35], v[34:35], v[234:235]
    v_cvt_pk_bf16_f32 v64, v32, v33
    v_cvt_pk_bf16_f32 v65, v34, v35
    v_cvt_pk_bf16_f32 v36, v200, v201
    v_cvt_pk_bf16_f32 v37, v202, v203
    v_cvt_pk_bf16_f32 v38, v236, v237
    v_cvt_pk_bf16_f32 v39, v238, v239
    v_lshlrev_b32 v200, 16, v36
    v_and_b32 v201, 0xffff0000, v36
    v_lshlrev_b32 v202, 16, v37
    v_and_b32 v203, 0xffff0000, v37
    v_pk_mul_f32 v[40:41], v[200:201], s[46:47]
    v_pk_mul_f32 v[42:43], v[202:203], s[46:47]
    v_lshlrev_b32 v236, 16, v38
    v_and_b32 v237, 0xffff0000, v38
    v_exp_f32 v40, v40
    v_exp_f32 v41, v41
    v_exp_f32 v42, v42
    v_exp_f32 v43, v43
    v_lshlrev_b32 v238, 16, v39
    v_and_b32 v239, 0xffff0000, v39
    v_pk_add_f32 v[40:41], v[40:41], s[48:49]
    v_pk_add_f32 v[42:43], v[42:43], s[48:49]
    v_rcp_f32 v40, v40
    v_rcp_f32 v41, v41
    v_rcp_f32 v42, v42
    v_rcp_f32 v43, v43
    s_nop 0
    v_pk_mul_f32 v[40:41], v[40:41], v[200:201]
    v_pk_mul_f32 v[42:43], v[42:43], v[202:203]
    v_cvt_pk_bf16_f32 v36, v40, v41
    v_cvt_pk_bf16_f32 v37, v42, v43
    v_lshlrev_b32 v40, 16, v36
    v_and_b32 v41, 0xffff0000, v36
    v_lshlrev_b32 v42, 16, v37
    v_and_b32 v43, 0xffff0000, v37
    v_pk_mul_f32 v[40:41], v[40:41], v[236:237]
    v_pk_mul_f32 v[42:43], v[42:43], v[238:239]
    v_cvt_pk_bf16_f32 v66, v40, v41
    v_cvt_pk_bf16_f32 v67, v42, v43
    buffer_store_dwordx4 v[64:67], v3, s[20:23], 0 offen offset:2048
    v_cvt_pk_bf16_f32 v44, v204, v205
    v_cvt_pk_bf16_f32 v45, v206, v207
    v_cvt_pk_bf16_f32 v46, v240, v241
    v_cvt_pk_bf16_f32 v47, v242, v243
    v_lshlrev_b32 v204, 16, v44
    v_and_b32 v205, 0xffff0000, v44
    v_lshlrev_b32 v206, 16, v45
    v_and_b32 v207, 0xffff0000, v45
    v_pk_mul_f32 v[48:49], v[204:205], s[46:47]
    v_pk_mul_f32 v[50:51], v[206:207], s[46:47]
    v_lshlrev_b32 v240, 16, v46
    v_and_b32 v241, 0xffff0000, v46
    v_exp_f32 v48, v48
    v_exp_f32 v49, v49
    v_exp_f32 v50, v50
    v_exp_f32 v51, v51
    v_lshlrev_b32 v242, 16, v47
    v_and_b32 v243, 0xffff0000, v47
    v_pk_add_f32 v[48:49], v[48:49], s[48:49]
    v_pk_add_f32 v[50:51], v[50:51], s[48:49]
    v_rcp_f32 v48, v48
    v_rcp_f32 v49, v49
    v_rcp_f32 v50, v50
    v_rcp_f32 v51, v51
    s_nop 0
    v_pk_mul_f32 v[48:49], v[48:49], v[204:205]
    v_pk_mul_f32 v[50:51], v[50:51], v[206:207]
    v_cvt_pk_bf16_f32 v44, v48, v49
    v_cvt_pk_bf16_f32 v45, v50, v51
    v_lshlrev_b32 v48, 16, v44
    v_and_b32 v49, 0xffff0000, v44
    v_lshlrev_b32 v50, 16, v45
    v_and_b32 v51, 0xffff0000, v45
    v_pk_mul_f32 v[48:49], v[48:49], v[240:241]
    v_pk_mul_f32 v[50:51], v[50:51], v[242:243]
    v_cvt_pk_bf16_f32 v52, v48, v49
    v_cvt_pk_bf16_f32 v53, v50, v51
    v_cvt_pk_bf16_f32 v20, v208, v209
    v_cvt_pk_bf16_f32 v21, v210, v211
    v_cvt_pk_bf16_f32 v22, v244, v245
    v_cvt_pk_bf16_f32 v23, v246, v247
    v_lshlrev_b32 v208, 16, v20
    v_and_b32 v209, 0xffff0000, v20
    v_lshlrev_b32 v210, 16, v21
    v_and_b32 v211, 0xffff0000, v21
    v_pk_mul_f32 v[24:25], v[208:209], s[46:47]
    v_pk_mul_f32 v[26:27], v[210:211], s[46:47]
    v_lshlrev_b32 v244, 16, v22
    v_and_b32 v245, 0xffff0000, v22
    v_exp_f32 v24, v24
    v_exp_f32 v25, v25
    v_exp_f32 v26, v26
    v_exp_f32 v27, v27
    v_lshlrev_b32 v246, 16, v23
    v_and_b32 v247, 0xffff0000, v23
    v_pk_add_f32 v[24:25], v[24:25], s[48:49]
    v_pk_add_f32 v[26:27], v[26:27], s[48:49]
    v_rcp_f32 v24, v24
    v_rcp_f32 v25, v25
    v_rcp_f32 v26, v26
    v_rcp_f32 v27, v27
    s_nop 0
    v_pk_mul_f32 v[24:25], v[24:25], v[208:209]
    v_pk_mul_f32 v[26:27], v[26:27], v[210:211]
    v_cvt_pk_bf16_f32 v20, v24, v25
    v_cvt_pk_bf16_f32 v21, v26, v27
    v_lshlrev_b32 v24, 16, v20
    v_and_b32 v25, 0xffff0000, v20
    v_lshlrev_b32 v26, 16, v21
    v_and_b32 v27, 0xffff0000, v21
    v_pk_mul_f32 v[24:25], v[24:25], v[244:245]
    v_pk_mul_f32 v[26:27], v[26:27], v[246:247]
    v_cvt_pk_bf16_f32 v54, v24, v25
    v_cvt_pk_bf16_f32 v55, v26, v27
    buffer_store_dwordx4 v[52:55], v3, s[20:23], 0 offen offset:3072
    v_cvt_pk_bf16_f32 v28, v212, v213
    v_cvt_pk_bf16_f32 v29, v214, v215
    v_cvt_pk_bf16_f32 v30, v248, v249
    v_cvt_pk_bf16_f32 v31, v250, v251
    v_lshlrev_b32 v212, 16, v28
    v_and_b32 v213, 0xffff0000, v28
    v_lshlrev_b32 v214, 16, v29
    v_and_b32 v215, 0xffff0000, v29
    v_pk_mul_f32 v[32:33], v[212:213], s[46:47]
    v_pk_mul_f32 v[34:35], v[214:215], s[46:47]
    v_lshlrev_b32 v248, 16, v30
    v_and_b32 v249, 0xffff0000, v30
    v_exp_f32 v32, v32
    v_exp_f32 v33, v33
    v_exp_f32 v34, v34
    v_exp_f32 v35, v35
    v_lshlrev_b32 v250, 16, v31
    v_and_b32 v251, 0xffff0000, v31
    v_pk_add_f32 v[32:33], v[32:33], s[48:49]
    v_pk_add_f32 v[34:35], v[34:35], s[48:49]
    v_rcp_f32 v32, v32
    v_rcp_f32 v33, v33
    v_rcp_f32 v34, v34
    v_rcp_f32 v35, v35
    s_nop 0
    v_pk_mul_f32 v[32:33], v[32:33], v[212:213]
    v_pk_mul_f32 v[34:35], v[34:35], v[214:215]
    v_cvt_pk_bf16_f32 v28, v32, v33
    v_cvt_pk_bf16_f32 v29, v34, v35
    v_lshlrev_b32 v32, 16, v28
    v_and_b32 v33, 0xffff0000, v28
    v_lshlrev_b32 v34, 16, v29
    v_and_b32 v35, 0xffff0000, v29
    v_pk_mul_f32 v[32:33], v[32:33], v[248:249]
    v_pk_mul_f32 v[34:35], v[34:35], v[250:251]
    v_cvt_pk_bf16_f32 v56, v32, v33
    v_cvt_pk_bf16_f32 v57, v34, v35
    buffer_store_dwordx2 v[56:57], v3, s[20:23], s45 offen offset:0
    s_branch L_g1_epi_done
L_g1_epi_odd:
    v_cvt_pk_bf16_f32 v20, v108, v109
    v_cvt_pk_bf16_f32 v21, v110, v111
    v_cvt_pk_bf16_f32 v22, v144, v145
    v_cvt_pk_bf16_f32 v23, v146, v147
    v_lshlrev_b32 v108, 16, v20
    v_and_b32 v109, 0xffff0000, v20
    v_lshlrev_b32 v110, 16, v21
    v_and_b32 v111, 0xffff0000, v21
    v_pk_mul_f32 v[24:25], v[108:109], s[46:47]
    v_pk_mul_f32 v[26:27], v[110:111], s[46:47]
    v_lshlrev_b32 v144, 16, v22
    v_and_b32 v145, 0xffff0000, v22
    v_exp_f32 v24, v24
    v_exp_f32 v25, v25
    v_exp_f32 v26, v26
    v_exp_f32 v27, v27
    v_lshlrev_b32 v146, 16, v23
    v_and_b32 v147, 0xffff0000, v23
    v_pk_add_f32 v[24:25], v[24:25], s[48:49]
    v_pk_add_f32 v[26:27], v[26:27], s[48:49]
    v_rcp_f32 v24, v24
    v_rcp_f32 v25, v25
    v_rcp_f32 v26, v26
    v_rcp_f32 v27, v27
    s_nop 0
    v_pk_mul_f32 v[24:25], v[24:25], v[108:109]
    v_pk_mul_f32 v[26:27], v[26:27], v[110:111]
    v_cvt_pk_bf16_f32 v20, v24, v25
    v_cvt_pk_bf16_f32 v21, v26, v27
    v_lshlrev_b32 v24, 16, v20
    v_and_b32 v25, 0xffff0000, v20
    v_lshlrev_b32 v26, 16, v21
    v_and_b32 v27, 0xffff0000, v21
    v_pk_mul_f32 v[24:25], v[24:25], v[144:145]
    v_pk_mul_f32 v[26:27], v[26:27], v[146:147]
    v_cvt_pk_bf16_f32 v54, v24, v25
    v_cvt_pk_bf16_f32 v55, v26, v27
    buffer_store_dwordx2 v[54:55], v2, s[20:23], 0 offen offset:8
    v_cvt_pk_bf16_f32 v28, v112, v113
    v_cvt_pk_bf16_f32 v29, v114, v115
    v_cvt_pk_bf16_f32 v30, v148, v149
    v_cvt_pk_bf16_f32 v31, v150, v151
    v_lshlrev_b32 v112, 16, v28
    v_and_b32 v113, 0xffff0000, v28
    v_lshlrev_b32 v114, 16, v29
    v_and_b32 v115, 0xffff0000, v29
    v_pk_mul_f32 v[32:33], v[112:113], s[46:47]
    v_pk_mul_f32 v[34:35], v[114:115], s[46:47]
    v_lshlrev_b32 v148, 16, v30
    v_and_b32 v149, 0xffff0000, v30
    v_exp_f32 v32, v32
    v_exp_f32 v33, v33
    v_exp_f32 v34, v34
    v_exp_f32 v35, v35
    v_lshlrev_b32 v150, 16, v31
    v_and_b32 v151, 0xffff0000, v31
    v_pk_add_f32 v[32:33], v[32:33], s[48:49]
    v_pk_add_f32 v[34:35], v[34:35], s[48:49]
    v_rcp_f32 v32, v32
    v_rcp_f32 v33, v33
    v_rcp_f32 v34, v34
    v_rcp_f32 v35, v35
    s_nop 0
    v_pk_mul_f32 v[32:33], v[32:33], v[112:113]
    v_pk_mul_f32 v[34:35], v[34:35], v[114:115]
    v_cvt_pk_bf16_f32 v28, v32, v33
    v_cvt_pk_bf16_f32 v29, v34, v35
    v_lshlrev_b32 v32, 16, v28
    v_and_b32 v33, 0xffff0000, v28
    v_lshlrev_b32 v34, 16, v29
    v_and_b32 v35, 0xffff0000, v29
    v_pk_mul_f32 v[32:33], v[32:33], v[148:149]
    v_pk_mul_f32 v[34:35], v[34:35], v[150:151]
    v_cvt_pk_bf16_f32 v56, v32, v33
    v_cvt_pk_bf16_f32 v57, v34, v35
    v_cvt_pk_bf16_f32 v36, v116, v117
    v_cvt_pk_bf16_f32 v37, v118, v119
    v_cvt_pk_bf16_f32 v38, v152, v153
    v_cvt_pk_bf16_f32 v39, v154, v155
    v_lshlrev_b32 v116, 16, v36
    v_and_b32 v117, 0xffff0000, v36
    v_lshlrev_b32 v118, 16, v37
    v_and_b32 v119, 0xffff0000, v37
    v_pk_mul_f32 v[40:41], v[116:117], s[46:47]
    v_pk_mul_f32 v[42:43], v[118:119], s[46:47]
    v_lshlrev_b32 v152, 16, v38
    v_and_b32 v153, 0xffff0000, v38
    v_exp_f32 v40, v40
    v_exp_f32 v41, v41
    v_exp_f32 v42, v42
    v_exp_f32 v43, v43
    v_lshlrev_b32 v154, 16, v39
    v_and_b32 v155, 0xffff0000, v39
    v_pk_add_f32 v[40:41], v[40:41], s[48:49]
    v_pk_add_f32 v[42:43], v[42:43], s[48:49]
    v_rcp_f32 v40, v40
    v_rcp_f32 v41, v41
    v_rcp_f32 v42, v42
    v_rcp_f32 v43, v43
    s_nop 0
    v_pk_mul_f32 v[40:41], v[40:41], v[116:117]
    v_pk_mul_f32 v[42:43], v[42:43], v[118:119]
    v_cvt_pk_bf16_f32 v36, v40, v41
    v_cvt_pk_bf16_f32 v37, v42, v43
    v_lshlrev_b32 v40, 16, v36
    v_and_b32 v41, 0xffff0000, v36
    v_lshlrev_b32 v42, 16, v37
    v_and_b32 v43, 0xffff0000, v37
    v_pk_mul_f32 v[40:41], v[40:41], v[152:153]
    v_pk_mul_f32 v[42:43], v[42:43], v[154:155]
    v_cvt_pk_bf16_f32 v58, v40, v41
    v_cvt_pk_bf16_f32 v59, v42, v43
    buffer_store_dwordx4 v[56:59], v2, s[20:23], 0 offen offset:1024
    v_cvt_pk_bf16_f32 v44, v120, v121
    v_cvt_pk_bf16_f32 v45, v122, v123
    v_cvt_pk_bf16_f32 v46, v156, v157
    v_cvt_pk_bf16_f32 v47, v158, v159
    v_lshlrev_b32 v120, 16, v44
    v_and_b32 v121, 0xffff0000, v44
    v_lshlrev_b32 v122, 16, v45
    v_and_b32 v123, 0xffff0000, v45
    v_pk_mul_f32 v[48:49], v[120:121], s[46:47]
    v_pk_mul_f32 v[50:51], v[122:123], s[46:47]
    v_lshlrev_b32 v156, 16, v46
    v_and_b32 v157, 0xffff0000, v46
    v_exp_f32 v48, v48
    v_exp_f32 v49, v49
    v_exp_f32 v50, v50
    v_exp_f32 v51, v51
    v_lshlrev_b32 v158, 16, v47
    v_and_b32 v159, 0xffff0000, v47
    v_pk_add_f32 v[48:49], v[48:49], s[48:49]
    v_pk_add_f32 v[50:51], v[50:51], s[48:49]
    v_rcp_f32 v48, v48
    v_rcp_f32 v49, v49
    v_rcp_f32 v50, v50
    v_rcp_f32 v51, v51
    s_nop 0
    v_pk_mul_f32 v[48:49], v[48:49], v[120:121]
    v_pk_mul_f32 v[50:51], v[50:51], v[122:123]
    v_cvt_pk_bf16_f32 v44, v48, v49
    v_cvt_pk_bf16_f32 v45, v50, v51
    v_lshlrev_b32 v48, 16, v44
    v_and_b32 v49, 0xffff0000, v44
    v_lshlrev_b32 v50, 16, v45
    v_and_b32 v51, 0xffff0000, v45
    v_pk_mul_f32 v[48:49], v[48:49], v[156:157]
    v_pk_mul_f32 v[50:51], v[50:51], v[158:159]
    v_cvt_pk_bf16_f32 v60, v48, v49
    v_cvt_pk_bf16_f32 v61, v50, v51
    v_cvt_pk_bf16_f32 v20, v124, v125
    v_cvt_pk_bf16_f32 v21, v126, v127
    v_cvt_pk_bf16_f32 v22, v160, v161
    v_cvt_pk_bf16_f32 v23, v162, v163
    v_lshlrev_b32 v124, 16, v20
    v_and_b32 v125, 0xffff0000, v20
    v_lshlrev_b32 v126, 16, v21
    v_and_b32 v127, 0xffff0000, v21
    v_pk_mul_f32 v[24:25], v[124:125], s[46:47]
    v_pk_mul_f32 v[26:27], v[126:127], s[46:47]
    v_lshlrev_b32 v160, 16, v22
    v_and_b32 v161, 0xffff0000, v22
    v_exp_f32 v24, v24
    v_exp_f32 v25, v25
    v_exp_f32 v26, v26
    v_exp_f32 v27, v27
    v_lshlrev_b32 v162, 16, v23
    v_and_b32 v163, 0xffff0000, v23
    v_pk_add_f32 v[24:25], v[24:25], s[48:49]
    v_pk_add_f32 v[26:27], v[26:27], s[48:49]
    v_rcp_f32 v24, v24
    v_rcp_f32 v25, v25
    v_rcp_f32 v26, v26
    v_rcp_f32 v27, v27
    s_nop 0
    v_pk_mul_f32 v[24:25], v[24:25], v[124:125]
    v_pk_mul_f32 v[26:27], v[26:27], v[126:127]
    v_cvt_pk_bf16_f32 v20, v24, v25
    v_cvt_pk_bf16_f32 v21, v26, v27
    v_lshlrev_b32 v24, 16, v20
    v_and_b32 v25, 0xffff0000, v20
    v_lshlrev_b32 v26, 16, v21
    v_and_b32 v27, 0xffff0000, v21
    v_pk_mul_f32 v[24:25], v[24:25], v[160:161]
    v_pk_mul_f32 v[26:27], v[26:27], v[162:163]
    v_cvt_pk_bf16_f32 v62, v24, v25
    v_cvt_pk_bf16_f32 v63, v26, v27
    buffer_store_dwordx4 v[60:63], v2, s[20:23], 0 offen offset:2048
    v_cvt_pk_bf16_f32 v28, v128, v129
    v_cvt_pk_bf16_f32 v29, v130, v131
    v_cvt_pk_bf16_f32 v30, v164, v165
    v_cvt_pk_bf16_f32 v31, v166, v167
    v_lshlrev_b32 v128, 16, v28
    v_and_b32 v129, 0xffff0000, v28
    v_lshlrev_b32 v130, 16, v29
    v_and_b32 v131, 0xffff0000, v29
    v_pk_mul_f32 v[32:33], v[128:129], s[46:47]
    v_pk_mul_f32 v[34:35], v[130:131], s[46:47]
    v_lshlrev_b32 v164, 16, v30
    v_and_b32 v165, 0xffff0000, v30
    v_exp_f32 v32, v32
    v_exp_f32 v33, v33
    v_exp_f32 v34, v34
    v_exp_f32 v35, v35
    v_lshlrev_b32 v166, 16, v31
    v_and_b32 v167, 0xffff0000, v31
    v_pk_add_f32 v[32:33], v[32:33], s[48:49]
    v_pk_add_f32 v[34:35], v[34:35], s[48:49]
    v_rcp_f32 v32, v32
    v_rcp_f32 v33, v33
    v_rcp_f32 v34, v34
    v_rcp_f32 v35, v35
    s_nop 0
    v_pk_mul_f32 v[32:33], v[32:33], v[128:129]
    v_pk_mul_f32 v[34:35], v[34:35], v[130:131]
    v_cvt_pk_bf16_f32 v28, v32, v33
    v_cvt_pk_bf16_f32 v29, v34, v35
    v_lshlrev_b32 v32, 16, v28
    v_and_b32 v33, 0xffff0000, v28
    v_lshlrev_b32 v34, 16, v29
    v_and_b32 v35, 0xffff0000, v29
    v_pk_mul_f32 v[32:33], v[32:33], v[164:165]
    v_pk_mul_f32 v[34:35], v[34:35], v[166:167]
    v_cvt_pk_bf16_f32 v64, v32, v33
    v_cvt_pk_bf16_f32 v65, v34, v35
    v_cvt_pk_bf16_f32 v36, v132, v133
    v_cvt_pk_bf16_f32 v37, v134, v135
    v_cvt_pk_bf16_f32 v38, v168, v169
    v_cvt_pk_bf16_f32 v39, v170, v171
    v_lshlrev_b32 v132, 16, v36
    v_and_b32 v133, 0xffff0000, v36
    v_lshlrev_b32 v134, 16, v37
    v_and_b32 v135, 0xffff0000, v37
    v_pk_mul_f32 v[40:41], v[132:133], s[46:47]
    v_pk_mul_f32 v[42:43], v[134:135], s[46:47]
    v_lshlrev_b32 v168, 16, v38
    v_and_b32 v169, 0xffff0000, v38
    v_exp_f32 v40, v40
    v_exp_f32 v41, v41
    v_exp_f32 v42, v42
    v_exp_f32 v43, v43
    v_lshlrev_b32 v170, 16, v39
    v_and_b32 v171, 0xffff0000, v39
    v_pk_add_f32 v[40:41], v[40:41], s[48:49]
    v_pk_add_f32 v[42:43], v[42:43], s[48:49]
    v_rcp_f32 v40, v40
    v_rcp_f32 v41, v41
    v_rcp_f32 v42, v42
    v_rcp_f32 v43, v43
    s_nop 0
    v_pk_mul_f32 v[40:41], v[40:41], v[132:133]
    v_pk_mul_f32 v[42:43], v[42:43], v[134:135]
    v_cvt_pk_bf16_f32 v36, v40, v41
    v_cvt_pk_bf16_f32 v37, v42, v43
    v_lshlrev_b32 v40, 16, v36
    v_and_b32 v41, 0xffff0000, v36
    v_lshlrev_b32 v42, 16, v37
    v_and_b32 v43, 0xffff0000, v37
    v_pk_mul_f32 v[40:41], v[40:41], v[168:169]
    v_pk_mul_f32 v[42:43], v[42:43], v[170:171]
    v_cvt_pk_bf16_f32 v66, v40, v41
    v_cvt_pk_bf16_f32 v67, v42, v43
    buffer_store_dwordx4 v[64:67], v2, s[20:23], 0 offen offset:3072
    v_cvt_pk_bf16_f32 v44, v136, v137
    v_cvt_pk_bf16_f32 v45, v138, v139
    v_cvt_pk_bf16_f32 v46, v172, v173
    v_cvt_pk_bf16_f32 v47, v174, v175
    v_lshlrev_b32 v136, 16, v44
    v_and_b32 v137, 0xffff0000, v44
    v_lshlrev_b32 v138, 16, v45
    v_and_b32 v139, 0xffff0000, v45
    v_pk_mul_f32 v[48:49], v[136:137], s[46:47]
    v_pk_mul_f32 v[50:51], v[138:139], s[46:47]
    v_lshlrev_b32 v172, 16, v46
    v_and_b32 v173, 0xffff0000, v46
    v_exp_f32 v48, v48
    v_exp_f32 v49, v49
    v_exp_f32 v50, v50
    v_exp_f32 v51, v51
    v_lshlrev_b32 v174, 16, v47
    v_and_b32 v175, 0xffff0000, v47
    v_pk_add_f32 v[48:49], v[48:49], s[48:49]
    v_pk_add_f32 v[50:51], v[50:51], s[48:49]
    v_rcp_f32 v48, v48
    v_rcp_f32 v49, v49
    v_rcp_f32 v50, v50
    v_rcp_f32 v51, v51
    s_nop 0
    v_pk_mul_f32 v[48:49], v[48:49], v[136:137]
    v_pk_mul_f32 v[50:51], v[50:51], v[138:139]
    v_cvt_pk_bf16_f32 v44, v48, v49
    v_cvt_pk_bf16_f32 v45, v50, v51
    v_lshlrev_b32 v48, 16, v44
    v_and_b32 v49, 0xffff0000, v44
    v_lshlrev_b32 v50, 16, v45
    v_and_b32 v51, 0xffff0000, v45
    v_pk_mul_f32 v[48:49], v[48:49], v[172:173]
    v_pk_mul_f32 v[50:51], v[50:51], v[174:175]
    v_cvt_pk_bf16_f32 v52, v48, v49
    v_cvt_pk_bf16_f32 v53, v50, v51
    v_cvt_pk_bf16_f32 v20, v140, v141
    v_cvt_pk_bf16_f32 v21, v142, v143
    v_cvt_pk_bf16_f32 v22, v176, v177
    v_cvt_pk_bf16_f32 v23, v178, v179
    v_lshlrev_b32 v140, 16, v20
    v_and_b32 v141, 0xffff0000, v20
    v_lshlrev_b32 v142, 16, v21
    v_and_b32 v143, 0xffff0000, v21
    v_pk_mul_f32 v[24:25], v[140:141], s[46:47]
    v_pk_mul_f32 v[26:27], v[142:143], s[46:47]
    v_lshlrev_b32 v176, 16, v22
    v_and_b32 v177, 0xffff0000, v22
    v_exp_f32 v24, v24
    v_exp_f32 v25, v25
    v_exp_f32 v26, v26
    v_exp_f32 v27, v27
    v_lshlrev_b32 v178, 16, v23
    v_and_b32 v179, 0xffff0000, v23
    v_pk_add_f32 v[24:25], v[24:25], s[48:49]
    v_pk_add_f32 v[26:27], v[26:27], s[48:49]
    v_rcp_f32 v24, v24
    v_rcp_f32 v25, v25
    v_rcp_f32 v26, v26
    v_rcp_f32 v27, v27
    s_nop 0
    v_pk_mul_f32 v[24:25], v[24:25], v[140:141]
    v_pk_mul_f32 v[26:27], v[26:27], v[142:143]
    v_cvt_pk_bf16_f32 v20, v24, v25
    v_cvt_pk_bf16_f32 v21, v26, v27
    v_lshlrev_b32 v24, 16, v20
    v_and_b32 v25, 0xffff0000, v20
    v_lshlrev_b32 v26, 16, v21
    v_and_b32 v27, 0xffff0000, v21
    v_pk_mul_f32 v[24:25], v[24:25], v[176:177]
    v_pk_mul_f32 v[26:27], v[26:27], v[178:179]
    v_cvt_pk_bf16_f32 v54, v24, v25
    v_cvt_pk_bf16_f32 v55, v26, v27
    buffer_store_dwordx4 v[52:55], v2, s[20:23], s45 offen offset:0
    v_cvt_pk_bf16_f32 v28, v180, v181
    v_cvt_pk_bf16_f32 v29, v182, v183
    v_cvt_pk_bf16_f32 v30, v216, v217
    v_cvt_pk_bf16_f32 v31, v218, v219
    v_lshlrev_b32 v180, 16, v28
    v_and_b32 v181, 0xffff0000, v28
    v_lshlrev_b32 v182, 16, v29
    v_and_b32 v183, 0xffff0000, v29
    v_pk_mul_f32 v[32:33], v[180:181], s[46:47]
    v_pk_mul_f32 v[34:35], v[182:183], s[46:47]
    v_lshlrev_b32 v216, 16, v30
    v_and_b32 v217, 0xffff0000, v30
    v_exp_f32 v32, v32
    v_exp_f32 v33, v33
    v_exp_f32 v34, v34
    v_exp_f32 v35, v35
    v_lshlrev_b32 v218, 16, v31
    v_and_b32 v219, 0xffff0000, v31
    v_pk_add_f32 v[32:33], v[32:33], s[48:49]
    v_pk_add_f32 v[34:35], v[34:35], s[48:49]
    v_rcp_f32 v32, v32
    v_rcp_f32 v33, v33
    v_rcp_f32 v34, v34
    v_rcp_f32 v35, v35
    s_nop 0
    v_pk_mul_f32 v[32:33], v[32:33], v[180:181]
    v_pk_mul_f32 v[34:35], v[34:35], v[182:183]
    v_cvt_pk_bf16_f32 v28, v32, v33
    v_cvt_pk_bf16_f32 v29, v34, v35
    v_lshlrev_b32 v32, 16, v28
    v_and_b32 v33, 0xffff0000, v28
    v_lshlrev_b32 v34, 16, v29
    v_and_b32 v35, 0xffff0000, v29
    v_pk_mul_f32 v[32:33], v[32:33], v[216:217]
    v_pk_mul_f32 v[34:35], v[34:35], v[218:219]
    v_cvt_pk_bf16_f32 v58, v32, v33
    v_cvt_pk_bf16_f32 v59, v34, v35
    buffer_store_dwordx2 v[58:59], v3, s[20:23], 0 offen offset:8
    v_cvt_pk_bf16_f32 v36, v184, v185
    v_cvt_pk_bf16_f32 v37, v186, v187
    v_cvt_pk_bf16_f32 v38, v220, v221
    v_cvt_pk_bf16_f32 v39, v222, v223
    v_lshlrev_b32 v184, 16, v36
    v_and_b32 v185, 0xffff0000, v36
    v_lshlrev_b32 v186, 16, v37
    v_and_b32 v187, 0xffff0000, v37
    v_pk_mul_f32 v[40:41], v[184:185], s[46:47]
    v_pk_mul_f32 v[42:43], v[186:187], s[46:47]
    v_lshlrev_b32 v220, 16, v38
    v_and_b32 v221, 0xffff0000, v38
    v_exp_f32 v40, v40
    v_exp_f32 v41, v41
    v_exp_f32 v42, v42
    v_exp_f32 v43, v43
    v_lshlrev_b32 v222, 16, v39
    v_and_b32 v223, 0xffff0000, v39
    v_pk_add_f32 v[40:41], v[40:41], s[48:49]
    v_pk_add_f32 v[42:43], v[42:43], s[48:49]
    v_rcp_f32 v40, v40
    v_rcp_f32 v41, v41
    v_rcp_f32 v42, v42
    v_rcp_f32 v43, v43
    s_nop 0
    v_pk_mul_f32 v[40:41], v[40:41], v[184:185]
    v_pk_mul_f32 v[42:43], v[42:43], v[186:187]
    v_cvt_pk_bf16_f32 v36, v40, v41
    v_cvt_pk_bf16_f32 v37, v42, v43
    v_lshlrev_b32 v40, 16, v36
    v_and_b32 v41, 0xffff0000, v36
    v_lshlrev_b32 v42, 16, v37
    v_and_b32 v43, 0xffff0000, v37
    v_pk_mul_f32 v[40:41], v[40:41], v[220:221]
    v_pk_mul_f32 v[42:43], v[42:43], v[222:223]
    v_cvt_pk_bf16_f32 v60, v40, v41
    v_cvt_pk_bf16_f32 v61, v42, v43
    v_cvt_pk_bf16_f32 v44, v188, v189
    v_cvt_pk_bf16_f32 v45, v190, v191
    v_cvt_pk_bf16_f32 v46, v224, v225
    v_cvt_pk_bf16_f32 v47, v226, v227
    v_lshlrev_b32 v188, 16, v44
    v_and_b32 v189, 0xffff0000, v44
    v_lshlrev_b32 v190, 16, v45
    v_and_b32 v191, 0xffff0000, v45
    v_pk_mul_f32 v[48:49], v[188:189], s[46:47]
    v_pk_mul_f32 v[50:51], v[190:191], s[46:47]
    v_lshlrev_b32 v224, 16, v46
    v_and_b32 v225, 0xffff0000, v46
    v_exp_f32 v48, v48
    v_exp_f32 v49, v49
    v_exp_f32 v50, v50
    v_exp_f32 v51, v51
    v_lshlrev_b32 v226, 16, v47
    v_and_b32 v227, 0xffff0000, v47
    v_pk_add_f32 v[48:49], v[48:49], s[48:49]
    v_pk_add_f32 v[50:51], v[50:51], s[48:49]
    v_rcp_f32 v48, v48
    v_rcp_f32 v49, v49
    v_rcp_f32 v50, v50
    v_rcp_f32 v51, v51
    s_nop 0
    v_pk_mul_f32 v[48:49], v[48:49], v[188:189]
    v_pk_mul_f32 v[50:51], v[50:51], v[190:191]
    v_cvt_pk_bf16_f32 v44, v48, v49
    v_cvt_pk_bf16_f32 v45, v50, v51
    v_lshlrev_b32 v48, 16, v44
    v_and_b32 v49, 0xffff0000, v44
    v_lshlrev_b32 v50, 16, v45
    v_and_b32 v51, 0xffff0000, v45
    v_pk_mul_f32 v[48:49], v[48:49], v[224:225]
    v_pk_mul_f32 v[50:51], v[50:51], v[226:227]
    v_cvt_pk_bf16_f32 v62, v48, v49
    v_cvt_pk_bf16_f32 v63, v50, v51
    buffer_store_dwordx4 v[60:63], v3, s[20:23], 0 offen offset:1024
    v_cvt_pk_bf16_f32 v20, v192, v193
    v_cvt_pk_bf16_f32 v21, v194, v195
    v_cvt_pk_bf16_f32 v22, v228, v229
    v_cvt_pk_bf16_f32 v23, v230, v231
    v_lshlrev_b32 v192, 16, v20
    v_and_b32 v193, 0xffff0000, v20
    v_lshlrev_b32 v194, 16, v21
    v_and_b32 v195, 0xffff0000, v21
    v_pk_mul_f32 v[24:25], v[192:193], s[46:47]
    v_pk_mul_f32 v[26:27], v[194:195], s[46:47]
    v_lshlrev_b32 v228, 16, v22
    v_and_b32 v229, 0xffff0000, v22
    v_exp_f32 v24, v24
    v_exp_f32 v25, v25
    v_exp_f32 v26, v26
    v_exp_f32 v27, v27
    v_lshlrev_b32 v230, 16, v23
    v_and_b32 v231, 0xffff0000, v23
    v_pk_add_f32 v[24:25], v[24:25], s[48:49]
    v_pk_add_f32 v[26:27], v[26:27], s[48:49]
    v_rcp_f32 v24, v24
    v_rcp_f32 v25, v25
    v_rcp_f32 v26, v26
    v_rcp_f32 v27, v27
    s_nop 0
    v_pk_mul_f32 v[24:25], v[24:25], v[192:193]
    v_pk_mul_f32 v[26:27], v[26:27], v[194:195]
    v_cvt_pk_bf16_f32 v20, v24, v25
    v_cvt_pk_bf16_f32 v21, v26, v27
    v_lshlrev_b32 v24, 16, v20
    v_and_b32 v25, 0xffff0000, v20
    v_lshlrev_b32 v26, 16, v21
    v_and_b32 v27, 0xffff0000, v21
    v_pk_mul_f32 v[24:25], v[24:25], v[228:229]
    v_pk_mul_f32 v[26:27], v[26:27], v[230:231]
    v_cvt_pk_bf16_f32 v64, v24, v25
    v_cvt_pk_bf16_f32 v65, v26, v27
    v_cvt_pk_bf16_f32 v28, v196, v197
    v_cvt_pk_bf16_f32 v29, v198, v199
    v_cvt_pk_bf16_f32 v30, v232, v233
    v_cvt_pk_bf16_f32 v31, v234, v235
    v_lshlrev_b32 v196, 16, v28
    v_and_b32 v197, 0xffff0000, v28
    v_lshlrev_b32 v198, 16, v29
    v_and_b32 v199, 0xffff0000, v29
    v_pk_mul_f32 v[32:33], v[196:197], s[46:47]
    v_pk_mul_f32 v[34:35], v[198:199], s[46:47]
    v_lshlrev_b32 v232, 16, v30
    v_and_b32 v233, 0xffff0000, v30
    v_exp_f32 v32, v32
    v_exp_f32 v33, v33
    v_exp_f32 v34, v34
    v_exp_f32 v35, v35
    v_lshlrev_b32 v234, 16, v31
    v_and_b32 v235, 0xffff0000, v31
    v_pk_add_f32 v[32:33], v[32:33], s[48:49]
    v_pk_add_f32 v[34:35], v[34:35], s[48:49]
    v_rcp_f32 v32, v32
    v_rcp_f32 v33, v33
    v_rcp_f32 v34, v34
    v_rcp_f32 v35, v35
    s_nop 0
    v_pk_mul_f32 v[32:33], v[32:33], v[196:197]
    v_pk_mul_f32 v[34:35], v[34:35], v[198:199]
    v_cvt_pk_bf16_f32 v28, v32, v33
    v_cvt_pk_bf16_f32 v29, v34, v35
    v_lshlrev_b32 v32, 16, v28
    v_and_b32 v33, 0xffff0000, v28
    v_lshlrev_b32 v34, 16, v29
    v_and_b32 v35, 0xffff0000, v29
    v_pk_mul_f32 v[32:33], v[32:33], v[232:233]
    v_pk_mul_f32 v[34:35], v[34:35], v[234:235]
    v_cvt_pk_bf16_f32 v66, v32, v33
    v_cvt_pk_bf16_f32 v67, v34, v35
    buffer_store_dwordx4 v[64:67], v3, s[20:23], 0 offen offset:2048
    v_cvt_pk_bf16_f32 v36, v200, v201
    v_cvt_pk_bf16_f32 v37, v202, v203
    v_cvt_pk_bf16_f32 v38, v236, v237
    v_cvt_pk_bf16_f32 v39, v238, v239
    v_lshlrev_b32 v200, 16, v36
    v_and_b32 v201, 0xffff0000, v36
    v_lshlrev_b32 v202, 16, v37
    v_and_b32 v203, 0xffff0000, v37
    v_pk_mul_f32 v[40:41], v[200:201], s[46:47]
    v_pk_mul_f32 v[42:43], v[202:203], s[46:47]
    v_lshlrev_b32 v236, 16, v38
    v_and_b32 v237, 0xffff0000, v38
    v_exp_f32 v40, v40
    v_exp_f32 v41, v41
    v_exp_f32 v42, v42
    v_exp_f32 v43, v43
    v_lshlrev_b32 v238, 16, v39
    v_and_b32 v239, 0xffff0000, v39
    v_pk_add_f32 v[40:41], v[40:41], s[48:49]
    v_pk_add_f32 v[42:43], v[42:43], s[48:49]
    v_rcp_f32 v40, v40
    v_rcp_f32 v41, v41
    v_rcp_f32 v42, v42
    v_rcp_f32 v43, v43
    s_nop 0
    v_pk_mul_f32 v[40:41], v[40:41], v[200:201]
    v_pk_mul_f32 v[42:43], v[42:43], v[202:203]
    v_cvt_pk_bf16_f32 v36, v40, v41
    v_cvt_pk_bf16_f32 v37, v42, v43
    v_lshlrev_b32 v40, 16, v36
    v_and_b32 v41, 0xffff0000, v36
    v_lshlrev_b32 v42, 16, v37
    v_and_b32 v43, 0xffff0000, v37
    v_pk_mul_f32 v[40:41], v[40:41], v[236:237]
    v_pk_mul_f32 v[42:43], v[42:43], v[238:239]
    v_cvt_pk_bf16_f32 v52, v40, v41
    v_cvt_pk_bf16_f32 v53, v42, v43
    v_cvt_pk_bf16_f32 v44, v204, v205
    v_cvt_pk_bf16_f32 v45, v206, v207
    v_cvt_pk_bf16_f32 v46, v240, v241
    v_cvt_pk_bf16_f32 v47, v242, v243
    v_lshlrev_b32 v204, 16, v44
    v_and_b32 v205, 0xffff0000, v44
    v_lshlrev_b32 v206, 16, v45
    v_and_b32 v207, 0xffff0000, v45
    v_pk_mul_f32 v[48:49], v[204:205], s[46:47]
    v_pk_mul_f32 v[50:51], v[206:207], s[46:47]
    v_lshlrev_b32 v240, 16, v46
    v_and_b32 v241, 0xffff0000, v46
    v_exp_f32 v48, v48
    v_exp_f32 v49, v49
    v_exp_f32 v50, v50
    v_exp_f32 v51, v51
    v_lshlrev_b32 v242, 16, v47
    v_and_b32 v243, 0xffff0000, v47
    v_pk_add_f32 v[48:49], v[48:49], s[48:49]
    v_pk_add_f32 v[50:51], v[50:51], s[48:49]
    v_rcp_f32 v48, v48
    v_rcp_f32 v49, v49
    v_rcp_f32 v50, v50
    v_rcp_f32 v51, v51
    s_nop 0
    v_pk_mul_f32 v[48:49], v[48:49], v[204:205]
    v_pk_mul_f32 v[50:51], v[50:51], v[206:207]
    v_cvt_pk_bf16_f32 v44, v48, v49
    v_cvt_pk_bf16_f32 v45, v50, v51
    v_lshlrev_b32 v48, 16, v44
    v_and_b32 v49, 0xffff0000, v44
    v_lshlrev_b32 v50, 16, v45
    v_and_b32 v51, 0xffff0000, v45
    v_pk_mul_f32 v[48:49], v[48:49], v[240:241]
    v_pk_mul_f32 v[50:51], v[50:51], v[242:243]
    v_cvt_pk_bf16_f32 v54, v48, v49
    v_cvt_pk_bf16_f32 v55, v50, v51
    buffer_store_dwordx4 v[52:55], v3, s[20:23], 0 offen offset:3072
    v_cvt_pk_bf16_f32 v20, v208, v209
    v_cvt_pk_bf16_f32 v21, v210, v211
    v_cvt_pk_bf16_f32 v22, v244, v245
    v_cvt_pk_bf16_f32 v23, v246, v247
    v_lshlrev_b32 v208, 16, v20
    v_and_b32 v209, 0xffff0000, v20
    v_lshlrev_b32 v210, 16, v21
    v_and_b32 v211, 0xffff0000, v21
    v_pk_mul_f32 v[24:25], v[208:209], s[46:47]
    v_pk_mul_f32 v[26:27], v[210:211], s[46:47]
    v_lshlrev_b32 v244, 16, v22
    v_and_b32 v245, 0xffff0000, v22
    v_exp_f32 v24, v24
    v_exp_f32 v25, v25
    v_exp_f32 v26, v26
    v_exp_f32 v27, v27
    v_lshlrev_b32 v246, 16, v23
    v_and_b32 v247, 0xffff0000, v23
    v_pk_add_f32 v[24:25], v[24:25], s[48:49]
    v_pk_add_f32 v[26:27], v[26:27], s[48:49]
    v_rcp_f32 v24, v24
    v_rcp_f32 v25, v25
    v_rcp_f32 v26, v26
    v_rcp_f32 v27, v27
    s_nop 0
    v_pk_mul_f32 v[24:25], v[24:25], v[208:209]
    v_pk_mul_f32 v[26:27], v[26:27], v[210:211]
    v_cvt_pk_bf16_f32 v20, v24, v25
    v_cvt_pk_bf16_f32 v21, v26, v27
    v_lshlrev_b32 v24, 16, v20
    v_and_b32 v25, 0xffff0000, v20
    v_lshlrev_b32 v26, 16, v21
    v_and_b32 v27, 0xffff0000, v21
    v_pk_mul_f32 v[24:25], v[24:25], v[244:245]
    v_pk_mul_f32 v[26:27], v[26:27], v[246:247]
    v_cvt_pk_bf16_f32 v56, v24, v25
    v_cvt_pk_bf16_f32 v57, v26, v27
    v_cvt_pk_bf16_f32 v28, v212, v213
    v_cvt_pk_bf16_f32 v29, v214, v215
    v_cvt_pk_bf16_f32 v30, v248, v249
    v_cvt_pk_bf16_f32 v31, v250, v251
    v_lshlrev_b32 v212, 16, v28
    v_and_b32 v213, 0xffff0000, v28
    v_lshlrev_b32 v214, 16, v29
    v_and_b32 v215, 0xffff0000, v29
    v_pk_mul_f32 v[32:33], v[212:213], s[46:47]
    v_pk_mul_f32 v[34:35], v[214:215], s[46:47]
    v_lshlrev_b32 v248, 16, v30
    v_and_b32 v249, 0xffff0000, v30
    v_exp_f32 v32, v32
    v_exp_f32 v33, v33
    v_exp_f32 v34, v34
    v_exp_f32 v35, v35
    v_lshlrev_b32 v250, 16, v31
    v_and_b32 v251, 0xffff0000, v31
    v_pk_add_f32 v[32:33], v[32:33], s[48:49]
    v_pk_add_f32 v[34:35], v[34:35], s[48:49]
    v_rcp_f32 v32, v32
    v_rcp_f32 v33, v33
    v_rcp_f32 v34, v34
    v_rcp_f32 v35, v35
    s_nop 0
    v_pk_mul_f32 v[32:33], v[32:33], v[212:213]
    v_pk_mul_f32 v[34:35], v[34:35], v[214:215]
    v_cvt_pk_bf16_f32 v28, v32, v33
    v_cvt_pk_bf16_f32 v29, v34, v35
    v_lshlrev_b32 v32, 16, v28
    v_and_b32 v33, 0xffff0000, v28
    v_lshlrev_b32 v34, 16, v29
    v_and_b32 v35, 0xffff0000, v29
    v_pk_mul_f32 v[32:33], v[32:33], v[248:249]
    v_pk_mul_f32 v[34:35], v[34:35], v[250:251]
    v_cvt_pk_bf16_f32 v58, v32, v33
    v_cvt_pk_bf16_f32 v59, v34, v35
    buffer_store_dwordx4 v[56:59], v3, s[20:23], s45 offen offset:0
L_g1_epi_done:
L_g1_end:
    s_endpgm
.globl gemm2_kernel
.p2align 8
.type gemm2_kernel,@function
gemm2_kernel:
    s_cmp_ge_u32 s2, 256
    s_cbranch_scc1 L_g2_end
    s_cmp_lt_u32 s2, 64
    s_cbranch_scc1 L_g2_pf
    s_sub_u32 s2, s2, 64
    s_load_dwordx2 s[4:5], s[0:1], 72
    s_load_dwordx2 s[6:7], s[0:1], 0
    s_load_dwordx2 s[8:9], s[0:1], 96
    s_load_dwordx2 s[10:11], s[0:1], 80
    v_and_b32 v1, 63, v0
    v_lshrrev_b32 v2, 6, v0
    s_nop 0
    v_readfirstlane_b32 s40, v2
    s_and_b32 s30, s2, 7
    s_lshr_b32 s31, s2, 3
    s_mul_i32 s32, s31, 43
    s_lshr_b32 s32, s32, 8
    s_mul_i32 s33, s32, 6
    s_sub_u32 s31, s31, s33
    s_lshr_b32 s29, s30, 2
    s_and_b32 s30, s30, 3
    s_lshl_b32 s30, s30, 2
    s_add_u32 s32, s32, s30
    s_and_b32 s41, s40, 3
    s_lshr_b32 s42, s40, 2
    s_cmp_eq_u32 s29, 0
    s_cselect_b32 s28, 1920, 0
    s_mul_i32 s33, s28, 1152
    s_mul_i32 s34, s31, 192
    s_add_u32 s33, s33, s34
    s_mul_i32 s36, s40, 3072
    s_movk_i32 s45, 5462
    s_mul_i32 s44, s40, 192
    s_add_u32 s43, s44, 0
    v_add_u32 v17, s43, v1
    v_mul_lo_u32 v18, v17, s45
    v_lshrrev_b32 v18, 16, v18
    v_mul_u32_u24 v19, 12, v18
    v_sub_u32 v19, v17, v19
    v_lshrrev_b32 v17, 1, v19
    v_bfe_u32 v16, v18, 2, 1
    v_sub_u32 v17, v17, v16
    v_cmp_gt_i32 vcc, 0, v17
    v_and_b32 v19, 1, v19
    v_lshlrev_b32 v19, 4, v19
    v_cndmask_b32 v17, v17, 5, vcc
    v_lshlrev_b32 v17, 5, v17
    v_mul_u32_u24 v18, 1152, v18
    v_add3_u32 v2, v17, v18, v19
    s_add_u32 s43, s44, 64
    v_add_u32 v17, s43, v1
    v_mul_lo_u32 v18, v17, s45
    v_lshrrev_b32 v18, 16, v18
    v_mul_u32_u24 v19, 12, v18
    v_sub_u32 v19, v17, v19
    v_lshrrev_b32 v17, 1, v19
    v_bfe_u32 v16, v18, 2, 1
    v_sub_u32 v17, v17, v16
    v_cmp_gt_i32 vcc, 0, v17
    v_and_b32 v19, 1, v19
    v_lshlrev_b32 v19, 4, v19
    v_cndmask_b32 v17, v17, 5, vcc
    v_lshlrev_b32 v17, 5, v17
    v_mul_u32_u24 v18, 1152, v18
    v_add3_u32 v3, v17, v18, v19
    s_add_u32 s43, s44, 128
    v_add_u32 v17, s43, v1
    v_mul_lo_u32 v18, v17, s45
    v_lshrrev_b32 v18, 16, v18
    v_mul_u32_u24 v19, 12, v18
    v_sub_u32 v19, v17, v19
    v_lshrrev_b32 v17, 1, v19
    v_bfe_u32 v16, v18, 2, 1
    v_sub_u32 v17, v17, v16
    v_cmp_gt_i32 vcc, 0, v17
    v_and_b32 v19, 1, v19
    v_lshlrev_b32 v19, 4, v19
    v_cndmask_b32 v17, v17, 5, vcc
    v_lshlrev_b32 v17, 5, v17
    v_mul_u32_u24 v18, 1152, v18
    v_add3_u32 v4, v17, v18, v19
    s_lshl_b32 s38, s32, 3
    s_lshl_b32 s39, s41, 1
    s_add_u32 s38, s38, s39
    s_mul_i32 s34, s38, 147456
    s_lshl_b32 s35, s28, 5
    s_add_u32 s34, s34, s35
    s_lshl_b32 s35, s42, 11
    s_add_u32 s34, s34, s35
    v_lshlrev_b32 v17, 4, v1
    v_add_u32 v5, s34, v17
    v_add_u32 v6, 147456, v5
    s_waitcnt lgkmcnt(0)
    s_add_u32 s12, s4, s33
    s_addc_u32 s13, s5, 0
    s_sub_u32 s14, 5308416, s33
    s_mov_b32 s15, 0x00020000
    s_add_u32 s16, s8, 16777216
    s_addc_u32 s17, s9, 0
    s_mov_b32 s18, 18874368
    s_mov_b32 s19, 0x00020000
    s_add_u32 s20, s8, 8388608
    s_addc_u32 s21, s9, 0
    s_mov_b32 s22, 2359296
    s_mov_b32 s23, 0x00020000
    s_add_u32 s24, s8, 37748736
    s_addc_u32 s25, s9, 0
    s_mov_b32 s26, 4718592
    s_mov_b32 s27, 0x00020000
    s_mov_b32 s72, s6
    s_mov_b32 s73, s7
    s_mov_b32 s74, 2359296
    s_mov_b32 s75, 0x00020000
    s_mov_b32 s76, s10
    s_mov_b32 s77, s11
    s_mov_b32 s78, 2359296
    s_mov_b32 s79, 0x00020000
    s_add_u32 s84, s8, 50331648
    s_addc_u32 s85, s9, 0
    s_mov_b32 s86, 4718592
    s_mov_b32 s87, 0x00020000
    s_add_u32 s80, s8, 58720256
    s_addc_u32 s81, s9, 0
    s_mov_b32 s82, 16384
    s_mov_b32 s83, 0x00020000
    s_mov_b32 s46, 0
    s_add_u32 m0, s36, 0
    s_nop 0
    buffer_load_dwordx4 v2, s[12:15], s46 offen lds
    s_add_u32 m0, s36, 1024
    s_nop 0
    buffer_load_dwordx4 v3, s[12:15], s46 offen lds
    s_add_u32 m0, s36, 2048
    s_nop 0
    buffer_load_dwordx4 v4, s[12:15], s46 offen lds
    s_mov_b32 s47, 0
    buffer_load_dwordx4 v[20:23], v5, s[16:19], s47 offen offset:0
    buffer_load_dwordx4 v[24:27], v5, s[16:19], s47 offen offset:1024
    buffer_load_dwordx4 v[28:31], v6, s[16:19], s47 offen offset:0
    buffer_load_dwordx4 v[32:35], v6, s[16:19], s47 offen offset:1024
    s_mov_b32 s46, 147456
    s_add_u32 m0, s36, 24576
    s_nop 0
    buffer_load_dwordx4 v2, s[12:15], s46 offen lds
    s_add_u32 m0, s36, 25600
    s_nop 0
    buffer_load_dwordx4 v3, s[12:15], s46 offen lds
    s_add_u32 m0, s36, 26624
    s_nop 0
    buffer_load_dwordx4 v4, s[12:15], s46 offen lds
    s_mov_b32 s47, 4096
    buffer_load_dwordx4 v[36:39], v5, s[16:19], s47 offen offset:0
    buffer_load_dwordx4 v[40:43], v5, s[16:19], s47 offen offset:1024
    buffer_load_dwordx4 v[44:47], v6, s[16:19], s47 offen offset:0
    buffer_load_dwordx4 v[48:51], v6, s[16:19], s47 offen offset:1024
    v_lshrrev_b32 v17, 2, v1
    v_mul_u32_u24 v17, 192, v17
    v_and_b32 v18, 3, v1
    v_lshlrev_b32 v18, 3, v18
    s_mul_i32 s43, s42, 12288
    v_add3_u32 v17, v17, v18, s43
    v_bfe_u32 v18, v1, 4, 1
    v_lshlrev_b32 v19, 5, v18
    v_add_u32 v8, v17, v19
    v_xor_b32 v18, 1, v18
    v_mul_u32_u24 v18, 160, v18
    v_add_u32 v9, v17, v18
    v_add_u32 v10, 49152, v8
    v_add_u32 v11, 49152, v9
    v_add_u32 v12, 98304, v8
    v_add_u32 v13, 98304, v9
    v_mov_b32 v124, 0
    v_mov_b32 v125, 0
    v_mov_b32 v126, 0
    v_mov_b32 v127, 0
    v_mov_b32 v128, 0
    v_mov_b32 v129, 0
    v_mov_b32 v130, 0
    v_mov_b32 v131, 0
    v_mov_b32 v132, 0
    v_mov_b32 v133, 0
    v_mov_b32 v134, 0
    v_mov_b32 v135, 0
    v_mov_b32 v136, 0
    v_mov_b32 v137, 0
    v_mov_b32 v138, 0
    v_mov_b32 v139, 0
    v_mov_b32 v140, 0
    v_mov_b32 v141, 0
    v_mov_b32 v142, 0
    v_mov_b32 v143, 0
    v_mov_b32 v144, 0
    v_mov_b32 v145, 0
    v_mov_b32 v146, 0
    v_mov_b32 v147, 0
    v_mov_b32 v148, 0
    v_mov_b32 v149, 0
    v_mov_b32 v150, 0
    v_mov_b32 v151, 0
    v_mov_b32 v152, 0
    v_mov_b32 v153, 0
    v_mov_b32 v154, 0
    v_mov_b32 v155, 0
    v_mov_b32 v156, 0
    v_mov_b32 v157, 0
    v_mov_b32 v158, 0
    v_mov_b32 v159, 0
    v_mov_b32 v160, 0
    v_mov_b32 v161, 0
    v_mov_b32 v162, 0
    v_mov_b32 v163, 0
    v_mov_b32 v164, 0
    v_mov_b32 v165, 0
    v_mov_b32 v166, 0
    v_mov_b32 v167, 0
    v_mov_b32 v168, 0
    v_mov_b32 v169, 0
    v_mov_b32 v170, 0
    v_mov_b32 v171, 0
    s_lshr_b32 s43, s2, 3
    s_lshl_b32 s43, s43, 2
    s_add_u32 s43, s43, s41
    s_mul_i32 s43, s43, 12
    v_add_u32 v17, s43, v1
    v_lshlrev_b32 v18, 7, v17
    v_lshrrev_b32 v19, 5, v17
    v_mul_u32_u24 v19, 147456, v19
    v_and_b32 v17, 31, v17
    v_lshlrev_b32 v17, 7, v17
    v_add_u32 v19, v19, v17
    s_cmp_eq_u32 s42, 0
    s_cselect_b64 vcc, -1, 0
    s_mul_i32 s43, s28, 1152
    s_add_u32 s92, s4, s43
    s_addc_u32 s93, s5, 0
    s_sub_u32 s94, 5308416, s43
    v_cndmask_b32 v247, v19, v18, vcc
    s_and_b32 s44, s2, 3
    s_mul_i32 s44, s44, 4718592
    s_lshl_b32 s45, s28, 5
    s_add_u32 s44, s44, s45
    s_add_u32 s44, s44, 32768
    s_cmp_eq_u32 s42, 0
    s_cselect_b32 s92, s92, s16
    s_cselect_b32 s93, s93, s17
    s_cselect_b32 s94, s94, s18
    s_mov_b32 s95, 0x00020000
    s_cselect_b32 s90, 1179648, s44
    s_mov_b32 s91, 4096
    s_cselect_b32 s91, 147456, s91
    s_mul_i32 s43, s40, 6144
    v_lshlrev_b32 v16, 4, v1
    v_add_u32 v14, s43, v16
    s_xor_b32 s44, s40, 4
    s_mul_i32 s44, s44, 6144
    v_add_u32 v7, s44, v16
    s_mul_i32 s44, s32, 6
    s_add_u32 s44, s44, s31
    s_mul_i32 s45, s44, 49152
    v_add_u32 v15, s45, v14
    s_lshl_b32 s48, s44, 7
    s_mov_b32 s49, 1
    s_movk_i32 s88, 4096
    v_and_b32 v17, 15, v1
    v_lshrrev_b32 v18, 4, v1
    s_add_u32 s43, s38, s42
    s_mul_i32 s43, s43, 18432
    s_mul_i32 s34, s31, 192
    s_add_u32 s34, s34, s43
    v_mul_u32_u24 v19, 1152, v17
    v_lshlrev_b32 v232, 3, v18
    v_add3_u32 v232, v19, v232, s34
    s_lshl_b32 s43, s43, 1
    s_mul_i32 s34, s31, 6144
    s_add_u32 s43, s43, s34
    v_add_u32 v233, s43, v16
    s_cmp_eq_u32 s29, 0
    s_cbranch_scc1 L_g2_consumer
    s_waitcnt vmcnt(7)
    s_barrier
    ds_read_b64_tr_b16 v[100:101], v8 offset:0
    ds_read_b64_tr_b16 v[102:103], v8 offset:3072
    ds_read_b64_tr_b16 v[104:105], v8 offset:32
    ds_read_b64_tr_b16 v[106:107], v8 offset:3104
    ds_read_b64_tr_b16 v[108:109], v8 offset:64
    ds_read_b64_tr_b16 v[110:111], v8 offset:3136
    ds_read_b64_tr_b16 v[112:113], v8 offset:96
    ds_read_b64_tr_b16 v[114:115], v8 offset:3168
    ds_read_b64_tr_b16 v[116:117], v8 offset:128
    ds_read_b64_tr_b16 v[118:119], v8 offset:3200
    ds_read_b64_tr_b16 v[120:121], v9 offset:0
    ds_read_b64_tr_b16 v[122:123], v9 offset:3072
    s_waitcnt lgkmcnt(10)
    v_mfma_f32_16x16x32_bf16 v[124:127], v[100:103], v[20:23], v[124:127]
    v_mfma_f32_16x16x32_bf16 v[148:151], v[100:103], v[28:31], v[148:151]
    s_mov_b32 s46, 294912
    s_add_u32 m0, s36, 49152
    s_nop 0
    buffer_load_dwordx4 v2, s[12:15], s46 offen lds
    s_add_u32 m0, s36, 50176
    s_nop 0
    buffer_load_dwordx4 v3, s[12:15], s46 offen lds
    s_add_u32 m0, s36, 51200
    s_nop 0
    buffer_load_dwordx4 v4, s[12:15], s46 offen lds
    ds_read_b64_tr_b16 v[100:101], v8 offset:6144
    ds_read_b64_tr_b16 v[102:103], v8 offset:9216
    s_waitcnt lgkmcnt(10)
    v_mfma_f32_16x16x32_bf16 v[128:131], v[104:107], v[20:23], v[128:131]
    v_mfma_f32_16x16x32_bf16 v[152:155], v[104:107], v[28:31], v[152:155]
    ds_read_b64_tr_b16 v[104:105], v8 offset:6176
    ds_read_b64_tr_b16 v[106:107], v8 offset:9248
    s_waitcnt lgkmcnt(10)
    v_mfma_f32_16x16x32_bf16 v[132:135], v[108:111], v[20:23], v[132:135]
    v_mfma_f32_16x16x32_bf16 v[156:159], v[108:111], v[28:31], v[156:159]
    s_mov_b32 s47, 8192
    buffer_load_dwordx4 v[52:55], v5, s[16:19], s47 offen offset:0
    buffer_load_dwordx4 v[56:59], v5, s[16:19], s47 offen offset:1024
    buffer_load_dwordx4 v[60:63], v6, s[16:19], s47 offen offset:0
    buffer_load_dwordx4 v[64:67], v6, s[16:19], s47 offen offset:1024
    ds_read_b64_tr_b16 v[108:109], v8 offset:6208
    ds_read_b64_tr_b16 v[110:111], v8 offset:9280
    s_waitcnt lgkmcnt(10)
    v_mfma_f32_16x16x32_bf16 v[136:139], v[112:115], v[20:23], v[136:139]
    v_mfma_f32_16x16x32_bf16 v[160:163], v[112:115], v[28:31], v[160:163]
    s_mov_b32 s46, 442368
    s_add_u32 m0, s36, 73728
    s_nop 0
    buffer_load_dwordx4 v2, s[12:15], s46 offen lds
    s_add_u32 m0, s36, 74752
    s_nop 0
    buffer_load_dwordx4 v3, s[12:15], s46 offen lds
    s_add_u32 m0, s36, 75776
    s_nop 0
    buffer_load_dwordx4 v4, s[12:15], s46 offen lds
    ds_read_b64_tr_b16 v[112:113], v8 offset:6240
    ds_read_b64_tr_b16 v[114:115], v8 offset:9312
    s_waitcnt lgkmcnt(10)
    v_mfma_f32_16x16x32_bf16 v[140:143], v[116:119], v[20:23], v[140:143]
    v_mfma_f32_16x16x32_bf16 v[164:167], v[116:119], v[28:31], v[164:167]
    s_mov_b32 s47, 12288
    buffer_load_dwordx4 v[68:71], v5, s[16:19], s47 offen offset:0
    buffer_load_dwordx4 v[72:75], v5, s[16:19], s47 offen offset:1024
    buffer_load_dwordx4 v[76:79], v6, s[16:19], s47 offen offset:0
    buffer_load_dwordx4 v[80:83], v6, s[16:19], s47 offen offset:1024
    ds_read_b64_tr_b16 v[116:117], v8 offset:6272
    ds_read_b64_tr_b16 v[118:119], v8 offset:9344
    s_waitcnt lgkmcnt(10)
    v_mfma_f32_16x16x32_bf16 v[144:147], v[120:123], v[20:23], v[144:147]
    v_mfma_f32_16x16x32_bf16 v[168:171], v[120:123], v[28:31], v[168:171]
    s_mov_b32 s47, 16384
    buffer_load_dwordx4 v[84:87], v5, s[16:19], s47 offen offset:0
    buffer_load_dwordx4 v[88:91], v5, s[16:19], s47 offen offset:1024
    buffer_load_dwordx4 v[92:95], v6, s[16:19], s47 offen offset:0
    buffer_load_dwordx4 v[96:99], v6, s[16:19], s47 offen offset:1024
    ds_read_b64_tr_b16 v[120:121], v9 offset:6144
    ds_read_b64_tr_b16 v[122:123], v9 offset:9216
    s_waitcnt lgkmcnt(10)
    v_mfma_f32_16x16x32_bf16 v[124:127], v[100:103], v[24:27], v[124:127]
    v_mfma_f32_16x16x32_bf16 v[148:151], v[100:103], v[32:35], v[148:151]
    s_waitcnt vmcnt(22)
    s_barrier
    ds_read_b64_tr_b16 v[100:101], v8 offset:24576
    ds_read_b64_tr_b16 v[102:103], v8 offset:27648
    s_waitcnt lgkmcnt(10)
    v_mfma_f32_16x16x32_bf16 v[128:131], v[104:107], v[24:27], v[128:131]
    v_mfma_f32_16x16x32_bf16 v[152:155], v[104:107], v[32:35], v[152:155]
    s_mov_b32 s46, 589824
    s_add_u32 m0, s36, 98304
    s_nop 0
    buffer_load_dwordx4 v2, s[12:15], s46 offen lds
    ds_read_b64_tr_b16 v[104:105], v8 offset:24608
    ds_read_b64_tr_b16 v[106:107], v8 offset:27680
    s_waitcnt lgkmcnt(10)
    v_mfma_f32_16x16x32_bf16 v[132:135], v[108:111], v[24:27], v[132:135]
    v_mfma_f32_16x16x32_bf16 v[156:159], v[108:111], v[32:35], v[156:159]
    s_add_u32 m0, s36, 99328
    s_nop 0
    buffer_load_dwordx4 v3, s[12:15], s46 offen lds
    ds_read_b64_tr_b16 v[108:109], v8 offset:24640
    ds_read_b64_tr_b16 v[110:111], v8 offset:27712
    s_waitcnt lgkmcnt(10)
    v_mfma_f32_16x16x32_bf16 v[136:139], v[112:115], v[24:27], v[136:139]
    v_mfma_f32_16x16x32_bf16 v[160:163], v[112:115], v[32:35], v[160:163]
    s_add_u32 m0, s36, 100352
    s_nop 0
    buffer_load_dwordx4 v4, s[12:15], s46 offen lds
    ds_read_b64_tr_b16 v[112:113], v8 offset:24672
    ds_read_b64_tr_b16 v[114:115], v8 offset:27744
    s_waitcnt lgkmcnt(10)
    v_mfma_f32_16x16x32_bf16 v[140:143], v[116:119], v[24:27], v[140:143]
    v_mfma_f32_16x16x32_bf16 v[164:167], v[116:119], v[32:35], v[164:167]
    ds_read_b64_tr_b16 v[116:117], v8 offset:24704
    ds_read_b64_tr_b16 v[118:119], v8 offset:27776
    s_waitcnt lgkmcnt(10)
    v_mfma_f32_16x16x32_bf16 v[144:147], v[120:123], v[24:27], v[144:147]
    v_mfma_f32_16x16x32_bf16 v[168:171], v[120:123], v[32:35], v[168:171]
    s_waitcnt vmcnt(21)
    ds_read_b64_tr_b16 v[120:121], v9 offset:24576
    ds_read_b64_tr_b16 v[122:123], v9 offset:27648
    s_waitcnt lgkmcnt(10)
    v_mfma_f32_16x16x32_bf16 v[124:127], v[100:103], v[36:39], v[124:127]
    v_mfma_f32_16x16x32_bf16 v[148:151], v[100:103], v[44:47], v[148:151]
    s_mov_b32 s47, 20480
    buffer_load_dwordx4 v[20:23], v5, s[16:19], s47 offen offset:0
    ds_read_b64_tr_b16 v[100:101], v8 offset:30720
    ds_read_b64_tr_b16 v[102:103], v8 offset:33792
    s_waitcnt lgkmcnt(10)
    v_mfma_f32_16x16x32_bf16 v[128:131], v[104:107], v[36:39], v[128:131]
    v_mfma_f32_16x16x32_bf16 v[152:155], v[104:107], v[44:47], v[152:155]
    buffer_load_dwordx4 v[24:27], v5, s[16:19], s47 offen offset:1024
    ds_read_b64_tr_b16 v[104:105], v8 offset:30752
    ds_read_b64_tr_b16 v[106:107], v8 offset:33824
    s_waitcnt lgkmcnt(10)
    v_mfma_f32_16x16x32_bf16 v[132:135], v[108:111], v[36:39], v[132:135]
    v_mfma_f32_16x16x32_bf16 v[156:159], v[108:111], v[44:47], v[156:159]
    buffer_load_dwordx4 v[28:31], v6, s[16:19], s47 offen offset:0
    ds_read_b64_tr_b16 v[108:109], v8 offset:30784
    ds_read_b64_tr_b16 v[110:111], v8 offset:33856
    s_waitcnt lgkmcnt(10)
    v_mfma_f32_16x16x32_bf16 v[136:139], v[112:115], v[36:39], v[136:139]
    v_mfma_f32_16x16x32_bf16 v[160:163], v[112:115], v[44:47], v[160:163]
    buffer_load_dwordx4 v[32:35], v6, s[16:19], s47 offen offset:1024
    ds_read_b64_tr_b16 v[112:113], v8 offset:30816
    ds_read_b64_tr_b16 v[114:115], v8 offset:33888
    s_waitcnt lgkmcnt(10)
    v_mfma_f32_16x16x32_bf16 v[140:143], v[116:119], v[36:39], v[140:143]
    v_mfma_f32_16x16x32_bf16 v[164:167], v[116:119], v[44:47], v[164:167]
    ds_read_b64_tr_b16 v[116:117], v8 offset:30848
    ds_read_b64_tr_b16 v[118:119], v8 offset:33920
    s_waitcnt lgkmcnt(10)
    v_mfma_f32_16x16x32_bf16 v[144:147], v[120:123], v[36:39], v[144:147]
    v_mfma_f32_16x16x32_bf16 v[168:171], v[120:123], v[44:47], v[168:171]
    ds_read_b64_tr_b16 v[120:121], v9 offset:30720
    ds_read_b64_tr_b16 v[122:123], v9 offset:33792
    s_waitcnt lgkmcnt(10)
    v_mfma_f32_16x16x32_bf16 v[124:127], v[100:103], v[40:43], v[124:127]
    v_mfma_f32_16x16x32_bf16 v[148:151], v[100:103], v[48:51], v[148:151]
    s_waitcnt vmcnt(22)
    s_barrier
    ds_read_b64_tr_b16 v[100:101], v10 offset:0
    ds_read_b64_tr_b16 v[102:103], v10 offset:3072
    s_waitcnt lgkmcnt(10)
    v_mfma_f32_16x16x32_bf16 v[128:131], v[104:107], v[40:43], v[128:131]
    v_mfma_f32_16x16x32_bf16 v[152:155], v[104:107], v[48:51], v[152:155]
    s_mov_b32 s46, 737280
    s_add_u32 m0, s36, 0
    s_nop 0
    buffer_load_dwordx4 v2, s[12:15], s46 offen lds
    ds_read_b64_tr_b16 v[104:105], v10 offset:32
    ds_read_b64_tr_b16 v[106:107], v10 offset:3104
    s_waitcnt lgkmcnt(10)
    v_mfma_f32_16x16x32_bf16 v[132:135], v[108:111], v[40:43], v[132:135]
    v_mfma_f32_16x16x32_bf16 v[156:159], v[108:111], v[48:51], v[156:159]
    s_add_u32 m0, s36, 1024
    s_nop 0
    buffer_load_dwordx4 v3, s[12:15], s46 offen lds
    ds_read_b64_tr_b16 v[108:109], v10 offset:64
    ds_read_b64_tr_b16 v[110:111], v10 offset:3136
    s_waitcnt lgkmcnt(10)
    v_mfma_f32_16x16x32_bf16 v[136:139], v[112:115], v[40:43], v[136:139]
    v_mfma_f32_16x16x32_bf16 v[160:163], v[112:115], v[48:51], v[160:163]
    s_add_u32 m0, s36, 2048
    s_nop 0
    buffer_load_dwordx4 v4, s[12:15], s46 offen lds
    ds_read_b64_tr_b16 v[112:113], v10 offset:96
    ds_read_b64_tr_b16 v[114:115], v10 offset:3168
    s_waitcnt lgkmcnt(10)
    v_mfma_f32_16x16x32_bf16 v[140:143], v[116:119], v[40:43], v[140:143]
    v_mfma_f32_16x16x32_bf16 v[164:167], v[116:119], v[48:51], v[164:167]
    ds_read_b64_tr_b16 v[116:117], v10 offset:128
    ds_read_b64_tr_b16 v[118:119], v10 offset:3200
    s_waitcnt lgkmcnt(10)
    v_mfma_f32_16x16x32_bf16 v[144:147], v[120:123], v[40:43], v[144:147]
    v_mfma_f32_16x16x32_bf16 v[168:171], v[120:123], v[48:51], v[168:171]
    s_waitcnt vmcnt(21)
    ds_read_b64_tr_b16 v[120:121], v11 offset:0
    ds_read_b64_tr_b16 v[122:123], v11 offset:3072
    s_waitcnt lgkmcnt(10)
    v_mfma_f32_16x16x32_bf16 v[124:127], v[100:103], v[52:55], v[124:127]
    v_mfma_f32_16x16x32_bf16 v[148:151], v[100:103], v[60:63], v[148:151]
    s_mov_b32 s47, 24576
    buffer_load_dwordx4 v[36:39], v5, s[16:19], s47 offen offset:0
    ds_read_b64_tr_b16 v[100:101], v10 offset:6144
    ds_read_b64_tr_b16 v[102:103], v10 offset:9216
    s_waitcnt lgkmcnt(10)
    v_mfma_f32_16x16x32_bf16 v[128:131], v[104:107], v[52:55], v[128:131]
    v_mfma_f32_16x16x32_bf16 v[152:155], v[104:107], v[60:63], v[152:155]
    buffer_load_dwordx4 v[40:43], v5, s[16:19], s47 offen offset:1024
    ds_read_b64_tr_b16 v[104:105], v10 offset:6176
    ds_read_b64_tr_b16 v[106:107], v10 offset:9248
    s_waitcnt lgkmcnt(10)
    v_mfma_f32_16x16x32_bf16 v[132:135], v[108:111], v[52:55], v[132:135]
    v_mfma_f32_16x16x32_bf16 v[156:159], v[108:111], v[60:63], v[156:159]
    buffer_load_dwordx4 v[44:47], v6, s[16:19], s47 offen offset:0
    ds_read_b64_tr_b16 v[108:109], v10 offset:6208
    ds_read_b64_tr_b16 v[110:111], v10 offset:9280
    s_waitcnt lgkmcnt(10)
    v_mfma_f32_16x16x32_bf16 v[136:139], v[112:115], v[52:55], v[136:139]
    v_mfma_f32_16x16x32_bf16 v[160:163], v[112:115], v[60:63], v[160:163]
    buffer_load_dwordx4 v[48:51], v6, s[16:19], s47 offen offset:1024
    ds_read_b64_tr_b16 v[112:113], v10 offset:6240
    ds_read_b64_tr_b16 v[114:115], v10 offset:9312
    s_waitcnt lgkmcnt(10)
    v_mfma_f32_16x16x32_bf16 v[140:143], v[116:119], v[52:55], v[140:143]
    v_mfma_f32_16x16x32_bf16 v[164:167], v[116:119], v[60:63], v[164:167]
    ds_read_b64_tr_b16 v[116:117], v10 offset:6272
    ds_read_b64_tr_b16 v[118:119], v10 offset:9344
    s_waitcnt lgkmcnt(10)
    v_mfma_f32_16x16x32_bf16 v[144:147], v[120:123], v[52:55], v[144:147]
    v_mfma_f32_16x16x32_bf16 v[168:171], v[120:123], v[60:63], v[168:171]
    ds_read_b64_tr_b16 v[120:121], v11 offset:6144
    ds_read_b64_tr_b16 v[122:123], v11 offset:9216
    s_waitcnt lgkmcnt(10)
    v_mfma_f32_16x16x32_bf16 v[124:127], v[100:103], v[56:59], v[124:127]
    v_mfma_f32_16x16x32_bf16 v[148:151], v[100:103], v[64:67], v[148:151]
    s_waitcnt vmcnt(22)
    s_barrier
    ds_read_b64_tr_b16 v[100:101], v10 offset:24576
    ds_read_b64_tr_b16 v[102:103], v10 offset:27648
    s_waitcnt lgkmcnt(10)
    v_mfma_f32_16x16x32_bf16 v[128:131], v[104:107], v[56:59], v[128:131]
    v_mfma_f32_16x16x32_bf16 v[152:155], v[104:107], v[64:67], v[152:155]
    s_mov_b32 s46, 884736
    s_add_u32 m0, s36, 24576
    s_nop 0
    buffer_load_dwordx4 v2, s[12:15], s46 offen lds
    ds_read_b64_tr_b16 v[104:105], v10 offset:24608
    ds_read_b64_tr_b16 v[106:107], v10 offset:27680
    s_waitcnt lgkmcnt(10)
    v_mfma_f32_16x16x32_bf16 v[132:135], v[108:111], v[56:59], v[132:135]
    v_mfma_f32_16x16x32_bf16 v[156:159], v[108:111], v[64:67], v[156:159]
    s_add_u32 m0, s36, 25600
    s_nop 0
    buffer_load_dwordx4 v3, s[12:15], s46 offen lds
    ds_read_b64_tr_b16 v[108:109], v10 offset:24640
    ds_read_b64_tr_b16 v[110:111], v10 offset:27712
    s_waitcnt lgkmcnt(10)
    v_mfma_f32_16x16x32_bf16 v[136:139], v[112:115], v[56:59], v[136:139]
    v_mfma_f32_16x16x32_bf16 v[160:163], v[112:115], v[64:67], v[160:163]
    s_add_u32 m0, s36, 26624
    s_nop 0
    buffer_load_dwordx4 v4, s[12:15], s46 offen lds
    ds_read_b64_tr_b16 v[112:113], v10 offset:24672
    ds_read_b64_tr_b16 v[114:115], v10 offset:27744
    s_waitcnt lgkmcnt(10)
    v_mfma_f32_16x16x32_bf16 v[140:143], v[116:119], v[56:59], v[140:143]
    v_mfma_f32_16x16x32_bf16 v[164:167], v[116:119], v[64:67], v[164:167]
    ds_read_b64_tr_b16 v[116:117], v10 offset:24704
    ds_read_b64_tr_b16 v[118:119], v10 offset:27776
    s_waitcnt lgkmcnt(10)
    v_mfma_f32_16x16x32_bf16 v[144:147], v[120:123], v[56:59], v[144:147]
    v_mfma_f32_16x16x32_bf16 v[168:171], v[120:123], v[64:67], v[168:171]
    s_waitcnt vmcnt(21)
    ds_read_b64_tr_b16 v[120:121], v11 offset:24576
    ds_read_b64_tr_b16 v[122:123], v11 offset:27648
    s_waitcnt lgkmcnt(10)
    v_mfma_f32_16x16x32_bf16 v[124:127], v[100:103], v[68:71], v[124:127]
    v_mfma_f32_16x16x32_bf16 v[148:151], v[100:103], v[76:79], v[148:151]
    s_mov_b32 s47, 28672
    buffer_load_dwordx4 v[52:55], v5, s[16:19], s47 offen offset:0
    ds_read_b64_tr_b16 v[100:101], v10 offset:30720
    ds_read_b64_tr_b16 v[102:103], v10 offset:33792
    s_waitcnt lgkmcnt(10)
    v_mfma_f32_16x16x32_bf16 v[128:131], v[104:107], v[68:71], v[128:131]
    v_mfma_f32_16x16x32_bf16 v[152:155], v[104:107], v[76:79], v[152:155]
    buffer_load_dwordx4 v[56:59], v5, s[16:19], s47 offen offset:1024
    ds_read_b64_tr_b16 v[104:105], v10 offset:30752
    ds_read_b64_tr_b16 v[106:107], v10 offset:33824
    s_waitcnt lgkmcnt(10)
    v_mfma_f32_16x16x32_bf16 v[132:135], v[108:111], v[68:71], v[132:135]
    v_mfma_f32_16x16x32_bf16 v[156:159], v[108:111], v[76:79], v[156:159]
    buffer_load_dwordx4 v[60:63], v6, s[16:19], s47 offen offset:0
    ds_read_b64_tr_b16 v[108:109], v10 offset:30784
    ds_read_b64_tr_b16 v[110:111], v10 offset:33856
    s_waitcnt lgkmcnt(10)
    v_mfma_f32_16x16x32_bf16 v[136:139], v[112:115], v[68:71], v[136:139]
    v_mfma_f32_16x16x32_bf16 v[160:163], v[112:115], v[76:79], v[160:163]
    buffer_load_dwordx4 v[64:67], v6, s[16:19], s47 offen offset:1024
    ds_read_b64_tr_b16 v[112:113], v10 offset:30816
    ds_read_b64_tr_b16 v[114:115], v10 offset:33888
    s_waitcnt lgkmcnt(10)
    v_mfma_f32_16x16x32_bf16 v[140:143], v[116:119], v[68:71], v[140:143]
    v_mfma_f32_16x16x32_bf16 v[164:167], v[116:119], v[76:79], v[164:167]
    ds_read_b64_tr_b16 v[116:117], v10 offset:30848
    ds_read_b64_tr_b16 v[118:119], v10 offset:33920
    s_waitcnt lgkmcnt(10)
    v_mfma_f32_16x16x32_bf16 v[144:147], v[120:123], v[68:71], v[144:147]
    v_mfma_f32_16x16x32_bf16 v[168:171], v[120:123], v[76:79], v[168:171]
    ds_read_b64_tr_b16 v[120:121], v11 offset:30720
    ds_read_b64_tr_b16 v[122:123], v11 offset:33792
    s_waitcnt lgkmcnt(10)
    v_mfma_f32_16x16x32_bf16 v[124:127], v[100:103], v[72:75], v[124:127]
    v_mfma_f32_16x16x32_bf16 v[148:151], v[100:103], v[80:83], v[148:151]
    s_waitcnt vmcnt(18)
    s_barrier
    ds_read_b64_tr_b16 v[100:101], v12 offset:0
    ds_read_b64_tr_b16 v[102:103], v12 offset:3072
    s_waitcnt lgkmcnt(10)
    v_mfma_f32_16x16x32_bf16 v[128:131], v[104:107], v[72:75], v[128:131]
    v_mfma_f32_16x16x32_bf16 v[152:155], v[104:107], v[80:83], v[152:155]
    s_mov_b32 s46, 1032192
    s_add_u32 m0, s36, 49152
    s_nop 0
    buffer_load_dwordx4 v2, s[12:15], s46 offen lds
    ds_read_b64_tr_b16 v[104:105], v12 offset:32
    ds_read_b64_tr_b16 v[106:107], v12 offset:3104
    s_waitcnt lgkmcnt(10)
    v_mfma_f32_16x16x32_bf16 v[132:135], v[108:111], v[72:75], v[132:135]
    v_mfma_f32_16x16x32_bf16 v[156:159], v[108:111], v[80:83], v[156:159]
    s_add_u32 m0, s36, 50176
    s_nop 0
    buffer_load_dwordx4 v3, s[12:15], s46 offen lds
    ds_read_b64_tr_b16 v[108:109], v12 offset:64
    ds_read_b64_tr_b16 v[110:111], v12 offset:3136
    s_waitcnt lgkmcnt(10)
    v_mfma_f32_16x16x32_bf16 v[136:139], v[112:115], v[72:75], v[136:139]
    v_mfma_f32_16x16x32_bf16 v[160:163], v[112:115], v[80:83], v[160:163]
    s_add_u32 m0, s36, 51200
    s_nop 0
    buffer_load_dwordx4 v4, s[12:15], s46 offen lds
    ds_read_b64_tr_b16 v[112:113], v12 offset:96
    ds_read_b64_tr_b16 v[114:115], v12 offset:3168
    s_waitcnt lgkmcnt(10)
    v_mfma_f32_16x16x32_bf16 v[140:143], v[116:119], v[72:75], v[140:143]
    v_mfma_f32_16x16x32_bf16 v[164:167], v[116:119], v[80:83], v[164:167]
    ds_read_b64_tr_b16 v[116:117], v12 offset:128
    ds_read_b64_tr_b16 v[118:119], v12 offset:3200
    s_waitcnt lgkmcnt(10)
    v_mfma_f32_16x16x32_bf16 v[144:147], v[120:123], v[72:75], v[144:147]
    v_mfma_f32_16x16x32_bf16 v[168:171], v[120:123], v[80:83], v[168:171]
    ds_read_b64_tr_b16 v[120:121], v13 offset:0
    ds_read_b64_tr_b16 v[122:123], v13 offset:3072
    s_waitcnt lgkmcnt(10)
    v_mfma_f32_16x16x32_bf16 v[124:127], v[100:103], v[84:87], v[124:127]
    v_mfma_f32_16x16x32_bf16 v[148:151], v[100:103], v[92:95], v[148:151]
    s_mov_b32 s47, 32768
    buffer_load_dwordx4 v[68:71], v5, s[16:19], s47 offen offset:0
    ds_read_b64_tr_b16 v[100:101], v12 offset:6144
    ds_read_b64_tr_b16 v[102:103], v12 offset:9216
    s_waitcnt lgkmcnt(10)
    v_mfma_f32_16x16x32_bf16 v[128:131], v[104:107], v[84:87], v[128:131]
    v_mfma_f32_16x16x32_bf16 v[152:155], v[104:107], v[92:95], v[152:155]
    buffer_load_dwordx4 v[72:75], v5, s[16:19], s47 offen offset:1024
    ds_read_b64_tr_b16 v[104:105], v12 offset:6176
    ds_read_b64_tr_b16 v[106:107], v12 offset:9248
    s_waitcnt lgkmcnt(10)
    v_mfma_f32_16x16x32_bf16 v[132:135], v[108:111], v[84:87], v[132:135]
    v_mfma_f32_16x16x32_bf16 v[156:159], v[108:111], v[92:95], v[156:159]
    buffer_load_dwordx4 v[76:79], v6, s[16:19], s47 offen offset:0
    ds_read_b64_tr_b16 v[108:109], v12 offset:6208
    ds_read_b64_tr_b16 v[110:111], v12 offset:9280
    s_waitcnt lgkmcnt(10)
    v_mfma_f32_16x16x32_bf16 v[136:139], v[112:115], v[84:87], v[136:139]
    v_mfma_f32_16x16x32_bf16 v[160:163], v[112:115], v[92:95], v[160:163]
    buffer_load_dwordx4 v[80:83], v6, s[16:19], s47 offen offset:1024
    ds_read_b64_tr_b16 v[112:113], v12 offset:6240
    ds_read_b64_tr_b16 v[114:115], v12 offset:9312
    s_waitcnt lgkmcnt(10)
    v_mfma_f32_16x16x32_bf16 v[140:143], v[116:119], v[84:87], v[140:143]
    v_mfma_f32_16x16x32_bf16 v[164:167], v[116:119], v[92:95], v[164:167]
    ds_read_b64_tr_b16 v[116:117], v12 offset:6272
    ds_read_b64_tr_b16 v[118:119], v12 offset:9344
    s_waitcnt lgkmcnt(10)
    v_mfma_f32_16x16x32_bf16 v[144:147], v[120:123], v[84:87], v[144:147]
    v_mfma_f32_16x16x32_bf16 v[168:171], v[120:123], v[92:95], v[168:171]
    ds_read_b64_tr_b16 v[120:121], v13 offset:6144
    ds_read_b64_tr_b16 v[122:123], v13 offset:9216
    s_waitcnt lgkmcnt(10)
    v_mfma_f32_16x16x32_bf16 v[124:127], v[100:103], v[88:91], v[124:127]
    v_mfma_f32_16x16x32_bf16 v[148:151], v[100:103], v[96:99], v[148:151]
    s_waitcnt vmcnt(18)
    s_barrier
    ds_read_b64_tr_b16 v[100:101], v8 offset:0
    ds_read_b64_tr_b16 v[102:103], v8 offset:3072
    s_waitcnt lgkmcnt(10)
    v_mfma_f32_16x16x32_bf16 v[128:131], v[104:107], v[88:91], v[128:131]
    v_mfma_f32_16x16x32_bf16 v[152:155], v[104:107], v[96:99], v[152:155]
    s_mov_b32 s46, 1179648
    s_add_u32 m0, s36, 73728
    s_nop 0
    buffer_load_dwordx4 v2, s[12:15], s46 offen lds
    ds_read_b64_tr_b16 v[104:105], v8 offset:32
    ds_read_b64_tr_b16 v[106:107], v8 offset:3104
    s_waitcnt lgkmcnt(10)
    v_mfma_f32_16x16x32_bf16 v[132:135], v[108:111], v[88:91], v[132:135]
    v_mfma_f32_16x16x32_bf16 v[156:159], v[108:111], v[96:99], v[156:159]
    s_add_u32 m0, s36, 74752
    s_nop 0
    buffer_load_dwordx4 v3, s[12:15], s46 offen lds
    ds_read_b64_tr_b16 v[108:109], v8 offset:64
    ds_read_b64_tr_b16 v[110:111], v8 offset:3136
    s_waitcnt lgkmcnt(10)
    v_mfma_f32_16x16x32_bf16 v[136:139], v[112:115], v[88:91], v[136:139]
    v_mfma_f32_16x16x32_bf16 v[160:163], v[112:115], v[96:99], v[160:163]
    s_add_u32 m0, s36, 75776
    s_nop 0
    buffer_load_dwordx4 v4, s[12:15], s46 offen lds
    ds_read_b64_tr_b16 v[112:113], v8 offset:96
    ds_read_b64_tr_b16 v[114:115], v8 offset:3168
    s_waitcnt lgkmcnt(10)
    v_mfma_f32_16x16x32_bf16 v[140:143], v[116:119], v[88:91], v[140:143]
    v_mfma_f32_16x16x32_bf16 v[164:167], v[116:119], v[96:99], v[164:167]
    ds_read_b64_tr_b16 v[116:117], v8 offset:128
    ds_read_b64_tr_b16 v[118:119], v8 offset:3200
    s_waitcnt lgkmcnt(10)
    v_mfma_f32_16x16x32_bf16 v[144:147], v[120:123], v[88:91], v[144:147]
    v_mfma_f32_16x16x32_bf16 v[168:171], v[120:123], v[96:99], v[168:171]
    ds_read_b64_tr_b16 v[120:121], v9 offset:0
    ds_read_b64_tr_b16 v[122:123], v9 offset:3072
    s_waitcnt lgkmcnt(10)
    v_mfma_f32_16x16x32_bf16 v[124:127], v[100:103], v[20:23], v[124:127]
    v_mfma_f32_16x16x32_bf16 v[148:151], v[100:103], v[28:31], v[148:151]
    s_mov_b32 s47, 36864
    buffer_load_dwordx4 v[84:87], v5, s[16:19], s47 offen offset:0
    ds_read_b64_tr_b16 v[100:101], v8 offset:6144
    ds_read_b64_tr_b16 v[102:103], v8 offset:9216
    s_waitcnt lgkmcnt(10)
    v_mfma_f32_16x16x32_bf16 v[128:131], v[104:107], v[20:23], v[128:131]
    v_mfma_f32_16x16x32_bf16 v[152:155], v[104:107], v[28:31], v[152:155]
    buffer_load_dwordx4 v[88:91], v5, s[16:19], s47 offen offset:1024
    ds_read_b64_tr_b16 v[104:105], v8 offset:6176
    ds_read_b64_tr_b16 v[106:107], v8 offset:9248
    s_waitcnt lgkmcnt(10)
    v_mfma_f32_16x16x32_bf16 v[132:135], v[108:111], v[20:23], v[132:135]
    v_mfma_f32_16x16x32_bf16 v[156:159], v[108:111], v[28:31], v[156:159]
    buffer_load_dwordx4 v[92:95], v6, s[16:19], s47 offen offset:0
    ds_read_b64_tr_b16 v[108:109], v8 offset:6208
    ds_read_b64_tr_b16 v[110:111], v8 offset:9280
    s_waitcnt lgkmcnt(10)
    v_mfma_f32_16x16x32_bf16 v[136:139], v[112:115], v[20:23], v[136:139]
    v_mfma_f32_16x16x32_bf16 v[160:163], v[112:115], v[28:31], v[160:163]
    buffer_load_dwordx4 v[96:99], v6, s[16:19], s47 offen offset:1024
    ds_read_b64_tr_b16 v[112:113], v8 offset:6240
    ds_read_b64_tr_b16 v[114:115], v8 offset:9312
    s_waitcnt lgkmcnt(10)
    v_mfma_f32_16x16x32_bf16 v[140:143], v[116:119], v[20:23], v[140:143]
    v_mfma_f32_16x16x32_bf16 v[164:167], v[116:119], v[28:31], v[164:167]
    ds_read_b64_tr_b16 v[116:117], v8 offset:6272
    ds_read_b64_tr_b16 v[118:119], v8 offset:9344
    s_waitcnt lgkmcnt(10)
    v_mfma_f32_16x16x32_bf16 v[144:147], v[120:123], v[20:23], v[144:147]
    v_mfma_f32_16x16x32_bf16 v[168:171], v[120:123], v[28:31], v[168:171]
    ds_read_b64_tr_b16 v[120:121], v9 offset:6144
    ds_read_b64_tr_b16 v[122:123], v9 offset:9216
    s_waitcnt lgkmcnt(10)
    v_mfma_f32_16x16x32_bf16 v[124:127], v[100:103], v[24:27], v[124:127]
    v_mfma_f32_16x16x32_bf16 v[148:151], v[100:103], v[32:35], v[148:151]
    s_waitcnt vmcnt(18)
    s_barrier
    ds_read_b64_tr_b16 v[100:101], v8 offset:24576
    ds_read_b64_tr_b16 v[102:103], v8 offset:27648
    s_waitcnt lgkmcnt(10)
    v_mfma_f32_16x16x32_bf16 v[128:131], v[104:107], v[24:27], v[128:131]
    v_mfma_f32_16x16x32_bf16 v[152:155], v[104:107], v[32:35], v[152:155]
    s_mov_b32 s46, 1327104
    s_add_u32 m0, s36, 98304
    s_nop 0
    buffer_load_dwordx4 v2, s[12:15], s46 offen lds
    ds_read_b64_tr_b16 v[104:105], v8 offset:24608
    ds_read_b64_tr_b16 v[106:107], v8 offset:27680
    s_waitcnt lgkmcnt(10)
    v_mfma_f32_16x16x32_bf16 v[132:135], v[108:111], v[24:27], v[132:135]
    v_mfma_f32_16x16x32_bf16 v[156:159], v[108:111], v[32:35], v[156:159]
    s_add_u32 m0, s36, 99328
    s_nop 0
    buffer_load_dwordx4 v3, s[12:15], s46 offen lds
    ds_read_b64_tr_b16 v[108:109], v8 offset:24640
    ds_read_b64_tr_b16 v[110:111], v8 offset:27712
    s_waitcnt lgkmcnt(10)
    v_mfma_f32_16x16x32_bf16 v[136:139], v[112:115], v[24:27], v[136:139]
    v_mfma_f32_16x16x32_bf16 v[160:163], v[112:115], v[32:35], v[160:163]
    s_add_u32 m0, s36, 100352
    s_nop 0
    buffer_load_dwordx4 v4, s[12:15], s46 offen lds
    ds_read_b64_tr_b16 v[112:113], v8 offset:24672
    ds_read_b64_tr_b16 v[114:115], v8 offset:27744
    s_waitcnt lgkmcnt(10)
    v_mfma_f32_16x16x32_bf16 v[140:143], v[116:119], v[24:27], v[140:143]
    v_mfma_f32_16x16x32_bf16 v[164:167], v[116:119], v[32:35], v[164:167]
    ds_read_b64_tr_b16 v[116:117], v8 offset:24704
    ds_read_b64_tr_b16 v[118:119], v8 offset:27776
    s_waitcnt lgkmcnt(10)
    v_mfma_f32_16x16x32_bf16 v[144:147], v[120:123], v[24:27], v[144:147]
    v_mfma_f32_16x16x32_bf16 v[168:171], v[120:123], v[32:35], v[168:171]
    ds_read_b64_tr_b16 v[120:121], v9 offset:24576
    ds_read_b64_tr_b16 v[122:123], v9 offset:27648
    s_waitcnt lgkmcnt(10)
    v_mfma_f32_16x16x32_bf16 v[124:127], v[100:103], v[36:39], v[124:127]
    v_mfma_f32_16x16x32_bf16 v[148:151], v[100:103], v[44:47], v[148:151]
    s_mov_b32 s47, 40960
    buffer_load_dwordx4 v[20:23], v5, s[16:19], s47 offen offset:0
    ds_read_b64_tr_b16 v[100:101], v8 offset:30720
    ds_read_b64_tr_b16 v[102:103], v8 offset:33792
    s_waitcnt lgkmcnt(10)
    v_mfma_f32_16x16x32_bf16 v[128:131], v[104:107], v[36:39], v[128:131]
    v_mfma_f32_16x16x32_bf16 v[152:155], v[104:107], v[44:47], v[152:155]
    buffer_load_dwordx4 v[24:27], v5, s[16:19], s47 offen offset:1024
    ds_read_b64_tr_b16 v[104:105], v8 offset:30752
    ds_read_b64_tr_b16 v[106:107], v8 offset:33824
    s_waitcnt lgkmcnt(10)
    v_mfma_f32_16x16x32_bf16 v[132:135], v[108:111], v[36:39], v[132:135]
    v_mfma_f32_16x16x32_bf16 v[156:159], v[108:111], v[44:47], v[156:159]
    buffer_load_dwordx4 v[28:31], v6, s[16:19], s47 offen offset:0
    ds_read_b64_tr_b16 v[108:109], v8 offset:30784
    ds_read_b64_tr_b16 v[110:111], v8 offset:33856
    s_waitcnt lgkmcnt(10)
    v_mfma_f32_16x16x32_bf16 v[136:139], v[112:115], v[36:39], v[136:139]
    v_mfma_f32_16x16x32_bf16 v[160:163], v[112:115], v[44:47], v[160:163]
    buffer_load_dwordx4 v[32:35], v6, s[16:19], s47 offen offset:1024
    ds_read_b64_tr_b16 v[112:113], v8 offset:30816
    ds_read_b64_tr_b16 v[114:115], v8 offset:33888
    s_waitcnt lgkmcnt(10)
    v_mfma_f32_16x16x32_bf16 v[140:143], v[116:119], v[36:39], v[140:143]
    v_mfma_f32_16x16x32_bf16 v[164:167], v[116:119], v[44:47], v[164:167]
    ds_read_b64_tr_b16 v[116:117], v8 offset:30848
    ds_read_b64_tr_b16 v[118:119], v8 offset:33920
    s_waitcnt lgkmcnt(10)
    v_mfma_f32_16x16x32_bf16 v[144:147], v[120:123], v[36:39], v[144:147]
    v_mfma_f32_16x16x32_bf16 v[168:171], v[120:123], v[44:47], v[168:171]
    ds_read_b64_tr_b16 v[120:121], v9 offset:30720
    ds_read_b64_tr_b16 v[122:123], v9 offset:33792
    s_waitcnt lgkmcnt(10)
    v_mfma_f32_16x16x32_bf16 v[124:127], v[100:103], v[40:43], v[124:127]
    v_mfma_f32_16x16x32_bf16 v[148:151], v[100:103], v[48:51], v[148:151]
    s_waitcnt vmcnt(18)
    s_barrier
    ds_read_b64_tr_b16 v[100:101], v10 offset:0
    ds_read_b64_tr_b16 v[102:103], v10 offset:3072
    s_waitcnt lgkmcnt(10)
    v_mfma_f32_16x16x32_bf16 v[128:131], v[104:107], v[40:43], v[128:131]
    v_mfma_f32_16x16x32_bf16 v[152:155], v[104:107], v[48:51], v[152:155]
    s_mov_b32 s46, 1474560
    s_add_u32 m0, s36, 0
    s_nop 0
    buffer_load_dwordx4 v2, s[12:15], s46 offen lds
    ds_read_b64_tr_b16 v[104:105], v10 offset:32
    ds_read_b64_tr_b16 v[106:107], v10 offset:3104
    s_waitcnt lgkmcnt(10)
    v_mfma_f32_16x16x32_bf16 v[132:135], v[108:111], v[40:43], v[132:135]
    v_mfma_f32_16x16x32_bf16 v[156:159], v[108:111], v[48:51], v[156:159]
    s_add_u32 m0, s36, 1024
    s_nop 0
    buffer_load_dwordx4 v3, s[12:15], s46 offen lds
    ds_read_b64_tr_b16 v[108:109], v10 offset:64
    ds_read_b64_tr_b16 v[110:111], v10 offset:3136
    s_waitcnt lgkmcnt(10)
    v_mfma_f32_16x16x32_bf16 v[136:139], v[112:115], v[40:43], v[136:139]
    v_mfma_f32_16x16x32_bf16 v[160:163], v[112:115], v[48:51], v[160:163]
    s_add_u32 m0, s36, 2048
    s_nop 0
    buffer_load_dwordx4 v4, s[12:15], s46 offen lds
    ds_read_b64_tr_b16 v[112:113], v10 offset:96
    ds_read_b64_tr_b16 v[114:115], v10 offset:3168
    s_waitcnt lgkmcnt(10)
    v_mfma_f32_16x16x32_bf16 v[140:143], v[116:119], v[40:43], v[140:143]
    v_mfma_f32_16x16x32_bf16 v[164:167], v[116:119], v[48:51], v[164:167]
    ds_read_b64_tr_b16 v[116:117], v10 offset:128
    ds_read_b64_tr_b16 v[118:119], v10 offset:3200
    s_waitcnt lgkmcnt(10)
    v_mfma_f32_16x16x32_bf16 v[144:147], v[120:123], v[40:43], v[144:147]
    v_mfma_f32_16x16x32_bf16 v[168:171], v[120:123], v[48:51], v[168:171]
    ds_read_b64_tr_b16 v[120:121], v11 offset:0
    ds_read_b64_tr_b16 v[122:123], v11 offset:3072
    s_waitcnt lgkmcnt(10)
    v_mfma_f32_16x16x32_bf16 v[124:127], v[100:103], v[52:55], v[124:127]
    v_mfma_f32_16x16x32_bf16 v[148:151], v[100:103], v[60:63], v[148:151]
    s_mov_b32 s47, 45056
    buffer_load_dwordx4 v[36:39], v5, s[16:19], s47 offen offset:0
    ds_read_b64_tr_b16 v[100:101], v10 offset:6144
    ds_read_b64_tr_b16 v[102:103], v10 offset:9216
    s_waitcnt lgkmcnt(10)
    v_mfma_f32_16x16x32_bf16 v[128:131], v[104:107], v[52:55], v[128:131]
    v_mfma_f32_16x16x32_bf16 v[152:155], v[104:107], v[60:63], v[152:155]
    buffer_load_dwordx4 v[40:43], v5, s[16:19], s47 offen offset:1024
    ds_read_b64_tr_b16 v[104:105], v10 offset:6176
    ds_read_b64_tr_b16 v[106:107], v10 offset:9248
    s_waitcnt lgkmcnt(10)
    v_mfma_f32_16x16x32_bf16 v[132:135], v[108:111], v[52:55], v[132:135]
    v_mfma_f32_16x16x32_bf16 v[156:159], v[108:111], v[60:63], v[156:159]
    buffer_load_dwordx4 v[44:47], v6, s[16:19], s47 offen offset:0
    ds_read_b64_tr_b16 v[108:109], v10 offset:6208
    ds_read_b64_tr_b16 v[110:111], v10 offset:9280
    s_waitcnt lgkmcnt(10)
    v_mfma_f32_16x16x32_bf16 v[136:139], v[112:115], v[52:55], v[136:139]
    v_mfma_f32_16x16x32_bf16 v[160:163], v[112:115], v[60:63], v[160:163]
    buffer_load_dwordx4 v[48:51], v6, s[16:19], s47 offen offset:1024
    ds_read_b64_tr_b16 v[112:113], v10 offset:6240
    ds_read_b64_tr_b16 v[114:115], v10 offset:9312
    s_waitcnt lgkmcnt(10)
    v_mfma_f32_16x16x32_bf16 v[140:143], v[116:119], v[52:55], v[140:143]
    v_mfma_f32_16x16x32_bf16 v[164:167], v[116:119], v[60:63], v[164:167]
    ds_read_b64_tr_b16 v[116:117], v10 offset:6272
    ds_read_b64_tr_b16 v[118:119], v10 offset:9344
    s_waitcnt lgkmcnt(10)
    v_mfma_f32_16x16x32_bf16 v[144:147], v[120:123], v[52:55], v[144:147]
    v_mfma_f32_16x16x32_bf16 v[168:171], v[120:123], v[60:63], v[168:171]
    ds_read_b64_tr_b16 v[120:121], v11 offset:6144
    ds_read_b64_tr_b16 v[122:123], v11 offset:9216
    s_waitcnt lgkmcnt(10)
    v_mfma_f32_16x16x32_bf16 v[124:127], v[100:103], v[56:59], v[124:127]
    v_mfma_f32_16x16x32_bf16 v[148:151], v[100:103], v[64:67], v[148:151]
    s_waitcnt vmcnt(18)
    s_barrier
    ds_read_b64_tr_b16 v[100:101], v10 offset:24576
    ds_read_b64_tr_b16 v[102:103], v10 offset:27648
    s_waitcnt lgkmcnt(10)
    v_mfma_f32_16x16x32_bf16 v[128:131], v[104:107], v[56:59], v[128:131]
    v_mfma_f32_16x16x32_bf16 v[152:155], v[104:107], v[64:67], v[152:155]
    s_mov_b32 s46, 1622016
    s_add_u32 m0, s36, 24576
    s_nop 0
    buffer_load_dwordx4 v2, s[12:15], s46 offen lds
    ds_read_b64_tr_b16 v[104:105], v10 offset:24608
    ds_read_b64_tr_b16 v[106:107], v10 offset:27680
    s_waitcnt lgkmcnt(10)
    v_mfma_f32_16x16x32_bf16 v[132:135], v[108:111], v[56:59], v[132:135]
    v_mfma_f32_16x16x32_bf16 v[156:159], v[108:111], v[64:67], v[156:159]
    s_add_u32 m0, s36, 25600
    s_nop 0
    buffer_load_dwordx4 v3, s[12:15], s46 offen lds
    ds_read_b64_tr_b16 v[108:109], v10 offset:24640
    ds_read_b64_tr_b16 v[110:111], v10 offset:27712
    s_waitcnt lgkmcnt(10)
    v_mfma_f32_16x16x32_bf16 v[136:139], v[112:115], v[56:59], v[136:139]
    v_mfma_f32_16x16x32_bf16 v[160:163], v[112:115], v[64:67], v[160:163]
    s_add_u32 m0, s36, 26624
    s_nop 0
    buffer_load_dwordx4 v4, s[12:15], s46 offen lds
    ds_read_b64_tr_b16 v[112:113], v10 offset:24672
    ds_read_b64_tr_b16 v[114:115], v10 offset:27744
    s_waitcnt lgkmcnt(10)
    v_mfma_f32_16x16x32_bf16 v[140:143], v[116:119], v[56:59], v[140:143]
    v_mfma_f32_16x16x32_bf16 v[164:167], v[116:119], v[64:67], v[164:167]
    ds_read_b64_tr_b16 v[116:117], v10 offset:24704
    ds_read_b64_tr_b16 v[118:119], v10 offset:27776
    s_waitcnt lgkmcnt(10)
    v_mfma_f32_16x16x32_bf16 v[144:147], v[120:123], v[56:59], v[144:147]
    v_mfma_f32_16x16x32_bf16 v[168:171], v[120:123], v[64:67], v[168:171]
    ds_read_b64_tr_b16 v[120:121], v11 offset:24576
    ds_read_b64_tr_b16 v[122:123], v11 offset:27648
    s_waitcnt lgkmcnt(10)
    v_mfma_f32_16x16x32_bf16 v[124:127], v[100:103], v[68:71], v[124:127]
    v_mfma_f32_16x16x32_bf16 v[148:151], v[100:103], v[76:79], v[148:151]
    s_mov_b32 s47, 49152
    buffer_load_dwordx4 v[52:55], v5, s[16:19], s47 offen offset:0
    ds_read_b64_tr_b16 v[100:101], v10 offset:30720
    ds_read_b64_tr_b16 v[102:103], v10 offset:33792
    s_waitcnt lgkmcnt(10)
    v_mfma_f32_16x16x32_bf16 v[128:131], v[104:107], v[68:71], v[128:131]
    v_mfma_f32_16x16x32_bf16 v[152:155], v[104:107], v[76:79], v[152:155]
    buffer_load_dwordx4 v[56:59], v5, s[16:19], s47 offen offset:1024
    ds_read_b64_tr_b16 v[104:105], v10 offset:30752
    ds_read_b64_tr_b16 v[106:107], v10 offset:33824
    s_waitcnt lgkmcnt(10)
    v_mfma_f32_16x16x32_bf16 v[132:135], v[108:111], v[68:71], v[132:135]
    v_mfma_f32_16x16x32_bf16 v[156:159], v[108:111], v[76:79], v[156:159]
    buffer_load_dwordx4 v[60:63], v6, s[16:19], s47 offen offset:0
    ds_read_b64_tr_b16 v[108:109], v10 offset:30784
    ds_read_b64_tr_b16 v[110:111], v10 offset:33856
    s_waitcnt lgkmcnt(10)
    v_mfma_f32_16x16x32_bf16 v[136:139], v[112:115], v[68:71], v[136:139]
    v_mfma_f32_16x16x32_bf16 v[160:163], v[112:115], v[76:79], v[160:163]
    buffer_load_dwordx4 v[64:67], v6, s[16:19], s47 offen offset:1024
    ds_read_b64_tr_b16 v[112:113], v10 offset:30816
    ds_read_b64_tr_b16 v[114:115], v10 offset:33888
    s_waitcnt lgkmcnt(10)
    v_mfma_f32_16x16x32_bf16 v[140:143], v[116:119], v[68:71], v[140:143]
    v_mfma_f32_16x16x32_bf16 v[164:167], v[116:119], v[76:79], v[164:167]
    ds_read_b64_tr_b16 v[116:117], v10 offset:30848
    ds_read_b64_tr_b16 v[118:119], v10 offset:33920
    s_waitcnt lgkmcnt(10)
    v_mfma_f32_16x16x32_bf16 v[144:147], v[120:123], v[68:71], v[144:147]
    v_mfma_f32_16x16x32_bf16 v[168:171], v[120:123], v[76:79], v[168:171]
    ds_read_b64_tr_b16 v[120:121], v11 offset:30720
    ds_read_b64_tr_b16 v[122:123], v11 offset:33792
    s_waitcnt lgkmcnt(10)
    v_mfma_f32_16x16x32_bf16 v[124:127], v[100:103], v[72:75], v[124:127]
    v_mfma_f32_16x16x32_bf16 v[148:151], v[100:103], v[80:83], v[148:151]
    s_waitcnt vmcnt(18)
    s_barrier
    ds_read_b64_tr_b16 v[100:101], v12 offset:0
    ds_read_b64_tr_b16 v[102:103], v12 offset:3072
    s_waitcnt lgkmcnt(10)
    v_mfma_f32_16x16x32_bf16 v[128:131], v[104:107], v[72:75], v[128:131]
    v_mfma_f32_16x16x32_bf16 v[152:155], v[104:107], v[80:83], v[152:155]
    s_mov_b32 s46, 1769472
    s_add_u32 m0, s36, 49152
    s_nop 0
    buffer_load_dwordx4 v2, s[12:15], s46 offen lds
    ds_read_b64_tr_b16 v[104:105], v12 offset:32
    ds_read_b64_tr_b16 v[106:107], v12 offset:3104
    s_waitcnt lgkmcnt(10)
    v_mfma_f32_16x16x32_bf16 v[132:135], v[108:111], v[72:75], v[132:135]
    v_mfma_f32_16x16x32_bf16 v[156:159], v[108:111], v[80:83], v[156:159]
    s_add_u32 m0, s36, 50176
    s_nop 0
    buffer_load_dwordx4 v3, s[12:15], s46 offen lds
    ds_read_b64_tr_b16 v[108:109], v12 offset:64
    ds_read_b64_tr_b16 v[110:111], v12 offset:3136
    s_waitcnt lgkmcnt(10)
    v_mfma_f32_16x16x32_bf16 v[136:139], v[112:115], v[72:75], v[136:139]
    v_mfma_f32_16x16x32_bf16 v[160:163], v[112:115], v[80:83], v[160:163]
    s_add_u32 m0, s36, 51200
    s_nop 0
    buffer_load_dwordx4 v4, s[12:15], s46 offen lds
    ds_read_b64_tr_b16 v[112:113], v12 offset:96
    ds_read_b64_tr_b16 v[114:115], v12 offset:3168
    s_waitcnt lgkmcnt(10)
    v_mfma_f32_16x16x32_bf16 v[140:143], v[116:119], v[72:75], v[140:143]
    v_mfma_f32_16x16x32_bf16 v[164:167], v[116:119], v[80:83], v[164:167]
    ds_read_b64_tr_b16 v[116:117], v12 offset:128
    ds_read_b64_tr_b16 v[118:119], v12 offset:3200
    s_waitcnt lgkmcnt(10)
    v_mfma_f32_16x16x32_bf16 v[144:147], v[120:123], v[72:75], v[144:147]
    v_mfma_f32_16x16x32_bf16 v[168:171], v[120:123], v[80:83], v[168:171]
    ds_read_b64_tr_b16 v[120:121], v13 offset:0
    ds_read_b64_tr_b16 v[122:123], v13 offset:3072
    s_waitcnt lgkmcnt(10)
    v_mfma_f32_16x16x32_bf16 v[124:127], v[100:103], v[84:87], v[124:127]
    v_mfma_f32_16x16x32_bf16 v[148:151], v[100:103], v[92:95], v[148:151]
    s_mov_b32 s47, 53248
    buffer_load_dwordx4 v[68:71], v5, s[16:19], s47 offen offset:0
    ds_read_b64_tr_b16 v[100:101], v12 offset:6144
    ds_read_b64_tr_b16 v[102:103], v12 offset:9216
    s_waitcnt lgkmcnt(10)
    v_mfma_f32_16x16x32_bf16 v[128:131], v[104:107], v[84:87], v[128:131]
    v_mfma_f32_16x16x32_bf16 v[152:155], v[104:107], v[92:95], v[152:155]
    buffer_load_dwordx4 v[72:75], v5, s[16:19], s47 offen offset:1024
    ds_read_b64_tr_b16 v[104:105], v12 offset:6176
    ds_read_b64_tr_b16 v[106:107], v12 offset:9248
    s_waitcnt lgkmcnt(10)
    v_mfma_f32_16x16x32_bf16 v[132:135], v[108:111], v[84:87], v[132:135]
    v_mfma_f32_16x16x32_bf16 v[156:159], v[108:111], v[92:95], v[156:159]
    buffer_load_dwordx4 v[76:79], v6, s[16:19], s47 offen offset:0
    ds_read_b64_tr_b16 v[108:109], v12 offset:6208
    ds_read_b64_tr_b16 v[110:111], v12 offset:9280
    s_waitcnt lgkmcnt(10)
    v_mfma_f32_16x16x32_bf16 v[136:139], v[112:115], v[84:87], v[136:139]
    v_mfma_f32_16x16x32_bf16 v[160:163], v[112:115], v[92:95], v[160:163]
    buffer_load_dwordx4 v[80:83], v6, s[16:19], s47 offen offset:1024
    ds_read_b64_tr_b16 v[112:113], v12 offset:6240
    ds_read_b64_tr_b16 v[114:115], v12 offset:9312
    s_waitcnt lgkmcnt(10)
    v_mfma_f32_16x16x32_bf16 v[140:143], v[116:119], v[84:87], v[140:143]
    v_mfma_f32_16x16x32_bf16 v[164:167], v[116:119], v[92:95], v[164:167]
    ds_read_b64_tr_b16 v[116:117], v12 offset:6272
    ds_read_b64_tr_b16 v[118:119], v12 offset:9344
    s_waitcnt lgkmcnt(10)
    v_mfma_f32_16x16x32_bf16 v[144:147], v[120:123], v[84:87], v[144:147]
    v_mfma_f32_16x16x32_bf16 v[168:171], v[120:123], v[92:95], v[168:171]
    ds_read_b64_tr_b16 v[120:121], v13 offset:6144
    ds_read_b64_tr_b16 v[122:123], v13 offset:9216
    s_waitcnt lgkmcnt(10)
    v_mfma_f32_16x16x32_bf16 v[124:127], v[100:103], v[88:91], v[124:127]
    v_mfma_f32_16x16x32_bf16 v[148:151], v[100:103], v[96:99], v[148:151]
    s_waitcnt vmcnt(18)
    s_barrier
    ds_read_b64_tr_b16 v[100:101], v8 offset:0
    ds_read_b64_tr_b16 v[102:103], v8 offset:3072
    s_waitcnt lgkmcnt(10)
    v_mfma_f32_16x16x32_bf16 v[128:131], v[104:107], v[88:91], v[128:131]
    v_mfma_f32_16x16x32_bf16 v[152:155], v[104:107], v[96:99], v[152:155]
    s_mov_b32 s46, 1916928
    s_add_u32 m0, s36, 73728
    s_nop 0
    buffer_load_dwordx4 v2, s[12:15], s46 offen lds
    ds_read_b64_tr_b16 v[104:105], v8 offset:32
    ds_read_b64_tr_b16 v[106:107], v8 offset:3104
    s_waitcnt lgkmcnt(10)
    v_mfma_f32_16x16x32_bf16 v[132:135], v[108:111], v[88:91], v[132:135]
    v_mfma_f32_16x16x32_bf16 v[156:159], v[108:111], v[96:99], v[156:159]
    s_add_u32 m0, s36, 74752
    s_nop 0
    buffer_load_dwordx4 v3, s[12:15], s46 offen lds
    ds_read_b64_tr_b16 v[108:109], v8 offset:64
    ds_read_b64_tr_b16 v[110:111], v8 offset:3136
    s_waitcnt lgkmcnt(10)
    v_mfma_f32_16x16x32_bf16 v[136:139], v[112:115], v[88:91], v[136:139]
    v_mfma_f32_16x16x32_bf16 v[160:163], v[112:115], v[96:99], v[160:163]
    s_add_u32 m0, s36, 75776
    s_nop 0
    buffer_load_dwordx4 v4, s[12:15], s46 offen lds
    ds_read_b64_tr_b16 v[112:113], v8 offset:96
    ds_read_b64_tr_b16 v[114:115], v8 offset:3168
    s_waitcnt lgkmcnt(10)
    v_mfma_f32_16x16x32_bf16 v[140:143], v[116:119], v[88:91], v[140:143]
    v_mfma_f32_16x16x32_bf16 v[164:167], v[116:119], v[96:99], v[164:167]
    ds_read_b64_tr_b16 v[116:117], v8 offset:128
    ds_read_b64_tr_b16 v[118:119], v8 offset:3200
    s_waitcnt lgkmcnt(10)
    v_mfma_f32_16x16x32_bf16 v[144:147], v[120:123], v[88:91], v[144:147]
    v_mfma_f32_16x16x32_bf16 v[168:171], v[120:123], v[96:99], v[168:171]
    ds_read_b64_tr_b16 v[120:121], v9 offset:0
    ds_read_b64_tr_b16 v[122:123], v9 offset:3072
    s_waitcnt lgkmcnt(10)
    v_mfma_f32_16x16x32_bf16 v[124:127], v[100:103], v[20:23], v[124:127]
    v_mfma_f32_16x16x32_bf16 v[148:151], v[100:103], v[28:31], v[148:151]
    s_mov_b32 s47, 57344
    buffer_load_dwordx4 v[84:87], v5, s[16:19], s47 offen offset:0
    ds_read_b64_tr_b16 v[100:101], v8 offset:6144
    ds_read_b64_tr_b16 v[102:103], v8 offset:9216
    s_waitcnt lgkmcnt(10)
    v_mfma_f32_16x16x32_bf16 v[128:131], v[104:107], v[20:23], v[128:131]
    v_mfma_f32_16x16x32_bf16 v[152:155], v[104:107], v[28:31], v[152:155]
    buffer_load_dwordx4 v[88:91], v5, s[16:19], s47 offen offset:1024
    ds_read_b64_tr_b16 v[104:105], v8 offset:6176
    ds_read_b64_tr_b16 v[106:107], v8 offset:9248
    s_waitcnt lgkmcnt(10)
    v_mfma_f32_16x16x32_bf16 v[132:135], v[108:111], v[20:23], v[132:135]
    v_mfma_f32_16x16x32_bf16 v[156:159], v[108:111], v[28:31], v[156:159]
    buffer_load_dwordx4 v[92:95], v6, s[16:19], s47 offen offset:0
    ds_read_b64_tr_b16 v[108:109], v8 offset:6208
    ds_read_b64_tr_b16 v[110:111], v8 offset:9280
    s_waitcnt lgkmcnt(10)
    v_mfma_f32_16x16x32_bf16 v[136:139], v[112:115], v[20:23], v[136:139]
    v_mfma_f32_16x16x32_bf16 v[160:163], v[112:115], v[28:31], v[160:163]
    buffer_load_dwordx4 v[96:99], v6, s[16:19], s47 offen offset:1024
    ds_read_b64_tr_b16 v[112:113], v8 offset:6240
    ds_read_b64_tr_b16 v[114:115], v8 offset:9312
    s_waitcnt lgkmcnt(10)
    v_mfma_f32_16x16x32_bf16 v[140:143], v[116:119], v[20:23], v[140:143]
    v_mfma_f32_16x16x32_bf16 v[164:167], v[116:119], v[28:31], v[164:167]
    ds_read_b64_tr_b16 v[116:117], v8 offset:6272
    ds_read_b64_tr_b16 v[118:119], v8 offset:9344
    s_waitcnt lgkmcnt(10)
    v_mfma_f32_16x16x32_bf16 v[144:147], v[120:123], v[20:23], v[144:147]
    v_mfma_f32_16x16x32_bf16 v[168:171], v[120:123], v[28:31], v[168:171]
    ds_read_b64_tr_b16 v[120:121], v9 offset:6144
    ds_read_b64_tr_b16 v[122:123], v9 offset:9216
    s_waitcnt lgkmcnt(10)
    v_mfma_f32_16x16x32_bf16 v[124:127], v[100:103], v[24:27], v[124:127]
    v_mfma_f32_16x16x32_bf16 v[148:151], v[100:103], v[32:35], v[148:151]
    s_waitcnt vmcnt(18)
    s_barrier
    ds_read_b64_tr_b16 v[100:101], v8 offset:24576
    ds_read_b64_tr_b16 v[102:103], v8 offset:27648
    s_waitcnt lgkmcnt(10)
    v_mfma_f32_16x16x32_bf16 v[128:131], v[104:107], v[24:27], v[128:131]
    v_mfma_f32_16x16x32_bf16 v[152:155], v[104:107], v[32:35], v[152:155]
    s_mov_b32 s46, 2064384
    s_add_u32 m0, s36, 98304
    s_nop 0
    buffer_load_dwordx4 v2, s[12:15], s46 offen lds
    ds_read_b64_tr_b16 v[104:105], v8 offset:24608
    ds_read_b64_tr_b16 v[106:107], v8 offset:27680
    s_waitcnt lgkmcnt(10)
    v_mfma_f32_16x16x32_bf16 v[132:135], v[108:111], v[24:27], v[132:135]
    v_mfma_f32_16x16x32_bf16 v[156:159], v[108:111], v[32:35], v[156:159]
    s_add_u32 m0, s36, 99328
    s_nop 0
    buffer_load_dwordx4 v3, s[12:15], s46 offen lds
    ds_read_b64_tr_b16 v[108:109], v8 offset:24640
    ds_read_b64_tr_b16 v[110:111], v8 offset:27712
    s_waitcnt lgkmcnt(10)
    v_mfma_f32_16x16x32_bf16 v[136:139], v[112:115], v[24:27], v[136:139]
    v_mfma_f32_16x16x32_bf16 v[160:163], v[112:115], v[32:35], v[160:163]
    s_add_u32 m0, s36, 100352
    s_nop 0
    buffer_load_dwordx4 v4, s[12:15], s46 offen lds
    ds_read_b64_tr_b16 v[112:113], v8 offset:24672
    ds_read_b64_tr_b16 v[114:115], v8 offset:27744
    s_waitcnt lgkmcnt(10)
    v_mfma_f32_16x16x32_bf16 v[140:143], v[116:119], v[24:27], v[140:143]
    v_mfma_f32_16x16x32_bf16 v[164:167], v[116:119], v[32:35], v[164:167]
    ds_read_b64_tr_b16 v[116:117], v8 offset:24704
    ds_read_b64_tr_b16 v[118:119], v8 offset:27776
    s_waitcnt lgkmcnt(10)
    v_mfma_f32_16x16x32_bf16 v[144:147], v[120:123], v[24:27], v[144:147]
    v_mfma_f32_16x16x32_bf16 v[168:171], v[120:123], v[32:35], v[168:171]
    ds_read_b64_tr_b16 v[120:121], v9 offset:24576
    ds_read_b64_tr_b16 v[122:123], v9 offset:27648
    s_waitcnt lgkmcnt(10)
    v_mfma_f32_16x16x32_bf16 v[124:127], v[100:103], v[36:39], v[124:127]
    v_mfma_f32_16x16x32_bf16 v[148:151], v[100:103], v[44:47], v[148:151]
    ds_read_b64_tr_b16 v[100:101], v8 offset:30720
    ds_read_b64_tr_b16 v[102:103], v8 offset:33792
    s_waitcnt lgkmcnt(10)
    v_mfma_f32_16x16x32_bf16 v[128:131], v[104:107], v[36:39], v[128:131]
    v_mfma_f32_16x16x32_bf16 v[152:155], v[104:107], v[44:47], v[152:155]
    ds_read_b64_tr_b16 v[104:105], v8 offset:30752
    ds_read_b64_tr_b16 v[106:107], v8 offset:33824
    s_waitcnt lgkmcnt(10)
    v_mfma_f32_16x16x32_bf16 v[132:135], v[108:111], v[36:39], v[132:135]
    v_mfma_f32_16x16x32_bf16 v[156:159], v[108:111], v[44:47], v[156:159]
    ds_read_b64_tr_b16 v[108:109], v8 offset:30784
    ds_read_b64_tr_b16 v[110:111], v8 offset:33856
    s_waitcnt lgkmcnt(10)
    v_mfma_f32_16x16x32_bf16 v[136:139], v[112:115], v[36:39], v[136:139]
    v_mfma_f32_16x16x32_bf16 v[160:163], v[112:115], v[44:47], v[160:163]
    ds_read_b64_tr_b16 v[112:113], v8 offset:30816
    ds_read_b64_tr_b16 v[114:115], v8 offset:33888
    s_waitcnt lgkmcnt(10)
    v_mfma_f32_16x16x32_bf16 v[140:143], v[116:119], v[36:39], v[140:143]
    v_mfma_f32_16x16x32_bf16 v[164:167], v[116:119], v[44:47], v[164:167]
    ds_read_b64_tr_b16 v[116:117], v8 offset:30848
    ds_read_b64_tr_b16 v[118:119], v8 offset:33920
    s_waitcnt lgkmcnt(10)
    v_mfma_f32_16x16x32_bf16 v[144:147], v[120:123], v[36:39], v[144:147]
    v_mfma_f32_16x16x32_bf16 v[168:171], v[120:123], v[44:47], v[168:171]
    ds_read_b64_tr_b16 v[120:121], v9 offset:30720
    ds_read_b64_tr_b16 v[122:123], v9 offset:33792
    s_waitcnt lgkmcnt(10)
    v_mfma_f32_16x16x32_bf16 v[124:127], v[100:103], v[40:43], v[124:127]
    v_mfma_f32_16x16x32_bf16 v[148:151], v[100:103], v[48:51], v[148:151]
    s_waitcnt vmcnt(14)
    s_barrier
    ds_read_b64_tr_b16 v[100:101], v10 offset:0
    ds_read_b64_tr_b16 v[102:103], v10 offset:3072
    s_waitcnt lgkmcnt(10)
    v_mfma_f32_16x16x32_bf16 v[128:131], v[104:107], v[40:43], v[128:131]
    v_mfma_f32_16x16x32_bf16 v[152:155], v[104:107], v[48:51], v[152:155]
    ds_read_b64_tr_b16 v[104:105], v10 offset:32
    ds_read_b64_tr_b16 v[106:107], v10 offset:3104
    s_waitcnt lgkmcnt(10)
    v_mfma_f32_16x16x32_bf16 v[132:135], v[108:111], v[40:43], v[132:135]
    v_mfma_f32_16x16x32_bf16 v[156:159], v[108:111], v[48:51], v[156:159]
    ds_read_b64_tr_b16 v[108:109], v10 offset:64
    ds_read_b64_tr_b16 v[110:111], v10 offset:3136
    s_waitcnt lgkmcnt(10)
    v_mfma_f32_16x16x32_bf16 v[136:139], v[112:115], v[40:43], v[136:139]
    v_mfma_f32_16x16x32_bf16 v[160:163], v[112:115], v[48:51], v[160:163]
    ds_read_b64_tr_b16 v[112:113], v10 offset:96
    ds_read_b64_tr_b16 v[114:115], v10 offset:3168
    s_waitcnt lgkmcnt(10)
    v_mfma_f32_16x16x32_bf16 v[140:143], v[116:119], v[40:43], v[140:143]
    v_mfma_f32_16x16x32_bf16 v[164:167], v[116:119], v[48:51], v[164:167]
    ds_read_b64_tr_b16 v[116:117], v10 offset:128
    ds_read_b64_tr_b16 v[118:119], v10 offset:3200
    s_waitcnt lgkmcnt(10)
    v_mfma_f32_16x16x32_bf16 v[144:147], v[120:123], v[40:43], v[144:147]
    v_mfma_f32_16x16x32_bf16 v[168:171], v[120:123], v[48:51], v[168:171]
    ds_read_b64_tr_b16 v[120:121], v11 offset:0
    ds_read_b64_tr_b16 v[122:123], v11 offset:3072
    s_waitcnt lgkmcnt(10)
    v_mfma_f32_16x16x32_bf16 v[124:127], v[100:103], v[52:55], v[124:127]
    v_mfma_f32_16x16x32_bf16 v[148:151], v[100:103], v[60:63], v[148:151]
    ds_read_b64_tr_b16 v[100:101], v10 offset:6144
    ds_read_b64_tr_b16 v[102:103], v10 offset:9216
    s_waitcnt lgkmcnt(10)
    v_mfma_f32_16x16x32_bf16 v[128:131], v[104:107], v[52:55], v[128:131]
    v_mfma_f32_16x16x32_bf16 v[152:155], v[104:107], v[60:63], v[152:155]
    ds_read_b64_tr_b16 v[104:105], v10 offset:6176
    ds_read_b64_tr_b16 v[106:107], v10 offset:9248
    s_waitcnt lgkmcnt(10)
    v_mfma_f32_16x16x32_bf16 v[132:135], v[108:111], v[52:55], v[132:135]
    v_mfma_f32_16x16x32_bf16 v[156:159], v[108:111], v[60:63], v[156:159]
    ds_read_b64_tr_b16 v[108:109], v10 offset:6208
    ds_read_b64_tr_b16 v[110:111], v10 offset:9280
    s_waitcnt lgkmcnt(10)
    v_mfma_f32_16x16x32_bf16 v[136:139], v[112:115], v[52:55], v[136:139]
    v_mfma_f32_16x16x32_bf16 v[160:163], v[112:115], v[60:63], v[160:163]
    ds_read_b64_tr_b16 v[112:113], v10 offset:6240
    ds_read_b64_tr_b16 v[114:115], v10 offset:9312
    s_waitcnt lgkmcnt(10)
    v_mfma_f32_16x16x32_bf16 v[140:143], v[116:119], v[52:55], v[140:143]
    v_mfma_f32_16x16x32_bf16 v[164:167], v[116:119], v[60:63], v[164:167]
    ds_read_b64_tr_b16 v[116:117], v10 offset:6272
    ds_read_b64_tr_b16 v[118:119], v10 offset:9344
    s_waitcnt lgkmcnt(10)
    v_mfma_f32_16x16x32_bf16 v[144:147], v[120:123], v[52:55], v[144:147]
    v_mfma_f32_16x16x32_bf16 v[168:171], v[120:123], v[60:63], v[168:171]
    ds_read_b64_tr_b16 v[120:121], v11 offset:6144
    ds_read_b64_tr_b16 v[122:123], v11 offset:9216
    s_waitcnt lgkmcnt(10)
    v_mfma_f32_16x16x32_bf16 v[124:127], v[100:103], v[56:59], v[124:127]
    v_mfma_f32_16x16x32_bf16 v[148:151], v[100:103], v[64:67], v[148:151]
    s_waitcnt vmcnt(7)
    s_barrier
    ds_read_b64_tr_b16 v[100:101], v10 offset:24576
    ds_read_b64_tr_b16 v[102:103], v10 offset:27648
    s_waitcnt lgkmcnt(10)
    v_mfma_f32_16x16x32_bf16 v[128:131], v[104:107], v[56:59], v[128:131]
    v_mfma_f32_16x16x32_bf16 v[152:155], v[104:107], v[64:67], v[152:155]
    ds_read_b64_tr_b16 v[104:105], v10 offset:24608
    ds_read_b64_tr_b16 v[106:107], v10 offset:27680
    s_waitcnt lgkmcnt(10)
    v_mfma_f32_16x16x32_bf16 v[132:135], v[108:111], v[56:59], v[132:135]
    v_mfma_f32_16x16x32_bf16 v[156:159], v[108:111], v[64:67], v[156:159]
    ds_read_b64_tr_b16 v[108:109], v10 offset:24640
    ds_read_b64_tr_b16 v[110:111], v10 offset:27712
    s_waitcnt lgkmcnt(10)
    v_mfma_f32_16x16x32_bf16 v[136:139], v[112:115], v[56:59], v[136:139]
    v_mfma_f32_16x16x32_bf16 v[160:163], v[112:115], v[64:67], v[160:163]
    ds_read_b64_tr_b16 v[112:113], v10 offset:24672
    ds_read_b64_tr_b16 v[114:115], v10 offset:27744
    s_waitcnt lgkmcnt(10)
    v_mfma_f32_16x16x32_bf16 v[140:143], v[116:119], v[56:59], v[140:143]
    v_mfma_f32_16x16x32_bf16 v[164:167], v[116:119], v[64:67], v[164:167]
    ds_read_b64_tr_b16 v[116:117], v10 offset:24704
    ds_read_b64_tr_b16 v[118:119], v10 offset:27776
    s_waitcnt lgkmcnt(10)
    v_mfma_f32_16x16x32_bf16 v[144:147], v[120:123], v[56:59], v[144:147]
    v_mfma_f32_16x16x32_bf16 v[168:171], v[120:123], v[64:67], v[168:171]
    ds_read_b64_tr_b16 v[120:121], v11 offset:24576
    ds_read_b64_tr_b16 v[122:123], v11 offset:27648
    s_waitcnt lgkmcnt(10)
    v_mfma_f32_16x16x32_bf16 v[124:127], v[100:103], v[68:71], v[124:127]
    v_mfma_f32_16x16x32_bf16 v[148:151], v[100:103], v[76:79], v[148:151]
    ds_read_b64_tr_b16 v[100:101], v10 offset:30720
    ds_read_b64_tr_b16 v[102:103], v10 offset:33792
    s_waitcnt lgkmcnt(10)
    v_mfma_f32_16x16x32_bf16 v[128:131], v[104:107], v[68:71], v[128:131]
    v_mfma_f32_16x16x32_bf16 v[152:155], v[104:107], v[76:79], v[152:155]
    ds_read_b64_tr_b16 v[104:105], v10 offset:30752
    ds_read_b64_tr_b16 v[106:107], v10 offset:33824
    s_waitcnt lgkmcnt(10)
    v_mfma_f32_16x16x32_bf16 v[132:135], v[108:111], v[68:71], v[132:135]
    v_mfma_f32_16x16x32_bf16 v[156:159], v[108:111], v[76:79], v[156:159]
    ds_read_b64_tr_b16 v[108:109], v10 offset:30784
    ds_read_b64_tr_b16 v[110:111], v10 offset:33856
    s_waitcnt lgkmcnt(10)
    v_mfma_f32_16x16x32_bf16 v[136:139], v[112:115], v[68:71], v[136:139]
    v_mfma_f32_16x16x32_bf16 v[160:163], v[112:115], v[76:79], v[160:163]
    ds_read_b64_tr_b16 v[112:113], v10 offset:30816
    ds_read_b64_tr_b16 v[114:115], v10 offset:33888
    s_waitcnt lgkmcnt(10)
    v_mfma_f32_16x16x32_bf16 v[140:143], v[116:119], v[68:71], v[140:143]
    v_mfma_f32_16x16x32_bf16 v[164:167], v[116:119], v[76:79], v[164:167]
    ds_read_b64_tr_b16 v[116:117], v10 offset:30848
    ds_read_b64_tr_b16 v[118:119], v10 offset:33920
    s_waitcnt lgkmcnt(10)
    v_mfma_f32_16x16x32_bf16 v[144:147], v[120:123], v[68:71], v[144:147]
    v_mfma_f32_16x16x32_bf16 v[168:171], v[120:123], v[76:79], v[168:171]
    ds_read_b64_tr_b16 v[120:121], v11 offset:30720
    ds_read_b64_tr_b16 v[122:123], v11 offset:33792
    s_waitcnt lgkmcnt(10)
    v_mfma_f32_16x16x32_bf16 v[124:127], v[100:103], v[72:75], v[124:127]
    v_mfma_f32_16x16x32_bf16 v[148:151], v[100:103], v[80:83], v[148:151]
    s_waitcnt vmcnt(0)
    s_barrier
    ds_read_b64_tr_b16 v[100:101], v12 offset:0
    ds_read_b64_tr_b16 v[102:103], v12 offset:3072
    s_waitcnt lgkmcnt(10)
    v_mfma_f32_16x16x32_bf16 v[128:131], v[104:107], v[72:75], v[128:131]
    v_mfma_f32_16x16x32_bf16 v[152:155], v[104:107], v[80:83], v[152:155]
    ds_read_b64_tr_b16 v[104:105], v12 offset:32
    ds_read_b64_tr_b16 v[106:107], v12 offset:3104
    s_waitcnt lgkmcnt(10)
    v_mfma_f32_16x16x32_bf16 v[132:135], v[108:111], v[72:75], v[132:135]
    v_mfma_f32_16x16x32_bf16 v[156:159], v[108:111], v[80:83], v[156:159]
    ds_read_b64_tr_b16 v[108:109], v12 offset:64
    ds_read_b64_tr_b16 v[110:111], v12 offset:3136
    s_waitcnt lgkmcnt(10)
    v_mfma_f32_16x16x32_bf16 v[136:139], v[112:115], v[72:75], v[136:139]
    v_mfma_f32_16x16x32_bf16 v[160:163], v[112:115], v[80:83], v[160:163]
    ds_read_b64_tr_b16 v[112:113], v12 offset:96
    ds_read_b64_tr_b16 v[114:115], v12 offset:3168
    s_waitcnt lgkmcnt(10)
    v_mfma_f32_16x16x32_bf16 v[140:143], v[116:119], v[72:75], v[140:143]
    v_mfma_f32_16x16x32_bf16 v[164:167], v[116:119], v[80:83], v[164:167]
    ds_read_b64_tr_b16 v[116:117], v12 offset:128
    ds_read_b64_tr_b16 v[118:119], v12 offset:3200
    s_waitcnt lgkmcnt(10)
    v_mfma_f32_16x16x32_bf16 v[144:147], v[120:123], v[72:75], v[144:147]
    v_mfma_f32_16x16x32_bf16 v[168:171], v[120:123], v[80:83], v[168:171]
    ds_read_b64_tr_b16 v[120:121], v13 offset:0
    ds_read_b64_tr_b16 v[122:123], v13 offset:3072
    s_waitcnt lgkmcnt(10)
    v_mfma_f32_16x16x32_bf16 v[124:127], v[100:103], v[84:87], v[124:127]
    v_mfma_f32_16x16x32_bf16 v[148:151], v[100:103], v[92:95], v[148:151]
    ds_read_b64_tr_b16 v[100:101], v12 offset:6144
    ds_read_b64_tr_b16 v[102:103], v12 offset:9216
    s_waitcnt lgkmcnt(10)
    v_mfma_f32_16x16x32_bf16 v[128:131], v[104:107], v[84:87], v[128:131]
    v_mfma_f32_16x16x32_bf16 v[152:155], v[104:107], v[92:95], v[152:155]
    ds_read_b64_tr_b16 v[104:105], v12 offset:6176
    ds_read_b64_tr_b16 v[106:107], v12 offset:9248
    s_waitcnt lgkmcnt(10)
    v_mfma_f32_16x16x32_bf16 v[132:135], v[108:111], v[84:87], v[132:135]
    v_mfma_f32_16x16x32_bf16 v[156:159], v[108:111], v[92:95], v[156:159]
    ds_read_b64_tr_b16 v[108:109], v12 offset:6208
    ds_read_b64_tr_b16 v[110:111], v12 offset:9280
    s_waitcnt lgkmcnt(10)
    v_mfma_f32_16x16x32_bf16 v[136:139], v[112:115], v[84:87], v[136:139]
    v_mfma_f32_16x16x32_bf16 v[160:163], v[112:115], v[92:95], v[160:163]
    ds_read_b64_tr_b16 v[112:113], v12 offset:6240
    ds_read_b64_tr_b16 v[114:115], v12 offset:9312
    s_waitcnt lgkmcnt(10)
    v_mfma_f32_16x16x32_bf16 v[140:143], v[116:119], v[84:87], v[140:143]
    v_mfma_f32_16x16x32_bf16 v[164:167], v[116:119], v[92:95], v[164:167]
    ds_read_b64_tr_b16 v[116:117], v12 offset:6272
    ds_read_b64_tr_b16 v[118:119], v12 offset:9344
    s_waitcnt lgkmcnt(10)
    v_mfma_f32_16x16x32_bf16 v[144:147], v[120:123], v[84:87], v[144:147]
    v_mfma_f32_16x16x32_bf16 v[168:171], v[120:123], v[92:95], v[168:171]
    ds_read_b64_tr_b16 v[120:121], v13 offset:6144
    ds_read_b64_tr_b16 v[122:123], v13 offset:9216
    s_waitcnt lgkmcnt(10)
    v_mfma_f32_16x16x32_bf16 v[124:127], v[100:103], v[88:91], v[124:127]
    v_mfma_f32_16x16x32_bf16 v[148:151], v[100:103], v[96:99], v[148:151]
    s_waitcnt lgkmcnt(8)
    v_mfma_f32_16x16x32_bf16 v[128:131], v[104:107], v[88:91], v[128:131]
    v_mfma_f32_16x16x32_bf16 v[152:155], v[104:107], v[96:99], v[152:155]
    s_waitcnt lgkmcnt(6)
    v_mfma_f32_16x16x32_bf16 v[132:135], v[108:111], v[88:91], v[132:135]
    v_mfma_f32_16x16x32_bf16 v[156:159], v[108:111], v[96:99], v[156:159]
    s_waitcnt lgkmcnt(4)
    v_mfma_f32_16x16x32_bf16 v[136:139], v[112:115], v[88:91], v[136:139]
    v_mfma_f32_16x16x32_bf16 v[160:163], v[112:115], v[96:99], v[160:163]
    s_waitcnt lgkmcnt(2)
    v_mfma_f32_16x16x32_bf16 v[140:143], v[116:119], v[88:91], v[140:143]
    v_mfma_f32_16x16x32_bf16 v[164:167], v[116:119], v[96:99], v[164:167]
    s_waitcnt lgkmcnt(0)
    v_mfma_f32_16x16x32_bf16 v[144:147], v[120:123], v[88:91], v[144:147]
    v_mfma_f32_16x16x32_bf16 v[168:171], v[120:123], v[96:99], v[168:171]
    s_barrier
    s_cmp_lt_u32 s40, 4
    s_cbranch_scc1 L_g2_x0a
    s_nop 4
    ds_write_b128 v14, v[124:127] offset:0
    ds_write_b128 v14, v[128:131] offset:1024
    ds_write_b128 v14, v[132:135] offset:2048
    ds_write_b128 v14, v[136:139] offset:3072
    ds_write_b128 v14, v[140:143] offset:4096
    ds_write_b128 v14, v[144:147] offset:5120
    v_mov_b32 v20, v148
    v_mov_b32 v21, v149
    v_mov_b32 v22, v150
    v_mov_b32 v23, v151
    v_mov_b32 v24, v152
    v_mov_b32 v25, v153
    v_mov_b32 v26, v154
    v_mov_b32 v27, v155
    v_mov_b32 v28, v156
    v_mov_b32 v29, v157
    v_mov_b32 v30, v158
    v_mov_b32 v31, v159
    v_mov_b32 v32, v160
    v_mov_b32 v33, v161
    v_mov_b32 v34, v162
    v_mov_b32 v35, v163
    v_mov_b32 v36, v164
    v_mov_b32 v37, v165
    v_mov_b32 v38, v166
    v_mov_b32 v39, v167
    v_mov_b32 v40, v168
    v_mov_b32 v41, v169
    v_mov_b32 v42, v170
    v_mov_b32 v43, v171
    s_branch L_g2_x0b
L_g2_x0a:
    s_nop 4
    ds_write_b128 v14, v[148:151] offset:0
    ds_write_b128 v14, v[152:155] offset:1024
    ds_write_b128 v14, v[156:159] offset:2048
    ds_write_b128 v14, v[160:163] offset:3072
    ds_write_b128 v14, v[164:167] offset:4096
    ds_write_b128 v14, v[168:171] offset:5120
    v_mov_b32 v20, v124
    v_mov_b32 v21, v125
    v_mov_b32 v22, v126
    v_mov_b32 v23, v127
    v_mov_b32 v24, v128
    v_mov_b32 v25, v129
    v_mov_b32 v26, v130
    v_mov_b32 v27, v131
    v_mov_b32 v28, v132
    v_mov_b32 v29, v133
    v_mov_b32 v30, v134
    v_mov_b32 v31, v135
    v_mov_b32 v32, v136
    v_mov_b32 v33, v137
    v_mov_b32 v34, v138
    v_mov_b32 v35, v139
    v_mov_b32 v36, v140
    v_mov_b32 v37, v141
    v_mov_b32 v38, v142
    v_mov_b32 v39, v143
    v_mov_b32 v40, v144
    v_mov_b32 v41, v145
    v_mov_b32 v42, v146
    v_mov_b32 v43, v147
L_g2_x0b:
    s_waitcnt lgkmcnt(0)
    s_barrier
    ds_read_b128 v[44:47], v7 offset:0
    ds_read_b128 v[48:51], v7 offset:1024
    ds_read_b128 v[52:55], v7 offset:2048
    ds_read_b128 v[56:59], v7 offset:3072
    ds_read_b128 v[60:63], v7 offset:4096
    ds_read_b128 v[64:67], v7 offset:5120
    s_waitcnt lgkmcnt(5)
    v_add_f32 v20, v20, v44
    v_add_f32 v21, v21, v45
    v_add_f32 v22, v22, v46
    v_add_f32 v23, v23, v47
    buffer_store_dwordx4 v[20:23], v15, s[84:87], 0 offen offset:0 sc1
    s_waitcnt lgkmcnt(4)
    v_add_f32 v24, v24, v48
    v_add_f32 v25, v25, v49
    v_add_f32 v26, v26, v50
    v_add_f32 v27, v27, v51
    buffer_store_dwordx4 v[24:27], v15, s[84:87], 0 offen offset:1024 sc1
    s_waitcnt lgkmcnt(3)
    v_add_f32 v28, v28, v52
    v_add_f32 v29, v29, v53
    v_add_f32 v30, v30, v54
    v_add_f32 v31, v31, v55
    buffer_store_dwordx4 v[28:31], v15, s[84:87], 0 offen offset:2048 sc1
    s_waitcnt lgkmcnt(2)
    v_add_f32 v32, v32, v56
    v_add_f32 v33, v33, v57
    v_add_f32 v34, v34, v58
    v_add_f32 v35, v35, v59
    buffer_store_dwordx4 v[32:35], v15, s[84:87], 0 offen offset:3072 sc1
    s_waitcnt lgkmcnt(1)
    v_add_f32 v36, v36, v60
    v_add_f32 v37, v37, v61
    v_add_f32 v38, v38, v62
    v_add_f32 v39, v39, v63
    buffer_store_dwordx4 v[36:39], v15, s[84:87], s88 offen offset:0 sc1
    s_waitcnt lgkmcnt(0)
    v_add_f32 v40, v40, v64
    v_add_f32 v41, v41, v65
    v_add_f32 v42, v42, v66
    v_add_f32 v43, v43, v67
    buffer_store_dwordx4 v[40:43], v15, s[84:87], s88 offen offset:1024 sc1
    s_waitcnt vmcnt(0)
    s_barrier
    s_cmp_lg_u32 s40, 0
    s_cbranch_scc1 L_g2_fin
    v_mov_b32 v20, s48
    v_mov_b32 v21, s49
    s_mov_b64 exec, 1
    buffer_store_dword v21, v20, s[80:83], 0 offen sc1
    s_mov_b64 exec, -1
    s_branch L_g2_fin
L_g2_consumer:
    s_waitcnt vmcnt(7)
    s_barrier
    ds_read_b64_tr_b16 v[100:101], v8 offset:0
    ds_read_b64_tr_b16 v[102:103], v8 offset:3072
    ds_read_b64_tr_b16 v[104:105], v8 offset:32
    ds_read_b64_tr_b16 v[106:107], v8 offset:3104
    ds_read_b64_tr_b16 v[108:109], v8 offset:64
    ds_read_b64_tr_b16 v[110:111], v8 offset:3136
    ds_read_b64_tr_b16 v[112:113], v8 offset:96
    ds_read_b64_tr_b16 v[114:115], v8 offset:3168
    ds_read_b64_tr_b16 v[116:117], v8 offset:128
    ds_read_b64_tr_b16 v[118:119], v8 offset:3200
    ds_read_b64_tr_b16 v[120:121], v9 offset:0
    ds_read_b64_tr_b16 v[122:123], v9 offset:3072
    s_waitcnt lgkmcnt(10)
    v_mfma_f32_16x16x32_bf16 v[124:127], v[100:103], v[20:23], v[124:127]
    v_mfma_f32_16x16x32_bf16 v[148:151], v[100:103], v[28:31], v[148:151]
    s_mov_b32 s46, 294912
    s_add_u32 m0, s36, 49152
    s_nop 0
    buffer_load_dwordx4 v2, s[12:15], s46 offen lds
    s_add_u32 m0, s36, 50176
    s_nop 0
    buffer_load_dwordx4 v3, s[12:15], s46 offen lds
    s_add_u32 m0, s36, 51200
    s_nop 0
    buffer_load_dwordx4 v4, s[12:15], s46 offen lds
    ds_read_b64_tr_b16 v[100:101], v8 offset:6144
    ds_read_b64_tr_b16 v[102:103], v8 offset:9216
    s_waitcnt lgkmcnt(10)
    v_mfma_f32_16x16x32_bf16 v[128:131], v[104:107], v[20:23], v[128:131]
    v_mfma_f32_16x16x32_bf16 v[152:155], v[104:107], v[28:31], v[152:155]
    ds_read_b64_tr_b16 v[104:105], v8 offset:6176
    ds_read_b64_tr_b16 v[106:107], v8 offset:9248
    s_waitcnt lgkmcnt(10)
    v_mfma_f32_16x16x32_bf16 v[132:135], v[108:111], v[20:23], v[132:135]
    v_mfma_f32_16x16x32_bf16 v[156:159], v[108:111], v[28:31], v[156:159]
    s_mov_b32 s47, 8192
    buffer_load_dwordx4 v[52:55], v5, s[16:19], s47 offen offset:0
    buffer_load_dwordx4 v[56:59], v5, s[16:19], s47 offen offset:1024
    buffer_load_dwordx4 v[60:63], v6, s[16:19], s47 offen offset:0
    buffer_load_dwordx4 v[64:67], v6, s[16:19], s47 offen offset:1024
    ds_read_b64_tr_b16 v[108:109], v8 offset:6208
    ds_read_b64_tr_b16 v[110:111], v8 offset:9280
    s_waitcnt lgkmcnt(10)
    v_mfma_f32_16x16x32_bf16 v[136:139], v[112:115], v[20:23], v[136:139]
    v_mfma_f32_16x16x32_bf16 v[160:163], v[112:115], v[28:31], v[160:163]
    s_mov_b32 s46, 442368
    s_add_u32 m0, s36, 73728
    s_nop 0
    buffer_load_dwordx4 v2, s[12:15], s46 offen lds
    s_add_u32 m0, s36, 74752
    s_nop 0
    buffer_load_dwordx4 v3, s[12:15], s46 offen lds
    s_add_u32 m0, s36, 75776
    s_nop 0
    buffer_load_dwordx4 v4, s[12:15], s46 offen lds
    ds_read_b64_tr_b16 v[112:113], v8 offset:6240
    ds_read_b64_tr_b16 v[114:115], v8 offset:9312
    s_waitcnt lgkmcnt(10)
    v_mfma_f32_16x16x32_bf16 v[140:143], v[116:119], v[20:23], v[140:143]
    v_mfma_f32_16x16x32_bf16 v[164:167], v[116:119], v[28:31], v[164:167]
    s_mov_b32 s47, 12288
    buffer_load_dwordx4 v[68:71], v5, s[16:19], s47 offen offset:0
    buffer_load_dwordx4 v[72:75], v5, s[16:19], s47 offen offset:1024
    buffer_load_dwordx4 v[76:79], v6, s[16:19], s47 offen offset:0
    buffer_load_dwordx4 v[80:83], v6, s[16:19], s47 offen offset:1024
    ds_read_b64_tr_b16 v[116:117], v8 offset:6272
    ds_read_b64_tr_b16 v[118:119], v8 offset:9344
    s_waitcnt lgkmcnt(10)
    v_mfma_f32_16x16x32_bf16 v[144:147], v[120:123], v[20:23], v[144:147]
    v_mfma_f32_16x16x32_bf16 v[168:171], v[120:123], v[28:31], v[168:171]
    s_mov_b32 s47, 16384
    buffer_load_dwordx4 v[84:87], v5, s[16:19], s47 offen offset:0
    buffer_load_dwordx4 v[88:91], v5, s[16:19], s47 offen offset:1024
    buffer_load_dwordx4 v[92:95], v6, s[16:19], s47 offen offset:0
    buffer_load_dwordx4 v[96:99], v6, s[16:19], s47 offen offset:1024
    ds_read_b64_tr_b16 v[120:121], v9 offset:6144
    ds_read_b64_tr_b16 v[122:123], v9 offset:9216
    s_waitcnt lgkmcnt(10)
    v_mfma_f32_16x16x32_bf16 v[124:127], v[100:103], v[24:27], v[124:127]
    v_mfma_f32_16x16x32_bf16 v[148:151], v[100:103], v[32:35], v[148:151]
    s_waitcnt vmcnt(22)
    s_barrier
    ds_read_b64_tr_b16 v[100:101], v8 offset:24576
    ds_read_b64_tr_b16 v[102:103], v8 offset:27648
    s_waitcnt lgkmcnt(10)
    v_mfma_f32_16x16x32_bf16 v[128:131], v[104:107], v[24:27], v[128:131]
    v_mfma_f32_16x16x32_bf16 v[152:155], v[104:107], v[32:35], v[152:155]
    s_mov_b32 s46, 589824
    s_add_u32 m0, s36, 98304
    s_nop 0
    buffer_load_dwordx4 v2, s[12:15], s46 offen lds
    ds_read_b64_tr_b16 v[104:105], v8 offset:24608
    ds_read_b64_tr_b16 v[106:107], v8 offset:27680
    s_waitcnt lgkmcnt(10)
    v_mfma_f32_16x16x32_bf16 v[132:135], v[108:111], v[24:27], v[132:135]
    v_mfma_f32_16x16x32_bf16 v[156:159], v[108:111], v[32:35], v[156:159]
    s_add_u32 m0, s36, 99328
    s_nop 0
    buffer_load_dwordx4 v3, s[12:15], s46 offen lds
    ds_read_b64_tr_b16 v[108:109], v8 offset:24640
    ds_read_b64_tr_b16 v[110:111], v8 offset:27712
    s_waitcnt lgkmcnt(10)
    v_mfma_f32_16x16x32_bf16 v[136:139], v[112:115], v[24:27], v[136:139]
    v_mfma_f32_16x16x32_bf16 v[160:163], v[112:115], v[32:35], v[160:163]
    s_add_u32 m0, s36, 100352
    s_nop 0
    buffer_load_dwordx4 v4, s[12:15], s46 offen lds
    ds_read_b64_tr_b16 v[112:113], v8 offset:24672
    ds_read_b64_tr_b16 v[114:115], v8 offset:27744
    s_waitcnt lgkmcnt(10)
    v_mfma_f32_16x16x32_bf16 v[140:143], v[116:119], v[24:27], v[140:143]
    v_mfma_f32_16x16x32_bf16 v[164:167], v[116:119], v[32:35], v[164:167]
    ds_read_b64_tr_b16 v[116:117], v8 offset:24704
    ds_read_b64_tr_b16 v[118:119], v8 offset:27776
    s_waitcnt lgkmcnt(10)
    v_mfma_f32_16x16x32_bf16 v[144:147], v[120:123], v[24:27], v[144:147]
    v_mfma_f32_16x16x32_bf16 v[168:171], v[120:123], v[32:35], v[168:171]
    s_waitcnt vmcnt(21)
    ds_read_b64_tr_b16 v[120:121], v9 offset:24576
    ds_read_b64_tr_b16 v[122:123], v9 offset:27648
    s_waitcnt lgkmcnt(10)
    v_mfma_f32_16x16x32_bf16 v[124:127], v[100:103], v[36:39], v[124:127]
    v_mfma_f32_16x16x32_bf16 v[148:151], v[100:103], v[44:47], v[148:151]
    s_mov_b32 s47, 20480
    buffer_load_dwordx4 v[20:23], v5, s[16:19], s47 offen offset:0
    ds_read_b64_tr_b16 v[100:101], v8 offset:30720
    ds_read_b64_tr_b16 v[102:103], v8 offset:33792
    s_waitcnt lgkmcnt(10)
    v_mfma_f32_16x16x32_bf16 v[128:131], v[104:107], v[36:39], v[128:131]
    v_mfma_f32_16x16x32_bf16 v[152:155], v[104:107], v[44:47], v[152:155]
    buffer_load_dwordx4 v[24:27], v5, s[16:19], s47 offen offset:1024
    ds_read_b64_tr_b16 v[104:105], v8 offset:30752
    ds_read_b64_tr_b16 v[106:107], v8 offset:33824
    s_waitcnt lgkmcnt(10)
    v_mfma_f32_16x16x32_bf16 v[132:135], v[108:111], v[36:39], v[132:135]
    v_mfma_f32_16x16x32_bf16 v[156:159], v[108:111], v[44:47], v[156:159]
    buffer_load_dwordx4 v[28:31], v6, s[16:19], s47 offen offset:0
    ds_read_b64_tr_b16 v[108:109], v8 offset:30784
    ds_read_b64_tr_b16 v[110:111], v8 offset:33856
    s_waitcnt lgkmcnt(10)
    v_mfma_f32_16x16x32_bf16 v[136:139], v[112:115], v[36:39], v[136:139]
    v_mfma_f32_16x16x32_bf16 v[160:163], v[112:115], v[44:47], v[160:163]
    buffer_load_dwordx4 v[32:35], v6, s[16:19], s47 offen offset:1024
    ds_read_b64_tr_b16 v[112:113], v8 offset:30816
    ds_read_b64_tr_b16 v[114:115], v8 offset:33888
    s_waitcnt lgkmcnt(10)
    v_mfma_f32_16x16x32_bf16 v[140:143], v[116:119], v[36:39], v[140:143]
    v_mfma_f32_16x16x32_bf16 v[164:167], v[116:119], v[44:47], v[164:167]
    ds_read_b64_tr_b16 v[116:117], v8 offset:30848
    ds_read_b64_tr_b16 v[118:119], v8 offset:33920
    s_waitcnt lgkmcnt(10)
    v_mfma_f32_16x16x32_bf16 v[144:147], v[120:123], v[36:39], v[144:147]
    v_mfma_f32_16x16x32_bf16 v[168:171], v[120:123], v[44:47], v[168:171]
    ds_read_b64_tr_b16 v[120:121], v9 offset:30720
    ds_read_b64_tr_b16 v[122:123], v9 offset:33792
    s_waitcnt lgkmcnt(10)
    v_mfma_f32_16x16x32_bf16 v[124:127], v[100:103], v[40:43], v[124:127]
    v_mfma_f32_16x16x32_bf16 v[148:151], v[100:103], v[48:51], v[148:151]
    s_waitcnt vmcnt(22)
    s_barrier
    ds_read_b64_tr_b16 v[100:101], v10 offset:0
    ds_read_b64_tr_b16 v[102:103], v10 offset:3072
    s_waitcnt lgkmcnt(10)
    v_mfma_f32_16x16x32_bf16 v[128:131], v[104:107], v[40:43], v[128:131]
    v_mfma_f32_16x16x32_bf16 v[152:155], v[104:107], v[48:51], v[152:155]
    s_mov_b32 s46, 737280
    s_add_u32 m0, s36, 0
    s_nop 0
    buffer_load_dwordx4 v2, s[12:15], s46 offen lds
    ds_read_b64_tr_b16 v[104:105], v10 offset:32
    ds_read_b64_tr_b16 v[106:107], v10 offset:3104
    s_waitcnt lgkmcnt(10)
    v_mfma_f32_16x16x32_bf16 v[132:135], v[108:111], v[40:43], v[132:135]
    v_mfma_f32_16x16x32_bf16 v[156:159], v[108:111], v[48:51], v[156:159]
    s_add_u32 m0, s36, 1024
    s_nop 0
    buffer_load_dwordx4 v3, s[12:15], s46 offen lds
    ds_read_b64_tr_b16 v[108:109], v10 offset:64
    ds_read_b64_tr_b16 v[110:111], v10 offset:3136
    s_waitcnt lgkmcnt(10)
    v_mfma_f32_16x16x32_bf16 v[136:139], v[112:115], v[40:43], v[136:139]
    v_mfma_f32_16x16x32_bf16 v[160:163], v[112:115], v[48:51], v[160:163]
    s_add_u32 m0, s36, 2048
    s_nop 0
    buffer_load_dwordx4 v4, s[12:15], s46 offen lds
    ds_read_b64_tr_b16 v[112:113], v10 offset:96
    ds_read_b64_tr_b16 v[114:115], v10 offset:3168
    s_waitcnt lgkmcnt(10)
    v_mfma_f32_16x16x32_bf16 v[140:143], v[116:119], v[40:43], v[140:143]
    v_mfma_f32_16x16x32_bf16 v[164:167], v[116:119], v[48:51], v[164:167]
    ds_read_b64_tr_b16 v[116:117], v10 offset:128
    ds_read_b64_tr_b16 v[118:119], v10 offset:3200
    s_waitcnt lgkmcnt(10)
    v_mfma_f32_16x16x32_bf16 v[144:147], v[120:123], v[40:43], v[144:147]
    v_mfma_f32_16x16x32_bf16 v[168:171], v[120:123], v[48:51], v[168:171]
    s_waitcnt vmcnt(21)
    ds_read_b64_tr_b16 v[120:121], v11 offset:0
    ds_read_b64_tr_b16 v[122:123], v11 offset:3072
    s_waitcnt lgkmcnt(10)
    v_mfma_f32_16x16x32_bf16 v[124:127], v[100:103], v[52:55], v[124:127]
    v_mfma_f32_16x16x32_bf16 v[148:151], v[100:103], v[60:63], v[148:151]
    s_mov_b32 s47, 24576
    buffer_load_dwordx4 v[36:39], v5, s[16:19], s47 offen offset:0
    ds_read_b64_tr_b16 v[100:101], v10 offset:6144
    ds_read_b64_tr_b16 v[102:103], v10 offset:9216
    s_waitcnt lgkmcnt(10)
    v_mfma_f32_16x16x32_bf16 v[128:131], v[104:107], v[52:55], v[128:131]
    v_mfma_f32_16x16x32_bf16 v[152:155], v[104:107], v[60:63], v[152:155]
    buffer_load_dwordx4 v[40:43], v5, s[16:19], s47 offen offset:1024
    ds_read_b64_tr_b16 v[104:105], v10 offset:6176
    ds_read_b64_tr_b16 v[106:107], v10 offset:9248
    s_waitcnt lgkmcnt(10)
    v_mfma_f32_16x16x32_bf16 v[132:135], v[108:111], v[52:55], v[132:135]
    v_mfma_f32_16x16x32_bf16 v[156:159], v[108:111], v[60:63], v[156:159]
    buffer_load_dwordx4 v[44:47], v6, s[16:19], s47 offen offset:0
    ds_read_b64_tr_b16 v[108:109], v10 offset:6208
    ds_read_b64_tr_b16 v[110:111], v10 offset:9280
    s_waitcnt lgkmcnt(10)
    v_mfma_f32_16x16x32_bf16 v[136:139], v[112:115], v[52:55], v[136:139]
    v_mfma_f32_16x16x32_bf16 v[160:163], v[112:115], v[60:63], v[160:163]
    buffer_load_dwordx4 v[48:51], v6, s[16:19], s47 offen offset:1024
    ds_read_b64_tr_b16 v[112:113], v10 offset:6240
    ds_read_b64_tr_b16 v[114:115], v10 offset:9312
    s_waitcnt lgkmcnt(10)
    v_mfma_f32_16x16x32_bf16 v[140:143], v[116:119], v[52:55], v[140:143]
    v_mfma_f32_16x16x32_bf16 v[164:167], v[116:119], v[60:63], v[164:167]
    ds_read_b64_tr_b16 v[116:117], v10 offset:6272
    ds_read_b64_tr_b16 v[118:119], v10 offset:9344
    s_waitcnt lgkmcnt(10)
    v_mfma_f32_16x16x32_bf16 v[144:147], v[120:123], v[52:55], v[144:147]
    v_mfma_f32_16x16x32_bf16 v[168:171], v[120:123], v[60:63], v[168:171]
    ds_read_b64_tr_b16 v[120:121], v11 offset:6144
    ds_read_b64_tr_b16 v[122:123], v11 offset:9216
    s_waitcnt lgkmcnt(10)
    v_mfma_f32_16x16x32_bf16 v[124:127], v[100:103], v[56:59], v[124:127]
    v_mfma_f32_16x16x32_bf16 v[148:151], v[100:103], v[64:67], v[148:151]
    s_waitcnt vmcnt(22)
    s_barrier
    ds_read_b64_tr_b16 v[100:101], v10 offset:24576
    ds_read_b64_tr_b16 v[102:103], v10 offset:27648
    s_waitcnt lgkmcnt(10)
    v_mfma_f32_16x16x32_bf16 v[128:131], v[104:107], v[56:59], v[128:131]
    v_mfma_f32_16x16x32_bf16 v[152:155], v[104:107], v[64:67], v[152:155]
    s_mov_b32 s46, 884736
    s_add_u32 m0, s36, 24576
    s_nop 0
    buffer_load_dwordx4 v2, s[12:15], s46 offen lds
    ds_read_b64_tr_b16 v[104:105], v10 offset:24608
    ds_read_b64_tr_b16 v[106:107], v10 offset:27680
    s_waitcnt lgkmcnt(10)
    v_mfma_f32_16x16x32_bf16 v[132:135], v[108:111], v[56:59], v[132:135]
    v_mfma_f32_16x16x32_bf16 v[156:159], v[108:111], v[64:67], v[156:159]
    s_add_u32 m0, s36, 25600
    s_nop 0
    buffer_load_dwordx4 v3, s[12:15], s46 offen lds
    ds_read_b64_tr_b16 v[108:109], v10 offset:24640
    ds_read_b64_tr_b16 v[110:111], v10 offset:27712
    s_waitcnt lgkmcnt(10)
    v_mfma_f32_16x16x32_bf16 v[136:139], v[112:115], v[56:59], v[136:139]
    v_mfma_f32_16x16x32_bf16 v[160:163], v[112:115], v[64:67], v[160:163]
    s_add_u32 m0, s36, 26624
    s_nop 0
    buffer_load_dwordx4 v4, s[12:15], s46 offen lds
    ds_read_b64_tr_b16 v[112:113], v10 offset:24672
    ds_read_b64_tr_b16 v[114:115], v10 offset:27744
    s_waitcnt lgkmcnt(10)
    v_mfma_f32_16x16x32_bf16 v[140:143], v[116:119], v[56:59], v[140:143]
    v_mfma_f32_16x16x32_bf16 v[164:167], v[116:119], v[64:67], v[164:167]
    ds_read_b64_tr_b16 v[116:117], v10 offset:24704
    ds_read_b64_tr_b16 v[118:119], v10 offset:27776
    s_waitcnt lgkmcnt(10)
    v_mfma_f32_16x16x32_bf16 v[144:147], v[120:123], v[56:59], v[144:147]
    v_mfma_f32_16x16x32_bf16 v[168:171], v[120:123], v[64:67], v[168:171]
    s_waitcnt vmcnt(21)
    ds_read_b64_tr_b16 v[120:121], v11 offset:24576
    ds_read_b64_tr_b16 v[122:123], v11 offset:27648
    s_waitcnt lgkmcnt(10)
    v_mfma_f32_16x16x32_bf16 v[124:127], v[100:103], v[68:71], v[124:127]
    v_mfma_f32_16x16x32_bf16 v[148:151], v[100:103], v[76:79], v[148:151]
    s_mov_b32 s47, 28672
    buffer_load_dwordx4 v[52:55], v5, s[16:19], s47 offen offset:0
    ds_read_b64_tr_b16 v[100:101], v10 offset:30720
    ds_read_b64_tr_b16 v[102:103], v10 offset:33792
    s_waitcnt lgkmcnt(10)
    v_mfma_f32_16x16x32_bf16 v[128:131], v[104:107], v[68:71], v[128:131]
    v_mfma_f32_16x16x32_bf16 v[152:155], v[104:107], v[76:79], v[152:155]
    buffer_load_dwordx4 v[56:59], v5, s[16:19], s47 offen offset:1024
    ds_read_b64_tr_b16 v[104:105], v10 offset:30752
    ds_read_b64_tr_b16 v[106:107], v10 offset:33824
    s_waitcnt lgkmcnt(10)
    v_mfma_f32_16x16x32_bf16 v[132:135], v[108:111], v[68:71], v[132:135]
    v_mfma_f32_16x16x32_bf16 v[156:159], v[108:111], v[76:79], v[156:159]
    buffer_load_dwordx4 v[60:63], v6, s[16:19], s47 offen offset:0
    ds_read_b64_tr_b16 v[108:109], v10 offset:30784
    ds_read_b64_tr_b16 v[110:111], v10 offset:33856
    s_waitcnt lgkmcnt(10)
    v_mfma_f32_16x16x32_bf16 v[136:139], v[112:115], v[68:71], v[136:139]
    v_mfma_f32_16x16x32_bf16 v[160:163], v[112:115], v[76:79], v[160:163]
    buffer_load_dwordx4 v[64:67], v6, s[16:19], s47 offen offset:1024
    ds_read_b64_tr_b16 v[112:113], v10 offset:30816
    ds_read_b64_tr_b16 v[114:115], v10 offset:33888
    s_waitcnt lgkmcnt(10)
    v_mfma_f32_16x16x32_bf16 v[140:143], v[116:119], v[68:71], v[140:143]
    v_mfma_f32_16x16x32_bf16 v[164:167], v[116:119], v[76:79], v[164:167]
    ds_read_b64_tr_b16 v[116:117], v10 offset:30848
    ds_read_b64_tr_b16 v[118:119], v10 offset:33920
    s_waitcnt lgkmcnt(10)
    v_mfma_f32_16x16x32_bf16 v[144:147], v[120:123], v[68:71], v[144:147]
    v_mfma_f32_16x16x32_bf16 v[168:171], v[120:123], v[76:79], v[168:171]
    ds_read_b64_tr_b16 v[120:121], v11 offset:30720
    ds_read_b64_tr_b16 v[122:123], v11 offset:33792
    s_waitcnt lgkmcnt(10)
    v_mfma_f32_16x16x32_bf16 v[124:127], v[100:103], v[72:75], v[124:127]
    v_mfma_f32_16x16x32_bf16 v[148:151], v[100:103], v[80:83], v[148:151]
    s_waitcnt vmcnt(18)
    s_barrier
    ds_read_b64_tr_b16 v[100:101], v12 offset:0
    ds_read_b64_tr_b16 v[102:103], v12 offset:3072
    s_waitcnt lgkmcnt(10)
    v_mfma_f32_16x16x32_bf16 v[128:131], v[104:107], v[72:75], v[128:131]
    v_mfma_f32_16x16x32_bf16 v[152:155], v[104:107], v[80:83], v[152:155]
    s_mov_b32 s46, 1032192
    s_add_u32 m0, s36, 49152
    s_nop 0
    buffer_load_dwordx4 v2, s[12:15], s46 offen lds
    ds_read_b64_tr_b16 v[104:105], v12 offset:32
    ds_read_b64_tr_b16 v[106:107], v12 offset:3104
    s_waitcnt lgkmcnt(10)
    v_mfma_f32_16x16x32_bf16 v[132:135], v[108:111], v[72:75], v[132:135]
    v_mfma_f32_16x16x32_bf16 v[156:159], v[108:111], v[80:83], v[156:159]
    s_add_u32 m0, s36, 50176
    s_nop 0
    buffer_load_dwordx4 v3, s[12:15], s46 offen lds
    ds_read_b64_tr_b16 v[108:109], v12 offset:64
    ds_read_b64_tr_b16 v[110:111], v12 offset:3136
    s_waitcnt lgkmcnt(10)
    v_mfma_f32_16x16x32_bf16 v[136:139], v[112:115], v[72:75], v[136:139]
    v_mfma_f32_16x16x32_bf16 v[160:163], v[112:115], v[80:83], v[160:163]
    s_add_u32 m0, s36, 51200
    s_nop 0
    buffer_load_dwordx4 v4, s[12:15], s46 offen lds
    ds_read_b64_tr_b16 v[112:113], v12 offset:96
    ds_read_b64_tr_b16 v[114:115], v12 offset:3168
    s_waitcnt lgkmcnt(10)
    v_mfma_f32_16x16x32_bf16 v[140:143], v[116:119], v[72:75], v[140:143]
    v_mfma_f32_16x16x32_bf16 v[164:167], v[116:119], v[80:83], v[164:167]
    ds_read_b64_tr_b16 v[116:117], v12 offset:128
    ds_read_b64_tr_b16 v[118:119], v12 offset:3200
    s_waitcnt lgkmcnt(10)
    v_mfma_f32_16x16x32_bf16 v[144:147], v[120:123], v[72:75], v[144:147]
    v_mfma_f32_16x16x32_bf16 v[168:171], v[120:123], v[80:83], v[168:171]
    ds_read_b64_tr_b16 v[120:121], v13 offset:0
    ds_read_b64_tr_b16 v[122:123], v13 offset:3072
    s_waitcnt lgkmcnt(10)
    v_mfma_f32_16x16x32_bf16 v[124:127], v[100:103], v[84:87], v[124:127]
    v_mfma_f32_16x16x32_bf16 v[148:151], v[100:103], v[92:95], v[148:151]
    s_mov_b32 s47, 32768
    buffer_load_dwordx4 v[68:71], v5, s[16:19], s47 offen offset:0
    ds_read_b64_tr_b16 v[100:101], v12 offset:6144
    ds_read_b64_tr_b16 v[102:103], v12 offset:9216
    s_waitcnt lgkmcnt(10)
    v_mfma_f32_16x16x32_bf16 v[128:131], v[104:107], v[84:87], v[128:131]
    v_mfma_f32_16x16x32_bf16 v[152:155], v[104:107], v[92:95], v[152:155]
    buffer_load_dwordx4 v[72:75], v5, s[16:19], s47 offen offset:1024
    ds_read_b64_tr_b16 v[104:105], v12 offset:6176
    ds_read_b64_tr_b16 v[106:107], v12 offset:9248
    s_waitcnt lgkmcnt(10)
    v_mfma_f32_16x16x32_bf16 v[132:135], v[108:111], v[84:87], v[132:135]
    v_mfma_f32_16x16x32_bf16 v[156:159], v[108:111], v[92:95], v[156:159]
    buffer_load_dwordx4 v[76:79], v6, s[16:19], s47 offen offset:0
    ds_read_b64_tr_b16 v[108:109], v12 offset:6208
    ds_read_b64_tr_b16 v[110:111], v12 offset:9280
    s_waitcnt lgkmcnt(10)
    v_mfma_f32_16x16x32_bf16 v[136:139], v[112:115], v[84:87], v[136:139]
    v_mfma_f32_16x16x32_bf16 v[160:163], v[112:115], v[92:95], v[160:163]
    buffer_load_dwordx4 v[80:83], v6, s[16:19], s47 offen offset:1024
    ds_read_b64_tr_b16 v[112:113], v12 offset:6240
    ds_read_b64_tr_b16 v[114:115], v12 offset:9312
    s_waitcnt lgkmcnt(10)
    v_mfma_f32_16x16x32_bf16 v[140:143], v[116:119], v[84:87], v[140:143]
    v_mfma_f32_16x16x32_bf16 v[164:167], v[116:119], v[92:95], v[164:167]
    ds_read_b64_tr_b16 v[116:117], v12 offset:6272
    ds_read_b64_tr_b16 v[118:119], v12 offset:9344
    s_waitcnt lgkmcnt(10)
    v_mfma_f32_16x16x32_bf16 v[144:147], v[120:123], v[84:87], v[144:147]
    v_mfma_f32_16x16x32_bf16 v[168:171], v[120:123], v[92:95], v[168:171]
    ds_read_b64_tr_b16 v[120:121], v13 offset:6144
    ds_read_b64_tr_b16 v[122:123], v13 offset:9216
    s_waitcnt lgkmcnt(10)
    v_mfma_f32_16x16x32_bf16 v[124:127], v[100:103], v[88:91], v[124:127]
    v_mfma_f32_16x16x32_bf16 v[148:151], v[100:103], v[96:99], v[148:151]
    s_waitcnt vmcnt(18)
    s_barrier
    ds_read_b64_tr_b16 v[100:101], v8 offset:0
    ds_read_b64_tr_b16 v[102:103], v8 offset:3072
    s_waitcnt lgkmcnt(10)
    v_mfma_f32_16x16x32_bf16 v[128:131], v[104:107], v[88:91], v[128:131]
    v_mfma_f32_16x16x32_bf16 v[152:155], v[104:107], v[96:99], v[152:155]
    s_mov_b32 s46, 1179648
    s_add_u32 m0, s36, 73728
    s_nop 0
    buffer_load_dwordx4 v2, s[12:15], s46 offen lds
    ds_read_b64_tr_b16 v[104:105], v8 offset:32
    ds_read_b64_tr_b16 v[106:107], v8 offset:3104
    s_waitcnt lgkmcnt(10)
    v_mfma_f32_16x16x32_bf16 v[132:135], v[108:111], v[88:91], v[132:135]
    v_mfma_f32_16x16x32_bf16 v[156:159], v[108:111], v[96:99], v[156:159]
    s_add_u32 m0, s36, 74752
    s_nop 0
    buffer_load_dwordx4 v3, s[12:15], s46 offen lds
    ds_read_b64_tr_b16 v[108:109], v8 offset:64
    ds_read_b64_tr_b16 v[110:111], v8 offset:3136
    s_waitcnt lgkmcnt(10)
    v_mfma_f32_16x16x32_bf16 v[136:139], v[112:115], v[88:91], v[136:139]
    v_mfma_f32_16x16x32_bf16 v[160:163], v[112:115], v[96:99], v[160:163]
    s_add_u32 m0, s36, 75776
    s_nop 0
    buffer_load_dwordx4 v4, s[12:15], s46 offen lds
    ds_read_b64_tr_b16 v[112:113], v8 offset:96
    ds_read_b64_tr_b16 v[114:115], v8 offset:3168
    s_waitcnt lgkmcnt(10)
    v_mfma_f32_16x16x32_bf16 v[140:143], v[116:119], v[88:91], v[140:143]
    v_mfma_f32_16x16x32_bf16 v[164:167], v[116:119], v[96:99], v[164:167]
    ds_read_b64_tr_b16 v[116:117], v8 offset:128
    ds_read_b64_tr_b16 v[118:119], v8 offset:3200
    s_waitcnt lgkmcnt(10)
    v_mfma_f32_16x16x32_bf16 v[144:147], v[120:123], v[88:91], v[144:147]
    v_mfma_f32_16x16x32_bf16 v[168:171], v[120:123], v[96:99], v[168:171]
    ds_read_b64_tr_b16 v[120:121], v9 offset:0
    ds_read_b64_tr_b16 v[122:123], v9 offset:3072
    s_waitcnt lgkmcnt(10)
    v_mfma_f32_16x16x32_bf16 v[124:127], v[100:103], v[20:23], v[124:127]
    v_mfma_f32_16x16x32_bf16 v[148:151], v[100:103], v[28:31], v[148:151]
    s_mov_b32 s47, 36864
    buffer_load_dwordx4 v[84:87], v5, s[16:19], s47 offen offset:0
    ds_read_b64_tr_b16 v[100:101], v8 offset:6144
    ds_read_b64_tr_b16 v[102:103], v8 offset:9216
    s_waitcnt lgkmcnt(10)
    v_mfma_f32_16x16x32_bf16 v[128:131], v[104:107], v[20:23], v[128:131]
    v_mfma_f32_16x16x32_bf16 v[152:155], v[104:107], v[28:31], v[152:155]
    buffer_load_dwordx4 v[88:91], v5, s[16:19], s47 offen offset:1024
    ds_read_b64_tr_b16 v[104:105], v8 offset:6176
    ds_read_b64_tr_b16 v[106:107], v8 offset:9248
    s_waitcnt lgkmcnt(10)
    v_mfma_f32_16x16x32_bf16 v[132:135], v[108:111], v[20:23], v[132:135]
    v_mfma_f32_16x16x32_bf16 v[156:159], v[108:111], v[28:31], v[156:159]
    buffer_load_dwordx4 v[92:95], v6, s[16:19], s47 offen offset:0
    ds_read_b64_tr_b16 v[108:109], v8 offset:6208
    ds_read_b64_tr_b16 v[110:111], v8 offset:9280
    s_waitcnt lgkmcnt(10)
    v_mfma_f32_16x16x32_bf16 v[136:139], v[112:115], v[20:23], v[136:139]
    v_mfma_f32_16x16x32_bf16 v[160:163], v[112:115], v[28:31], v[160:163]
    buffer_load_dwordx4 v[96:99], v6, s[16:19], s47 offen offset:1024
    ds_read_b64_tr_b16 v[112:113], v8 offset:6240
    ds_read_b64_tr_b16 v[114:115], v8 offset:9312
    s_waitcnt lgkmcnt(10)
    v_mfma_f32_16x16x32_bf16 v[140:143], v[116:119], v[20:23], v[140:143]
    v_mfma_f32_16x16x32_bf16 v[164:167], v[116:119], v[28:31], v[164:167]
    ds_read_b64_tr_b16 v[116:117], v8 offset:6272
    ds_read_b64_tr_b16 v[118:119], v8 offset:9344
    s_waitcnt lgkmcnt(10)
    v_mfma_f32_16x16x32_bf16 v[144:147], v[120:123], v[20:23], v[144:147]
    v_mfma_f32_16x16x32_bf16 v[168:171], v[120:123], v[28:31], v[168:171]
    ds_read_b64_tr_b16 v[120:121], v9 offset:6144
    ds_read_b64_tr_b16 v[122:123], v9 offset:9216
    s_waitcnt lgkmcnt(10)
    v_mfma_f32_16x16x32_bf16 v[124:127], v[100:103], v[24:27], v[124:127]
    v_mfma_f32_16x16x32_bf16 v[148:151], v[100:103], v[32:35], v[148:151]
    s_waitcnt vmcnt(18)
    s_barrier
    ds_read_b64_tr_b16 v[100:101], v8 offset:24576
    ds_read_b64_tr_b16 v[102:103], v8 offset:27648
    s_waitcnt lgkmcnt(10)
    v_mfma_f32_16x16x32_bf16 v[128:131], v[104:107], v[24:27], v[128:131]
    v_mfma_f32_16x16x32_bf16 v[152:155], v[104:107], v[32:35], v[152:155]
    s_mov_b32 s46, 1327104
    s_add_u32 m0, s36, 98304
    s_nop 0
    buffer_load_dwordx4 v2, s[12:15], s46 offen lds
    ds_read_b64_tr_b16 v[104:105], v8 offset:24608
    ds_read_b64_tr_b16 v[106:107], v8 offset:27680
    s_waitcnt lgkmcnt(10)
    v_mfma_f32_16x16x32_bf16 v[132:135], v[108:111], v[24:27], v[132:135]
    v_mfma_f32_16x16x32_bf16 v[156:159], v[108:111], v[32:35], v[156:159]
    s_add_u32 m0, s36, 99328
    s_nop 0
    buffer_load_dwordx4 v3, s[12:15], s46 offen lds
    ds_read_b64_tr_b16 v[108:109], v8 offset:24640
    ds_read_b64_tr_b16 v[110:111], v8 offset:27712
    s_waitcnt lgkmcnt(10)
    v_mfma_f32_16x16x32_bf16 v[136:139], v[112:115], v[24:27], v[136:139]
    v_mfma_f32_16x16x32_bf16 v[160:163], v[112:115], v[32:35], v[160:163]
    s_add_u32 m0, s36, 100352
    s_nop 0
    buffer_load_dwordx4 v4, s[12:15], s46 offen lds
    ds_read_b64_tr_b16 v[112:113], v8 offset:24672
    ds_read_b64_tr_b16 v[114:115], v8 offset:27744
    s_waitcnt lgkmcnt(10)
    v_mfma_f32_16x16x32_bf16 v[140:143], v[116:119], v[24:27], v[140:143]
    v_mfma_f32_16x16x32_bf16 v[164:167], v[116:119], v[32:35], v[164:167]
    ds_read_b64_tr_b16 v[116:117], v8 offset:24704
    ds_read_b64_tr_b16 v[118:119], v8 offset:27776
    s_waitcnt lgkmcnt(10)
    v_mfma_f32_16x16x32_bf16 v[144:147], v[120:123], v[24:27], v[144:147]
    v_mfma_f32_16x16x32_bf16 v[168:171], v[120:123], v[32:35], v[168:171]
    ds_read_b64_tr_b16 v[120:121], v9 offset:24576
    ds_read_b64_tr_b16 v[122:123], v9 offset:27648
    s_waitcnt lgkmcnt(10)
    v_mfma_f32_16x16x32_bf16 v[124:127], v[100:103], v[36:39], v[124:127]
    v_mfma_f32_16x16x32_bf16 v[148:151], v[100:103], v[44:47], v[148:151]
    s_mov_b32 s47, 40960
    buffer_load_dwordx4 v[20:23], v5, s[16:19], s47 offen offset:0
    buffer_load_dwordx4 v[172:175], v233, s[24:27], 0 offen offset:0
    buffer_load_dwordx4 v[176:179], v233, s[24:27], 0 offen offset:1024
    buffer_load_dwordx4 v[180:183], v233, s[24:27], 0 offen offset:2048
    buffer_load_dwordx4 v[184:187], v233, s[24:27], 0 offen offset:3072
    buffer_load_dwordx4 v[188:191], v233, s[24:27], s88 offen offset:0
    buffer_load_dwordx4 v[192:195], v233, s[24:27], s88 offen offset:1024
    ds_read_b64_tr_b16 v[100:101], v8 offset:30720
    ds_read_b64_tr_b16 v[102:103], v8 offset:33792
    s_waitcnt lgkmcnt(10)
    v_mfma_f32_16x16x32_bf16 v[128:131], v[104:107], v[36:39], v[128:131]
    v_mfma_f32_16x16x32_bf16 v[152:155], v[104:107], v[44:47], v[152:155]
    buffer_load_dwordx4 v[24:27], v5, s[16:19], s47 offen offset:1024
    ds_read_b64_tr_b16 v[104:105], v8 offset:30752
    ds_read_b64_tr_b16 v[106:107], v8 offset:33824
    s_waitcnt lgkmcnt(10)
    v_mfma_f32_16x16x32_bf16 v[132:135], v[108:111], v[36:39], v[132:135]
    v_mfma_f32_16x16x32_bf16 v[156:159], v[108:111], v[44:47], v[156:159]
    buffer_load_dwordx4 v[28:31], v6, s[16:19], s47 offen offset:0
    ds_read_b64_tr_b16 v[108:109], v8 offset:30784
    ds_read_b64_tr_b16 v[110:111], v8 offset:33856
    s_waitcnt lgkmcnt(10)
    v_mfma_f32_16x16x32_bf16 v[136:139], v[112:115], v[36:39], v[136:139]
    v_mfma_f32_16x16x32_bf16 v[160:163], v[112:115], v[44:47], v[160:163]
    buffer_load_dwordx4 v[32:35], v6, s[16:19], s47 offen offset:1024
    ds_read_b64_tr_b16 v[112:113], v8 offset:30816
    ds_read_b64_tr_b16 v[114:115], v8 offset:33888
    s_waitcnt lgkmcnt(10)
    v_mfma_f32_16x16x32_bf16 v[140:143], v[116:119], v[36:39], v[140:143]
    v_mfma_f32_16x16x32_bf16 v[164:167], v[116:119], v[44:47], v[164:167]
    ds_read_b64_tr_b16 v[116:117], v8 offset:30848
    ds_read_b64_tr_b16 v[118:119], v8 offset:33920
    s_waitcnt lgkmcnt(10)
    v_mfma_f32_16x16x32_bf16 v[144:147], v[120:123], v[36:39], v[144:147]
    v_mfma_f32_16x16x32_bf16 v[168:171], v[120:123], v[44:47], v[168:171]
    ds_read_b64_tr_b16 v[120:121], v9 offset:30720
    ds_read_b64_tr_b16 v[122:123], v9 offset:33792
    s_waitcnt lgkmcnt(10)
    v_mfma_f32_16x16x32_bf16 v[124:127], v[100:103], v[40:43], v[124:127]
    v_mfma_f32_16x16x32_bf16 v[148:151], v[100:103], v[48:51], v[148:151]
    s_waitcnt vmcnt(24)
    s_barrier
    ds_read_b64_tr_b16 v[100:101], v10 offset:0
    ds_read_b64_tr_b16 v[102:103], v10 offset:3072
    s_waitcnt lgkmcnt(10)
    v_mfma_f32_16x16x32_bf16 v[128:131], v[104:107], v[40:43], v[128:131]
    v_mfma_f32_16x16x32_bf16 v[152:155], v[104:107], v[48:51], v[152:155]
    s_mov_b32 s46, 1474560
    s_add_u32 m0, s36, 0
    s_nop 0
    buffer_load_dwordx4 v2, s[12:15], s46 offen lds
    ds_read_b64_tr_b16 v[104:105], v10 offset:32
    ds_read_b64_tr_b16 v[106:107], v10 offset:3104
    s_waitcnt lgkmcnt(10)
    v_mfma_f32_16x16x32_bf16 v[132:135], v[108:111], v[40:43], v[132:135]
    v_mfma_f32_16x16x32_bf16 v[156:159], v[108:111], v[48:51], v[156:159]
    s_add_u32 m0, s36, 1024
    s_nop 0
    buffer_load_dwordx4 v3, s[12:15], s46 offen lds
    ds_read_b64_tr_b16 v[108:109], v10 offset:64
    ds_read_b64_tr_b16 v[110:111], v10 offset:3136
    s_waitcnt lgkmcnt(10)
    v_mfma_f32_16x16x32_bf16 v[136:139], v[112:115], v[40:43], v[136:139]
    v_mfma_f32_16x16x32_bf16 v[160:163], v[112:115], v[48:51], v[160:163]
    s_add_u32 m0, s36, 2048
    s_nop 0
    buffer_load_dwordx4 v4, s[12:15], s46 offen lds
    ds_read_b64_tr_b16 v[112:113], v10 offset:96
    ds_read_b64_tr_b16 v[114:115], v10 offset:3168
    s_waitcnt lgkmcnt(10)
    v_mfma_f32_16x16x32_bf16 v[140:143], v[116:119], v[40:43], v[140:143]
    v_mfma_f32_16x16x32_bf16 v[164:167], v[116:119], v[48:51], v[164:167]
    ds_read_b64_tr_b16 v[116:117], v10 offset:128
    ds_read_b64_tr_b16 v[118:119], v10 offset:3200
    s_waitcnt lgkmcnt(10)
    v_mfma_f32_16x16x32_bf16 v[144:147], v[120:123], v[40:43], v[144:147]
    v_mfma_f32_16x16x32_bf16 v[168:171], v[120:123], v[48:51], v[168:171]
    ds_read_b64_tr_b16 v[120:121], v11 offset:0
    ds_read_b64_tr_b16 v[122:123], v11 offset:3072
    s_waitcnt lgkmcnt(10)
    v_mfma_f32_16x16x32_bf16 v[124:127], v[100:103], v[52:55], v[124:127]
    v_mfma_f32_16x16x32_bf16 v[148:151], v[100:103], v[60:63], v[148:151]
    s_mov_b32 s47, 45056
    buffer_load_dwordx4 v[36:39], v5, s[16:19], s47 offen offset:0
    ds_read_b64_tr_b16 v[100:101], v10 offset:6144
    ds_read_b64_tr_b16 v[102:103], v10 offset:9216
    s_waitcnt lgkmcnt(10)
    v_mfma_f32_16x16x32_bf16 v[128:131], v[104:107], v[52:55], v[128:131]
    v_mfma_f32_16x16x32_bf16 v[152:155], v[104:107], v[60:63], v[152:155]
    buffer_load_dwordx4 v[40:43], v5, s[16:19], s47 offen offset:1024
    ds_read_b64_tr_b16 v[104:105], v10 offset:6176
    ds_read_b64_tr_b16 v[106:107], v10 offset:9248
    s_waitcnt lgkmcnt(10)
    v_mfma_f32_16x16x32_bf16 v[132:135], v[108:111], v[52:55], v[132:135]
    v_mfma_f32_16x16x32_bf16 v[156:159], v[108:111], v[60:63], v[156:159]
    buffer_load_dwordx4 v[44:47], v6, s[16:19], s47 offen offset:0
    ds_read_b64_tr_b16 v[108:109], v10 offset:6208
    ds_read_b64_tr_b16 v[110:111], v10 offset:9280
    s_waitcnt lgkmcnt(10)
    v_mfma_f32_16x16x32_bf16 v[136:139], v[112:115], v[52:55], v[136:139]
    v_mfma_f32_16x16x32_bf16 v[160:163], v[112:115], v[60:63], v[160:163]
    buffer_load_dwordx4 v[48:51], v6, s[16:19], s47 offen offset:1024
    ds_read_b64_tr_b16 v[112:113], v10 offset:6240
    ds_read_b64_tr_b16 v[114:115], v10 offset:9312
    s_waitcnt lgkmcnt(10)
    v_mfma_f32_16x16x32_bf16 v[140:143], v[116:119], v[52:55], v[140:143]
    v_mfma_f32_16x16x32_bf16 v[164:167], v[116:119], v[60:63], v[164:167]
    ds_read_b64_tr_b16 v[116:117], v10 offset:6272
    ds_read_b64_tr_b16 v[118:119], v10 offset:9344
    s_waitcnt lgkmcnt(10)
    v_mfma_f32_16x16x32_bf16 v[144:147], v[120:123], v[52:55], v[144:147]
    v_mfma_f32_16x16x32_bf16 v[168:171], v[120:123], v[60:63], v[168:171]
    ds_read_b64_tr_b16 v[120:121], v11 offset:6144
    ds_read_b64_tr_b16 v[122:123], v11 offset:9216
    s_waitcnt lgkmcnt(10)
    v_mfma_f32_16x16x32_bf16 v[124:127], v[100:103], v[56:59], v[124:127]
    v_mfma_f32_16x16x32_bf16 v[148:151], v[100:103], v[64:67], v[148:151]
    s_waitcnt vmcnt(24)
    s_barrier
    ds_read_b64_tr_b16 v[100:101], v10 offset:24576
    ds_read_b64_tr_b16 v[102:103], v10 offset:27648
    s_waitcnt lgkmcnt(10)
    v_mfma_f32_16x16x32_bf16 v[128:131], v[104:107], v[56:59], v[128:131]
    v_mfma_f32_16x16x32_bf16 v[152:155], v[104:107], v[64:67], v[152:155]
    s_mov_b32 s46, 1622016
    s_add_u32 m0, s36, 24576
    s_nop 0
    buffer_load_dwordx4 v2, s[12:15], s46 offen lds
    ds_read_b64_tr_b16 v[104:105], v10 offset:24608
    ds_read_b64_tr_b16 v[106:107], v10 offset:27680
    s_waitcnt lgkmcnt(10)
    v_mfma_f32_16x16x32_bf16 v[132:135], v[108:111], v[56:59], v[132:135]
    v_mfma_f32_16x16x32_bf16 v[156:159], v[108:111], v[64:67], v[156:159]
    s_add_u32 m0, s36, 25600
    s_nop 0
    buffer_load_dwordx4 v3, s[12:15], s46 offen lds
    ds_read_b64_tr_b16 v[108:109], v10 offset:24640
    ds_read_b64_tr_b16 v[110:111], v10 offset:27712
    s_waitcnt lgkmcnt(10)
    v_mfma_f32_16x16x32_bf16 v[136:139], v[112:115], v[56:59], v[136:139]
    v_mfma_f32_16x16x32_bf16 v[160:163], v[112:115], v[64:67], v[160:163]
    s_add_u32 m0, s36, 26624
    s_nop 0
    buffer_load_dwordx4 v4, s[12:15], s46 offen lds
    ds_read_b64_tr_b16 v[112:113], v10 offset:24672
    ds_read_b64_tr_b16 v[114:115], v10 offset:27744
    s_waitcnt lgkmcnt(10)
    v_mfma_f32_16x16x32_bf16 v[140:143], v[116:119], v[56:59], v[140:143]
    v_mfma_f32_16x16x32_bf16 v[164:167], v[116:119], v[64:67], v[164:167]
    ds_read_b64_tr_b16 v[116:117], v10 offset:24704
    ds_read_b64_tr_b16 v[118:119], v10 offset:27776
    s_waitcnt lgkmcnt(10)
    v_mfma_f32_16x16x32_bf16 v[144:147], v[120:123], v[56:59], v[144:147]
    v_mfma_f32_16x16x32_bf16 v[168:171], v[120:123], v[64:67], v[168:171]
    ds_read_b64_tr_b16 v[120:121], v11 offset:24576
    ds_read_b64_tr_b16 v[122:123], v11 offset:27648
    s_waitcnt lgkmcnt(10)
    v_mfma_f32_16x16x32_bf16 v[124:127], v[100:103], v[68:71], v[124:127]
    v_mfma_f32_16x16x32_bf16 v[148:151], v[100:103], v[76:79], v[148:151]
    s_mov_b32 s47, 49152
    buffer_load_dwordx4 v[52:55], v5, s[16:19], s47 offen offset:0
    ds_read_b64_tr_b16 v[100:101], v10 offset:30720
    ds_read_b64_tr_b16 v[102:103], v10 offset:33792
    s_waitcnt lgkmcnt(10)
    v_mfma_f32_16x16x32_bf16 v[128:131], v[104:107], v[68:71], v[128:131]
    v_mfma_f32_16x16x32_bf16 v[152:155], v[104:107], v[76:79], v[152:155]
    buffer_load_dwordx4 v[56:59], v5, s[16:19], s47 offen offset:1024
    ds_read_b64_tr_b16 v[104:105], v10 offset:30752
    ds_read_b64_tr_b16 v[106:107], v10 offset:33824
    s_waitcnt lgkmcnt(10)
    v_mfma_f32_16x16x32_bf16 v[132:135], v[108:111], v[68:71], v[132:135]
    v_mfma_f32_16x16x32_bf16 v[156:159], v[108:111], v[76:79], v[156:159]
    buffer_load_dwordx4 v[60:63], v6, s[16:19], s47 offen offset:0
    ds_read_b64_tr_b16 v[108:109], v10 offset:30784
    ds_read_b64_tr_b16 v[110:111], v10 offset:33856
    s_waitcnt lgkmcnt(10)
    v_mfma_f32_16x16x32_bf16 v[136:139], v[112:115], v[68:71], v[136:139]
    v_mfma_f32_16x16x32_bf16 v[160:163], v[112:115], v[76:79], v[160:163]
    buffer_load_dwordx4 v[64:67], v6, s[16:19], s47 offen offset:1024
    ds_read_b64_tr_b16 v[112:113], v10 offset:30816
    ds_read_b64_tr_b16 v[114:115], v10 offset:33888
    s_waitcnt lgkmcnt(10)
    v_mfma_f32_16x16x32_bf16 v[140:143], v[116:119], v[68:71], v[140:143]
    v_mfma_f32_16x16x32_bf16 v[164:167], v[116:119], v[76:79], v[164:167]
    ds_read_b64_tr_b16 v[116:117], v10 offset:30848
    ds_read_b64_tr_b16 v[118:119], v10 offset:33920
    s_waitcnt lgkmcnt(10)
    v_mfma_f32_16x16x32_bf16 v[144:147], v[120:123], v[68:71], v[144:147]
    v_mfma_f32_16x16x32_bf16 v[168:171], v[120:123], v[76:79], v[168:171]
    ds_read_b64_tr_b16 v[120:121], v11 offset:30720
    ds_read_b64_tr_b16 v[122:123], v11 offset:33792
    s_waitcnt lgkmcnt(10)
    v_mfma_f32_16x16x32_bf16 v[124:127], v[100:103], v[72:75], v[124:127]
    v_mfma_f32_16x16x32_bf16 v[148:151], v[100:103], v[80:83], v[148:151]
    s_waitcnt vmcnt(24)
    s_barrier
    ds_read_b64_tr_b16 v[100:101], v12 offset:0
    ds_read_b64_tr_b16 v[102:103], v12 offset:3072
    s_waitcnt lgkmcnt(10)
    v_mfma_f32_16x16x32_bf16 v[128:131], v[104:107], v[72:75], v[128:131]
    v_mfma_f32_16x16x32_bf16 v[152:155], v[104:107], v[80:83], v[152:155]
    s_mov_b32 s46, 1769472
    s_add_u32 m0, s36, 49152
    s_nop 0
    buffer_load_dwordx4 v2, s[12:15], s46 offen lds
    ds_read_b64_tr_b16 v[104:105], v12 offset:32
    ds_read_b64_tr_b16 v[106:107], v12 offset:3104
    s_waitcnt lgkmcnt(10)
    v_mfma_f32_16x16x32_bf16 v[132:135], v[108:111], v[72:75], v[132:135]
    v_mfma_f32_16x16x32_bf16 v[156:159], v[108:111], v[80:83], v[156:159]
    s_add_u32 m0, s36, 50176
    s_nop 0
    buffer_load_dwordx4 v3, s[12:15], s46 offen lds
    ds_read_b64_tr_b16 v[108:109], v12 offset:64
    ds_read_b64_tr_b16 v[110:111], v12 offset:3136
    s_waitcnt lgkmcnt(10)
    v_mfma_f32_16x16x32_bf16 v[136:139], v[112:115], v[72:75], v[136:139]
    v_mfma_f32_16x16x32_bf16 v[160:163], v[112:115], v[80:83], v[160:163]
    s_add_u32 m0, s36, 51200
    s_nop 0
    buffer_load_dwordx4 v4, s[12:15], s46 offen lds
    ds_read_b64_tr_b16 v[112:113], v12 offset:96
    ds_read_b64_tr_b16 v[114:115], v12 offset:3168
    s_waitcnt lgkmcnt(10)
    v_mfma_f32_16x16x32_bf16 v[140:143], v[116:119], v[72:75], v[140:143]
    v_mfma_f32_16x16x32_bf16 v[164:167], v[116:119], v[80:83], v[164:167]
    ds_read_b64_tr_b16 v[116:117], v12 offset:128
    ds_read_b64_tr_b16 v[118:119], v12 offset:3200
    s_waitcnt lgkmcnt(10)
    v_mfma_f32_16x16x32_bf16 v[144:147], v[120:123], v[72:75], v[144:147]
    v_mfma_f32_16x16x32_bf16 v[168:171], v[120:123], v[80:83], v[168:171]
    ds_read_b64_tr_b16 v[120:121], v13 offset:0
    ds_read_b64_tr_b16 v[122:123], v13 offset:3072
    s_waitcnt lgkmcnt(10)
    v_mfma_f32_16x16x32_bf16 v[124:127], v[100:103], v[84:87], v[124:127]
    v_mfma_f32_16x16x32_bf16 v[148:151], v[100:103], v[92:95], v[148:151]
    s_mov_b32 s47, 53248
    buffer_load_dwordx4 v[68:71], v5, s[16:19], s47 offen offset:0
    ds_read_b64_tr_b16 v[100:101], v12 offset:6144
    ds_read_b64_tr_b16 v[102:103], v12 offset:9216
    s_waitcnt lgkmcnt(10)
    v_mfma_f32_16x16x32_bf16 v[128:131], v[104:107], v[84:87], v[128:131]
    v_mfma_f32_16x16x32_bf16 v[152:155], v[104:107], v[92:95], v[152:155]
    buffer_load_dwordx4 v[72:75], v5, s[16:19], s47 offen offset:1024
    ds_read_b64_tr_b16 v[104:105], v12 offset:6176
    ds_read_b64_tr_b16 v[106:107], v12 offset:9248
    s_waitcnt lgkmcnt(10)
    v_mfma_f32_16x16x32_bf16 v[132:135], v[108:111], v[84:87], v[132:135]
    v_mfma_f32_16x16x32_bf16 v[156:159], v[108:111], v[92:95], v[156:159]
    buffer_load_dwordx4 v[76:79], v6, s[16:19], s47 offen offset:0
    ds_read_b64_tr_b16 v[108:109], v12 offset:6208
    ds_read_b64_tr_b16 v[110:111], v12 offset:9280
    s_waitcnt lgkmcnt(10)
    v_mfma_f32_16x16x32_bf16 v[136:139], v[112:115], v[84:87], v[136:139]
    v_mfma_f32_16x16x32_bf16 v[160:163], v[112:115], v[92:95], v[160:163]
    buffer_load_dwordx4 v[80:83], v6, s[16:19], s47 offen offset:1024
    ds_read_b64_tr_b16 v[112:113], v12 offset:6240
    ds_read_b64_tr_b16 v[114:115], v12 offset:9312
    s_waitcnt lgkmcnt(10)
    v_mfma_f32_16x16x32_bf16 v[140:143], v[116:119], v[84:87], v[140:143]
    v_mfma_f32_16x16x32_bf16 v[164:167], v[116:119], v[92:95], v[164:167]
    ds_read_b64_tr_b16 v[116:117], v12 offset:6272
    ds_read_b64_tr_b16 v[118:119], v12 offset:9344
    s_waitcnt lgkmcnt(10)
    v_mfma_f32_16x16x32_bf16 v[144:147], v[120:123], v[84:87], v[144:147]
    v_mfma_f32_16x16x32_bf16 v[168:171], v[120:123], v[92:95], v[168:171]
    ds_read_b64_tr_b16 v[120:121], v13 offset:6144
    ds_read_b64_tr_b16 v[122:123], v13 offset:9216
    s_waitcnt lgkmcnt(10)
    v_mfma_f32_16x16x32_bf16 v[124:127], v[100:103], v[88:91], v[124:127]
    v_mfma_f32_16x16x32_bf16 v[148:151], v[100:103], v[96:99], v[148:151]
    s_waitcnt vmcnt(18)
    s_barrier
    ds_read_b64_tr_b16 v[100:101], v8 offset:0
    ds_read_b64_tr_b16 v[102:103], v8 offset:3072
    s_waitcnt lgkmcnt(10)
    v_mfma_f32_16x16x32_bf16 v[128:131], v[104:107], v[88:91], v[128:131]
    v_mfma_f32_16x16x32_bf16 v[152:155], v[104:107], v[96:99], v[152:155]
    s_mov_b32 s46, 1916928
    s_add_u32 m0, s36, 73728
    s_nop 0
    buffer_load_dwordx4 v2, s[12:15], s46 offen lds
    ds_read_b64_tr_b16 v[104:105], v8 offset:32
    ds_read_b64_tr_b16 v[106:107], v8 offset:3104
    s_waitcnt lgkmcnt(10)
    v_mfma_f32_16x16x32_bf16 v[132:135], v[108:111], v[88:91], v[132:135]
    v_mfma_f32_16x16x32_bf16 v[156:159], v[108:111], v[96:99], v[156:159]
    s_add_u32 m0, s36, 74752
    s_nop 0
    buffer_load_dwordx4 v3, s[12:15], s46 offen lds
    ds_read_b64_tr_b16 v[108:109], v8 offset:64
    ds_read_b64_tr_b16 v[110:111], v8 offset:3136
    s_waitcnt lgkmcnt(10)
    v_mfma_f32_16x16x32_bf16 v[136:139], v[112:115], v[88:91], v[136:139]
    v_mfma_f32_16x16x32_bf16 v[160:163], v[112:115], v[96:99], v[160:163]
    s_add_u32 m0, s36, 75776
    s_nop 0
    buffer_load_dwordx4 v4, s[12:15], s46 offen lds
    ds_read_b64_tr_b16 v[112:113], v8 offset:96
    ds_read_b64_tr_b16 v[114:115], v8 offset:3168
    s_waitcnt lgkmcnt(10)
    v_mfma_f32_16x16x32_bf16 v[140:143], v[116:119], v[88:91], v[140:143]
    v_mfma_f32_16x16x32_bf16 v[164:167], v[116:119], v[96:99], v[164:167]
    ds_read_b64_tr_b16 v[116:117], v8 offset:128
    ds_read_b64_tr_b16 v[118:119], v8 offset:3200
    s_waitcnt lgkmcnt(10)
    v_mfma_f32_16x16x32_bf16 v[144:147], v[120:123], v[88:91], v[144:147]
    v_mfma_f32_16x16x32_bf16 v[168:171], v[120:123], v[96:99], v[168:171]
    ds_read_b64_tr_b16 v[120:121], v9 offset:0
    ds_read_b64_tr_b16 v[122:123], v9 offset:3072
    s_waitcnt lgkmcnt(10)
    v_mfma_f32_16x16x32_bf16 v[124:127], v[100:103], v[20:23], v[124:127]
    v_mfma_f32_16x16x32_bf16 v[148:151], v[100:103], v[28:31], v[148:151]
    s_mov_b32 s47, 57344
    buffer_load_dwordx4 v[84:87], v5, s[16:19], s47 offen offset:0
    ds_read_b64_tr_b16 v[100:101], v8 offset:6144
    ds_read_b64_tr_b16 v[102:103], v8 offset:9216
    s_waitcnt lgkmcnt(10)
    v_mfma_f32_16x16x32_bf16 v[128:131], v[104:107], v[20:23], v[128:131]
    v_mfma_f32_16x16x32_bf16 v[152:155], v[104:107], v[28:31], v[152:155]
    buffer_load_dwordx4 v[88:91], v5, s[16:19], s47 offen offset:1024
    ds_read_b64_tr_b16 v[104:105], v8 offset:6176
    ds_read_b64_tr_b16 v[106:107], v8 offset:9248
    s_waitcnt lgkmcnt(10)
    v_mfma_f32_16x16x32_bf16 v[132:135], v[108:111], v[20:23], v[132:135]
    v_mfma_f32_16x16x32_bf16 v[156:159], v[108:111], v[28:31], v[156:159]
    buffer_load_dwordx4 v[92:95], v6, s[16:19], s47 offen offset:0
    ds_read_b64_tr_b16 v[108:109], v8 offset:6208
    ds_read_b64_tr_b16 v[110:111], v8 offset:9280
    s_waitcnt lgkmcnt(10)
    v_mfma_f32_16x16x32_bf16 v[136:139], v[112:115], v[20:23], v[136:139]
    v_mfma_f32_16x16x32_bf16 v[160:163], v[112:115], v[28:31], v[160:163]
    buffer_load_dwordx4 v[96:99], v6, s[16:19], s47 offen offset:1024
    ds_read_b64_tr_b16 v[112:113], v8 offset:6240
    ds_read_b64_tr_b16 v[114:115], v8 offset:9312
    s_waitcnt lgkmcnt(10)
    v_mfma_f32_16x16x32_bf16 v[140:143], v[116:119], v[20:23], v[140:143]
    v_mfma_f32_16x16x32_bf16 v[164:167], v[116:119], v[28:31], v[164:167]
    ds_read_b64_tr_b16 v[116:117], v8 offset:6272
    ds_read_b64_tr_b16 v[118:119], v8 offset:9344
    s_waitcnt lgkmcnt(10)
    v_mfma_f32_16x16x32_bf16 v[144:147], v[120:123], v[20:23], v[144:147]
    v_mfma_f32_16x16x32_bf16 v[168:171], v[120:123], v[28:31], v[168:171]
    ds_read_b64_tr_b16 v[120:121], v9 offset:6144
    ds_read_b64_tr_b16 v[122:123], v9 offset:9216
    s_waitcnt lgkmcnt(10)
    v_mfma_f32_16x16x32_bf16 v[124:127], v[100:103], v[24:27], v[124:127]
    v_mfma_f32_16x16x32_bf16 v[148:151], v[100:103], v[32:35], v[148:151]
    s_waitcnt vmcnt(18)
    s_barrier
    ds_read_b64_tr_b16 v[100:101], v8 offset:24576
    ds_read_b64_tr_b16 v[102:103], v8 offset:27648
    s_waitcnt lgkmcnt(10)
    v_mfma_f32_16x16x32_bf16 v[128:131], v[104:107], v[24:27], v[128:131]
    v_mfma_f32_16x16x32_bf16 v[152:155], v[104:107], v[32:35], v[152:155]
    s_mov_b32 s46, 2064384
    s_add_u32 m0, s36, 98304
    s_nop 0
    buffer_load_dwordx4 v2, s[12:15], s46 offen lds
    ds_read_b64_tr_b16 v[104:105], v8 offset:24608
    ds_read_b64_tr_b16 v[106:107], v8 offset:27680
    s_waitcnt lgkmcnt(10)
    v_mfma_f32_16x16x32_bf16 v[132:135], v[108:111], v[24:27], v[132:135]
    v_mfma_f32_16x16x32_bf16 v[156:159], v[108:111], v[32:35], v[156:159]
    s_add_u32 m0, s36, 99328
    s_nop 0
    buffer_load_dwordx4 v3, s[12:15], s46 offen lds
    ds_read_b64_tr_b16 v[108:109], v8 offset:24640
    ds_read_b64_tr_b16 v[110:111], v8 offset:27712
    s_waitcnt lgkmcnt(10)
    v_mfma_f32_16x16x32_bf16 v[136:139], v[112:115], v[24:27], v[136:139]
    v_mfma_f32_16x16x32_bf16 v[160:163], v[112:115], v[32:35], v[160:163]
    s_add_u32 m0, s36, 100352
    s_nop 0
    buffer_load_dwordx4 v4, s[12:15], s46 offen lds
    ds_read_b64_tr_b16 v[112:113], v8 offset:24672
    ds_read_b64_tr_b16 v[114:115], v8 offset:27744
    s_waitcnt lgkmcnt(10)
    v_mfma_f32_16x16x32_bf16 v[140:143], v[116:119], v[24:27], v[140:143]
    v_mfma_f32_16x16x32_bf16 v[164:167], v[116:119], v[32:35], v[164:167]
    ds_read_b64_tr_b16 v[116:117], v8 offset:24704
    ds_read_b64_tr_b16 v[118:119], v8 offset:27776
    s_waitcnt lgkmcnt(10)
    v_mfma_f32_16x16x32_bf16 v[144:147], v[120:123], v[24:27], v[144:147]
    v_mfma_f32_16x16x32_bf16 v[168:171], v[120:123], v[32:35], v[168:171]
    ds_read_b64_tr_b16 v[120:121], v9 offset:24576
    ds_read_b64_tr_b16 v[122:123], v9 offset:27648
    s_waitcnt lgkmcnt(10)
    v_mfma_f32_16x16x32_bf16 v[124:127], v[100:103], v[36:39], v[124:127]
    v_mfma_f32_16x16x32_bf16 v[148:151], v[100:103], v[44:47], v[148:151]
    s_mov_b32 s47, 61440
    buffer_load_dwordx4 v[20:23], v5, s[16:19], s47 offen offset:0
    ds_read_b64_tr_b16 v[100:101], v8 offset:30720
    ds_read_b64_tr_b16 v[102:103], v8 offset:33792
    s_waitcnt lgkmcnt(10)
    v_mfma_f32_16x16x32_bf16 v[128:131], v[104:107], v[36:39], v[128:131]
    v_mfma_f32_16x16x32_bf16 v[152:155], v[104:107], v[44:47], v[152:155]
    buffer_load_dwordx4 v[24:27], v5, s[16:19], s47 offen offset:1024
    ds_read_b64_tr_b16 v[104:105], v8 offset:30752
    ds_read_b64_tr_b16 v[106:107], v8 offset:33824
    s_waitcnt lgkmcnt(10)
    v_mfma_f32_16x16x32_bf16 v[132:135], v[108:111], v[36:39], v[132:135]
    v_mfma_f32_16x16x32_bf16 v[156:159], v[108:111], v[44:47], v[156:159]
    buffer_load_dwordx4 v[28:31], v6, s[16:19], s47 offen offset:0
    ds_read_b64_tr_b16 v[108:109], v8 offset:30784
    ds_read_b64_tr_b16 v[110:111], v8 offset:33856
    s_waitcnt lgkmcnt(10)
    v_mfma_f32_16x16x32_bf16 v[136:139], v[112:115], v[36:39], v[136:139]
    v_mfma_f32_16x16x32_bf16 v[160:163], v[112:115], v[44:47], v[160:163]
    buffer_load_dwordx4 v[32:35], v6, s[16:19], s47 offen offset:1024
    ds_read_b64_tr_b16 v[112:113], v8 offset:30816
    ds_read_b64_tr_b16 v[114:115], v8 offset:33888
    s_waitcnt lgkmcnt(10)
    v_mfma_f32_16x16x32_bf16 v[140:143], v[116:119], v[36:39], v[140:143]
    v_mfma_f32_16x16x32_bf16 v[164:167], v[116:119], v[44:47], v[164:167]
    ds_read_b64_tr_b16 v[116:117], v8 offset:30848
    ds_read_b64_tr_b16 v[118:119], v8 offset:33920
    s_waitcnt lgkmcnt(10)
    v_mfma_f32_16x16x32_bf16 v[144:147], v[120:123], v[36:39], v[144:147]
    v_mfma_f32_16x16x32_bf16 v[168:171], v[120:123], v[44:47], v[168:171]
    ds_read_b64_tr_b16 v[120:121], v9 offset:30720
    ds_read_b64_tr_b16 v[122:123], v9 offset:33792
    s_waitcnt lgkmcnt(10)
    v_mfma_f32_16x16x32_bf16 v[124:127], v[100:103], v[40:43], v[124:127]
    v_mfma_f32_16x16x32_bf16 v[148:151], v[100:103], v[48:51], v[148:151]
    s_waitcnt vmcnt(18)
    s_barrier
    ds_read_b64_tr_b16 v[100:101], v10 offset:0
    ds_read_b64_tr_b16 v[102:103], v10 offset:3072
    s_waitcnt lgkmcnt(10)
    v_mfma_f32_16x16x32_bf16 v[128:131], v[104:107], v[40:43], v[128:131]
    v_mfma_f32_16x16x32_bf16 v[152:155], v[104:107], v[48:51], v[152:155]
    s_mov_b32 s46, 2211840
    s_add_u32 m0, s36, 0
    s_nop 0
    buffer_load_dwordx4 v2, s[12:15], s46 offen lds
    ds_read_b64_tr_b16 v[104:105], v10 offset:32
    ds_read_b64_tr_b16 v[106:107], v10 offset:3104
    s_waitcnt lgkmcnt(10)
    v_mfma_f32_16x16x32_bf16 v[132:135], v[108:111], v[40:43], v[132:135]
    v_mfma_f32_16x16x32_bf16 v[156:159], v[108:111], v[48:51], v[156:159]
    s_add_u32 m0, s36, 1024
    s_nop 0
    buffer_load_dwordx4 v3, s[12:15], s46 offen lds
    ds_read_b64_tr_b16 v[108:109], v10 offset:64
    ds_read_b64_tr_b16 v[110:111], v10 offset:3136
    s_waitcnt lgkmcnt(10)
    v_mfma_f32_16x16x32_bf16 v[136:139], v[112:115], v[40:43], v[136:139]
    v_mfma_f32_16x16x32_bf16 v[160:163], v[112:115], v[48:51], v[160:163]
    s_add_u32 m0, s36, 2048
    s_nop 0
    buffer_load_dwordx4 v4, s[12:15], s46 offen lds
    ds_read_b64_tr_b16 v[112:113], v10 offset:96
    ds_read_b64_tr_b16 v[114:115], v10 offset:3168
    s_waitcnt lgkmcnt(10)
    v_mfma_f32_16x16x32_bf16 v[140:143], v[116:119], v[40:43], v[140:143]
    v_mfma_f32_16x16x32_bf16 v[164:167], v[116:119], v[48:51], v[164:167]
    ds_read_b64_tr_b16 v[116:117], v10 offset:128
    ds_read_b64_tr_b16 v[118:119], v10 offset:3200
    s_waitcnt lgkmcnt(10)
    v_mfma_f32_16x16x32_bf16 v[144:147], v[120:123], v[40:43], v[144:147]
    v_mfma_f32_16x16x32_bf16 v[168:171], v[120:123], v[48:51], v[168:171]
    ds_read_b64_tr_b16 v[120:121], v11 offset:0
    ds_read_b64_tr_b16 v[122:123], v11 offset:3072
    s_waitcnt lgkmcnt(10)
    v_mfma_f32_16x16x32_bf16 v[124:127], v[100:103], v[52:55], v[124:127]
    v_mfma_f32_16x16x32_bf16 v[148:151], v[100:103], v[60:63], v[148:151]
    s_mov_b32 s47, 65536
    buffer_load_dwordx4 v[36:39], v5, s[16:19], s47 offen offset:0
    ds_read_b64_tr_b16 v[100:101], v10 offset:6144
    ds_read_b64_tr_b16 v[102:103], v10 offset:9216
    s_waitcnt lgkmcnt(10)
    v_mfma_f32_16x16x32_bf16 v[128:131], v[104:107], v[52:55], v[128:131]
    v_mfma_f32_16x16x32_bf16 v[152:155], v[104:107], v[60:63], v[152:155]
    buffer_load_dwordx4 v[40:43], v5, s[16:19], s47 offen offset:1024
    ds_read_b64_tr_b16 v[104:105], v10 offset:6176
    ds_read_b64_tr_b16 v[106:107], v10 offset:9248
    s_waitcnt lgkmcnt(10)
    v_mfma_f32_16x16x32_bf16 v[132:135], v[108:111], v[52:55], v[132:135]
    v_mfma_f32_16x16x32_bf16 v[156:159], v[108:111], v[60:63], v[156:159]
    buffer_load_dwordx4 v[44:47], v6, s[16:19], s47 offen offset:0
    ds_read_b64_tr_b16 v[108:109], v10 offset:6208
    ds_read_b64_tr_b16 v[110:111], v10 offset:9280
    s_waitcnt lgkmcnt(10)
    v_mfma_f32_16x16x32_bf16 v[136:139], v[112:115], v[52:55], v[136:139]
    v_mfma_f32_16x16x32_bf16 v[160:163], v[112:115], v[60:63], v[160:163]
    buffer_load_dwordx4 v[48:51], v6, s[16:19], s47 offen offset:1024
    ds_read_b64_tr_b16 v[112:113], v10 offset:6240
    ds_read_b64_tr_b16 v[114:115], v10 offset:9312
    s_waitcnt lgkmcnt(10)
    v_mfma_f32_16x16x32_bf16 v[140:143], v[116:119], v[52:55], v[140:143]
    v_mfma_f32_16x16x32_bf16 v[164:167], v[116:119], v[60:63], v[164:167]
    ds_read_b64_tr_b16 v[116:117], v10 offset:6272
    ds_read_b64_tr_b16 v[118:119], v10 offset:9344
    s_waitcnt lgkmcnt(10)
    v_mfma_f32_16x16x32_bf16 v[144:147], v[120:123], v[52:55], v[144:147]
    v_mfma_f32_16x16x32_bf16 v[168:171], v[120:123], v[60:63], v[168:171]
    ds_read_b64_tr_b16 v[120:121], v11 offset:6144
    ds_read_b64_tr_b16 v[122:123], v11 offset:9216
    s_waitcnt lgkmcnt(10)
    v_mfma_f32_16x16x32_bf16 v[124:127], v[100:103], v[56:59], v[124:127]
    v_mfma_f32_16x16x32_bf16 v[148:151], v[100:103], v[64:67], v[148:151]
    s_waitcnt vmcnt(18)
    s_barrier
    ds_read_b64_tr_b16 v[100:101], v10 offset:24576
    ds_read_b64_tr_b16 v[102:103], v10 offset:27648
    s_waitcnt lgkmcnt(10)
    v_mfma_f32_16x16x32_bf16 v[128:131], v[104:107], v[56:59], v[128:131]
    v_mfma_f32_16x16x32_bf16 v[152:155], v[104:107], v[64:67], v[152:155]
    s_mov_b32 s46, 2359296
    s_add_u32 m0, s36, 24576
    s_nop 0
    buffer_load_dwordx4 v2, s[12:15], s46 offen lds
    ds_read_b64_tr_b16 v[104:105], v10 offset:24608
    ds_read_b64_tr_b16 v[106:107], v10 offset:27680
    s_waitcnt lgkmcnt(10)
    v_mfma_f32_16x16x32_bf16 v[132:135], v[108:111], v[56:59], v[132:135]
    v_mfma_f32_16x16x32_bf16 v[156:159], v[108:111], v[64:67], v[156:159]
    s_add_u32 m0, s36, 25600
    s_nop 0
    buffer_load_dwordx4 v3, s[12:15], s46 offen lds
    ds_read_b64_tr_b16 v[108:109], v10 offset:24640
    ds_read_b64_tr_b16 v[110:111], v10 offset:27712
    s_waitcnt lgkmcnt(10)
    v_mfma_f32_16x16x32_bf16 v[136:139], v[112:115], v[56:59], v[136:139]
    v_mfma_f32_16x16x32_bf16 v[160:163], v[112:115], v[64:67], v[160:163]
    s_add_u32 m0, s36, 26624
    s_nop 0
    buffer_load_dwordx4 v4, s[12:15], s46 offen lds
    ds_read_b64_tr_b16 v[112:113], v10 offset:24672
    ds_read_b64_tr_b16 v[114:115], v10 offset:27744
    s_waitcnt lgkmcnt(10)
    v_mfma_f32_16x16x32_bf16 v[140:143], v[116:119], v[56:59], v[140:143]
    v_mfma_f32_16x16x32_bf16 v[164:167], v[116:119], v[64:67], v[164:167]
    ds_read_b64_tr_b16 v[116:117], v10 offset:24704
    ds_read_b64_tr_b16 v[118:119], v10 offset:27776
    s_waitcnt lgkmcnt(10)
    v_mfma_f32_16x16x32_bf16 v[144:147], v[120:123], v[56:59], v[144:147]
    v_mfma_f32_16x16x32_bf16 v[168:171], v[120:123], v[64:67], v[168:171]
    ds_read_b64_tr_b16 v[120:121], v11 offset:24576
    ds_read_b64_tr_b16 v[122:123], v11 offset:27648
    s_waitcnt lgkmcnt(10)
    v_mfma_f32_16x16x32_bf16 v[124:127], v[100:103], v[68:71], v[124:127]
    v_mfma_f32_16x16x32_bf16 v[148:151], v[100:103], v[76:79], v[148:151]
    s_mov_b32 s47, 69632
    buffer_load_dwordx4 v[52:55], v5, s[16:19], s47 offen offset:0
    ds_read_b64_tr_b16 v[100:101], v10 offset:30720
    ds_read_b64_tr_b16 v[102:103], v10 offset:33792
    s_waitcnt lgkmcnt(10)
    v_mfma_f32_16x16x32_bf16 v[128:131], v[104:107], v[68:71], v[128:131]
    v_mfma_f32_16x16x32_bf16 v[152:155], v[104:107], v[76:79], v[152:155]
    buffer_load_dwordx4 v[56:59], v5, s[16:19], s47 offen offset:1024
    ds_read_b64_tr_b16 v[104:105], v10 offset:30752
    ds_read_b64_tr_b16 v[106:107], v10 offset:33824
    s_waitcnt lgkmcnt(10)
    v_mfma_f32_16x16x32_bf16 v[132:135], v[108:111], v[68:71], v[132:135]
    v_mfma_f32_16x16x32_bf16 v[156:159], v[108:111], v[76:79], v[156:159]
    buffer_load_dwordx4 v[60:63], v6, s[16:19], s47 offen offset:0
    ds_read_b64_tr_b16 v[108:109], v10 offset:30784
    ds_read_b64_tr_b16 v[110:111], v10 offset:33856
    s_waitcnt lgkmcnt(10)
    v_mfma_f32_16x16x32_bf16 v[136:139], v[112:115], v[68:71], v[136:139]
    v_mfma_f32_16x16x32_bf16 v[160:163], v[112:115], v[76:79], v[160:163]
    buffer_load_dwordx4 v[64:67], v6, s[16:19], s47 offen offset:1024
    ds_read_b64_tr_b16 v[112:113], v10 offset:30816
    ds_read_b64_tr_b16 v[114:115], v10 offset:33888
    s_waitcnt lgkmcnt(10)
    v_mfma_f32_16x16x32_bf16 v[140:143], v[116:119], v[68:71], v[140:143]
    v_mfma_f32_16x16x32_bf16 v[164:167], v[116:119], v[76:79], v[164:167]
    ds_read_b64_tr_b16 v[116:117], v10 offset:30848
    ds_read_b64_tr_b16 v[118:119], v10 offset:33920
    s_waitcnt lgkmcnt(10)
    v_mfma_f32_16x16x32_bf16 v[144:147], v[120:123], v[68:71], v[144:147]
    v_mfma_f32_16x16x32_bf16 v[168:171], v[120:123], v[76:79], v[168:171]
    ds_read_b64_tr_b16 v[120:121], v11 offset:30720
    ds_read_b64_tr_b16 v[122:123], v11 offset:33792
    s_waitcnt lgkmcnt(10)
    v_mfma_f32_16x16x32_bf16 v[124:127], v[100:103], v[72:75], v[124:127]
    v_mfma_f32_16x16x32_bf16 v[148:151], v[100:103], v[80:83], v[148:151]
    s_waitcnt vmcnt(18)
    s_barrier
    ds_read_b64_tr_b16 v[100:101], v12 offset:0
    ds_read_b64_tr_b16 v[102:103], v12 offset:3072
    s_waitcnt lgkmcnt(10)
    v_mfma_f32_16x16x32_bf16 v[128:131], v[104:107], v[72:75], v[128:131]
    v_mfma_f32_16x16x32_bf16 v[152:155], v[104:107], v[80:83], v[152:155]
    s_mov_b32 s46, 2506752
    s_add_u32 m0, s36, 49152
    s_nop 0
    buffer_load_dwordx4 v2, s[12:15], s46 offen lds
    ds_read_b64_tr_b16 v[104:105], v12 offset:32
    ds_read_b64_tr_b16 v[106:107], v12 offset:3104
    s_waitcnt lgkmcnt(10)
    v_mfma_f32_16x16x32_bf16 v[132:135], v[108:111], v[72:75], v[132:135]
    v_mfma_f32_16x16x32_bf16 v[156:159], v[108:111], v[80:83], v[156:159]
    s_add_u32 m0, s36, 50176
    s_nop 0
    buffer_load_dwordx4 v3, s[12:15], s46 offen lds
    ds_read_b64_tr_b16 v[108:109], v12 offset:64
    ds_read_b64_tr_b16 v[110:111], v12 offset:3136
    s_waitcnt lgkmcnt(10)
    v_mfma_f32_16x16x32_bf16 v[136:139], v[112:115], v[72:75], v[136:139]
    v_mfma_f32_16x16x32_bf16 v[160:163], v[112:115], v[80:83], v[160:163]
    s_add_u32 m0, s36, 51200
    s_nop 0
    buffer_load_dwordx4 v4, s[12:15], s46 offen lds
    ds_read_b64_tr_b16 v[112:113], v12 offset:96
    ds_read_b64_tr_b16 v[114:115], v12 offset:3168
    s_waitcnt lgkmcnt(10)
    v_mfma_f32_16x16x32_bf16 v[140:143], v[116:119], v[72:75], v[140:143]
    v_mfma_f32_16x16x32_bf16 v[164:167], v[116:119], v[80:83], v[164:167]
    ds_read_b64_tr_b16 v[116:117], v12 offset:128
    ds_read_b64_tr_b16 v[118:119], v12 offset:3200
    s_waitcnt lgkmcnt(10)
    v_mfma_f32_16x16x32_bf16 v[144:147], v[120:123], v[72:75], v[144:147]
    v_mfma_f32_16x16x32_bf16 v[168:171], v[120:123], v[80:83], v[168:171]
    ds_read_b64_tr_b16 v[120:121], v13 offset:0
    ds_read_b64_tr_b16 v[122:123], v13 offset:3072
    s_waitcnt lgkmcnt(10)
    v_mfma_f32_16x16x32_bf16 v[124:127], v[100:103], v[84:87], v[124:127]
    v_mfma_f32_16x16x32_bf16 v[148:151], v[100:103], v[92:95], v[148:151]
    s_mov_b32 s47, 73728
    buffer_load_dwordx4 v[68:71], v5, s[16:19], s47 offen offset:0
    ds_read_b64_tr_b16 v[100:101], v12 offset:6144
    ds_read_b64_tr_b16 v[102:103], v12 offset:9216
    s_waitcnt lgkmcnt(10)
    v_mfma_f32_16x16x32_bf16 v[128:131], v[104:107], v[84:87], v[128:131]
    v_mfma_f32_16x16x32_bf16 v[152:155], v[104:107], v[92:95], v[152:155]
    buffer_load_dwordx4 v[72:75], v5, s[16:19], s47 offen offset:1024
    ds_read_b64_tr_b16 v[104:105], v12 offset:6176
    ds_read_b64_tr_b16 v[106:107], v12 offset:9248
    s_waitcnt lgkmcnt(10)
    v_mfma_f32_16x16x32_bf16 v[132:135], v[108:111], v[84:87], v[132:135]
    v_mfma_f32_16x16x32_bf16 v[156:159], v[108:111], v[92:95], v[156:159]
    buffer_load_dwordx4 v[76:79], v6, s[16:19], s47 offen offset:0
    ds_read_b64_tr_b16 v[108:109], v12 offset:6208
    ds_read_b64_tr_b16 v[110:111], v12 offset:9280
    s_waitcnt lgkmcnt(10)
    v_mfma_f32_16x16x32_bf16 v[136:139], v[112:115], v[84:87], v[136:139]
    v_mfma_f32_16x16x32_bf16 v[160:163], v[112:115], v[92:95], v[160:163]
    buffer_load_dwordx4 v[80:83], v6, s[16:19], s47 offen offset:1024
    ds_read_b64_tr_b16 v[112:113], v12 offset:6240
    ds_read_b64_tr_b16 v[114:115], v12 offset:9312
    s_waitcnt lgkmcnt(10)
    v_mfma_f32_16x16x32_bf16 v[140:143], v[116:119], v[84:87], v[140:143]
    v_mfma_f32_16x16x32_bf16 v[164:167], v[116:119], v[92:95], v[164:167]
    ds_read_b64_tr_b16 v[116:117], v12 offset:6272
    ds_read_b64_tr_b16 v[118:119], v12 offset:9344
    s_waitcnt lgkmcnt(10)
    v_mfma_f32_16x16x32_bf16 v[144:147], v[120:123], v[84:87], v[144:147]
    v_mfma_f32_16x16x32_bf16 v[168:171], v[120:123], v[92:95], v[168:171]
    ds_read_b64_tr_b16 v[120:121], v13 offset:6144
    ds_read_b64_tr_b16 v[122:123], v13 offset:9216
    s_waitcnt lgkmcnt(10)
    v_mfma_f32_16x16x32_bf16 v[124:127], v[100:103], v[88:91], v[124:127]
    v_mfma_f32_16x16x32_bf16 v[148:151], v[100:103], v[96:99], v[148:151]
    s_waitcnt vmcnt(18)
    s_barrier
    ds_read_b64_tr_b16 v[100:101], v8 offset:0
    ds_read_b64_tr_b16 v[102:103], v8 offset:3072
    s_waitcnt lgkmcnt(10)
    v_mfma_f32_16x16x32_bf16 v[128:131], v[104:107], v[88:91], v[128:131]
    v_mfma_f32_16x16x32_bf16 v[152:155], v[104:107], v[96:99], v[152:155]
    s_mov_b32 s46, 2654208
    s_add_u32 m0, s36, 73728
    s_nop 0
    buffer_load_dwordx4 v2, s[12:15], s46 offen lds
    ds_read_b64_tr_b16 v[104:105], v8 offset:32
    ds_read_b64_tr_b16 v[106:107], v8 offset:3104
    s_waitcnt lgkmcnt(10)
    v_mfma_f32_16x16x32_bf16 v[132:135], v[108:111], v[88:91], v[132:135]
    v_mfma_f32_16x16x32_bf16 v[156:159], v[108:111], v[96:99], v[156:159]
    s_add_u32 m0, s36, 74752
    s_nop 0
    buffer_load_dwordx4 v3, s[12:15], s46 offen lds
    ds_read_b64_tr_b16 v[108:109], v8 offset:64
    ds_read_b64_tr_b16 v[110:111], v8 offset:3136
    s_waitcnt lgkmcnt(10)
    v_mfma_f32_16x16x32_bf16 v[136:139], v[112:115], v[88:91], v[136:139]
    v_mfma_f32_16x16x32_bf16 v[160:163], v[112:115], v[96:99], v[160:163]
    s_add_u32 m0, s36, 75776
    s_nop 0
    buffer_load_dwordx4 v4, s[12:15], s46 offen lds
    ds_read_b64_tr_b16 v[112:113], v8 offset:96
    ds_read_b64_tr_b16 v[114:115], v8 offset:3168
    s_waitcnt lgkmcnt(10)
    v_mfma_f32_16x16x32_bf16 v[140:143], v[116:119], v[88:91], v[140:143]
    v_mfma_f32_16x16x32_bf16 v[164:167], v[116:119], v[96:99], v[164:167]
    ds_read_b64_tr_b16 v[116:117], v8 offset:128
    ds_read_b64_tr_b16 v[118:119], v8 offset:3200
    s_waitcnt lgkmcnt(10)
    v_mfma_f32_16x16x32_bf16 v[144:147], v[120:123], v[88:91], v[144:147]
    v_mfma_f32_16x16x32_bf16 v[168:171], v[120:123], v[96:99], v[168:171]
    ds_read_b64_tr_b16 v[120:121], v9 offset:0
    ds_read_b64_tr_b16 v[122:123], v9 offset:3072
    s_waitcnt lgkmcnt(10)
    v_mfma_f32_16x16x32_bf16 v[124:127], v[100:103], v[20:23], v[124:127]
    v_mfma_f32_16x16x32_bf16 v[148:151], v[100:103], v[28:31], v[148:151]
    s_mov_b32 s47, 77824
    buffer_load_dwordx4 v[84:87], v5, s[16:19], s47 offen offset:0
    ds_read_b64_tr_b16 v[100:101], v8 offset:6144
    ds_read_b64_tr_b16 v[102:103], v8 offset:9216
    s_waitcnt lgkmcnt(10)
    v_mfma_f32_16x16x32_bf16 v[128:131], v[104:107], v[20:23], v[128:131]
    v_mfma_f32_16x16x32_bf16 v[152:155], v[104:107], v[28:31], v[152:155]
    buffer_load_dwordx4 v[88:91], v5, s[16:19], s47 offen offset:1024
    ds_read_b64_tr_b16 v[104:105], v8 offset:6176
    ds_read_b64_tr_b16 v[106:107], v8 offset:9248
    s_waitcnt lgkmcnt(10)
    v_mfma_f32_16x16x32_bf16 v[132:135], v[108:111], v[20:23], v[132:135]
    v_mfma_f32_16x16x32_bf16 v[156:159], v[108:111], v[28:31], v[156:159]
    buffer_load_dwordx4 v[92:95], v6, s[16:19], s47 offen offset:0
    ds_read_b64_tr_b16 v[108:109], v8 offset:6208
    ds_read_b64_tr_b16 v[110:111], v8 offset:9280
    s_waitcnt lgkmcnt(10)
    v_mfma_f32_16x16x32_bf16 v[136:139], v[112:115], v[20:23], v[136:139]
    v_mfma_f32_16x16x32_bf16 v[160:163], v[112:115], v[28:31], v[160:163]
    buffer_load_dwordx4 v[96:99], v6, s[16:19], s47 offen offset:1024
    ds_read_b64_tr_b16 v[112:113], v8 offset:6240
    ds_read_b64_tr_b16 v[114:115], v8 offset:9312
    s_waitcnt lgkmcnt(10)
    v_mfma_f32_16x16x32_bf16 v[140:143], v[116:119], v[20:23], v[140:143]
    v_mfma_f32_16x16x32_bf16 v[164:167], v[116:119], v[28:31], v[164:167]
    ds_read_b64_tr_b16 v[116:117], v8 offset:6272
    ds_read_b64_tr_b16 v[118:119], v8 offset:9344
    s_waitcnt lgkmcnt(10)
    v_mfma_f32_16x16x32_bf16 v[144:147], v[120:123], v[20:23], v[144:147]
    v_mfma_f32_16x16x32_bf16 v[168:171], v[120:123], v[28:31], v[168:171]
    ds_read_b64_tr_b16 v[120:121], v9 offset:6144
    ds_read_b64_tr_b16 v[122:123], v9 offset:9216
    s_waitcnt lgkmcnt(10)
    v_mfma_f32_16x16x32_bf16 v[124:127], v[100:103], v[24:27], v[124:127]
    v_mfma_f32_16x16x32_bf16 v[148:151], v[100:103], v[32:35], v[148:151]
    s_waitcnt vmcnt(18)
    s_barrier
    ds_read_b64_tr_b16 v[100:101], v8 offset:24576
    ds_read_b64_tr_b16 v[102:103], v8 offset:27648
    s_waitcnt lgkmcnt(10)
    v_mfma_f32_16x16x32_bf16 v[128:131], v[104:107], v[24:27], v[128:131]
    v_mfma_f32_16x16x32_bf16 v[152:155], v[104:107], v[32:35], v[152:155]
    s_mov_b32 s46, 2801664
    s_add_u32 m0, s36, 98304
    s_nop 0
    buffer_load_dwordx4 v2, s[12:15], s46 offen lds
    ds_read_b64_tr_b16 v[104:105], v8 offset:24608
    ds_read_b64_tr_b16 v[106:107], v8 offset:27680
    s_waitcnt lgkmcnt(10)
    v_mfma_f32_16x16x32_bf16 v[132:135], v[108:111], v[24:27], v[132:135]
    v_mfma_f32_16x16x32_bf16 v[156:159], v[108:111], v[32:35], v[156:159]
    s_add_u32 m0, s36, 99328
    s_nop 0
    buffer_load_dwordx4 v3, s[12:15], s46 offen lds
    ds_read_b64_tr_b16 v[108:109], v8 offset:24640
    ds_read_b64_tr_b16 v[110:111], v8 offset:27712
    s_waitcnt lgkmcnt(10)
    v_mfma_f32_16x16x32_bf16 v[136:139], v[112:115], v[24:27], v[136:139]
    v_mfma_f32_16x16x32_bf16 v[160:163], v[112:115], v[32:35], v[160:163]
    s_add_u32 m0, s36, 100352
    s_nop 0
    buffer_load_dwordx4 v4, s[12:15], s46 offen lds
    ds_read_b64_tr_b16 v[112:113], v8 offset:24672
    ds_read_b64_tr_b16 v[114:115], v8 offset:27744
    s_waitcnt lgkmcnt(10)
    v_mfma_f32_16x16x32_bf16 v[140:143], v[116:119], v[24:27], v[140:143]
    v_mfma_f32_16x16x32_bf16 v[164:167], v[116:119], v[32:35], v[164:167]
    ds_read_b64_tr_b16 v[116:117], v8 offset:24704
    ds_read_b64_tr_b16 v[118:119], v8 offset:27776
    s_waitcnt lgkmcnt(10)
    v_mfma_f32_16x16x32_bf16 v[144:147], v[120:123], v[24:27], v[144:147]
    v_mfma_f32_16x16x32_bf16 v[168:171], v[120:123], v[32:35], v[168:171]
    ds_read_b64_tr_b16 v[120:121], v9 offset:24576
    ds_read_b64_tr_b16 v[122:123], v9 offset:27648
    s_waitcnt lgkmcnt(10)
    v_mfma_f32_16x16x32_bf16 v[124:127], v[100:103], v[36:39], v[124:127]
    v_mfma_f32_16x16x32_bf16 v[148:151], v[100:103], v[44:47], v[148:151]
    s_mov_b32 s47, 81920
    buffer_load_dwordx4 v[20:23], v5, s[16:19], s47 offen offset:0
    ds_read_b64_tr_b16 v[100:101], v8 offset:30720
    ds_read_b64_tr_b16 v[102:103], v8 offset:33792
    s_waitcnt lgkmcnt(10)
    v_mfma_f32_16x16x32_bf16 v[128:131], v[104:107], v[36:39], v[128:131]
    v_mfma_f32_16x16x32_bf16 v[152:155], v[104:107], v[44:47], v[152:155]
    buffer_load_dwordx4 v[24:27], v5, s[16:19], s47 offen offset:1024
    ds_read_b64_tr_b16 v[104:105], v8 offset:30752
    ds_read_b64_tr_b16 v[106:107], v8 offset:33824
    s_waitcnt lgkmcnt(10)
    v_mfma_f32_16x16x32_bf16 v[132:135], v[108:111], v[36:39], v[132:135]
    v_mfma_f32_16x16x32_bf16 v[156:159], v[108:111], v[44:47], v[156:159]
    buffer_load_dwordx4 v[28:31], v6, s[16:19], s47 offen offset:0
    ds_read_b64_tr_b16 v[108:109], v8 offset:30784
    ds_read_b64_tr_b16 v[110:111], v8 offset:33856
    s_waitcnt lgkmcnt(10)
    v_mfma_f32_16x16x32_bf16 v[136:139], v[112:115], v[36:39], v[136:139]
    v_mfma_f32_16x16x32_bf16 v[160:163], v[112:115], v[44:47], v[160:163]
    buffer_load_dwordx4 v[32:35], v6, s[16:19], s47 offen offset:1024
    ds_read_b64_tr_b16 v[112:113], v8 offset:30816
    ds_read_b64_tr_b16 v[114:115], v8 offset:33888
    s_waitcnt lgkmcnt(10)
    v_mfma_f32_16x16x32_bf16 v[140:143], v[116:119], v[36:39], v[140:143]
    v_mfma_f32_16x16x32_bf16 v[164:167], v[116:119], v[44:47], v[164:167]
    ds_read_b64_tr_b16 v[116:117], v8 offset:30848
    ds_read_b64_tr_b16 v[118:119], v8 offset:33920
    s_waitcnt lgkmcnt(10)
    v_mfma_f32_16x16x32_bf16 v[144:147], v[120:123], v[36:39], v[144:147]
    v_mfma_f32_16x16x32_bf16 v[168:171], v[120:123], v[44:47], v[168:171]
    ds_read_b64_tr_b16 v[120:121], v9 offset:30720
    ds_read_b64_tr_b16 v[122:123], v9 offset:33792
    s_waitcnt lgkmcnt(10)
    v_mfma_f32_16x16x32_bf16 v[124:127], v[100:103], v[40:43], v[124:127]
    v_mfma_f32_16x16x32_bf16 v[148:151], v[100:103], v[48:51], v[148:151]
    s_waitcnt vmcnt(18)
    s_barrier
    ds_read_b64_tr_b16 v[100:101], v10 offset:0
    ds_read_b64_tr_b16 v[102:103], v10 offset:3072
    s_waitcnt lgkmcnt(10)
    v_mfma_f32_16x16x32_bf16 v[128:131], v[104:107], v[40:43], v[128:131]
    v_mfma_f32_16x16x32_bf16 v[152:155], v[104:107], v[48:51], v[152:155]
    s_mov_b32 s46, 2949120
    s_add_u32 m0, s36, 0
    s_nop 0
    buffer_load_dwordx4 v2, s[12:15], s46 offen lds
    ds_read_b64_tr_b16 v[104:105], v10 offset:32
    ds_read_b64_tr_b16 v[106:107], v10 offset:3104
    s_waitcnt lgkmcnt(10)
    v_mfma_f32_16x16x32_bf16 v[132:135], v[108:111], v[40:43], v[132:135]
    v_mfma_f32_16x16x32_bf16 v[156:159], v[108:111], v[48:51], v[156:159]
    s_add_u32 m0, s36, 1024
    s_nop 0
    buffer_load_dwordx4 v3, s[12:15], s46 offen lds
    ds_read_b64_tr_b16 v[108:109], v10 offset:64
    ds_read_b64_tr_b16 v[110:111], v10 offset:3136
    s_waitcnt lgkmcnt(10)
    v_mfma_f32_16x16x32_bf16 v[136:139], v[112:115], v[40:43], v[136:139]
    v_mfma_f32_16x16x32_bf16 v[160:163], v[112:115], v[48:51], v[160:163]
    s_add_u32 m0, s36, 2048
    s_nop 0
    buffer_load_dwordx4 v4, s[12:15], s46 offen lds
    ds_read_b64_tr_b16 v[112:113], v10 offset:96
    ds_read_b64_tr_b16 v[114:115], v10 offset:3168
    s_waitcnt lgkmcnt(10)
    v_mfma_f32_16x16x32_bf16 v[140:143], v[116:119], v[40:43], v[140:143]
    v_mfma_f32_16x16x32_bf16 v[164:167], v[116:119], v[48:51], v[164:167]
    ds_read_b64_tr_b16 v[116:117], v10 offset:128
    ds_read_b64_tr_b16 v[118:119], v10 offset:3200
    s_waitcnt lgkmcnt(10)
    v_mfma_f32_16x16x32_bf16 v[144:147], v[120:123], v[40:43], v[144:147]
    v_mfma_f32_16x16x32_bf16 v[168:171], v[120:123], v[48:51], v[168:171]
    ds_read_b64_tr_b16 v[120:121], v11 offset:0
    ds_read_b64_tr_b16 v[122:123], v11 offset:3072
    s_waitcnt lgkmcnt(10)
    v_mfma_f32_16x16x32_bf16 v[124:127], v[100:103], v[52:55], v[124:127]
    v_mfma_f32_16x16x32_bf16 v[148:151], v[100:103], v[60:63], v[148:151]
    ds_read_b64_tr_b16 v[100:101], v10 offset:6144
    ds_read_b64_tr_b16 v[102:103], v10 offset:9216
    s_waitcnt lgkmcnt(10)
    v_mfma_f32_16x16x32_bf16 v[128:131], v[104:107], v[52:55], v[128:131]
    v_mfma_f32_16x16x32_bf16 v[152:155], v[104:107], v[60:63], v[152:155]
    ds_read_b64_tr_b16 v[104:105], v10 offset:6176
    ds_read_b64_tr_b16 v[106:107], v10 offset:9248
    s_waitcnt lgkmcnt(10)
    v_mfma_f32_16x16x32_bf16 v[132:135], v[108:111], v[52:55], v[132:135]
    v_mfma_f32_16x16x32_bf16 v[156:159], v[108:111], v[60:63], v[156:159]
    ds_read_b64_tr_b16 v[108:109], v10 offset:6208
    ds_read_b64_tr_b16 v[110:111], v10 offset:9280
    s_waitcnt lgkmcnt(10)
    v_mfma_f32_16x16x32_bf16 v[136:139], v[112:115], v[52:55], v[136:139]
    v_mfma_f32_16x16x32_bf16 v[160:163], v[112:115], v[60:63], v[160:163]
    ds_read_b64_tr_b16 v[112:113], v10 offset:6240
    ds_read_b64_tr_b16 v[114:115], v10 offset:9312
    s_waitcnt lgkmcnt(10)
    v_mfma_f32_16x16x32_bf16 v[140:143], v[116:119], v[52:55], v[140:143]
    v_mfma_f32_16x16x32_bf16 v[164:167], v[116:119], v[60:63], v[164:167]
    ds_read_b64_tr_b16 v[116:117], v10 offset:6272
    ds_read_b64_tr_b16 v[118:119], v10 offset:9344
    s_waitcnt lgkmcnt(10)
    v_mfma_f32_16x16x32_bf16 v[144:147], v[120:123], v[52:55], v[144:147]
    v_mfma_f32_16x16x32_bf16 v[168:171], v[120:123], v[60:63], v[168:171]
    ds_read_b64_tr_b16 v[120:121], v11 offset:6144
    ds_read_b64_tr_b16 v[122:123], v11 offset:9216
    s_waitcnt lgkmcnt(10)
    v_mfma_f32_16x16x32_bf16 v[124:127], v[100:103], v[56:59], v[124:127]
    v_mfma_f32_16x16x32_bf16 v[148:151], v[100:103], v[64:67], v[148:151]
    s_waitcnt vmcnt(14)
    s_barrier
    ds_read_b64_tr_b16 v[100:101], v10 offset:24576
    ds_read_b64_tr_b16 v[102:103], v10 offset:27648
    s_waitcnt lgkmcnt(10)
    v_mfma_f32_16x16x32_bf16 v[128:131], v[104:107], v[56:59], v[128:131]
    v_mfma_f32_16x16x32_bf16 v[152:155], v[104:107], v[64:67], v[152:155]
    ds_read_b64_tr_b16 v[104:105], v10 offset:24608
    ds_read_b64_tr_b16 v[106:107], v10 offset:27680
    s_waitcnt lgkmcnt(10)
    v_mfma_f32_16x16x32_bf16 v[132:135], v[108:111], v[56:59], v[132:135]
    v_mfma_f32_16x16x32_bf16 v[156:159], v[108:111], v[64:67], v[156:159]
    ds_read_b64_tr_b16 v[108:109], v10 offset:24640
    ds_read_b64_tr_b16 v[110:111], v10 offset:27712
    s_waitcnt lgkmcnt(10)
    v_mfma_f32_16x16x32_bf16 v[136:139], v[112:115], v[56:59], v[136:139]
    v_mfma_f32_16x16x32_bf16 v[160:163], v[112:115], v[64:67], v[160:163]
    ds_read_b64_tr_b16 v[112:113], v10 offset:24672
    ds_read_b64_tr_b16 v[114:115], v10 offset:27744
    s_waitcnt lgkmcnt(10)
    v_mfma_f32_16x16x32_bf16 v[140:143], v[116:119], v[56:59], v[140:143]
    v_mfma_f32_16x16x32_bf16 v[164:167], v[116:119], v[64:67], v[164:167]
    ds_read_b64_tr_b16 v[116:117], v10 offset:24704
    ds_read_b64_tr_b16 v[118:119], v10 offset:27776
    s_waitcnt lgkmcnt(10)
    v_mfma_f32_16x16x32_bf16 v[144:147], v[120:123], v[56:59], v[144:147]
    v_mfma_f32_16x16x32_bf16 v[168:171], v[120:123], v[64:67], v[168:171]
    ds_read_b64_tr_b16 v[120:121], v11 offset:24576
    ds_read_b64_tr_b16 v[122:123], v11 offset:27648
    s_waitcnt lgkmcnt(10)
    v_mfma_f32_16x16x32_bf16 v[124:127], v[100:103], v[68:71], v[124:127]
    v_mfma_f32_16x16x32_bf16 v[148:151], v[100:103], v[76:79], v[148:151]
    v_mov_b32 v17, s48
    buffer_load_dword v244, v17, s[80:83], 0 offen sc1
    ds_read_b64_tr_b16 v[100:101], v10 offset:30720
    ds_read_b64_tr_b16 v[102:103], v10 offset:33792
    s_waitcnt lgkmcnt(10)
    v_mfma_f32_16x16x32_bf16 v[128:131], v[104:107], v[68:71], v[128:131]
    v_mfma_f32_16x16x32_bf16 v[152:155], v[104:107], v[76:79], v[152:155]
    s_lshl_b32 s43, s31, 7
    s_add_u32 s43, s43, 12288
    v_mov_b32 v235, s43
    buffer_load_dword v245, v235, s[80:83], 0 offen sc1
    v_lshrrev_b32 v17, 4, v1
    v_lshlrev_b32 v17, 12, v17
    v_and_b32 v18, 15, v1
    v_lshlrev_b32 v18, 4, v18
    v_add_u32 v234, v17, v18
    s_mul_i32 s96, s31, 96
    s_mul_i32 s35, s40, 12
    s_add_u32 s96, s96, s35
    s_lshl_b32 s96, s96, 12
    s_lshl_b32 s35, s32, 8
    s_add_u32 s96, s96, s35
    s_add_u32 s97, s96, 16384
    s_add_u32 s98, s96, 32768
    ds_read_b64_tr_b16 v[104:105], v10 offset:30752
    ds_read_b64_tr_b16 v[106:107], v10 offset:33824
    s_waitcnt lgkmcnt(10)
    v_mfma_f32_16x16x32_bf16 v[132:135], v[108:111], v[68:71], v[132:135]
    v_mfma_f32_16x16x32_bf16 v[156:159], v[108:111], v[76:79], v[156:159]
    ds_read_b64_tr_b16 v[108:109], v10 offset:30784
    ds_read_b64_tr_b16 v[110:111], v10 offset:33856
    s_waitcnt lgkmcnt(10)
    v_mfma_f32_16x16x32_bf16 v[136:139], v[112:115], v[68:71], v[136:139]
    v_mfma_f32_16x16x32_bf16 v[160:163], v[112:115], v[76:79], v[160:163]
    ds_read_b64_tr_b16 v[112:113], v10 offset:30816
    ds_read_b64_tr_b16 v[114:115], v10 offset:33888
    s_waitcnt lgkmcnt(10)
    v_mfma_f32_16x16x32_bf16 v[140:143], v[116:119], v[68:71], v[140:143]
    v_mfma_f32_16x16x32_bf16 v[164:167], v[116:119], v[76:79], v[164:167]
    ds_read_b64_tr_b16 v[116:117], v10 offset:30848
    ds_read_b64_tr_b16 v[118:119], v10 offset:33920
    s_waitcnt lgkmcnt(10)
    v_mfma_f32_16x16x32_bf16 v[144:147], v[120:123], v[68:71], v[144:147]
    v_mfma_f32_16x16x32_bf16 v[168:171], v[120:123], v[76:79], v[168:171]
    ds_read_b64_tr_b16 v[120:121], v11 offset:30720
    ds_read_b64_tr_b16 v[122:123], v11 offset:33792
    s_waitcnt lgkmcnt(10)
    v_mfma_f32_16x16x32_bf16 v[124:127], v[100:103], v[72:75], v[124:127]
    v_mfma_f32_16x16x32_bf16 v[148:151], v[100:103], v[80:83], v[148:151]
    s_waitcnt vmcnt(9)
    s_barrier
    ds_read_b64_tr_b16 v[100:101], v12 offset:0
    ds_read_b64_tr_b16 v[102:103], v12 offset:3072
    s_waitcnt lgkmcnt(10)
    v_mfma_f32_16x16x32_bf16 v[128:131], v[104:107], v[72:75], v[128:131]
    v_mfma_f32_16x16x32_bf16 v[152:155], v[104:107], v[80:83], v[152:155]
    ds_read_b64_tr_b16 v[104:105], v12 offset:32
    ds_read_b64_tr_b16 v[106:107], v12 offset:3104
    s_waitcnt lgkmcnt(10)
    v_mfma_f32_16x16x32_bf16 v[132:135], v[108:111], v[72:75], v[132:135]
    v_mfma_f32_16x16x32_bf16 v[156:159], v[108:111], v[80:83], v[156:159]
    ds_read_b64_tr_b16 v[108:109], v12 offset:64
    ds_read_b64_tr_b16 v[110:111], v12 offset:3136
    s_waitcnt lgkmcnt(10)
    v_mfma_f32_16x16x32_bf16 v[136:139], v[112:115], v[72:75], v[136:139]
    v_mfma_f32_16x16x32_bf16 v[160:163], v[112:115], v[80:83], v[160:163]
    ds_read_b64_tr_b16 v[112:113], v12 offset:96
    ds_read_b64_tr_b16 v[114:115], v12 offset:3168
    s_waitcnt lgkmcnt(10)
    v_mfma_f32_16x16x32_bf16 v[140:143], v[116:119], v[72:75], v[140:143]
    v_mfma_f32_16x16x32_bf16 v[164:167], v[116:119], v[80:83], v[164:167]
    ds_read_b64_tr_b16 v[116:117], v12 offset:128
    ds_read_b64_tr_b16 v[118:119], v12 offset:3200
    s_waitcnt lgkmcnt(10)
    v_mfma_f32_16x16x32_bf16 v[144:147], v[120:123], v[72:75], v[144:147]
    v_mfma_f32_16x16x32_bf16 v[168:171], v[120:123], v[80:83], v[168:171]
    ds_read_b64_tr_b16 v[120:121], v13 offset:0
    ds_read_b64_tr_b16 v[122:123], v13 offset:3072
    s_waitcnt lgkmcnt(10)
    v_mfma_f32_16x16x32_bf16 v[124:127], v[100:103], v[84:87], v[124:127]
    v_mfma_f32_16x16x32_bf16 v[148:151], v[100:103], v[92:95], v[148:151]
    s_waitcnt vmcnt(1)
    v_readfirstlane_b32 s43, v244
    v_mov_b32 v17, s48
    s_nop 2
    s_and_b32 s43, s43, s49
    s_cbranch_scc1 L_g2_go2
L_g2_poll2:
    s_sleep 8
    buffer_load_dword v18, v17, s[80:83], 0 offen sc1
    s_waitcnt vmcnt(0)
    v_readfirstlane_b32 s43, v18
    s_nop 3
    s_and_b32 s43, s43, s49
    s_cbranch_scc0 L_g2_poll2
L_g2_go2:
    buffer_load_dwordx4 v[196:199], v15, s[84:87], 0 offen offset:0 sc1
    buffer_load_dwordx4 v[200:203], v15, s[84:87], 0 offen offset:1024 sc1
    buffer_load_dwordx4 v[204:207], v15, s[84:87], 0 offen offset:2048 sc1
    buffer_load_dwordx4 v[208:211], v15, s[84:87], 0 offen offset:3072 sc1
    buffer_load_dwordx4 v[212:215], v15, s[84:87], s88 offen offset:0 sc1
    buffer_load_dwordx4 v[216:219], v15, s[84:87], s88 offen offset:1024 sc1
    ds_read_b64_tr_b16 v[100:101], v12 offset:6144
    ds_read_b64_tr_b16 v[102:103], v12 offset:9216
    s_waitcnt lgkmcnt(10)
    v_mfma_f32_16x16x32_bf16 v[128:131], v[104:107], v[84:87], v[128:131]
    v_mfma_f32_16x16x32_bf16 v[152:155], v[104:107], v[92:95], v[152:155]
    ds_read_b64_tr_b16 v[104:105], v12 offset:6176
    ds_read_b64_tr_b16 v[106:107], v12 offset:9248
    s_waitcnt lgkmcnt(10)
    v_mfma_f32_16x16x32_bf16 v[132:135], v[108:111], v[84:87], v[132:135]
    v_mfma_f32_16x16x32_bf16 v[156:159], v[108:111], v[92:95], v[156:159]
    ds_read_b64_tr_b16 v[108:109], v12 offset:6208
    ds_read_b64_tr_b16 v[110:111], v12 offset:9280
    s_waitcnt lgkmcnt(10)
    v_mfma_f32_16x16x32_bf16 v[136:139], v[112:115], v[84:87], v[136:139]
    v_mfma_f32_16x16x32_bf16 v[160:163], v[112:115], v[92:95], v[160:163]
    ds_read_b64_tr_b16 v[112:113], v12 offset:6240
    ds_read_b64_tr_b16 v[114:115], v12 offset:9312
    s_waitcnt lgkmcnt(10)
    v_mfma_f32_16x16x32_bf16 v[140:143], v[116:119], v[84:87], v[140:143]
    v_mfma_f32_16x16x32_bf16 v[164:167], v[116:119], v[92:95], v[164:167]
    ds_read_b64_tr_b16 v[116:117], v12 offset:6272
    ds_read_b64_tr_b16 v[118:119], v12 offset:9344
    s_waitcnt lgkmcnt(10)
    v_mfma_f32_16x16x32_bf16 v[144:147], v[120:123], v[84:87], v[144:147]
    v_mfma_f32_16x16x32_bf16 v[168:171], v[120:123], v[92:95], v[168:171]
    ds_read_b64_tr_b16 v[120:121], v13 offset:6144
    ds_read_b64_tr_b16 v[122:123], v13 offset:9216
    s_waitcnt lgkmcnt(10)
    v_mfma_f32_16x16x32_bf16 v[124:127], v[100:103], v[88:91], v[124:127]
    v_mfma_f32_16x16x32_bf16 v[148:151], v[100:103], v[96:99], v[148:151]
    s_barrier
    ds_read_b64_tr_b16 v[100:101], v8 offset:0
    ds_read_b64_tr_b16 v[102:103], v8 offset:3072
    s_waitcnt lgkmcnt(10)
    v_mfma_f32_16x16x32_bf16 v[128:131], v[104:107], v[88:91], v[128:131]
    v_mfma_f32_16x16x32_bf16 v[152:155], v[104:107], v[96:99], v[152:155]
    ds_read_b64_tr_b16 v[104:105], v8 offset:32
    ds_read_b64_tr_b16 v[106:107], v8 offset:3104
    s_waitcnt lgkmcnt(10)
    v_mfma_f32_16x16x32_bf16 v[132:135], v[108:111], v[88:91], v[132:135]
    v_mfma_f32_16x16x32_bf16 v[156:159], v[108:111], v[96:99], v[156:159]
    ds_read_b64_tr_b16 v[108:109], v8 offset:64
    ds_read_b64_tr_b16 v[110:111], v8 offset:3136
    s_waitcnt lgkmcnt(10)
    v_mfma_f32_16x16x32_bf16 v[136:139], v[112:115], v[88:91], v[136:139]
    v_mfma_f32_16x16x32_bf16 v[160:163], v[112:115], v[96:99], v[160:163]
    ds_read_b64_tr_b16 v[112:113], v8 offset:96
    ds_read_b64_tr_b16 v[114:115], v8 offset:3168
    s_waitcnt lgkmcnt(10)
    v_mfma_f32_16x16x32_bf16 v[140:143], v[116:119], v[88:91], v[140:143]
    v_mfma_f32_16x16x32_bf16 v[164:167], v[116:119], v[96:99], v[164:167]
    ds_read_b64_tr_b16 v[116:117], v8 offset:128
    ds_read_b64_tr_b16 v[118:119], v8 offset:3200
    s_waitcnt lgkmcnt(10)
    v_mfma_f32_16x16x32_bf16 v[144:147], v[120:123], v[88:91], v[144:147]
    v_mfma_f32_16x16x32_bf16 v[168:171], v[120:123], v[96:99], v[168:171]
    ds_read_b64_tr_b16 v[120:121], v9 offset:0
    ds_read_b64_tr_b16 v[122:123], v9 offset:3072
    s_waitcnt lgkmcnt(10)
    v_mfma_f32_16x16x32_bf16 v[124:127], v[100:103], v[20:23], v[124:127]
    v_mfma_f32_16x16x32_bf16 v[148:151], v[100:103], v[28:31], v[148:151]
    ds_read_b64_tr_b16 v[100:101], v8 offset:6144
    ds_read_b64_tr_b16 v[102:103], v8 offset:9216
    s_waitcnt lgkmcnt(10)
    v_mfma_f32_16x16x32_bf16 v[128:131], v[104:107], v[20:23], v[128:131]
    v_mfma_f32_16x16x32_bf16 v[152:155], v[104:107], v[28:31], v[152:155]
    s_waitcnt vmcnt(6)
    v_readfirstlane_b32 s89, v245
    s_nop 3
    s_cmp_lt_u32 s89, 384
    s_cbranch_scc1 L_g2_cc
    buffer_load_dwordx4 v[220:223], v234, s[20:23], s96 offen sc1
    buffer_load_dwordx4 v[224:227], v234, s[20:23], s97 offen sc1
    buffer_load_dwordx4 v[228:231], v234, s[20:23], s98 offen sc1
L_g2_cc:
    ds_read_b64_tr_b16 v[104:105], v8 offset:6176
    ds_read_b64_tr_b16 v[106:107], v8 offset:9248
    s_waitcnt lgkmcnt(10)
    v_mfma_f32_16x16x32_bf16 v[132:135], v[108:111], v[20:23], v[132:135]
    v_mfma_f32_16x16x32_bf16 v[156:159], v[108:111], v[28:31], v[156:159]
    ds_read_b64_tr_b16 v[108:109], v8 offset:6208
    ds_read_b64_tr_b16 v[110:111], v8 offset:9280
    s_waitcnt lgkmcnt(10)
    v_mfma_f32_16x16x32_bf16 v[136:139], v[112:115], v[20:23], v[136:139]
    v_mfma_f32_16x16x32_bf16 v[160:163], v[112:115], v[28:31], v[160:163]
    ds_read_b64_tr_b16 v[112:113], v8 offset:6240
    ds_read_b64_tr_b16 v[114:115], v8 offset:9312
    s_waitcnt lgkmcnt(10)
    v_mfma_f32_16x16x32_bf16 v[140:143], v[116:119], v[20:23], v[140:143]
    v_mfma_f32_16x16x32_bf16 v[164:167], v[116:119], v[28:31], v[164:167]
    ds_read_b64_tr_b16 v[116:117], v8 offset:6272
    ds_read_b64_tr_b16 v[118:119], v8 offset:9344
    s_waitcnt lgkmcnt(10)
    v_mfma_f32_16x16x32_bf16 v[144:147], v[120:123], v[20:23], v[144:147]
    v_mfma_f32_16x16x32_bf16 v[168:171], v[120:123], v[28:31], v[168:171]
    ds_read_b64_tr_b16 v[120:121], v9 offset:6144
    ds_read_b64_tr_b16 v[122:123], v9 offset:9216
    s_waitcnt lgkmcnt(10)
    v_mfma_f32_16x16x32_bf16 v[124:127], v[100:103], v[24:27], v[124:127]
    v_mfma_f32_16x16x32_bf16 v[148:151], v[100:103], v[32:35], v[148:151]
    s_waitcnt lgkmcnt(8)
    v_mfma_f32_16x16x32_bf16 v[128:131], v[104:107], v[24:27], v[128:131]
    v_mfma_f32_16x16x32_bf16 v[152:155], v[104:107], v[32:35], v[152:155]
    s_waitcnt lgkmcnt(6)
    v_mfma_f32_16x16x32_bf16 v[132:135], v[108:111], v[24:27], v[132:135]
    v_mfma_f32_16x16x32_bf16 v[156:159], v[108:111], v[32:35], v[156:159]
    s_waitcnt lgkmcnt(4)
    v_mfma_f32_16x16x32_bf16 v[136:139], v[112:115], v[24:27], v[136:139]
    v_mfma_f32_16x16x32_bf16 v[160:163], v[112:115], v[32:35], v[160:163]
    s_waitcnt lgkmcnt(2)
    v_mfma_f32_16x16x32_bf16 v[140:143], v[116:119], v[24:27], v[140:143]
    v_mfma_f32_16x16x32_bf16 v[164:167], v[116:119], v[32:35], v[164:167]
    s_waitcnt lgkmcnt(0)
    v_mfma_f32_16x16x32_bf16 v[144:147], v[120:123], v[24:27], v[144:147]
    v_mfma_f32_16x16x32_bf16 v[168:171], v[120:123], v[32:35], v[168:171]
    s_cmp_ge_u32 s89, 384
    s_cbranch_scc1 L_g2_go
L_g2_poll:
    s_sleep 24
    buffer_load_dword v18, v235, s[80:83], 0 offen sc1
    s_waitcnt vmcnt(0)
    v_readfirstlane_b32 s44, v18
    s_nop 3
    s_cmp_ge_u32 s44, 384
    s_cbranch_scc0 L_g2_poll
    buffer_load_dwordx4 v[220:223], v234, s[20:23], s96 offen sc1
    buffer_load_dwordx4 v[224:227], v234, s[20:23], s97 offen sc1
    buffer_load_dwordx4 v[228:231], v234, s[20:23], s98 offen sc1
L_g2_go:
    s_mul_i32 s35, s40, 3072
    s_add_u32 s35, s35, 122880
    v_add_u32 v19, s35, v16
    s_barrier
    s_cmp_lt_u32 s40, 4
    s_cbranch_scc1 L_g2_x1a
    s_nop 4
    ds_write_b128 v14, v[124:127] offset:0
    ds_write_b128 v14, v[128:131] offset:1024
    ds_write_b128 v14, v[132:135] offset:2048
    ds_write_b128 v14, v[136:139] offset:3072
    ds_write_b128 v14, v[140:143] offset:4096
    ds_write_b128 v14, v[144:147] offset:5120
    v_mov_b32 v20, v148
    v_mov_b32 v21, v149
    v_mov_b32 v22, v150
    v_mov_b32 v23, v151
    v_mov_b32 v24, v152
    v_mov_b32 v25, v153
    v_mov_b32 v26, v154
    v_mov_b32 v27, v155
    v_mov_b32 v28, v156
    v_mov_b32 v29, v157
    v_mov_b32 v30, v158
    v_mov_b32 v31, v159
    v_mov_b32 v32, v160
    v_mov_b32 v33, v161
    v_mov_b32 v34, v162
    v_mov_b32 v35, v163
    v_mov_b32 v36, v164
    v_mov_b32 v37, v165
    v_mov_b32 v38, v166
    v_mov_b32 v39, v167
    v_mov_b32 v40, v168
    v_mov_b32 v41, v169
    v_mov_b32 v42, v170
    v_mov_b32 v43, v171
    s_branch L_g2_x1b
L_g2_x1a:
    s_nop 4
    ds_write_b128 v14, v[148:151] offset:0
    ds_write_b128 v14, v[152:155] offset:1024
    ds_write_b128 v14, v[156:159] offset:2048
    ds_write_b128 v14, v[160:163] offset:3072
    ds_write_b128 v14, v[164:167] offset:4096
    ds_write_b128 v14, v[168:171] offset:5120
    v_mov_b32 v20, v124
    v_mov_b32 v21, v125
    v_mov_b32 v22, v126
    v_mov_b32 v23, v127
    v_mov_b32 v24, v128
    v_mov_b32 v25, v129
    v_mov_b32 v26, v130
    v_mov_b32 v27, v131
    v_mov_b32 v28, v132
    v_mov_b32 v29, v133
    v_mov_b32 v30, v134
    v_mov_b32 v31, v135
    v_mov_b32 v32, v136
    v_mov_b32 v33, v137
    v_mov_b32 v34, v138
    v_mov_b32 v35, v139
    v_mov_b32 v36, v140
    v_mov_b32 v37, v141
    v_mov_b32 v38, v142
    v_mov_b32 v39, v143
    v_mov_b32 v40, v144
    v_mov_b32 v41, v145
    v_mov_b32 v42, v146
    v_mov_b32 v43, v147
L_g2_x1b:
    v_lshrrev_b32 v16, 2, v1
    v_lshlrev_b32 v16, 8, v16
    v_and_b32 v17, 3, v1
    v_lshlrev_b32 v17, 3, v17
    s_lshl_b32 s43, s41, 6
    s_lshl_b32 s44, s42, 5
    s_add_u32 s43, s43, s44
    s_add_u32 s43, s43, 122880
    v_add3_u32 v16, v16, v17, s43
    s_waitcnt vmcnt(3)
    v_add_f32 v20, v20, v196
    v_add_f32 v21, v21, v197
    v_add_f32 v22, v22, v198
    v_add_f32 v23, v23, v199
    v_add_f32 v24, v24, v200
    v_add_f32 v25, v25, v201
    v_add_f32 v26, v26, v202
    v_add_f32 v27, v27, v203
    v_add_f32 v28, v28, v204
    v_add_f32 v29, v29, v205
    v_add_f32 v30, v30, v206
    v_add_f32 v31, v31, v207
    v_add_f32 v32, v32, v208
    v_add_f32 v33, v33, v209
    v_add_f32 v34, v34, v210
    v_add_f32 v35, v35, v211
    v_add_f32 v36, v36, v212
    v_add_f32 v37, v37, v213
    v_add_f32 v38, v38, v214
    v_add_f32 v39, v39, v215
    v_add_f32 v40, v40, v216
    v_add_f32 v41, v41, v217
    v_add_f32 v42, v42, v218
    v_add_f32 v43, v43, v219
    s_waitcnt vmcnt(0)
    ds_write_b128 v19, v[220:223] offset:0
    ds_write_b128 v19, v[224:227] offset:1024
    ds_write_b128 v19, v[228:231] offset:2048
    s_waitcnt lgkmcnt(0)
    s_barrier
    ds_read_b128 v[44:47], v7 offset:0
    ds_read_b128 v[48:51], v7 offset:1024
    ds_read_b128 v[52:55], v7 offset:2048
    ds_read_b128 v[56:59], v7 offset:3072
    ds_read_b128 v[60:63], v7 offset:4096
    ds_read_b128 v[64:67], v7 offset:5120
    ds_read_b64_tr_b16 v[68:69], v16 offset:0
    ds_read_b64_tr_b16 v[70:71], v16 offset:4096
    ds_read_b64_tr_b16 v[72:73], v16 offset:8192
    ds_read_b64_tr_b16 v[74:75], v16 offset:12288
    ds_read_b64_tr_b16 v[76:77], v16 offset:16384
    ds_read_b64_tr_b16 v[78:79], v16 offset:20480
    s_waitcnt lgkmcnt(0)
    v_add_f32 v20, v20, v44
    v_add_f32 v21, v21, v45
    v_add_f32 v22, v22, v46
    v_add_f32 v23, v23, v47
    v_lshlrev_b32 v92, 16, v174
    v_and_b32 v93, 0xffff0000, v174
    v_lshlrev_b32 v94, 16, v68
    v_and_b32 v95, 0xffff0000, v68
    v_mul_f32 v92, v92, v94
    v_mul_f32 v93, v93, v95
    v_cvt_pk_bf16_f32 v94, v92, v93
    v_lshlrev_b32 v92, 16, v94
    v_and_b32 v93, 0xffff0000, v94
    v_lshlrev_b32 v95, 16, v172
    v_and_b32 v96, 0xffff0000, v172
    v_add_f32 v92, v92, v95
    v_add_f32 v93, v93, v96
    v_cvt_pk_bf16_f32 v94, v92, v93
    v_lshlrev_b32 v92, 16, v94
    v_and_b32 v93, 0xffff0000, v94
    v_cvt_pk_bf16_f32 v94, v20, v21
    v_lshlrev_b32 v95, 16, v94
    v_and_b32 v96, 0xffff0000, v94
    v_add_f32 v92, v92, v95
    v_add_f32 v93, v93, v96
    v_cvt_pk_bf16_f32 v172, v92, v93
    v_lshlrev_b32 v92, 16, v175
    v_and_b32 v93, 0xffff0000, v175
    v_lshlrev_b32 v94, 16, v69
    v_and_b32 v95, 0xffff0000, v69
    v_mul_f32 v92, v92, v94
    v_mul_f32 v93, v93, v95
    v_cvt_pk_bf16_f32 v94, v92, v93
    v_lshlrev_b32 v92, 16, v94
    v_and_b32 v93, 0xffff0000, v94
    v_lshlrev_b32 v95, 16, v173
    v_and_b32 v96, 0xffff0000, v173
    v_add_f32 v92, v92, v95
    v_add_f32 v93, v93, v96
    v_cvt_pk_bf16_f32 v94, v92, v93
    v_lshlrev_b32 v92, 16, v94
    v_and_b32 v93, 0xffff0000, v94
    v_cvt_pk_bf16_f32 v94, v22, v23
    v_lshlrev_b32 v95, 16, v94
    v_and_b32 v96, 0xffff0000, v94
    v_add_f32 v92, v92, v95
    v_add_f32 v93, v93, v96
    v_cvt_pk_bf16_f32 v173, v92, v93
    buffer_store_dwordx2 v[172:173], v232, s[76:79], 0 offen offset:0
    v_add_f32 v24, v24, v48
    v_add_f32 v25, v25, v49
    v_add_f32 v26, v26, v50
    v_add_f32 v27, v27, v51
    v_lshlrev_b32 v98, 16, v178
    v_and_b32 v99, 0xffff0000, v178
    v_lshlrev_b32 v100, 16, v70
    v_and_b32 v101, 0xffff0000, v70
    v_mul_f32 v98, v98, v100
    v_mul_f32 v99, v99, v101
    v_cvt_pk_bf16_f32 v100, v98, v99
    v_lshlrev_b32 v98, 16, v100
    v_and_b32 v99, 0xffff0000, v100
    v_lshlrev_b32 v101, 16, v176
    v_and_b32 v102, 0xffff0000, v176
    v_add_f32 v98, v98, v101
    v_add_f32 v99, v99, v102
    v_cvt_pk_bf16_f32 v100, v98, v99
    v_lshlrev_b32 v98, 16, v100
    v_and_b32 v99, 0xffff0000, v100
    v_cvt_pk_bf16_f32 v100, v24, v25
    v_lshlrev_b32 v101, 16, v100
    v_and_b32 v102, 0xffff0000, v100
    v_add_f32 v98, v98, v101
    v_add_f32 v99, v99, v102
    v_cvt_pk_bf16_f32 v176, v98, v99
    v_lshlrev_b32 v98, 16, v179
    v_and_b32 v99, 0xffff0000, v179
    v_lshlrev_b32 v100, 16, v71
    v_and_b32 v101, 0xffff0000, v71
    v_mul_f32 v98, v98, v100
    v_mul_f32 v99, v99, v101
    v_cvt_pk_bf16_f32 v100, v98, v99
    v_lshlrev_b32 v98, 16, v100
    v_and_b32 v99, 0xffff0000, v100
    v_lshlrev_b32 v101, 16, v177
    v_and_b32 v102, 0xffff0000, v177
    v_add_f32 v98, v98, v101
    v_add_f32 v99, v99, v102
    v_cvt_pk_bf16_f32 v100, v98, v99
    v_lshlrev_b32 v98, 16, v100
    v_and_b32 v99, 0xffff0000, v100
    v_cvt_pk_bf16_f32 v100, v26, v27
    v_lshlrev_b32 v101, 16, v100
    v_and_b32 v102, 0xffff0000, v100
    v_add_f32 v98, v98, v101
    v_add_f32 v99, v99, v102
    v_cvt_pk_bf16_f32 v177, v98, v99
    buffer_store_dwordx2 v[176:177], v232, s[76:79], 0 offen offset:32
    v_add_f32 v28, v28, v52
    v_add_f32 v29, v29, v53
    v_add_f32 v30, v30, v54
    v_add_f32 v31, v31, v55
    v_lshlrev_b32 v92, 16, v182
    v_and_b32 v93, 0xffff0000, v182
    v_lshlrev_b32 v94, 16, v72
    v_and_b32 v95, 0xffff0000, v72
    v_mul_f32 v92, v92, v94
    v_mul_f32 v93, v93, v95
    v_cvt_pk_bf16_f32 v94, v92, v93
    v_lshlrev_b32 v92, 16, v94
    v_and_b32 v93, 0xffff0000, v94
    v_lshlrev_b32 v95, 16, v180
    v_and_b32 v96, 0xffff0000, v180
    v_add_f32 v92, v92, v95
    v_add_f32 v93, v93, v96
    v_cvt_pk_bf16_f32 v94, v92, v93
    v_lshlrev_b32 v92, 16, v94
    v_and_b32 v93, 0xffff0000, v94
    v_cvt_pk_bf16_f32 v94, v28, v29
    v_lshlrev_b32 v95, 16, v94
    v_and_b32 v96, 0xffff0000, v94
    v_add_f32 v92, v92, v95
    v_add_f32 v93, v93, v96
    v_cvt_pk_bf16_f32 v180, v92, v93
    v_lshlrev_b32 v92, 16, v183
    v_and_b32 v93, 0xffff0000, v183
    v_lshlrev_b32 v94, 16, v73
    v_and_b32 v95, 0xffff0000, v73
    v_mul_f32 v92, v92, v94
    v_mul_f32 v93, v93, v95
    v_cvt_pk_bf16_f32 v94, v92, v93
    v_lshlrev_b32 v92, 16, v94
    v_and_b32 v93, 0xffff0000, v94
    v_lshlrev_b32 v95, 16, v181
    v_and_b32 v96, 0xffff0000, v181
    v_add_f32 v92, v92, v95
    v_add_f32 v93, v93, v96
    v_cvt_pk_bf16_f32 v94, v92, v93
    v_lshlrev_b32 v92, 16, v94
    v_and_b32 v93, 0xffff0000, v94
    v_cvt_pk_bf16_f32 v94, v30, v31
    v_lshlrev_b32 v95, 16, v94
    v_and_b32 v96, 0xffff0000, v94
    v_add_f32 v92, v92, v95
    v_add_f32 v93, v93, v96
    v_cvt_pk_bf16_f32 v181, v92, v93
    buffer_store_dwordx2 v[180:181], v232, s[76:79], 0 offen offset:64
    v_add_f32 v32, v32, v56
    v_add_f32 v33, v33, v57
    v_add_f32 v34, v34, v58
    v_add_f32 v35, v35, v59
    v_lshlrev_b32 v98, 16, v186
    v_and_b32 v99, 0xffff0000, v186
    v_lshlrev_b32 v100, 16, v74
    v_and_b32 v101, 0xffff0000, v74
    v_mul_f32 v98, v98, v100
    v_mul_f32 v99, v99, v101
    v_cvt_pk_bf16_f32 v100, v98, v99
    v_lshlrev_b32 v98, 16, v100
    v_and_b32 v99, 0xffff0000, v100
    v_lshlrev_b32 v101, 16, v184
    v_and_b32 v102, 0xffff0000, v184
    v_add_f32 v98, v98, v101
    v_add_f32 v99, v99, v102
    v_cvt_pk_bf16_f32 v100, v98, v99
    v_lshlrev_b32 v98, 16, v100
    v_and_b32 v99, 0xffff0000, v100
    v_cvt_pk_bf16_f32 v100, v32, v33
    v_lshlrev_b32 v101, 16, v100
    v_and_b32 v102, 0xffff0000, v100
    v_add_f32 v98, v98, v101
    v_add_f32 v99, v99, v102
    v_cvt_pk_bf16_f32 v184, v98, v99
    v_lshlrev_b32 v98, 16, v187
    v_and_b32 v99, 0xffff0000, v187
    v_lshlrev_b32 v100, 16, v75
    v_and_b32 v101, 0xffff0000, v75
    v_mul_f32 v98, v98, v100
    v_mul_f32 v99, v99, v101
    v_cvt_pk_bf16_f32 v100, v98, v99
    v_lshlrev_b32 v98, 16, v100
    v_and_b32 v99, 0xffff0000, v100
    v_lshlrev_b32 v101, 16, v185
    v_and_b32 v102, 0xffff0000, v185
    v_add_f32 v98, v98, v101
    v_add_f32 v99, v99, v102
    v_cvt_pk_bf16_f32 v100, v98, v99
    v_lshlrev_b32 v98, 16, v100
    v_and_b32 v99, 0xffff0000, v100
    v_cvt_pk_bf16_f32 v100, v34, v35
    v_lshlrev_b32 v101, 16, v100
    v_and_b32 v102, 0xffff0000, v100
    v_add_f32 v98, v98, v101
    v_add_f32 v99, v99, v102
    v_cvt_pk_bf16_f32 v185, v98, v99
    buffer_store_dwordx2 v[184:185], v232, s[76:79], 0 offen offset:96
    v_add_f32 v36, v36, v60
    v_add_f32 v37, v37, v61
    v_add_f32 v38, v38, v62
    v_add_f32 v39, v39, v63
    v_lshlrev_b32 v92, 16, v190
    v_and_b32 v93, 0xffff0000, v190
    v_lshlrev_b32 v94, 16, v76
    v_and_b32 v95, 0xffff0000, v76
    v_mul_f32 v92, v92, v94
    v_mul_f32 v93, v93, v95
    v_cvt_pk_bf16_f32 v94, v92, v93
    v_lshlrev_b32 v92, 16, v94
    v_and_b32 v93, 0xffff0000, v94
    v_lshlrev_b32 v95, 16, v188
    v_and_b32 v96, 0xffff0000, v188
    v_add_f32 v92, v92, v95
    v_add_f32 v93, v93, v96
    v_cvt_pk_bf16_f32 v94, v92, v93
    v_lshlrev_b32 v92, 16, v94
    v_and_b32 v93, 0xffff0000, v94
    v_cvt_pk_bf16_f32 v94, v36, v37
    v_lshlrev_b32 v95, 16, v94
    v_and_b32 v96, 0xffff0000, v94
    v_add_f32 v92, v92, v95
    v_add_f32 v93, v93, v96
    v_cvt_pk_bf16_f32 v188, v92, v93
    v_lshlrev_b32 v92, 16, v191
    v_and_b32 v93, 0xffff0000, v191
    v_lshlrev_b32 v94, 16, v77
    v_and_b32 v95, 0xffff0000, v77
    v_mul_f32 v92, v92, v94
    v_mul_f32 v93, v93, v95
    v_cvt_pk_bf16_f32 v94, v92, v93
    v_lshlrev_b32 v92, 16, v94
    v_and_b32 v93, 0xffff0000, v94
    v_lshlrev_b32 v95, 16, v189
    v_and_b32 v96, 0xffff0000, v189
    v_add_f32 v92, v92, v95
    v_add_f32 v93, v93, v96
    v_cvt_pk_bf16_f32 v94, v92, v93
    v_lshlrev_b32 v92, 16, v94
    v_and_b32 v93, 0xffff0000, v94
    v_cvt_pk_bf16_f32 v94, v38, v39
    v_lshlrev_b32 v95, 16, v94
    v_and_b32 v96, 0xffff0000, v94
    v_add_f32 v92, v92, v95
    v_add_f32 v93, v93, v96
    v_cvt_pk_bf16_f32 v189, v92, v93
    buffer_store_dwordx2 v[188:189], v232, s[76:79], 0 offen offset:128
    v_add_f32 v40, v40, v64
    v_add_f32 v41, v41, v65
    v_add_f32 v42, v42, v66
    v_add_f32 v43, v43, v67
    v_lshlrev_b32 v98, 16, v194
    v_and_b32 v99, 0xffff0000, v194
    v_lshlrev_b32 v100, 16, v78
    v_and_b32 v101, 0xffff0000, v78
    v_mul_f32 v98, v98, v100
    v_mul_f32 v99, v99, v101
    v_cvt_pk_bf16_f32 v100, v98, v99
    v_lshlrev_b32 v98, 16, v100
    v_and_b32 v99, 0xffff0000, v100
    v_lshlrev_b32 v101, 16, v192
    v_and_b32 v102, 0xffff0000, v192
    v_add_f32 v98, v98, v101
    v_add_f32 v99, v99, v102
    v_cvt_pk_bf16_f32 v100, v98, v99
    v_lshlrev_b32 v98, 16, v100
    v_and_b32 v99, 0xffff0000, v100
    v_cvt_pk_bf16_f32 v100, v40, v41
    v_lshlrev_b32 v101, 16, v100
    v_and_b32 v102, 0xffff0000, v100
    v_add_f32 v98, v98, v101
    v_add_f32 v99, v99, v102
    v_cvt_pk_bf16_f32 v192, v98, v99
    v_lshlrev_b32 v98, 16, v195
    v_and_b32 v99, 0xffff0000, v195
    v_lshlrev_b32 v100, 16, v79
    v_and_b32 v101, 0xffff0000, v79
    v_mul_f32 v98, v98, v100
    v_mul_f32 v99, v99, v101
    v_cvt_pk_bf16_f32 v100, v98, v99
    v_lshlrev_b32 v98, 16, v100
    v_and_b32 v99, 0xffff0000, v100
    v_lshlrev_b32 v101, 16, v193
    v_and_b32 v102, 0xffff0000, v193
    v_add_f32 v98, v98, v101
    v_add_f32 v99, v99, v102
    v_cvt_pk_bf16_f32 v100, v98, v99
    v_lshlrev_b32 v98, 16, v100
    v_and_b32 v99, 0xffff0000, v100
    v_cvt_pk_bf16_f32 v100, v42, v43
    v_lshlrev_b32 v101, 16, v100
    v_and_b32 v102, 0xffff0000, v100
    v_add_f32 v98, v98, v101
    v_add_f32 v99, v99, v102
    v_cvt_pk_bf16_f32 v193, v98, v99
    buffer_store_dwordx2 v[192:193], v232, s[76:79], 0 offen offset:160
L_g2_fin:
    s_endpgm
L_g2_pf:
    s_load_dwordx2 s[44:45], s[0:1], 72
    s_load_dwordx2 s[8:9], s[0:1], 96
    s_load_dwordx4 s[4:7], s[0:1], 32
    v_and_b32 v1, 63, v0
    v_lshrrev_b32 v2, 6, v0
    s_nop 0
    v_readfirstlane_b32 s40, v2
    s_lshl_b32 s31, s40, 6
    s_add_u32 s30, s2, s31
    s_mul_i32 s31, s40, 13056
    s_lshl_b32 s32, s30, 12
    v_lshlrev_b32 v2, 4, v1
    s_waitcnt lgkmcnt(0)
    s_mov_b32 s12, s4
    s_mov_b32 s13, s5
    s_mov_b32 s14, 2359296
    s_mov_b32 s15, 0x00020000
    s_mov_b32 s16, s6
    s_mov_b32 s17, s7
    s_mov_b32 s18, 1152
    s_mov_b32 s19, 0x00020000
    s_add_u32 s20, s8, 4194304
    s_addc_u32 s21, s9, 0
    s_mov_b32 s22, 2359296
    s_mov_b32 s23, 0x00020000
    s_add_u32 s24, s8, 8388608
    s_addc_u32 s25, s9, 0
    s_mov_b32 s26, 2359296
    s_mov_b32 s27, 0x00020000
    s_add_u32 s36, s8, 58720256
    s_addc_u32 s37, s9, 0
    s_mov_b32 s38, 16384
    s_mov_b32 s39, 0x00020000
    buffer_load_dwordx4 v[48:51], v2, s[12:15], s32 offen offset:0
    buffer_load_dword v52, v2, s[12:15], s32 offen offset:16
    buffer_load_dwordx4 v[54:57], v2, s[12:15], s32 offen offset:1024
    buffer_load_dword v58, v2, s[12:15], s32 offen offset:1040
    buffer_load_dwordx4 v[60:63], v2, s[12:15], s32 offen offset:2048
    buffer_load_dword v64, v2, s[12:15], s32 offen offset:2064
    buffer_load_dwordx4 v[66:69], v2, s[12:15], s32 offen offset:3072
    buffer_load_dword v70, v2, s[12:15], s32 offen offset:3088
    s_add_u32 m0, s31, 8448
    s_add_u32 s33, s32, 0
    buffer_load_dwordx4 v2, s[20:23], s33 offen lds
    s_add_u32 m0, s31, 9472
    s_add_u32 s33, s32, 1024
    buffer_load_dwordx4 v2, s[20:23], s33 offen lds
    s_add_u32 m0, s31, 10496
    s_add_u32 s33, s32, 2048
    buffer_load_dwordx4 v2, s[20:23], s33 offen lds
    s_add_u32 m0, s31, 11520
    s_add_u32 s33, s32, 3072
    buffer_load_dwordx4 v2, s[20:23], s33 offen lds
    s_lshl_b32 s33, s30, 1
    v_mov_b32 v3, s33
    buffer_load_ushort v3, v3, s[16:19], 0 offen
    s_add_u32 s46, s2, 512
    s_lshl_b32 s47, s46, 12
    s_mov_b32 s48, 104448
    s_cmp_ge_u32 s40, 4
    s_cbranch_scc1 L_g2_pf2
    buffer_load_dwordx4 v[176:179], v2, s[12:15], s47 offen offset:0
    buffer_load_dword v180, v2, s[12:15], s47 offen offset:16
    buffer_load_dwordx4 v[182:185], v2, s[12:15], s47 offen offset:1024
    buffer_load_dword v186, v2, s[12:15], s47 offen offset:1040
    buffer_load_dwordx4 v[188:191], v2, s[12:15], s47 offen offset:2048
    buffer_load_dword v192, v2, s[12:15], s47 offen offset:2064
    buffer_load_dwordx4 v[194:197], v2, s[12:15], s47 offen offset:3072
    buffer_load_dword v198, v2, s[12:15], s47 offen offset:3088
    s_add_u32 m0, s48, 8448
    s_add_u32 s33, s47, 0
    buffer_load_dwordx4 v2, s[20:23], s33 offen lds
    s_add_u32 m0, s48, 9472
    s_add_u32 s33, s47, 1024
    buffer_load_dwordx4 v2, s[20:23], s33 offen lds
    s_add_u32 m0, s48, 10496
    s_add_u32 s33, s47, 2048
    buffer_load_dwordx4 v2, s[20:23], s33 offen lds
    s_add_u32 m0, s48, 11520
    s_add_u32 s33, s47, 3072
    buffer_load_dwordx4 v2, s[20:23], s33 offen lds
    s_lshl_b32 s33, s46, 1
    v_mov_b32 v200, s33
    buffer_load_ushort v200, v200, s[16:19], 0 offen
L_g2_pf2:
    s_barrier
    s_and_b32 s50, s2, 7
    s_and_b32 s51, s2, 56
    s_add_u32 s51, s51, s40
    s_lshr_b32 s52, s50, 2
    v_lshlrev_b32 v199, 7, v1
    s_lshl_b32 s53, s51, 13
    v_lshrrev_b32 v5, 4, v1
    v_mul_u32_u24 v5, 147456, v5
    v_and_b32 v6, 15, v1
    v_lshlrev_b32 v6, 7, v6
    v_add_u32 v181, v5, v6
    s_and_b32 s54, s50, 3
    s_lshl_b32 s54, s54, 5
    s_and_b32 s55, s51, 7
    s_lshl_b32 s55, s55, 2
    s_add_u32 s54, s54, s55
    s_mul_i32 s54, s54, 147456
    s_cmp_eq_u32 s52, 0
    s_cselect_b32 s55, 61440, 0
    s_cselect_b32 s52, 2211840, 0
    s_mov_b32 s58, 2211840
    s_cselect_b32 s58, 3096576, s58
    s_cselect_b32 s43, 42, 30
    s_add_u32 s54, s54, s55
    s_lshr_b32 s50, s51, 3
    s_lshl_b32 s55, s50, 11
    s_add_u32 s54, s54, s55
    s_add_u32 s56, s44, s52
    s_addc_u32 s57, s45, 0
    s_mov_b32 s59, 0x00020000
    s_add_u32 s60, s8, 16777216
    s_addc_u32 s61, s9, 0
    s_mov_b32 s62, 18874368
    s_mov_b32 s63, 0x00020000
    buffer_load_dword v201, v199, s[56:59], s53 offen
    s_add_u32 s53, s53, 524288
    s_cmp_ge_u32 s50, s43
    s_cselect_b32 s55, 0x7f000000, s54
    buffer_load_dword v201, v181, s[60:63], s55 offen
    s_add_u32 s54, s54, 16384
    s_add_u32 s50, s50, 8
    buffer_load_dword v201, v199, s[56:59], s53 offen
    s_add_u32 s53, s53, 524288
    s_cmp_ge_u32 s50, s43
    s_cselect_b32 s55, 0x7f000000, s54
    buffer_load_dword v201, v181, s[60:63], s55 offen
    s_add_u32 s54, s54, 16384
    s_add_u32 s50, s50, 8
    buffer_load_dword v201, v199, s[56:59], s53 offen
    s_add_u32 s53, s53, 524288
    s_cmp_ge_u32 s50, s43
    s_cselect_b32 s55, 0x7f000000, s54
    buffer_load_dword v201, v181, s[60:63], s55 offen
    s_add_u32 s54, s54, 16384
    s_add_u32 s50, s50, 8
    s_mov_b32 s49, 0
    v_and_b32 v9, 15, v1
    v_lshrrev_b32 v10, 4, v1
    v_lshlrev_b32 v12, 4, v10
    s_waitcnt vmcnt(6)
    v_add_u32 v8, s31, v2
    v_lshlrev_b32 v11, 1, v9
    v_add_u32 v11, v11, v12
    v_and_b32 v14, 1, v9
    v_cmp_eq_u32 vcc, 1, v14
    v_mov_b32 v14, 4224
    s_nop 1
    v_cndmask_b32 v14, v14, 2, vcc
    v_add_u32 v11, v11, v14
    v_add_u32 v11, s31, v11
    v_lshlrev_b32 v13, 5, v9
    v_sub_u32 v13, v12, v13
    v_add_u32 v13, 8928, v13
    v_add_u32 v13, s31, v13
    v_add_u32 v14, 960, v11
    v_add_u32 v15, 1920, v11
    v_add_u32 v202, 2880, v11
    v_add_u32 v203, 3840, v11
    v_mov_b32 v4, 0
    v_mov_b32 v5, 0
    v_mov_b32 v6, 0
    v_mov_b32 v7, 0
    s_mov_b32 exec_hi, 0
    ds_write_b128 v8, v[4:7] offset:12544
    s_mov_b32 exec_lo, 3
    ds_write_b128 v8, v[4:7]
    s_mov_b32 exec_lo, 1
    ds_write_b128 v8, v[4:7] offset:4224
    s_mov_b64 exec, -1
    v_mov_b32 v16, 0
    v_mov_b32 v17, 0
    v_mov_b32 v18, 0
    v_mov_b32 v19, 0
    v_mov_b32 v20, 0
    v_mov_b32 v21, 0
    v_mov_b32 v22, 0
    v_mov_b32 v23, 0
    v_mov_b32 v24, 0
    v_mov_b32 v25, 0
    v_mov_b32 v26, 0
    v_mov_b32 v27, 0
    v_mov_b32 v28, 0
    v_mov_b32 v29, 0
    v_mov_b32 v30, 0
    v_mov_b32 v31, 0
    v_mov_b32 v32, 0
    v_mov_b32 v33, 0
    v_mov_b32 v34, 0
    v_mov_b32 v35, 0
    v_mov_b32 v36, 0
    v_mov_b32 v37, 0
    v_mov_b32 v38, 0
    v_mov_b32 v39, 0
    v_mov_b32 v40, 0
    v_mov_b32 v41, 0
    v_mov_b32 v42, 0
    v_mov_b32 v43, 0
    v_mov_b32 v44, 0
    v_mov_b32 v45, 0
    v_mov_b32 v46, 0
    v_mov_b32 v47, 0
    ds_write_b128 v8, v[48:51] offset:32
    v_alignbit_b32 v112, v49, v48, 16
    v_alignbit_b32 v113, v50, v49, 16
    v_alignbit_b32 v114, v51, v50, 16
    v_alignbit_b32 v115, v52, v51, 16
    ds_write_b128 v8, v[112:115] offset:4256
    v_lshlrev_b32 v7, 16, v48
    s_mov_b64 exec, 1
    ds_write_b128 v8, v[4:7] offset:4240
    s_mov_b64 exec, -1
    ds_write_b128 v8, v[54:57] offset:1056
    v_alignbit_b32 v116, v55, v54, 16
    v_alignbit_b32 v117, v56, v55, 16
    v_alignbit_b32 v118, v57, v56, 16
    v_alignbit_b32 v119, v58, v57, 16
    ds_write_b128 v8, v[116:119] offset:5280
    ds_write_b128 v8, v[60:63] offset:2080
    v_alignbit_b32 v112, v61, v60, 16
    v_alignbit_b32 v113, v62, v61, 16
    v_alignbit_b32 v114, v63, v62, 16
    v_alignbit_b32 v115, v64, v63, 16
    ds_write_b128 v8, v[112:115] offset:6304
    ds_write_b128 v8, v[66:69] offset:3104
    v_alignbit_b32 v116, v67, v66, 16
    v_alignbit_b32 v117, v68, v67, 16
    v_alignbit_b32 v118, v69, v68, 16
    v_alignbit_b32 v119, v70, v69, 16
    ds_write_b128 v8, v[116:119] offset:7328
    s_waitcnt lgkmcnt(0)
    ds_read2_b32 v[48:49], v11 offset0:0 offset1:1
    ds_read2_b32 v[50:51], v11 offset0:2 offset1:3
    ds_read_b128 v[80:83], v13 offset:3584
    ds_read2_b32 v[52:53], v11 offset0:128 offset1:129
    ds_read2_b32 v[54:55], v11 offset0:130 offset1:131
    ds_read_b128 v[84:87], v13 offset:3072
    ds_read2_b32 v[56:57], v14 offset0:16 offset1:17
    ds_read2_b32 v[58:59], v14 offset0:18 offset1:19
    ds_read_b128 v[88:91], v13 offset:2560
    ds_read2_b32 v[60:61], v14 offset0:144 offset1:145
    ds_read2_b32 v[62:63], v14 offset0:146 offset1:147
    ds_read_b128 v[92:95], v13 offset:2048
    ds_read2_b32 v[64:65], v15 offset0:32 offset1:33
    ds_read2_b32 v[66:67], v15 offset0:34 offset1:35
    ds_read_b128 v[96:99], v13 offset:1536
    ds_read2_b32 v[68:69], v15 offset0:160 offset1:161
    ds_read2_b32 v[70:71], v15 offset0:162 offset1:163
    ds_read_b128 v[100:103], v13 offset:1024
    ds_read2_b32 v[72:73], v202 offset0:48 offset1:49
    ds_read2_b32 v[74:75], v202 offset0:50 offset1:51
    ds_read_b128 v[104:107], v13 offset:512
    ds_read2_b32 v[76:77], v202 offset0:176 offset1:177
    ds_read2_b32 v[78:79], v202 offset0:178 offset1:179
    ds_read_b128 v[108:111], v13 offset:0
    s_waitcnt lgkmcnt(0)
    ds_read2_b32 v[112:113], v11 offset0:16 offset1:17
    ds_read2_b32 v[114:115], v11 offset0:18 offset1:19
    ds_read_b128 v[144:147], v13 offset:3648
    ds_read2_b32 v[116:117], v11 offset0:144 offset1:145
    ds_read2_b32 v[118:119], v11 offset0:146 offset1:147
    ds_read_b128 v[148:151], v13 offset:3136
    ds_read2_b32 v[120:121], v14 offset0:32 offset1:33
    ds_read2_b32 v[122:123], v14 offset0:34 offset1:35
    ds_read_b128 v[152:155], v13 offset:2624
    ds_read2_b32 v[124:125], v14 offset0:160 offset1:161
    ds_read2_b32 v[126:127], v14 offset0:162 offset1:163
    ds_read_b128 v[156:159], v13 offset:2112
    ds_read2_b32 v[128:129], v15 offset0:48 offset1:49
    ds_read2_b32 v[130:131], v15 offset0:50 offset1:51
    ds_read_b128 v[160:163], v13 offset:1600
    ds_read2_b32 v[132:133], v15 offset0:176 offset1:177
    ds_read2_b32 v[134:135], v15 offset0:178 offset1:179
    ds_read_b128 v[164:167], v13 offset:1088
    ds_read2_b32 v[136:137], v202 offset0:64 offset1:65
    ds_read2_b32 v[138:139], v202 offset0:66 offset1:67
    ds_read_b128 v[168:171], v13 offset:576
    ds_read2_b32 v[140:141], v202 offset0:192 offset1:193
    ds_read2_b32 v[142:143], v202 offset0:194 offset1:195
    ds_read_b128 v[172:175], v13 offset:64
    v_mfma_f32_16x16x32_bf16 v[16:19], v[48:51], v[80:83], v[16:19]
    v_mfma_f32_16x16x32_bf16 v[20:23], v[48:51], v[84:87], v[20:23]
    v_mfma_f32_16x16x32_bf16 v[20:23], v[52:55], v[80:83], v[20:23]
    v_mfma_f32_16x16x32_bf16 v[24:27], v[48:51], v[88:91], v[24:27]
    v_mfma_f32_16x16x32_bf16 v[24:27], v[52:55], v[84:87], v[24:27]
    v_mfma_f32_16x16x32_bf16 v[24:27], v[56:59], v[80:83], v[24:27]
    v_mfma_f32_16x16x32_bf16 v[28:31], v[48:51], v[92:95], v[28:31]
    v_mfma_f32_16x16x32_bf16 v[28:31], v[52:55], v[88:91], v[28:31]
    v_mfma_f32_16x16x32_bf16 v[28:31], v[56:59], v[84:87], v[28:31]
    v_mfma_f32_16x16x32_bf16 v[28:31], v[60:63], v[80:83], v[28:31]
    v_mfma_f32_16x16x32_bf16 v[32:35], v[48:51], v[96:99], v[32:35]
    v_mfma_f32_16x16x32_bf16 v[32:35], v[52:55], v[92:95], v[32:35]
    v_mfma_f32_16x16x32_bf16 v[32:35], v[56:59], v[88:91], v[32:35]
    v_mfma_f32_16x16x32_bf16 v[32:35], v[60:63], v[84:87], v[32:35]
    v_mfma_f32_16x16x32_bf16 v[32:35], v[64:67], v[80:83], v[32:35]
    v_mfma_f32_16x16x32_bf16 v[36:39], v[48:51], v[100:103], v[36:39]
    v_mfma_f32_16x16x32_bf16 v[36:39], v[52:55], v[96:99], v[36:39]
    v_mfma_f32_16x16x32_bf16 v[36:39], v[56:59], v[92:95], v[36:39]
    v_mfma_f32_16x16x32_bf16 v[36:39], v[60:63], v[88:91], v[36:39]
    v_mfma_f32_16x16x32_bf16 v[36:39], v[64:67], v[84:87], v[36:39]
    v_mfma_f32_16x16x32_bf16 v[36:39], v[68:71], v[80:83], v[36:39]
    v_mfma_f32_16x16x32_bf16 v[40:43], v[48:51], v[104:107], v[40:43]
    v_mfma_f32_16x16x32_bf16 v[40:43], v[52:55], v[100:103], v[40:43]
    v_mfma_f32_16x16x32_bf16 v[40:43], v[56:59], v[96:99], v[40:43]
    v_mfma_f32_16x16x32_bf16 v[40:43], v[60:63], v[92:95], v[40:43]
    v_mfma_f32_16x16x32_bf16 v[40:43], v[64:67], v[88:91], v[40:43]
    v_mfma_f32_16x16x32_bf16 v[40:43], v[68:71], v[84:87], v[40:43]
    v_mfma_f32_16x16x32_bf16 v[40:43], v[72:75], v[80:83], v[40:43]
    v_mfma_f32_16x16x32_bf16 v[44:47], v[48:51], v[108:111], v[44:47]
    v_mfma_f32_16x16x32_bf16 v[44:47], v[52:55], v[104:107], v[44:47]
    v_mfma_f32_16x16x32_bf16 v[44:47], v[56:59], v[100:103], v[44:47]
    v_mfma_f32_16x16x32_bf16 v[44:47], v[60:63], v[96:99], v[44:47]
    v_mfma_f32_16x16x32_bf16 v[44:47], v[64:67], v[92:95], v[44:47]
    v_mfma_f32_16x16x32_bf16 v[44:47], v[68:71], v[88:91], v[44:47]
    v_mfma_f32_16x16x32_bf16 v[44:47], v[72:75], v[84:87], v[44:47]
    v_mfma_f32_16x16x32_bf16 v[44:47], v[76:79], v[80:83], v[44:47]
    s_waitcnt lgkmcnt(0)
    ds_read2_b32 v[48:49], v11 offset0:32 offset1:33
    ds_read2_b32 v[50:51], v11 offset0:34 offset1:35
    ds_read_b128 v[80:83], v13 offset:3712
    ds_read2_b32 v[52:53], v11 offset0:160 offset1:161
    ds_read2_b32 v[54:55], v11 offset0:162 offset1:163
    ds_read_b128 v[84:87], v13 offset:3200
    ds_read2_b32 v[56:57], v14 offset0:48 offset1:49
    ds_read2_b32 v[58:59], v14 offset0:50 offset1:51
    ds_read_b128 v[88:91], v13 offset:2688
    ds_read2_b32 v[60:61], v14 offset0:176 offset1:177
    ds_read2_b32 v[62:63], v14 offset0:178 offset1:179
    ds_read_b128 v[92:95], v13 offset:2176
    ds_read2_b32 v[64:65], v15 offset0:64 offset1:65
    ds_read2_b32 v[66:67], v15 offset0:66 offset1:67
    ds_read_b128 v[96:99], v13 offset:1664
    ds_read2_b32 v[68:69], v15 offset0:192 offset1:193
    ds_read2_b32 v[70:71], v15 offset0:194 offset1:195
    ds_read_b128 v[100:103], v13 offset:1152
    ds_read2_b32 v[72:73], v202 offset0:80 offset1:81
    ds_read2_b32 v[74:75], v202 offset0:82 offset1:83
    ds_read_b128 v[104:107], v13 offset:640
    ds_read2_b32 v[76:77], v202 offset0:208 offset1:209
    ds_read2_b32 v[78:79], v202 offset0:210 offset1:211
    ds_read_b128 v[108:111], v13 offset:128
    v_mfma_f32_16x16x32_bf16 v[16:19], v[112:115], v[144:147], v[16:19]
    v_mfma_f32_16x16x32_bf16 v[20:23], v[112:115], v[148:151], v[20:23]
    v_mfma_f32_16x16x32_bf16 v[20:23], v[116:119], v[144:147], v[20:23]
    v_mfma_f32_16x16x32_bf16 v[24:27], v[112:115], v[152:155], v[24:27]
    v_mfma_f32_16x16x32_bf16 v[24:27], v[116:119], v[148:151], v[24:27]
    v_mfma_f32_16x16x32_bf16 v[24:27], v[120:123], v[144:147], v[24:27]
    v_mfma_f32_16x16x32_bf16 v[28:31], v[112:115], v[156:159], v[28:31]
    v_mfma_f32_16x16x32_bf16 v[28:31], v[116:119], v[152:155], v[28:31]
    v_mfma_f32_16x16x32_bf16 v[28:31], v[120:123], v[148:151], v[28:31]
    v_mfma_f32_16x16x32_bf16 v[28:31], v[124:127], v[144:147], v[28:31]
    v_mfma_f32_16x16x32_bf16 v[32:35], v[112:115], v[160:163], v[32:35]
    v_mfma_f32_16x16x32_bf16 v[32:35], v[116:119], v[156:159], v[32:35]
    v_mfma_f32_16x16x32_bf16 v[32:35], v[120:123], v[152:155], v[32:35]
    v_mfma_f32_16x16x32_bf16 v[32:35], v[124:127], v[148:151], v[32:35]
    v_mfma_f32_16x16x32_bf16 v[32:35], v[128:131], v[144:147], v[32:35]
    v_mfma_f32_16x16x32_bf16 v[36:39], v[112:115], v[164:167], v[36:39]
    v_mfma_f32_16x16x32_bf16 v[36:39], v[116:119], v[160:163], v[36:39]
    v_mfma_f32_16x16x32_bf16 v[36:39], v[120:123], v[156:159], v[36:39]
    v_mfma_f32_16x16x32_bf16 v[36:39], v[124:127], v[152:155], v[36:39]
    v_mfma_f32_16x16x32_bf16 v[36:39], v[128:131], v[148:151], v[36:39]
    v_mfma_f32_16x16x32_bf16 v[36:39], v[132:135], v[144:147], v[36:39]
    v_mfma_f32_16x16x32_bf16 v[40:43], v[112:115], v[168:171], v[40:43]
    v_mfma_f32_16x16x32_bf16 v[40:43], v[116:119], v[164:167], v[40:43]
    v_mfma_f32_16x16x32_bf16 v[40:43], v[120:123], v[160:163], v[40:43]
    v_mfma_f32_16x16x32_bf16 v[40:43], v[124:127], v[156:159], v[40:43]
    v_mfma_f32_16x16x32_bf16 v[40:43], v[128:131], v[152:155], v[40:43]
    v_mfma_f32_16x16x32_bf16 v[40:43], v[132:135], v[148:151], v[40:43]
    v_mfma_f32_16x16x32_bf16 v[40:43], v[136:139], v[144:147], v[40:43]
    v_mfma_f32_16x16x32_bf16 v[44:47], v[112:115], v[172:175], v[44:47]
    v_mfma_f32_16x16x32_bf16 v[44:47], v[116:119], v[168:171], v[44:47]
    v_mfma_f32_16x16x32_bf16 v[44:47], v[120:123], v[164:167], v[44:47]
    v_mfma_f32_16x16x32_bf16 v[44:47], v[124:127], v[160:163], v[44:47]
    v_mfma_f32_16x16x32_bf16 v[44:47], v[128:131], v[156:159], v[44:47]
    v_mfma_f32_16x16x32_bf16 v[44:47], v[132:135], v[152:155], v[44:47]
    v_mfma_f32_16x16x32_bf16 v[44:47], v[136:139], v[148:151], v[44:47]
    v_mfma_f32_16x16x32_bf16 v[44:47], v[140:143], v[144:147], v[44:47]
    s_waitcnt lgkmcnt(0)
    ds_read2_b32 v[112:113], v11 offset0:48 offset1:49
    ds_read2_b32 v[114:115], v11 offset0:50 offset1:51
    ds_read_b128 v[144:147], v13 offset:3776
    ds_read2_b32 v[116:117], v11 offset0:176 offset1:177
    ds_read2_b32 v[118:119], v11 offset0:178 offset1:179
    ds_read_b128 v[148:151], v13 offset:3264
    ds_read2_b32 v[120:121], v14 offset0:64 offset1:65
    ds_read2_b32 v[122:123], v14 offset0:66 offset1:67
    ds_read_b128 v[152:155], v13 offset:2752
    ds_read2_b32 v[124:125], v14 offset0:192 offset1:193
    ds_read2_b32 v[126:127], v14 offset0:194 offset1:195
    ds_read_b128 v[156:159], v13 offset:2240
    ds_read2_b32 v[128:129], v15 offset0:80 offset1:81
    ds_read2_b32 v[130:131], v15 offset0:82 offset1:83
    ds_read_b128 v[160:163], v13 offset:1728
    ds_read2_b32 v[132:133], v15 offset0:208 offset1:209
    ds_read2_b32 v[134:135], v15 offset0:210 offset1:211
    ds_read_b128 v[164:167], v13 offset:1216
    ds_read2_b32 v[136:137], v202 offset0:96 offset1:97
    ds_read2_b32 v[138:139], v202 offset0:98 offset1:99
    ds_read_b128 v[168:171], v13 offset:704
    ds_read2_b32 v[140:141], v202 offset0:224 offset1:225
    ds_read2_b32 v[142:143], v202 offset0:226 offset1:227
    ds_read_b128 v[172:175], v13 offset:192
    v_mfma_f32_16x16x32_bf16 v[16:19], v[48:51], v[80:83], v[16:19]
    v_mfma_f32_16x16x32_bf16 v[20:23], v[48:51], v[84:87], v[20:23]
    v_mfma_f32_16x16x32_bf16 v[20:23], v[52:55], v[80:83], v[20:23]
    v_mfma_f32_16x16x32_bf16 v[24:27], v[48:51], v[88:91], v[24:27]
    v_mfma_f32_16x16x32_bf16 v[24:27], v[52:55], v[84:87], v[24:27]
    v_mfma_f32_16x16x32_bf16 v[24:27], v[56:59], v[80:83], v[24:27]
    v_mfma_f32_16x16x32_bf16 v[28:31], v[48:51], v[92:95], v[28:31]
    v_mfma_f32_16x16x32_bf16 v[28:31], v[52:55], v[88:91], v[28:31]
    v_mfma_f32_16x16x32_bf16 v[28:31], v[56:59], v[84:87], v[28:31]
    v_mfma_f32_16x16x32_bf16 v[28:31], v[60:63], v[80:83], v[28:31]
    v_mfma_f32_16x16x32_bf16 v[32:35], v[48:51], v[96:99], v[32:35]
    v_mfma_f32_16x16x32_bf16 v[32:35], v[52:55], v[92:95], v[32:35]
    v_mfma_f32_16x16x32_bf16 v[32:35], v[56:59], v[88:91], v[32:35]
    v_mfma_f32_16x16x32_bf16 v[32:35], v[60:63], v[84:87], v[32:35]
    v_mfma_f32_16x16x32_bf16 v[32:35], v[64:67], v[80:83], v[32:35]
    v_mfma_f32_16x16x32_bf16 v[36:39], v[48:51], v[100:103], v[36:39]
    v_mfma_f32_16x16x32_bf16 v[36:39], v[52:55], v[96:99], v[36:39]
    v_mfma_f32_16x16x32_bf16 v[36:39], v[56:59], v[92:95], v[36:39]
    v_mfma_f32_16x16x32_bf16 v[36:39], v[60:63], v[88:91], v[36:39]
    v_mfma_f32_16x16x32_bf16 v[36:39], v[64:67], v[84:87], v[36:39]
    v_mfma_f32_16x16x32_bf16 v[36:39], v[68:71], v[80:83], v[36:39]
    v_mfma_f32_16x16x32_bf16 v[40:43], v[48:51], v[104:107], v[40:43]
    v_mfma_f32_16x16x32_bf16 v[40:43], v[52:55], v[100:103], v[40:43]
    v_mfma_f32_16x16x32_bf16 v[40:43], v[56:59], v[96:99], v[40:43]
    v_mfma_f32_16x16x32_bf16 v[40:43], v[60:63], v[92:95], v[40:43]
    v_mfma_f32_16x16x32_bf16 v[40:43], v[64:67], v[88:91], v[40:43]
    v_mfma_f32_16x16x32_bf16 v[40:43], v[68:71], v[84:87], v[40:43]
    v_mfma_f32_16x16x32_bf16 v[40:43], v[72:75], v[80:83], v[40:43]
    v_mfma_f32_16x16x32_bf16 v[44:47], v[48:51], v[108:111], v[44:47]
    v_mfma_f32_16x16x32_bf16 v[44:47], v[52:55], v[104:107], v[44:47]
    v_mfma_f32_16x16x32_bf16 v[44:47], v[56:59], v[100:103], v[44:47]
    v_mfma_f32_16x16x32_bf16 v[44:47], v[60:63], v[96:99], v[44:47]
    v_mfma_f32_16x16x32_bf16 v[44:47], v[64:67], v[92:95], v[44:47]
    v_mfma_f32_16x16x32_bf16 v[44:47], v[68:71], v[88:91], v[44:47]
    v_mfma_f32_16x16x32_bf16 v[44:47], v[72:75], v[84:87], v[44:47]
    v_mfma_f32_16x16x32_bf16 v[44:47], v[76:79], v[80:83], v[44:47]
    s_waitcnt lgkmcnt(0)
    ds_read2_b32 v[48:49], v11 offset0:64 offset1:65
    ds_read2_b32 v[50:51], v11 offset0:66 offset1:67
    ds_read_b128 v[80:83], v13 offset:3840
    ds_read2_b32 v[52:53], v11 offset0:192 offset1:193
    ds_read2_b32 v[54:55], v11 offset0:194 offset1:195
    ds_read_b128 v[84:87], v13 offset:3328
    ds_read2_b32 v[56:57], v14 offset0:80 offset1:81
    ds_read2_b32 v[58:59], v14 offset0:82 offset1:83
    ds_read_b128 v[88:91], v13 offset:2816
    ds_read2_b32 v[60:61], v14 offset0:208 offset1:209
    ds_read2_b32 v[62:63], v14 offset0:210 offset1:211
    ds_read_b128 v[92:95], v13 offset:2304
    ds_read2_b32 v[64:65], v15 offset0:96 offset1:97
    ds_read2_b32 v[66:67], v15 offset0:98 offset1:99
    ds_read_b128 v[96:99], v13 offset:1792
    ds_read2_b32 v[68:69], v15 offset0:224 offset1:225
    ds_read2_b32 v[70:71], v15 offset0:226 offset1:227
    ds_read_b128 v[100:103], v13 offset:1280
    ds_read2_b32 v[72:73], v202 offset0:112 offset1:113
    ds_read2_b32 v[74:75], v202 offset0:114 offset1:115
    ds_read_b128 v[104:107], v13 offset:768
    ds_read2_b32 v[76:77], v203 offset0:0 offset1:1
    ds_read2_b32 v[78:79], v203 offset0:2 offset1:3
    ds_read_b128 v[108:111], v13 offset:256
    v_mfma_f32_16x16x32_bf16 v[16:19], v[112:115], v[144:147], v[16:19]
    v_mfma_f32_16x16x32_bf16 v[20:23], v[112:115], v[148:151], v[20:23]
    v_mfma_f32_16x16x32_bf16 v[20:23], v[116:119], v[144:147], v[20:23]
    v_mfma_f32_16x16x32_bf16 v[24:27], v[112:115], v[152:155], v[24:27]
    v_mfma_f32_16x16x32_bf16 v[24:27], v[116:119], v[148:151], v[24:27]
    v_mfma_f32_16x16x32_bf16 v[24:27], v[120:123], v[144:147], v[24:27]
    v_mfma_f32_16x16x32_bf16 v[28:31], v[112:115], v[156:159], v[28:31]
    v_mfma_f32_16x16x32_bf16 v[28:31], v[116:119], v[152:155], v[28:31]
    v_mfma_f32_16x16x32_bf16 v[28:31], v[120:123], v[148:151], v[28:31]
    v_mfma_f32_16x16x32_bf16 v[28:31], v[124:127], v[144:147], v[28:31]
    v_mfma_f32_16x16x32_bf16 v[32:35], v[112:115], v[160:163], v[32:35]
    v_mfma_f32_16x16x32_bf16 v[32:35], v[116:119], v[156:159], v[32:35]
    v_mfma_f32_16x16x32_bf16 v[32:35], v[120:123], v[152:155], v[32:35]
    v_mfma_f32_16x16x32_bf16 v[32:35], v[124:127], v[148:151], v[32:35]
    v_mfma_f32_16x16x32_bf16 v[32:35], v[128:131], v[144:147], v[32:35]
    v_mfma_f32_16x16x32_bf16 v[36:39], v[112:115], v[164:167], v[36:39]
    v_mfma_f32_16x16x32_bf16 v[36:39], v[116:119], v[160:163], v[36:39]
    v_mfma_f32_16x16x32_bf16 v[36:39], v[120:123], v[156:159], v[36:39]
    v_mfma_f32_16x16x32_bf16 v[36:39], v[124:127], v[152:155], v[36:39]
    v_mfma_f32_16x16x32_bf16 v[36:39], v[128:131], v[148:151], v[36:39]
    v_mfma_f32_16x16x32_bf16 v[36:39], v[132:135], v[144:147], v[36:39]
    v_mfma_f32_16x16x32_bf16 v[40:43], v[112:115], v[168:171], v[40:43]
    v_mfma_f32_16x16x32_bf16 v[40:43], v[116:119], v[164:167], v[40:43]
    v_mfma_f32_16x16x32_bf16 v[40:43], v[120:123], v[160:163], v[40:43]
    v_mfma_f32_16x16x32_bf16 v[40:43], v[124:127], v[156:159], v[40:43]
    v_mfma_f32_16x16x32_bf16 v[40:43], v[128:131], v[152:155], v[40:43]
    v_mfma_f32_16x16x32_bf16 v[40:43], v[132:135], v[148:151], v[40:43]
    v_mfma_f32_16x16x32_bf16 v[40:43], v[136:139], v[144:147], v[40:43]
    v_mfma_f32_16x16x32_bf16 v[44:47], v[112:115], v[172:175], v[44:47]
    v_mfma_f32_16x16x32_bf16 v[44:47], v[116:119], v[168:171], v[44:47]
    v_mfma_f32_16x16x32_bf16 v[44:47], v[120:123], v[164:167], v[44:47]
    v_mfma_f32_16x16x32_bf16 v[44:47], v[124:127], v[160:163], v[44:47]
    v_mfma_f32_16x16x32_bf16 v[44:47], v[128:131], v[156:159], v[44:47]
    v_mfma_f32_16x16x32_bf16 v[44:47], v[132:135], v[152:155], v[44:47]
    v_mfma_f32_16x16x32_bf16 v[44:47], v[136:139], v[148:151], v[44:47]
    v_mfma_f32_16x16x32_bf16 v[44:47], v[140:143], v[144:147], v[44:47]
    s_waitcnt lgkmcnt(0)
    ds_read2_b32 v[112:113], v11 offset0:80 offset1:81
    ds_read2_b32 v[114:115], v11 offset0:82 offset1:83
    ds_read_b128 v[144:147], v13 offset:3904
    ds_read2_b32 v[116:117], v11 offset0:208 offset1:209
    ds_read2_b32 v[118:119], v11 offset0:210 offset1:211
    ds_read_b128 v[148:151], v13 offset:3392
    ds_read2_b32 v[120:121], v14 offset0:96 offset1:97
    ds_read2_b32 v[122:123], v14 offset0:98 offset1:99
    ds_read_b128 v[152:155], v13 offset:2880
    ds_read2_b32 v[124:125], v14 offset0:224 offset1:225
    ds_read2_b32 v[126:127], v14 offset0:226 offset1:227
    ds_read_b128 v[156:159], v13 offset:2368
    ds_read2_b32 v[128:129], v15 offset0:112 offset1:113
    ds_read2_b32 v[130:131], v15 offset0:114 offset1:115
    ds_read_b128 v[160:163], v13 offset:1856
    ds_read2_b32 v[132:133], v202 offset0:0 offset1:1
    ds_read2_b32 v[134:135], v202 offset0:2 offset1:3
    ds_read_b128 v[164:167], v13 offset:1344
    ds_read2_b32 v[136:137], v202 offset0:128 offset1:129
    ds_read2_b32 v[138:139], v202 offset0:130 offset1:131
    ds_read_b128 v[168:171], v13 offset:832
    ds_read2_b32 v[140:141], v203 offset0:16 offset1:17
    ds_read2_b32 v[142:143], v203 offset0:18 offset1:19
    ds_read_b128 v[172:175], v13 offset:320
    v_mfma_f32_16x16x32_bf16 v[16:19], v[48:51], v[80:83], v[16:19]
    v_mfma_f32_16x16x32_bf16 v[20:23], v[48:51], v[84:87], v[20:23]
    v_mfma_f32_16x16x32_bf16 v[20:23], v[52:55], v[80:83], v[20:23]
    v_mfma_f32_16x16x32_bf16 v[24:27], v[48:51], v[88:91], v[24:27]
    v_mfma_f32_16x16x32_bf16 v[24:27], v[52:55], v[84:87], v[24:27]
    v_mfma_f32_16x16x32_bf16 v[24:27], v[56:59], v[80:83], v[24:27]
    v_mfma_f32_16x16x32_bf16 v[28:31], v[48:51], v[92:95], v[28:31]
    v_mfma_f32_16x16x32_bf16 v[28:31], v[52:55], v[88:91], v[28:31]
    v_mfma_f32_16x16x32_bf16 v[28:31], v[56:59], v[84:87], v[28:31]
    v_mfma_f32_16x16x32_bf16 v[28:31], v[60:63], v[80:83], v[28:31]
    v_mfma_f32_16x16x32_bf16 v[32:35], v[48:51], v[96:99], v[32:35]
    v_mfma_f32_16x16x32_bf16 v[32:35], v[52:55], v[92:95], v[32:35]
    v_mfma_f32_16x16x32_bf16 v[32:35], v[56:59], v[88:91], v[32:35]
    v_mfma_f32_16x16x32_bf16 v[32:35], v[60:63], v[84:87], v[32:35]
    v_mfma_f32_16x16x32_bf16 v[32:35], v[64:67], v[80:83], v[32:35]
    v_mfma_f32_16x16x32_bf16 v[36:39], v[48:51], v[100:103], v[36:39]
    v_mfma_f32_16x16x32_bf16 v[36:39], v[52:55], v[96:99], v[36:39]
    v_mfma_f32_16x16x32_bf16 v[36:39], v[56:59], v[92:95], v[36:39]
    v_mfma_f32_16x16x32_bf16 v[36:39], v[60:63], v[88:91], v[36:39]
    v_mfma_f32_16x16x32_bf16 v[36:39], v[64:67], v[84:87], v[36:39]
    v_mfma_f32_16x16x32_bf16 v[36:39], v[68:71], v[80:83], v[36:39]
    v_mfma_f32_16x16x32_bf16 v[40:43], v[48:51], v[104:107], v[40:43]
    v_mfma_f32_16x16x32_bf16 v[40:43], v[52:55], v[100:103], v[40:43]
    v_mfma_f32_16x16x32_bf16 v[40:43], v[56:59], v[96:99], v[40:43]
    v_mfma_f32_16x16x32_bf16 v[40:43], v[60:63], v[92:95], v[40:43]
    v_mfma_f32_16x16x32_bf16 v[40:43], v[64:67], v[88:91], v[40:43]
    v_mfma_f32_16x16x32_bf16 v[40:43], v[68:71], v[84:87], v[40:43]
    v_mfma_f32_16x16x32_bf16 v[40:43], v[72:75], v[80:83], v[40:43]
    v_mfma_f32_16x16x32_bf16 v[44:47], v[48:51], v[108:111], v[44:47]
    v_mfma_f32_16x16x32_bf16 v[44:47], v[52:55], v[104:107], v[44:47]
    v_mfma_f32_16x16x32_bf16 v[44:47], v[56:59], v[100:103], v[44:47]
    v_mfma_f32_16x16x32_bf16 v[44:47], v[60:63], v[96:99], v[44:47]
    v_mfma_f32_16x16x32_bf16 v[44:47], v[64:67], v[92:95], v[44:47]
    v_mfma_f32_16x16x32_bf16 v[44:47], v[68:71], v[88:91], v[44:47]
    v_mfma_f32_16x16x32_bf16 v[44:47], v[72:75], v[84:87], v[44:47]
    v_mfma_f32_16x16x32_bf16 v[44:47], v[76:79], v[80:83], v[44:47]
    s_waitcnt lgkmcnt(0)
    ds_read2_b32 v[48:49], v11 offset0:96 offset1:97
    ds_read2_b32 v[50:51], v11 offset0:98 offset1:99
    ds_read_b128 v[80:83], v13 offset:3968
    ds_read2_b32 v[52:53], v11 offset0:224 offset1:225
    ds_read2_b32 v[54:55], v11 offset0:226 offset1:227
    ds_read_b128 v[84:87], v13 offset:3456
    ds_read2_b32 v[56:57], v14 offset0:112 offset1:113
    ds_read2_b32 v[58:59], v14 offset0:114 offset1:115
    ds_read_b128 v[88:91], v13 offset:2944
    ds_read2_b32 v[60:61], v15 offset0:0 offset1:1
    ds_read2_b32 v[62:63], v15 offset0:2 offset1:3
    ds_read_b128 v[92:95], v13 offset:2432
    ds_read2_b32 v[64:65], v15 offset0:128 offset1:129
    ds_read2_b32 v[66:67], v15 offset0:130 offset1:131
    ds_read_b128 v[96:99], v13 offset:1920
    ds_read2_b32 v[68:69], v202 offset0:16 offset1:17
    ds_read2_b32 v[70:71], v202 offset0:18 offset1:19
    ds_read_b128 v[100:103], v13 offset:1408
    ds_read2_b32 v[72:73], v202 offset0:144 offset1:145
    ds_read2_b32 v[74:75], v202 offset0:146 offset1:147
    ds_read_b128 v[104:107], v13 offset:896
    ds_read2_b32 v[76:77], v203 offset0:32 offset1:33
    ds_read2_b32 v[78:79], v203 offset0:34 offset1:35
    ds_read_b128 v[108:111], v13 offset:384
    v_mfma_f32_16x16x32_bf16 v[16:19], v[112:115], v[144:147], v[16:19]
    v_mfma_f32_16x16x32_bf16 v[20:23], v[112:115], v[148:151], v[20:23]
    v_mfma_f32_16x16x32_bf16 v[20:23], v[116:119], v[144:147], v[20:23]
    v_mfma_f32_16x16x32_bf16 v[24:27], v[112:115], v[152:155], v[24:27]
    v_mfma_f32_16x16x32_bf16 v[24:27], v[116:119], v[148:151], v[24:27]
    v_mfma_f32_16x16x32_bf16 v[24:27], v[120:123], v[144:147], v[24:27]
    v_mfma_f32_16x16x32_bf16 v[28:31], v[112:115], v[156:159], v[28:31]
    v_mfma_f32_16x16x32_bf16 v[28:31], v[116:119], v[152:155], v[28:31]
    v_mfma_f32_16x16x32_bf16 v[28:31], v[120:123], v[148:151], v[28:31]
    v_mfma_f32_16x16x32_bf16 v[28:31], v[124:127], v[144:147], v[28:31]
    v_mfma_f32_16x16x32_bf16 v[32:35], v[112:115], v[160:163], v[32:35]
    v_mfma_f32_16x16x32_bf16 v[32:35], v[116:119], v[156:159], v[32:35]
    v_mfma_f32_16x16x32_bf16 v[32:35], v[120:123], v[152:155], v[32:35]
    v_mfma_f32_16x16x32_bf16 v[32:35], v[124:127], v[148:151], v[32:35]
    v_mfma_f32_16x16x32_bf16 v[32:35], v[128:131], v[144:147], v[32:35]
    v_mfma_f32_16x16x32_bf16 v[36:39], v[112:115], v[164:167], v[36:39]
    v_mfma_f32_16x16x32_bf16 v[36:39], v[116:119], v[160:163], v[36:39]
    v_mfma_f32_16x16x32_bf16 v[36:39], v[120:123], v[156:159], v[36:39]
    v_mfma_f32_16x16x32_bf16 v[36:39], v[124:127], v[152:155], v[36:39]
    v_mfma_f32_16x16x32_bf16 v[36:39], v[128:131], v[148:151], v[36:39]
    v_mfma_f32_16x16x32_bf16 v[36:39], v[132:135], v[144:147], v[36:39]
    v_mfma_f32_16x16x32_bf16 v[40:43], v[112:115], v[168:171], v[40:43]
    v_mfma_f32_16x16x32_bf16 v[40:43], v[116:119], v[164:167], v[40:43]
    v_mfma_f32_16x16x32_bf16 v[40:43], v[120:123], v[160:163], v[40:43]
    v_mfma_f32_16x16x32_bf16 v[40:43], v[124:127], v[156:159], v[40:43]
    v_mfma_f32_16x16x32_bf16 v[40:43], v[128:131], v[152:155], v[40:43]
    v_mfma_f32_16x16x32_bf16 v[40:43], v[132:135], v[148:151], v[40:43]
    v_mfma_f32_16x16x32_bf16 v[40:43], v[136:139], v[144:147], v[40:43]
    v_mfma_f32_16x16x32_bf16 v[44:47], v[112:115], v[172:175], v[44:47]
    v_mfma_f32_16x16x32_bf16 v[44:47], v[116:119], v[168:171], v[44:47]
    v_mfma_f32_16x16x32_bf16 v[44:47], v[120:123], v[164:167], v[44:47]
    v_mfma_f32_16x16x32_bf16 v[44:47], v[124:127], v[160:163], v[44:47]
    v_mfma_f32_16x16x32_bf16 v[44:47], v[128:131], v[156:159], v[44:47]
    v_mfma_f32_16x16x32_bf16 v[44:47], v[132:135], v[152:155], v[44:47]
    v_mfma_f32_16x16x32_bf16 v[44:47], v[136:139], v[148:151], v[44:47]
    v_mfma_f32_16x16x32_bf16 v[44:47], v[140:143], v[144:147], v[44:47]
    s_waitcnt lgkmcnt(0)
    ds_read2_b32 v[112:113], v11 offset0:112 offset1:113
    ds_read2_b32 v[114:115], v11 offset0:114 offset1:115
    ds_read_b128 v[144:147], v13 offset:4032
    ds_read2_b32 v[116:117], v14 offset0:0 offset1:1
    ds_read2_b32 v[118:119], v14 offset0:2 offset1:3
    ds_read_b128 v[148:151], v13 offset:3520
    ds_read2_b32 v[120:121], v14 offset0:128 offset1:129
    ds_read2_b32 v[122:123], v14 offset0:130 offset1:131
    ds_read_b128 v[152:155], v13 offset:3008
    ds_read2_b32 v[124:125], v15 offset0:16 offset1:17
    ds_read2_b32 v[126:127], v15 offset0:18 offset1:19
    ds_read_b128 v[156:159], v13 offset:2496
    ds_read2_b32 v[128:129], v15 offset0:144 offset1:145
    ds_read2_b32 v[130:131], v15 offset0:146 offset1:147
    ds_read_b128 v[160:163], v13 offset:1984
    ds_read2_b32 v[132:133], v202 offset0:32 offset1:33
    ds_read2_b32 v[134:135], v202 offset0:34 offset1:35
    ds_read_b128 v[164:167], v13 offset:1472
    ds_read2_b32 v[136:137], v202 offset0:160 offset1:161
    ds_read2_b32 v[138:139], v202 offset0:162 offset1:163
    ds_read_b128 v[168:171], v13 offset:960
    ds_read2_b32 v[140:141], v203 offset0:48 offset1:49
    ds_read2_b32 v[142:143], v203 offset0:50 offset1:51
    ds_read_b128 v[172:175], v13 offset:448
    v_mfma_f32_16x16x32_bf16 v[16:19], v[48:51], v[80:83], v[16:19]
    v_mfma_f32_16x16x32_bf16 v[20:23], v[48:51], v[84:87], v[20:23]
    v_mfma_f32_16x16x32_bf16 v[20:23], v[52:55], v[80:83], v[20:23]
    v_mfma_f32_16x16x32_bf16 v[24:27], v[48:51], v[88:91], v[24:27]
    v_mfma_f32_16x16x32_bf16 v[24:27], v[52:55], v[84:87], v[24:27]
    v_mfma_f32_16x16x32_bf16 v[24:27], v[56:59], v[80:83], v[24:27]
    v_mfma_f32_16x16x32_bf16 v[28:31], v[48:51], v[92:95], v[28:31]
    v_mfma_f32_16x16x32_bf16 v[28:31], v[52:55], v[88:91], v[28:31]
    v_mfma_f32_16x16x32_bf16 v[28:31], v[56:59], v[84:87], v[28:31]
    v_mfma_f32_16x16x32_bf16 v[28:31], v[60:63], v[80:83], v[28:31]
    v_mfma_f32_16x16x32_bf16 v[32:35], v[48:51], v[96:99], v[32:35]
    v_mfma_f32_16x16x32_bf16 v[32:35], v[52:55], v[92:95], v[32:35]
    v_mfma_f32_16x16x32_bf16 v[32:35], v[56:59], v[88:91], v[32:35]
    v_mfma_f32_16x16x32_bf16 v[32:35], v[60:63], v[84:87], v[32:35]
    v_mfma_f32_16x16x32_bf16 v[32:35], v[64:67], v[80:83], v[32:35]
    v_mfma_f32_16x16x32_bf16 v[36:39], v[48:51], v[100:103], v[36:39]
    v_mfma_f32_16x16x32_bf16 v[36:39], v[52:55], v[96:99], v[36:39]
    v_mfma_f32_16x16x32_bf16 v[36:39], v[56:59], v[92:95], v[36:39]
    v_mfma_f32_16x16x32_bf16 v[36:39], v[60:63], v[88:91], v[36:39]
    v_mfma_f32_16x16x32_bf16 v[36:39], v[64:67], v[84:87], v[36:39]
    v_mfma_f32_16x16x32_bf16 v[36:39], v[68:71], v[80:83], v[36:39]
    v_mfma_f32_16x16x32_bf16 v[40:43], v[48:51], v[104:107], v[40:43]
    v_mfma_f32_16x16x32_bf16 v[40:43], v[52:55], v[100:103], v[40:43]
    v_mfma_f32_16x16x32_bf16 v[40:43], v[56:59], v[96:99], v[40:43]
    v_mfma_f32_16x16x32_bf16 v[40:43], v[60:63], v[92:95], v[40:43]
    v_mfma_f32_16x16x32_bf16 v[40:43], v[64:67], v[88:91], v[40:43]
    v_mfma_f32_16x16x32_bf16 v[40:43], v[68:71], v[84:87], v[40:43]
    v_mfma_f32_16x16x32_bf16 v[40:43], v[72:75], v[80:83], v[40:43]
    v_mfma_f32_16x16x32_bf16 v[44:47], v[48:51], v[108:111], v[44:47]
    v_mfma_f32_16x16x32_bf16 v[44:47], v[52:55], v[104:107], v[44:47]
    v_mfma_f32_16x16x32_bf16 v[44:47], v[56:59], v[100:103], v[44:47]
    v_mfma_f32_16x16x32_bf16 v[44:47], v[60:63], v[96:99], v[44:47]
    v_mfma_f32_16x16x32_bf16 v[44:47], v[64:67], v[92:95], v[44:47]
    v_mfma_f32_16x16x32_bf16 v[44:47], v[68:71], v[88:91], v[44:47]
    v_mfma_f32_16x16x32_bf16 v[44:47], v[72:75], v[84:87], v[44:47]
    v_mfma_f32_16x16x32_bf16 v[44:47], v[76:79], v[80:83], v[44:47]
    s_waitcnt lgkmcnt(0)
    v_mfma_f32_16x16x32_bf16 v[16:19], v[112:115], v[144:147], v[16:19]
    v_mfma_f32_16x16x32_bf16 v[20:23], v[112:115], v[148:151], v[20:23]
    v_mfma_f32_16x16x32_bf16 v[20:23], v[116:119], v[144:147], v[20:23]
    v_mfma_f32_16x16x32_bf16 v[24:27], v[112:115], v[152:155], v[24:27]
    v_mfma_f32_16x16x32_bf16 v[24:27], v[116:119], v[148:151], v[24:27]
    v_mfma_f32_16x16x32_bf16 v[24:27], v[120:123], v[144:147], v[24:27]
    v_mfma_f32_16x16x32_bf16 v[28:31], v[112:115], v[156:159], v[28:31]
    v_mfma_f32_16x16x32_bf16 v[28:31], v[116:119], v[152:155], v[28:31]
    v_mfma_f32_16x16x32_bf16 v[28:31], v[120:123], v[148:151], v[28:31]
    v_mfma_f32_16x16x32_bf16 v[28:31], v[124:127], v[144:147], v[28:31]
    v_mfma_f32_16x16x32_bf16 v[32:35], v[112:115], v[160:163], v[32:35]
    v_mfma_f32_16x16x32_bf16 v[32:35], v[116:119], v[156:159], v[32:35]
    v_mfma_f32_16x16x32_bf16 v[32:35], v[120:123], v[152:155], v[32:35]
    v_mfma_f32_16x16x32_bf16 v[32:35], v[124:127], v[148:151], v[32:35]
    v_mfma_f32_16x16x32_bf16 v[32:35], v[128:131], v[144:147], v[32:35]
    v_mfma_f32_16x16x32_bf16 v[36:39], v[112:115], v[164:167], v[36:39]
    v_mfma_f32_16x16x32_bf16 v[36:39], v[116:119], v[160:163], v[36:39]
    v_mfma_f32_16x16x32_bf16 v[36:39], v[120:123], v[156:159], v[36:39]
    v_mfma_f32_16x16x32_bf16 v[36:39], v[124:127], v[152:155], v[36:39]
    v_mfma_f32_16x16x32_bf16 v[36:39], v[128:131], v[148:151], v[36:39]
    v_mfma_f32_16x16x32_bf16 v[36:39], v[132:135], v[144:147], v[36:39]
    v_mfma_f32_16x16x32_bf16 v[40:43], v[112:115], v[168:171], v[40:43]
    v_mfma_f32_16x16x32_bf16 v[40:43], v[116:119], v[164:167], v[40:43]
    v_mfma_f32_16x16x32_bf16 v[40:43], v[120:123], v[160:163], v[40:43]
    v_mfma_f32_16x16x32_bf16 v[40:43], v[124:127], v[156:159], v[40:43]
    v_mfma_f32_16x16x32_bf16 v[40:43], v[128:131], v[152:155], v[40:43]
    v_mfma_f32_16x16x32_bf16 v[40:43], v[132:135], v[148:151], v[40:43]
    v_mfma_f32_16x16x32_bf16 v[40:43], v[136:139], v[144:147], v[40:43]
    v_mfma_f32_16x16x32_bf16 v[44:47], v[112:115], v[172:175], v[44:47]
    v_mfma_f32_16x16x32_bf16 v[44:47], v[116:119], v[168:171], v[44:47]
    v_mfma_f32_16x16x32_bf16 v[44:47], v[120:123], v[164:167], v[44:47]
    v_mfma_f32_16x16x32_bf16 v[44:47], v[124:127], v[160:163], v[44:47]
    v_mfma_f32_16x16x32_bf16 v[44:47], v[128:131], v[156:159], v[44:47]
    v_mfma_f32_16x16x32_bf16 v[44:47], v[132:135], v[152:155], v[44:47]
    v_mfma_f32_16x16x32_bf16 v[44:47], v[136:139], v[148:151], v[44:47]
    v_mfma_f32_16x16x32_bf16 v[44:47], v[140:143], v[144:147], v[44:47]
    v_lshlrev_b32 v3, 16, v3
    v_lshlrev_b32 v14, 5, v9
    v_lshlrev_b32 v15, 3, v10
    v_add_u32 v14, v14, v15
    v_sub_u32 v15, 8952, v14
    v_add_u32 v15, s31, v15
    v_add_u32 v14, s32, v14
    ds_read_b64 v[48:49], v15 offset:3584
    ds_read_b64 v[50:51], v15 offset:3072
    ds_read_b64 v[52:53], v15 offset:2560
    ds_read_b64 v[54:55], v15 offset:2048
    ds_read_b64 v[56:57], v15 offset:1536
    ds_read_b64 v[58:59], v15 offset:1024
    ds_read_b64 v[60:61], v15 offset:512
    ds_read_b64 v[62:63], v15 offset:0
    s_waitcnt lgkmcnt(0)
    v_and_b32 v64, 0xffff0000, v49
    v_lshlrev_b32 v65, 16, v49
    v_and_b32 v66, 0xffff0000, v48
    v_lshlrev_b32 v67, 16, v48
    v_mul_f32 v64, v64, v3
    v_mul_f32 v65, v65, v3
    v_mul_f32 v66, v66, v3
    v_mul_f32 v67, v67, v3
    v_cvt_pk_bf16_f32 v68, v64, v65
    v_cvt_pk_bf16_f32 v69, v66, v67
    v_cvt_pk_bf16_f32 v70, v16, v17
    v_cvt_pk_bf16_f32 v71, v18, v19
    v_lshlrev_b32 v64, 16, v68
    v_and_b32 v65, 0xffff0000, v68
    v_lshlrev_b32 v66, 16, v69
    v_and_b32 v67, 0xffff0000, v69
    v_lshlrev_b32 v16, 16, v70
    v_and_b32 v17, 0xffff0000, v70
    v_lshlrev_b32 v18, 16, v71
    v_and_b32 v19, 0xffff0000, v71
    v_add_f32 v64, v64, v16
    v_add_f32 v65, v65, v17
    v_add_f32 v66, v66, v18
    v_add_f32 v67, v67, v19
    v_cvt_pk_bf16_f32 v16, v64, v65
    v_cvt_pk_bf16_f32 v17, v66, v67
    buffer_store_dwordx2 v[16:17], v14, s[24:27], 0 offen offset:0 sc1
    v_and_b32 v72, 0xffff0000, v51
    v_lshlrev_b32 v73, 16, v51
    v_and_b32 v74, 0xffff0000, v50
    v_lshlrev_b32 v75, 16, v50
    v_mul_f32 v72, v72, v3
    v_mul_f32 v73, v73, v3
    v_mul_f32 v74, v74, v3
    v_mul_f32 v75, v75, v3
    v_cvt_pk_bf16_f32 v76, v72, v73
    v_cvt_pk_bf16_f32 v77, v74, v75
    v_cvt_pk_bf16_f32 v78, v20, v21
    v_cvt_pk_bf16_f32 v79, v22, v23
    v_lshlrev_b32 v72, 16, v76
    v_and_b32 v73, 0xffff0000, v76
    v_lshlrev_b32 v74, 16, v77
    v_and_b32 v75, 0xffff0000, v77
    v_lshlrev_b32 v20, 16, v78
    v_and_b32 v21, 0xffff0000, v78
    v_lshlrev_b32 v22, 16, v79
    v_and_b32 v23, 0xffff0000, v79
    v_add_f32 v72, v72, v20
    v_add_f32 v73, v73, v21
    v_add_f32 v74, v74, v22
    v_add_f32 v75, v75, v23
    v_cvt_pk_bf16_f32 v20, v72, v73
    v_cvt_pk_bf16_f32 v21, v74, v75
    buffer_store_dwordx2 v[20:21], v14, s[24:27], 0 offen offset:512 sc1
    v_and_b32 v64, 0xffff0000, v53
    v_lshlrev_b32 v65, 16, v53
    v_and_b32 v66, 0xffff0000, v52
    v_lshlrev_b32 v67, 16, v52
    v_mul_f32 v64, v64, v3
    v_mul_f32 v65, v65, v3
    v_mul_f32 v66, v66, v3
    v_mul_f32 v67, v67, v3
    v_cvt_pk_bf16_f32 v68, v64, v65
    v_cvt_pk_bf16_f32 v69, v66, v67
    v_cvt_pk_bf16_f32 v70, v24, v25
    v_cvt_pk_bf16_f32 v71, v26, v27
    v_lshlrev_b32 v64, 16, v68
    v_and_b32 v65, 0xffff0000, v68
    v_lshlrev_b32 v66, 16, v69
    v_and_b32 v67, 0xffff0000, v69
    v_lshlrev_b32 v24, 16, v70
    v_and_b32 v25, 0xffff0000, v70
    v_lshlrev_b32 v26, 16, v71
    v_and_b32 v27, 0xffff0000, v71
    v_add_f32 v64, v64, v24
    v_add_f32 v65, v65, v25
    v_add_f32 v66, v66, v26
    v_add_f32 v67, v67, v27
    v_cvt_pk_bf16_f32 v24, v64, v65
    v_cvt_pk_bf16_f32 v25, v66, v67
    buffer_store_dwordx2 v[24:25], v14, s[24:27], 0 offen offset:1024 sc1
    v_and_b32 v72, 0xffff0000, v55
    v_lshlrev_b32 v73, 16, v55
    v_and_b32 v74, 0xffff0000, v54
    v_lshlrev_b32 v75, 16, v54
    v_mul_f32 v72, v72, v3
    v_mul_f32 v73, v73, v3
    v_mul_f32 v74, v74, v3
    v_mul_f32 v75, v75, v3
    v_cvt_pk_bf16_f32 v76, v72, v73
    v_cvt_pk_bf16_f32 v77, v74, v75
    v_cvt_pk_bf16_f32 v78, v28, v29
    v_cvt_pk_bf16_f32 v79, v30, v31
    v_lshlrev_b32 v72, 16, v76
    v_and_b32 v73, 0xffff0000, v76
    v_lshlrev_b32 v74, 16, v77
    v_and_b32 v75, 0xffff0000, v77
    v_lshlrev_b32 v28, 16, v78
    v_and_b32 v29, 0xffff0000, v78
    v_lshlrev_b32 v30, 16, v79
    v_and_b32 v31, 0xffff0000, v79
    v_add_f32 v72, v72, v28
    v_add_f32 v73, v73, v29
    v_add_f32 v74, v74, v30
    v_add_f32 v75, v75, v31
    v_cvt_pk_bf16_f32 v28, v72, v73
    v_cvt_pk_bf16_f32 v29, v74, v75
    buffer_store_dwordx2 v[28:29], v14, s[24:27], 0 offen offset:1536 sc1
    v_and_b32 v64, 0xffff0000, v57
    v_lshlrev_b32 v65, 16, v57
    v_and_b32 v66, 0xffff0000, v56
    v_lshlrev_b32 v67, 16, v56
    v_mul_f32 v64, v64, v3
    v_mul_f32 v65, v65, v3
    v_mul_f32 v66, v66, v3
    v_mul_f32 v67, v67, v3
    v_cvt_pk_bf16_f32 v68, v64, v65
    v_cvt_pk_bf16_f32 v69, v66, v67
    v_cvt_pk_bf16_f32 v70, v32, v33
    v_cvt_pk_bf16_f32 v71, v34, v35
    v_lshlrev_b32 v64, 16, v68
    v_and_b32 v65, 0xffff0000, v68
    v_lshlrev_b32 v66, 16, v69
    v_and_b32 v67, 0xffff0000, v69
    v_lshlrev_b32 v32, 16, v70
    v_and_b32 v33, 0xffff0000, v70
    v_lshlrev_b32 v34, 16, v71
    v_and_b32 v35, 0xffff0000, v71
    v_add_f32 v64, v64, v32
    v_add_f32 v65, v65, v33
    v_add_f32 v66, v66, v34
    v_add_f32 v67, v67, v35
    v_cvt_pk_bf16_f32 v32, v64, v65
    v_cvt_pk_bf16_f32 v33, v66, v67
    buffer_store_dwordx2 v[32:33], v14, s[24:27], 0 offen offset:2048 sc1
    v_and_b32 v72, 0xffff0000, v59
    v_lshlrev_b32 v73, 16, v59
    v_and_b32 v74, 0xffff0000, v58
    v_lshlrev_b32 v75, 16, v58
    v_mul_f32 v72, v72, v3
    v_mul_f32 v73, v73, v3
    v_mul_f32 v74, v74, v3
    v_mul_f32 v75, v75, v3
    v_cvt_pk_bf16_f32 v76, v72, v73
    v_cvt_pk_bf16_f32 v77, v74, v75
    v_cvt_pk_bf16_f32 v78, v36, v37
    v_cvt_pk_bf16_f32 v79, v38, v39
    v_lshlrev_b32 v72, 16, v76
    v_and_b32 v73, 0xffff0000, v76
    v_lshlrev_b32 v74, 16, v77
    v_and_b32 v75, 0xffff0000, v77
    v_lshlrev_b32 v36, 16, v78
    v_and_b32 v37, 0xffff0000, v78
    v_lshlrev_b32 v38, 16, v79
    v_and_b32 v39, 0xffff0000, v79
    v_add_f32 v72, v72, v36
    v_add_f32 v73, v73, v37
    v_add_f32 v74, v74, v38
    v_add_f32 v75, v75, v39
    v_cvt_pk_bf16_f32 v36, v72, v73
    v_cvt_pk_bf16_f32 v37, v74, v75
    buffer_store_dwordx2 v[36:37], v14, s[24:27], 0 offen offset:2560 sc1
    v_and_b32 v64, 0xffff0000, v61
    v_lshlrev_b32 v65, 16, v61
    v_and_b32 v66, 0xffff0000, v60
    v_lshlrev_b32 v67, 16, v60
    v_mul_f32 v64, v64, v3
    v_mul_f32 v65, v65, v3
    v_mul_f32 v66, v66, v3
    v_mul_f32 v67, v67, v3
    v_cvt_pk_bf16_f32 v68, v64, v65
    v_cvt_pk_bf16_f32 v69, v66, v67
    v_cvt_pk_bf16_f32 v70, v40, v41
    v_cvt_pk_bf16_f32 v71, v42, v43
    v_lshlrev_b32 v64, 16, v68
    v_and_b32 v65, 0xffff0000, v68
    v_lshlrev_b32 v66, 16, v69
    v_and_b32 v67, 0xffff0000, v69
    v_lshlrev_b32 v40, 16, v70
    v_and_b32 v41, 0xffff0000, v70
    v_lshlrev_b32 v42, 16, v71
    v_and_b32 v43, 0xffff0000, v71
    v_add_f32 v64, v64, v40
    v_add_f32 v65, v65, v41
    v_add_f32 v66, v66, v42
    v_add_f32 v67, v67, v43
    v_cvt_pk_bf16_f32 v40, v64, v65
    v_cvt_pk_bf16_f32 v41, v66, v67
    buffer_store_dwordx2 v[40:41], v14, s[24:27], 0 offen offset:3072 sc1
    v_and_b32 v72, 0xffff0000, v63
    v_lshlrev_b32 v73, 16, v63
    v_and_b32 v74, 0xffff0000, v62
    v_lshlrev_b32 v75, 16, v62
    v_mul_f32 v72, v72, v3
    v_mul_f32 v73, v73, v3
    v_mul_f32 v74, v74, v3
    v_mul_f32 v75, v75, v3
    v_cvt_pk_bf16_f32 v76, v72, v73
    v_cvt_pk_bf16_f32 v77, v74, v75
    v_cvt_pk_bf16_f32 v78, v44, v45
    v_cvt_pk_bf16_f32 v79, v46, v47
    v_lshlrev_b32 v72, 16, v76
    v_and_b32 v73, 0xffff0000, v76
    v_lshlrev_b32 v74, 16, v77
    v_and_b32 v75, 0xffff0000, v77
    v_lshlrev_b32 v44, 16, v78
    v_and_b32 v45, 0xffff0000, v78
    v_lshlrev_b32 v46, 16, v79
    v_and_b32 v47, 0xffff0000, v79
    v_add_f32 v72, v72, v44
    v_add_f32 v73, v73, v45
    v_add_f32 v74, v74, v46
    v_add_f32 v75, v75, v47
    v_cvt_pk_bf16_f32 v44, v72, v73
    v_cvt_pk_bf16_f32 v45, v74, v75
    buffer_store_dwordx2 v[44:45], v14, s[24:27], 0 offen offset:3584 sc1
    s_mul_i32 s33, s30, 683
    s_lshr_b32 s33, s33, 16
    s_lshl_b32 s33, s33, 7
    s_add_u32 s33, s33, 12288
    s_cmp_ge_u32 s40, 4
    s_cbranch_scc1 L_g2_pub
    s_mov_b32 s32, s47
    s_mov_b32 s31, s48
    v_mov_b32 v48, v176
    v_mov_b32 v49, v177
    v_mov_b32 v50, v178
    v_mov_b32 v51, v179
    v_mov_b32 v52, v180
    v_mov_b32 v53, v181
    v_mov_b32 v54, v182
    v_mov_b32 v55, v183
    v_mov_b32 v56, v184
    v_mov_b32 v57, v185
    v_mov_b32 v58, v186
    v_mov_b32 v59, v187
    v_mov_b32 v60, v188
    v_mov_b32 v61, v189
    v_mov_b32 v62, v190
    v_mov_b32 v63, v191
    v_mov_b32 v64, v192
    v_mov_b32 v65, v193
    v_mov_b32 v66, v194
    v_mov_b32 v67, v195
    v_mov_b32 v68, v196
    v_mov_b32 v69, v197
    v_mov_b32 v70, v198
    v_mov_b32 v71, v199
    v_mov_b32 v3, v200
    s_cmp_lg_u32 s40, 0
    s_cbranch_scc1 L_g2_q1
    v_add_u32 v8, s31, v2
    v_lshlrev_b32 v11, 1, v9
    v_add_u32 v11, v11, v12
    v_and_b32 v14, 1, v9
    v_cmp_eq_u32 vcc, 1, v14
    v_mov_b32 v14, 4224
    s_nop 1
    v_cndmask_b32 v14, v14, 2, vcc
    v_add_u32 v11, v11, v14
    v_add_u32 v11, s31, v11
    v_lshlrev_b32 v13, 5, v9
    v_sub_u32 v13, v12, v13
    v_add_u32 v13, 8928, v13
    v_add_u32 v13, s31, v13
    v_add_u32 v14, 960, v11
    v_add_u32 v15, 1920, v11
    v_add_u32 v202, 2880, v11
    v_add_u32 v203, 3840, v11
    v_mov_b32 v4, 0
    v_mov_b32 v5, 0
    v_mov_b32 v6, 0
    v_mov_b32 v7, 0
    s_mov_b32 exec_hi, 0
    ds_write_b128 v8, v[4:7] offset:12544
    s_mov_b32 exec_lo, 3
    ds_write_b128 v8, v[4:7]
    s_mov_b32 exec_lo, 1
    ds_write_b128 v8, v[4:7] offset:4224
    s_mov_b64 exec, -1
    v_mov_b32 v44, 0
    v_mov_b32 v45, 0
    v_mov_b32 v46, 0
    v_mov_b32 v47, 0
    v_mov_b32 v16, 0
    v_mov_b32 v17, 0
    v_mov_b32 v18, 0
    v_mov_b32 v19, 0
    ds_write_b128 v8, v[48:51] offset:32
    v_alignbit_b32 v112, v49, v48, 16
    v_alignbit_b32 v113, v50, v49, 16
    v_alignbit_b32 v114, v51, v50, 16
    v_alignbit_b32 v115, v52, v51, 16
    ds_write_b128 v8, v[112:115] offset:4256
    v_lshlrev_b32 v7, 16, v48
    s_mov_b64 exec, 1
    ds_write_b128 v8, v[4:7] offset:4240
    s_mov_b64 exec, -1
    ds_write_b128 v8, v[54:57] offset:1056
    v_alignbit_b32 v116, v55, v54, 16
    v_alignbit_b32 v117, v56, v55, 16
    v_alignbit_b32 v118, v57, v56, 16
    v_alignbit_b32 v119, v58, v57, 16
    ds_write_b128 v8, v[116:119] offset:5280
    ds_write_b128 v8, v[60:63] offset:2080
    v_alignbit_b32 v112, v61, v60, 16
    v_alignbit_b32 v113, v62, v61, 16
    v_alignbit_b32 v114, v63, v62, 16
    v_alignbit_b32 v115, v64, v63, 16
    ds_write_b128 v8, v[112:115] offset:6304
    ds_write_b128 v8, v[66:69] offset:3104
    v_alignbit_b32 v116, v67, v66, 16
    v_alignbit_b32 v117, v68, v67, 16
    v_alignbit_b32 v118, v69, v68, 16
    v_alignbit_b32 v119, v70, v69, 16
    ds_write_b128 v8, v[116:119] offset:7328
    s_waitcnt lgkmcnt(0)
    ds_read2_b32 v[48:49], v11 offset0:0 offset1:1
    ds_read2_b32 v[50:51], v11 offset0:2 offset1:3
    ds_read_b128 v[80:83], v13 offset:3584
    ds_read2_b32 v[52:53], v11 offset0:128 offset1:129
    ds_read2_b32 v[54:55], v11 offset0:130 offset1:131
    ds_read_b128 v[84:87], v13 offset:3072
    ds_read2_b32 v[56:57], v14 offset0:16 offset1:17
    ds_read2_b32 v[58:59], v14 offset0:18 offset1:19
    ds_read_b128 v[88:91], v13 offset:2560
    ds_read2_b32 v[60:61], v14 offset0:144 offset1:145
    ds_read2_b32 v[62:63], v14 offset0:146 offset1:147
    ds_read_b128 v[92:95], v13 offset:2048
    ds_read2_b32 v[64:65], v15 offset0:32 offset1:33
    ds_read2_b32 v[66:67], v15 offset0:34 offset1:35
    ds_read_b128 v[96:99], v13 offset:1536
    ds_read2_b32 v[68:69], v15 offset0:160 offset1:161
    ds_read2_b32 v[70:71], v15 offset0:162 offset1:163
    ds_read_b128 v[100:103], v13 offset:1024
    ds_read2_b32 v[72:73], v202 offset0:48 offset1:49
    ds_read2_b32 v[74:75], v202 offset0:50 offset1:51
    ds_read_b128 v[104:107], v13 offset:512
    ds_read2_b32 v[76:77], v202 offset0:176 offset1:177
    ds_read2_b32 v[78:79], v202 offset0:178 offset1:179
    ds_read_b128 v[108:111], v13 offset:0
    s_waitcnt lgkmcnt(0)
    ds_read2_b32 v[112:113], v11 offset0:16 offset1:17
    ds_read2_b32 v[114:115], v11 offset0:18 offset1:19
    ds_read_b128 v[144:147], v13 offset:3648
    ds_read2_b32 v[116:117], v11 offset0:144 offset1:145
    ds_read2_b32 v[118:119], v11 offset0:146 offset1:147
    ds_read_b128 v[148:151], v13 offset:3136
    ds_read2_b32 v[120:121], v14 offset0:32 offset1:33
    ds_read2_b32 v[122:123], v14 offset0:34 offset1:35
    ds_read_b128 v[152:155], v13 offset:2624
    ds_read2_b32 v[124:125], v14 offset0:160 offset1:161
    ds_read2_b32 v[126:127], v14 offset0:162 offset1:163
    ds_read_b128 v[156:159], v13 offset:2112
    ds_read2_b32 v[128:129], v15 offset0:48 offset1:49
    ds_read2_b32 v[130:131], v15 offset0:50 offset1:51
    ds_read_b128 v[160:163], v13 offset:1600
    ds_read2_b32 v[132:133], v15 offset0:176 offset1:177
    ds_read2_b32 v[134:135], v15 offset0:178 offset1:179
    ds_read_b128 v[164:167], v13 offset:1088
    ds_read2_b32 v[136:137], v202 offset0:64 offset1:65
    ds_read2_b32 v[138:139], v202 offset0:66 offset1:67
    ds_read_b128 v[168:171], v13 offset:576
    ds_read2_b32 v[140:141], v202 offset0:192 offset1:193
    ds_read2_b32 v[142:143], v202 offset0:194 offset1:195
    ds_read_b128 v[172:175], v13 offset:64
    v_mfma_f32_16x16x32_bf16 v[44:47], v[48:51], v[108:111], v[44:47]
    v_mfma_f32_16x16x32_bf16 v[44:47], v[52:55], v[104:107], v[44:47]
    v_mfma_f32_16x16x32_bf16 v[44:47], v[56:59], v[100:103], v[44:47]
    v_mfma_f32_16x16x32_bf16 v[44:47], v[60:63], v[96:99], v[44:47]
    v_mfma_f32_16x16x32_bf16 v[44:47], v[64:67], v[92:95], v[44:47]
    v_mfma_f32_16x16x32_bf16 v[44:47], v[68:71], v[88:91], v[44:47]
    v_mfma_f32_16x16x32_bf16 v[44:47], v[72:75], v[84:87], v[44:47]
    v_mfma_f32_16x16x32_bf16 v[44:47], v[76:79], v[80:83], v[44:47]
    v_mfma_f32_16x16x32_bf16 v[16:19], v[48:51], v[80:83], v[16:19]
    s_waitcnt lgkmcnt(0)
    ds_read2_b32 v[48:49], v11 offset0:32 offset1:33
    ds_read2_b32 v[50:51], v11 offset0:34 offset1:35
    ds_read_b128 v[80:83], v13 offset:3712
    ds_read2_b32 v[52:53], v11 offset0:160 offset1:161
    ds_read2_b32 v[54:55], v11 offset0:162 offset1:163
    ds_read_b128 v[84:87], v13 offset:3200
    ds_read2_b32 v[56:57], v14 offset0:48 offset1:49
    ds_read2_b32 v[58:59], v14 offset0:50 offset1:51
    ds_read_b128 v[88:91], v13 offset:2688
    ds_read2_b32 v[60:61], v14 offset0:176 offset1:177
    ds_read2_b32 v[62:63], v14 offset0:178 offset1:179
    ds_read_b128 v[92:95], v13 offset:2176
    ds_read2_b32 v[64:65], v15 offset0:64 offset1:65
    ds_read2_b32 v[66:67], v15 offset0:66 offset1:67
    ds_read_b128 v[96:99], v13 offset:1664
    ds_read2_b32 v[68:69], v15 offset0:192 offset1:193
    ds_read2_b32 v[70:71], v15 offset0:194 offset1:195
    ds_read_b128 v[100:103], v13 offset:1152
    ds_read2_b32 v[72:73], v202 offset0:80 offset1:81
    ds_read2_b32 v[74:75], v202 offset0:82 offset1:83
    ds_read_b128 v[104:107], v13 offset:640
    ds_read2_b32 v[76:77], v202 offset0:208 offset1:209
    ds_read2_b32 v[78:79], v202 offset0:210 offset1:211
    ds_read_b128 v[108:111], v13 offset:128
    v_mfma_f32_16x16x32_bf16 v[44:47], v[112:115], v[172:175], v[44:47]
    v_mfma_f32_16x16x32_bf16 v[44:47], v[116:119], v[168:171], v[44:47]
    v_mfma_f32_16x16x32_bf16 v[44:47], v[120:123], v[164:167], v[44:47]
    v_mfma_f32_16x16x32_bf16 v[44:47], v[124:127], v[160:163], v[44:47]
    v_mfma_f32_16x16x32_bf16 v[44:47], v[128:131], v[156:159], v[44:47]
    v_mfma_f32_16x16x32_bf16 v[44:47], v[132:135], v[152:155], v[44:47]
    v_mfma_f32_16x16x32_bf16 v[44:47], v[136:139], v[148:151], v[44:47]
    v_mfma_f32_16x16x32_bf16 v[44:47], v[140:143], v[144:147], v[44:47]
    v_mfma_f32_16x16x32_bf16 v[16:19], v[112:115], v[144:147], v[16:19]
    s_waitcnt lgkmcnt(0)
    ds_read2_b32 v[112:113], v11 offset0:48 offset1:49
    ds_read2_b32 v[114:115], v11 offset0:50 offset1:51
    ds_read_b128 v[144:147], v13 offset:3776
    ds_read2_b32 v[116:117], v11 offset0:176 offset1:177
    ds_read2_b32 v[118:119], v11 offset0:178 offset1:179
    ds_read_b128 v[148:151], v13 offset:3264
    ds_read2_b32 v[120:121], v14 offset0:64 offset1:65
    ds_read2_b32 v[122:123], v14 offset0:66 offset1:67
    ds_read_b128 v[152:155], v13 offset:2752
    ds_read2_b32 v[124:125], v14 offset0:192 offset1:193
    ds_read2_b32 v[126:127], v14 offset0:194 offset1:195
    ds_read_b128 v[156:159], v13 offset:2240
    ds_read2_b32 v[128:129], v15 offset0:80 offset1:81
    ds_read2_b32 v[130:131], v15 offset0:82 offset1:83
    ds_read_b128 v[160:163], v13 offset:1728
    ds_read2_b32 v[132:133], v15 offset0:208 offset1:209
    ds_read2_b32 v[134:135], v15 offset0:210 offset1:211
    ds_read_b128 v[164:167], v13 offset:1216
    ds_read2_b32 v[136:137], v202 offset0:96 offset1:97
    ds_read2_b32 v[138:139], v202 offset0:98 offset1:99
    ds_read_b128 v[168:171], v13 offset:704
    ds_read2_b32 v[140:141], v202 offset0:224 offset1:225
    ds_read2_b32 v[142:143], v202 offset0:226 offset1:227
    ds_read_b128 v[172:175], v13 offset:192
    v_mfma_f32_16x16x32_bf16 v[44:47], v[48:51], v[108:111], v[44:47]
    v_mfma_f32_16x16x32_bf16 v[44:47], v[52:55], v[104:107], v[44:47]
    v_mfma_f32_16x16x32_bf16 v[44:47], v[56:59], v[100:103], v[44:47]
    v_mfma_f32_16x16x32_bf16 v[44:47], v[60:63], v[96:99], v[44:47]
    v_mfma_f32_16x16x32_bf16 v[44:47], v[64:67], v[92:95], v[44:47]
    v_mfma_f32_16x16x32_bf16 v[44:47], v[68:71], v[88:91], v[44:47]
    v_mfma_f32_16x16x32_bf16 v[44:47], v[72:75], v[84:87], v[44:47]
    v_mfma_f32_16x16x32_bf16 v[44:47], v[76:79], v[80:83], v[44:47]
    v_mfma_f32_16x16x32_bf16 v[16:19], v[48:51], v[80:83], v[16:19]
    s_waitcnt lgkmcnt(0)
    ds_read2_b32 v[48:49], v11 offset0:64 offset1:65
    ds_read2_b32 v[50:51], v11 offset0:66 offset1:67
    ds_read_b128 v[80:83], v13 offset:3840
    ds_read2_b32 v[52:53], v11 offset0:192 offset1:193
    ds_read2_b32 v[54:55], v11 offset0:194 offset1:195
    ds_read_b128 v[84:87], v13 offset:3328
    ds_read2_b32 v[56:57], v14 offset0:80 offset1:81
    ds_read2_b32 v[58:59], v14 offset0:82 offset1:83
    ds_read_b128 v[88:91], v13 offset:2816
    ds_read2_b32 v[60:61], v14 offset0:208 offset1:209
    ds_read2_b32 v[62:63], v14 offset0:210 offset1:211
    ds_read_b128 v[92:95], v13 offset:2304
    ds_read2_b32 v[64:65], v15 offset0:96 offset1:97
    ds_read2_b32 v[66:67], v15 offset0:98 offset1:99
    ds_read_b128 v[96:99], v13 offset:1792
    ds_read2_b32 v[68:69], v15 offset0:224 offset1:225
    ds_read2_b32 v[70:71], v15 offset0:226 offset1:227
    ds_read_b128 v[100:103], v13 offset:1280
    ds_read2_b32 v[72:73], v202 offset0:112 offset1:113
    ds_read2_b32 v[74:75], v202 offset0:114 offset1:115
    ds_read_b128 v[104:107], v13 offset:768
    ds_read2_b32 v[76:77], v203 offset0:0 offset1:1
    ds_read2_b32 v[78:79], v203 offset0:2 offset1:3
    ds_read_b128 v[108:111], v13 offset:256
    v_mfma_f32_16x16x32_bf16 v[44:47], v[112:115], v[172:175], v[44:47]
    v_mfma_f32_16x16x32_bf16 v[44:47], v[116:119], v[168:171], v[44:47]
    v_mfma_f32_16x16x32_bf16 v[44:47], v[120:123], v[164:167], v[44:47]
    v_mfma_f32_16x16x32_bf16 v[44:47], v[124:127], v[160:163], v[44:47]
    v_mfma_f32_16x16x32_bf16 v[44:47], v[128:131], v[156:159], v[44:47]
    v_mfma_f32_16x16x32_bf16 v[44:47], v[132:135], v[152:155], v[44:47]
    v_mfma_f32_16x16x32_bf16 v[44:47], v[136:139], v[148:151], v[44:47]
    v_mfma_f32_16x16x32_bf16 v[44:47], v[140:143], v[144:147], v[44:47]
    v_mfma_f32_16x16x32_bf16 v[16:19], v[112:115], v[144:147], v[16:19]
    s_waitcnt lgkmcnt(0)
    ds_read2_b32 v[112:113], v11 offset0:80 offset1:81
    ds_read2_b32 v[114:115], v11 offset0:82 offset1:83
    ds_read_b128 v[144:147], v13 offset:3904
    ds_read2_b32 v[116:117], v11 offset0:208 offset1:209
    ds_read2_b32 v[118:119], v11 offset0:210 offset1:211
    ds_read_b128 v[148:151], v13 offset:3392
    ds_read2_b32 v[120:121], v14 offset0:96 offset1:97
    ds_read2_b32 v[122:123], v14 offset0:98 offset1:99
    ds_read_b128 v[152:155], v13 offset:2880
    ds_read2_b32 v[124:125], v14 offset0:224 offset1:225
    ds_read2_b32 v[126:127], v14 offset0:226 offset1:227
    ds_read_b128 v[156:159], v13 offset:2368
    ds_read2_b32 v[128:129], v15 offset0:112 offset1:113
    ds_read2_b32 v[130:131], v15 offset0:114 offset1:115
    ds_read_b128 v[160:163], v13 offset:1856
    ds_read2_b32 v[132:133], v202 offset0:0 offset1:1
    ds_read2_b32 v[134:135], v202 offset0:2 offset1:3
    ds_read_b128 v[164:167], v13 offset:1344
    ds_read2_b32 v[136:137], v202 offset0:128 offset1:129
    ds_read2_b32 v[138:139], v202 offset0:130 offset1:131
    ds_read_b128 v[168:171], v13 offset:832
    ds_read2_b32 v[140:141], v203 offset0:16 offset1:17
    ds_read2_b32 v[142:143], v203 offset0:18 offset1:19
    ds_read_b128 v[172:175], v13 offset:320
    v_mfma_f32_16x16x32_bf16 v[44:47], v[48:51], v[108:111], v[44:47]
    v_mfma_f32_16x16x32_bf16 v[44:47], v[52:55], v[104:107], v[44:47]
    v_mfma_f32_16x16x32_bf16 v[44:47], v[56:59], v[100:103], v[44:47]
    v_mfma_f32_16x16x32_bf16 v[44:47], v[60:63], v[96:99], v[44:47]
    v_mfma_f32_16x16x32_bf16 v[44:47], v[64:67], v[92:95], v[44:47]
    v_mfma_f32_16x16x32_bf16 v[44:47], v[68:71], v[88:91], v[44:47]
    v_mfma_f32_16x16x32_bf16 v[44:47], v[72:75], v[84:87], v[44:47]
    v_mfma_f32_16x16x32_bf16 v[44:47], v[76:79], v[80:83], v[44:47]
    v_mfma_f32_16x16x32_bf16 v[16:19], v[48:51], v[80:83], v[16:19]
    s_waitcnt lgkmcnt(0)
    ds_read2_b32 v[48:49], v11 offset0:96 offset1:97
    ds_read2_b32 v[50:51], v11 offset0:98 offset1:99
    ds_read_b128 v[80:83], v13 offset:3968
    ds_read2_b32 v[52:53], v11 offset0:224 offset1:225
    ds_read2_b32 v[54:55], v11 offset0:226 offset1:227
    ds_read_b128 v[84:87], v13 offset:3456
    ds_read2_b32 v[56:57], v14 offset0:112 offset1:113
    ds_read2_b32 v[58:59], v14 offset0:114 offset1:115
    ds_read_b128 v[88:91], v13 offset:2944
    ds_read2_b32 v[60:61], v15 offset0:0 offset1:1
    ds_read2_b32 v[62:63], v15 offset0:2 offset1:3
    ds_read_b128 v[92:95], v13 offset:2432
    ds_read2_b32 v[64:65], v15 offset0:128 offset1:129
    ds_read2_b32 v[66:67], v15 offset0:130 offset1:131
    ds_read_b128 v[96:99], v13 offset:1920
    ds_read2_b32 v[68:69], v202 offset0:16 offset1:17
    ds_read2_b32 v[70:71], v202 offset0:18 offset1:19
    ds_read_b128 v[100:103], v13 offset:1408
    ds_read2_b32 v[72:73], v202 offset0:144 offset1:145
    ds_read2_b32 v[74:75], v202 offset0:146 offset1:147
    ds_read_b128 v[104:107], v13 offset:896
    ds_read2_b32 v[76:77], v203 offset0:32 offset1:33
    ds_read2_b32 v[78:79], v203 offset0:34 offset1:35
    ds_read_b128 v[108:111], v13 offset:384
    v_mfma_f32_16x16x32_bf16 v[44:47], v[112:115], v[172:175], v[44:47]
    v_mfma_f32_16x16x32_bf16 v[44:47], v[116:119], v[168:171], v[44:47]
    v_mfma_f32_16x16x32_bf16 v[44:47], v[120:123], v[164:167], v[44:47]
    v_mfma_f32_16x16x32_bf16 v[44:47], v[124:127], v[160:163], v[44:47]
    v_mfma_f32_16x16x32_bf16 v[44:47], v[128:131], v[156:159], v[44:47]
    v_mfma_f32_16x16x32_bf16 v[44:47], v[132:135], v[152:155], v[44:47]
    v_mfma_f32_16x16x32_bf16 v[44:47], v[136:139], v[148:151], v[44:47]
    v_mfma_f32_16x16x32_bf16 v[44:47], v[140:143], v[144:147], v[44:47]
    v_mfma_f32_16x16x32_bf16 v[16:19], v[112:115], v[144:147], v[16:19]
    s_waitcnt lgkmcnt(0)
    ds_read2_b32 v[112:113], v11 offset0:112 offset1:113
    ds_read2_b32 v[114:115], v11 offset0:114 offset1:115
    ds_read_b128 v[144:147], v13 offset:4032
    ds_read2_b32 v[116:117], v14 offset0:0 offset1:1
    ds_read2_b32 v[118:119], v14 offset0:2 offset1:3
    ds_read_b128 v[148:151], v13 offset:3520
    ds_read2_b32 v[120:121], v14 offset0:128 offset1:129
    ds_read2_b32 v[122:123], v14 offset0:130 offset1:131
    ds_read_b128 v[152:155], v13 offset:3008
    ds_read2_b32 v[124:125], v15 offset0:16 offset1:17
    ds_read2_b32 v[126:127], v15 offset0:18 offset1:19
    ds_read_b128 v[156:159], v13 offset:2496
    ds_read2_b32 v[128:129], v15 offset0:144 offset1:145
    ds_read2_b32 v[130:131], v15 offset0:146 offset1:147
    ds_read_b128 v[160:163], v13 offset:1984
    ds_read2_b32 v[132:133], v202 offset0:32 offset1:33
    ds_read2_b32 v[134:135], v202 offset0:34 offset1:35
    ds_read_b128 v[164:167], v13 offset:1472
    ds_read2_b32 v[136:137], v202 offset0:160 offset1:161
    ds_read2_b32 v[138:139], v202 offset0:162 offset1:163
    ds_read_b128 v[168:171], v13 offset:960
    ds_read2_b32 v[140:141], v203 offset0:48 offset1:49
    ds_read2_b32 v[142:143], v203 offset0:50 offset1:51
    ds_read_b128 v[172:175], v13 offset:448
    v_mfma_f32_16x16x32_bf16 v[44:47], v[48:51], v[108:111], v[44:47]
    v_mfma_f32_16x16x32_bf16 v[44:47], v[52:55], v[104:107], v[44:47]
    v_mfma_f32_16x16x32_bf16 v[44:47], v[56:59], v[100:103], v[44:47]
    v_mfma_f32_16x16x32_bf16 v[44:47], v[60:63], v[96:99], v[44:47]
    v_mfma_f32_16x16x32_bf16 v[44:47], v[64:67], v[92:95], v[44:47]
    v_mfma_f32_16x16x32_bf16 v[44:47], v[68:71], v[88:91], v[44:47]
    v_mfma_f32_16x16x32_bf16 v[44:47], v[72:75], v[84:87], v[44:47]
    v_mfma_f32_16x16x32_bf16 v[44:47], v[76:79], v[80:83], v[44:47]
    v_mfma_f32_16x16x32_bf16 v[16:19], v[48:51], v[80:83], v[16:19]
    s_waitcnt lgkmcnt(0)
    v_mfma_f32_16x16x32_bf16 v[44:47], v[112:115], v[172:175], v[44:47]
    v_mfma_f32_16x16x32_bf16 v[44:47], v[116:119], v[168:171], v[44:47]
    v_mfma_f32_16x16x32_bf16 v[44:47], v[120:123], v[164:167], v[44:47]
    v_mfma_f32_16x16x32_bf16 v[44:47], v[124:127], v[160:163], v[44:47]
    v_mfma_f32_16x16x32_bf16 v[44:47], v[128:131], v[156:159], v[44:47]
    v_mfma_f32_16x16x32_bf16 v[44:47], v[132:135], v[152:155], v[44:47]
    v_mfma_f32_16x16x32_bf16 v[44:47], v[136:139], v[148:151], v[44:47]
    v_mfma_f32_16x16x32_bf16 v[44:47], v[140:143], v[144:147], v[44:47]
    v_mfma_f32_16x16x32_bf16 v[16:19], v[112:115], v[144:147], v[16:19]
    v_lshlrev_b32 v3, 16, v3
    v_lshlrev_b32 v14, 5, v9
    v_lshlrev_b32 v15, 3, v10
    v_add_u32 v14, v14, v15
    v_sub_u32 v15, 8952, v14
    v_add_u32 v15, s31, v15
    v_add_u32 v14, s32, v14
    ds_read_b64 v[62:63], v15 offset:0
    ds_read_b64 v[48:49], v15 offset:3584
    s_waitcnt lgkmcnt(0)
    v_and_b32 v64, 0xffff0000, v63
    v_lshlrev_b32 v65, 16, v63
    v_and_b32 v66, 0xffff0000, v62
    v_lshlrev_b32 v67, 16, v62
    v_mul_f32 v64, v64, v3
    v_mul_f32 v65, v65, v3
    v_mul_f32 v66, v66, v3
    v_mul_f32 v67, v67, v3
    v_cvt_pk_bf16_f32 v68, v64, v65
    v_cvt_pk_bf16_f32 v69, v66, v67
    v_cvt_pk_bf16_f32 v70, v44, v45
    v_cvt_pk_bf16_f32 v71, v46, v47
    v_lshlrev_b32 v64, 16, v68
    v_and_b32 v65, 0xffff0000, v68
    v_lshlrev_b32 v66, 16, v69
    v_and_b32 v67, 0xffff0000, v69
    v_lshlrev_b32 v44, 16, v70
    v_and_b32 v45, 0xffff0000, v70
    v_lshlrev_b32 v46, 16, v71
    v_and_b32 v47, 0xffff0000, v71
    v_add_f32 v64, v64, v44
    v_add_f32 v65, v65, v45
    v_add_f32 v66, v66, v46
    v_add_f32 v67, v67, v47
    v_cvt_pk_bf16_f32 v44, v64, v65
    v_cvt_pk_bf16_f32 v45, v66, v67
    buffer_store_dwordx2 v[44:45], v14, s[24:27], 0 offen offset:3584 sc1
    v_and_b32 v72, 0xffff0000, v49
    v_lshlrev_b32 v73, 16, v49
    v_and_b32 v74, 0xffff0000, v48
    v_lshlrev_b32 v75, 16, v48
    v_mul_f32 v72, v72, v3
    v_mul_f32 v73, v73, v3
    v_mul_f32 v74, v74, v3
    v_mul_f32 v75, v75, v3
    v_cvt_pk_bf16_f32 v76, v72, v73
    v_cvt_pk_bf16_f32 v77, v74, v75
    v_cvt_pk_bf16_f32 v78, v16, v17
    v_cvt_pk_bf16_f32 v79, v18, v19
    v_lshlrev_b32 v72, 16, v76
    v_and_b32 v73, 0xffff0000, v76
    v_lshlrev_b32 v74, 16, v77
    v_and_b32 v75, 0xffff0000, v77
    v_lshlrev_b32 v16, 16, v78
    v_and_b32 v17, 0xffff0000, v78
    v_lshlrev_b32 v18, 16, v79
    v_and_b32 v19, 0xffff0000, v79
    v_add_f32 v72, v72, v16
    v_add_f32 v73, v73, v17
    v_add_f32 v74, v74, v18
    v_add_f32 v75, v75, v19
    v_cvt_pk_bf16_f32 v16, v72, v73
    v_cvt_pk_bf16_f32 v17, v74, v75
    buffer_store_dwordx2 v[16:17], v14, s[24:27], 0 offen offset:0 sc1
    s_branch L_g2_pub2
L_g2_q1:
    s_cmp_lg_u32 s40, 1
    s_cbranch_scc1 L_g2_q2
    v_add_u32 v8, s31, v2
    v_lshlrev_b32 v11, 1, v9
    v_add_u32 v11, v11, v12
    v_and_b32 v14, 1, v9
    v_cmp_eq_u32 vcc, 1, v14
    v_mov_b32 v14, 4224
    s_nop 1
    v_cndmask_b32 v14, v14, 2, vcc
    v_add_u32 v11, v11, v14
    v_add_u32 v11, s31, v11
    v_lshlrev_b32 v13, 5, v9
    v_sub_u32 v13, v12, v13
    v_add_u32 v13, 8928, v13
    v_add_u32 v13, s31, v13
    v_add_u32 v14, 960, v11
    v_add_u32 v15, 1920, v11
    v_add_u32 v202, 2880, v11
    v_add_u32 v203, 3840, v11
    v_mov_b32 v4, 0
    v_mov_b32 v5, 0
    v_mov_b32 v6, 0
    v_mov_b32 v7, 0
    s_mov_b32 exec_hi, 0
    ds_write_b128 v8, v[4:7] offset:12544
    s_mov_b32 exec_lo, 3
    ds_write_b128 v8, v[4:7]
    s_mov_b32 exec_lo, 1
    ds_write_b128 v8, v[4:7] offset:4224
    s_mov_b64 exec, -1
    v_mov_b32 v40, 0
    v_mov_b32 v41, 0
    v_mov_b32 v42, 0
    v_mov_b32 v43, 0
    v_mov_b32 v20, 0
    v_mov_b32 v21, 0
    v_mov_b32 v22, 0
    v_mov_b32 v23, 0
    ds_write_b128 v8, v[48:51] offset:32
    v_alignbit_b32 v112, v49, v48, 16
    v_alignbit_b32 v113, v50, v49, 16
    v_alignbit_b32 v114, v51, v50, 16
    v_alignbit_b32 v115, v52, v51, 16
    ds_write_b128 v8, v[112:115] offset:4256
    v_lshlrev_b32 v7, 16, v48
    s_mov_b64 exec, 1
    ds_write_b128 v8, v[4:7] offset:4240
    s_mov_b64 exec, -1
    ds_write_b128 v8, v[54:57] offset:1056
    v_alignbit_b32 v116, v55, v54, 16
    v_alignbit_b32 v117, v56, v55, 16
    v_alignbit_b32 v118, v57, v56, 16
    v_alignbit_b32 v119, v58, v57, 16
    ds_write_b128 v8, v[116:119] offset:5280
    ds_write_b128 v8, v[60:63] offset:2080
    v_alignbit_b32 v112, v61, v60, 16
    v_alignbit_b32 v113, v62, v61, 16
    v_alignbit_b32 v114, v63, v62, 16
    v_alignbit_b32 v115, v64, v63, 16
    ds_write_b128 v8, v[112:115] offset:6304
    ds_write_b128 v8, v[66:69] offset:3104
    v_alignbit_b32 v116, v67, v66, 16
    v_alignbit_b32 v117, v68, v67, 16
    v_alignbit_b32 v118, v69, v68, 16
    v_alignbit_b32 v119, v70, v69, 16
    ds_write_b128 v8, v[116:119] offset:7328
    s_waitcnt lgkmcnt(0)
    ds_read2_b32 v[48:49], v11 offset0:0 offset1:1
    ds_read2_b32 v[50:51], v11 offset0:2 offset1:3
    ds_read_b128 v[80:83], v13 offset:3584
    ds_read2_b32 v[52:53], v11 offset0:128 offset1:129
    ds_read2_b32 v[54:55], v11 offset0:130 offset1:131
    ds_read_b128 v[84:87], v13 offset:3072
    ds_read2_b32 v[56:57], v14 offset0:16 offset1:17
    ds_read2_b32 v[58:59], v14 offset0:18 offset1:19
    ds_read_b128 v[88:91], v13 offset:2560
    ds_read2_b32 v[60:61], v14 offset0:144 offset1:145
    ds_read2_b32 v[62:63], v14 offset0:146 offset1:147
    ds_read_b128 v[92:95], v13 offset:2048
    ds_read2_b32 v[64:65], v15 offset0:32 offset1:33
    ds_read2_b32 v[66:67], v15 offset0:34 offset1:35
    ds_read_b128 v[96:99], v13 offset:1536
    ds_read2_b32 v[68:69], v15 offset0:160 offset1:161
    ds_read2_b32 v[70:71], v15 offset0:162 offset1:163
    ds_read_b128 v[100:103], v13 offset:1024
    ds_read2_b32 v[72:73], v202 offset0:48 offset1:49
    ds_read2_b32 v[74:75], v202 offset0:50 offset1:51
    ds_read_b128 v[104:107], v13 offset:512
    s_waitcnt lgkmcnt(0)
    ds_read2_b32 v[112:113], v11 offset0:16 offset1:17
    ds_read2_b32 v[114:115], v11 offset0:18 offset1:19
    ds_read_b128 v[144:147], v13 offset:3648
    ds_read2_b32 v[116:117], v11 offset0:144 offset1:145
    ds_read2_b32 v[118:119], v11 offset0:146 offset1:147
    ds_read_b128 v[148:151], v13 offset:3136
    ds_read2_b32 v[120:121], v14 offset0:32 offset1:33
    ds_read2_b32 v[122:123], v14 offset0:34 offset1:35
    ds_read_b128 v[152:155], v13 offset:2624
    ds_read2_b32 v[124:125], v14 offset0:160 offset1:161
    ds_read2_b32 v[126:127], v14 offset0:162 offset1:163
    ds_read_b128 v[156:159], v13 offset:2112
    ds_read2_b32 v[128:129], v15 offset0:48 offset1:49
    ds_read2_b32 v[130:131], v15 offset0:50 offset1:51
    ds_read_b128 v[160:163], v13 offset:1600
    ds_read2_b32 v[132:133], v15 offset0:176 offset1:177
    ds_read2_b32 v[134:135], v15 offset0:178 offset1:179
    ds_read_b128 v[164:167], v13 offset:1088
    ds_read2_b32 v[136:137], v202 offset0:64 offset1:65
    ds_read2_b32 v[138:139], v202 offset0:66 offset1:67
    ds_read_b128 v[168:171], v13 offset:576
    v_mfma_f32_16x16x32_bf16 v[40:43], v[48:51], v[104:107], v[40:43]
    v_mfma_f32_16x16x32_bf16 v[40:43], v[52:55], v[100:103], v[40:43]
    v_mfma_f32_16x16x32_bf16 v[40:43], v[56:59], v[96:99], v[40:43]
    v_mfma_f32_16x16x32_bf16 v[40:43], v[60:63], v[92:95], v[40:43]
    v_mfma_f32_16x16x32_bf16 v[40:43], v[64:67], v[88:91], v[40:43]
    v_mfma_f32_16x16x32_bf16 v[40:43], v[68:71], v[84:87], v[40:43]
    v_mfma_f32_16x16x32_bf16 v[40:43], v[72:75], v[80:83], v[40:43]
    v_mfma_f32_16x16x32_bf16 v[20:23], v[48:51], v[84:87], v[20:23]
    v_mfma_f32_16x16x32_bf16 v[20:23], v[52:55], v[80:83], v[20:23]
    s_waitcnt lgkmcnt(0)
    ds_read2_b32 v[48:49], v11 offset0:32 offset1:33
    ds_read2_b32 v[50:51], v11 offset0:34 offset1:35
    ds_read_b128 v[80:83], v13 offset:3712
    ds_read2_b32 v[52:53], v11 offset0:160 offset1:161
    ds_read2_b32 v[54:55], v11 offset0:162 offset1:163
    ds_read_b128 v[84:87], v13 offset:3200
    ds_read2_b32 v[56:57], v14 offset0:48 offset1:49
    ds_read2_b32 v[58:59], v14 offset0:50 offset1:51
    ds_read_b128 v[88:91], v13 offset:2688
    ds_read2_b32 v[60:61], v14 offset0:176 offset1:177
    ds_read2_b32 v[62:63], v14 offset0:178 offset1:179
    ds_read_b128 v[92:95], v13 offset:2176
    ds_read2_b32 v[64:65], v15 offset0:64 offset1:65
    ds_read2_b32 v[66:67], v15 offset0:66 offset1:67
    ds_read_b128 v[96:99], v13 offset:1664
    ds_read2_b32 v[68:69], v15 offset0:192 offset1:193
    ds_read2_b32 v[70:71], v15 offset0:194 offset1:195
    ds_read_b128 v[100:103], v13 offset:1152
    ds_read2_b32 v[72:73], v202 offset0:80 offset1:81
    ds_read2_b32 v[74:75], v202 offset0:82 offset1:83
    ds_read_b128 v[104:107], v13 offset:640
    v_mfma_f32_16x16x32_bf16 v[40:43], v[112:115], v[168:171], v[40:43]
    v_mfma_f32_16x16x32_bf16 v[40:43], v[116:119], v[164:167], v[40:43]
    v_mfma_f32_16x16x32_bf16 v[40:43], v[120:123], v[160:163], v[40:43]
    v_mfma_f32_16x16x32_bf16 v[40:43], v[124:127], v[156:159], v[40:43]
    v_mfma_f32_16x16x32_bf16 v[40:43], v[128:131], v[152:155], v[40:43]
    v_mfma_f32_16x16x32_bf16 v[40:43], v[132:135], v[148:151], v[40:43]
    v_mfma_f32_16x16x32_bf16 v[40:43], v[136:139], v[144:147], v[40:43]
    v_mfma_f32_16x16x32_bf16 v[20:23], v[112:115], v[148:151], v[20:23]
    v_mfma_f32_16x16x32_bf16 v[20:23], v[116:119], v[144:147], v[20:23]
    s_waitcnt lgkmcnt(0)
    ds_read2_b32 v[112:113], v11 offset0:48 offset1:49
    ds_read2_b32 v[114:115], v11 offset0:50 offset1:51
    ds_read_b128 v[144:147], v13 offset:3776
    ds_read2_b32 v[116:117], v11 offset0:176 offset1:177
    ds_read2_b32 v[118:119], v11 offset0:178 offset1:179
    ds_read_b128 v[148:151], v13 offset:3264
    ds_read2_b32 v[120:121], v14 offset0:64 offset1:65
    ds_read2_b32 v[122:123], v14 offset0:66 offset1:67
    ds_read_b128 v[152:155], v13 offset:2752
    ds_read2_b32 v[124:125], v14 offset0:192 offset1:193
    ds_read2_b32 v[126:127], v14 offset0:194 offset1:195
    ds_read_b128 v[156:159], v13 offset:2240
    ds_read2_b32 v[128:129], v15 offset0:80 offset1:81
    ds_read2_b32 v[130:131], v15 offset0:82 offset1:83
    ds_read_b128 v[160:163], v13 offset:1728
    ds_read2_b32 v[132:133], v15 offset0:208 offset1:209
    ds_read2_b32 v[134:135], v15 offset0:210 offset1:211
    ds_read_b128 v[164:167], v13 offset:1216
    ds_read2_b32 v[136:137], v202 offset0:96 offset1:97
    ds_read2_b32 v[138:139], v202 offset0:98 offset1:99
    ds_read_b128 v[168:171], v13 offset:704
    v_mfma_f32_16x16x32_bf16 v[40:43], v[48:51], v[104:107], v[40:43]
    v_mfma_f32_16x16x32_bf16 v[40:43], v[52:55], v[100:103], v[40:43]
    v_mfma_f32_16x16x32_bf16 v[40:43], v[56:59], v[96:99], v[40:43]
    v_mfma_f32_16x16x32_bf16 v[40:43], v[60:63], v[92:95], v[40:43]
    v_mfma_f32_16x16x32_bf16 v[40:43], v[64:67], v[88:91], v[40:43]
    v_mfma_f32_16x16x32_bf16 v[40:43], v[68:71], v[84:87], v[40:43]
    v_mfma_f32_16x16x32_bf16 v[40:43], v[72:75], v[80:83], v[40:43]
    v_mfma_f32_16x16x32_bf16 v[20:23], v[48:51], v[84:87], v[20:23]
    v_mfma_f32_16x16x32_bf16 v[20:23], v[52:55], v[80:83], v[20:23]
    s_waitcnt lgkmcnt(0)
    ds_read2_b32 v[48:49], v11 offset0:64 offset1:65
    ds_read2_b32 v[50:51], v11 offset0:66 offset1:67
    ds_read_b128 v[80:83], v13 offset:3840
    ds_read2_b32 v[52:53], v11 offset0:192 offset1:193
    ds_read2_b32 v[54:55], v11 offset0:194 offset1:195
    ds_read_b128 v[84:87], v13 offset:3328
    ds_read2_b32 v[56:57], v14 offset0:80 offset1:81
    ds_read2_b32 v[58:59], v14 offset0:82 offset1:83
    ds_read_b128 v[88:91], v13 offset:2816
    ds_read2_b32 v[60:61], v14 offset0:208 offset1:209
    ds_read2_b32 v[62:63], v14 offset0:210 offset1:211
    ds_read_b128 v[92:95], v13 offset:2304
    ds_read2_b32 v[64:65], v15 offset0:96 offset1:97
    ds_read2_b32 v[66:67], v15 offset0:98 offset1:99
    ds_read_b128 v[96:99], v13 offset:1792
    ds_read2_b32 v[68:69], v15 offset0:224 offset1:225
    ds_read2_b32 v[70:71], v15 offset0:226 offset1:227
    ds_read_b128 v[100:103], v13 offset:1280
    ds_read2_b32 v[72:73], v202 offset0:112 offset1:113
    ds_read2_b32 v[74:75], v202 offset0:114 offset1:115
    ds_read_b128 v[104:107], v13 offset:768
    v_mfma_f32_16x16x32_bf16 v[40:43], v[112:115], v[168:171], v[40:43]
    v_mfma_f32_16x16x32_bf16 v[40:43], v[116:119], v[164:167], v[40:43]
    v_mfma_f32_16x16x32_bf16 v[40:43], v[120:123], v[160:163], v[40:43]
    v_mfma_f32_16x16x32_bf16 v[40:43], v[124:127], v[156:159], v[40:43]
    v_mfma_f32_16x16x32_bf16 v[40:43], v[128:131], v[152:155], v[40:43]
    v_mfma_f32_16x16x32_bf16 v[40:43], v[132:135], v[148:151], v[40:43]
    v_mfma_f32_16x16x32_bf16 v[40:43], v[136:139], v[144:147], v[40:43]
    v_mfma_f32_16x16x32_bf16 v[20:23], v[112:115], v[148:151], v[20:23]
    v_mfma_f32_16x16x32_bf16 v[20:23], v[116:119], v[144:147], v[20:23]
    s_waitcnt lgkmcnt(0)
    ds_read2_b32 v[112:113], v11 offset0:80 offset1:81
    ds_read2_b32 v[114:115], v11 offset0:82 offset1:83
    ds_read_b128 v[144:147], v13 offset:3904
    ds_read2_b32 v[116:117], v11 offset0:208 offset1:209
    ds_read2_b32 v[118:119], v11 offset0:210 offset1:211
    ds_read_b128 v[148:151], v13 offset:3392
    ds_read2_b32 v[120:121], v14 offset0:96 offset1:97
    ds_read2_b32 v[122:123], v14 offset0:98 offset1:99
    ds_read_b128 v[152:155], v13 offset:2880
    ds_read2_b32 v[124:125], v14 offset0:224 offset1:225
    ds_read2_b32 v[126:127], v14 offset0:226 offset1:227
    ds_read_b128 v[156:159], v13 offset:2368
    ds_read2_b32 v[128:129], v15 offset0:112 offset1:113
    ds_read2_b32 v[130:131], v15 offset0:114 offset1:115
    ds_read_b128 v[160:163], v13 offset:1856
    ds_read2_b32 v[132:133], v202 offset0:0 offset1:1
    ds_read2_b32 v[134:135], v202 offset0:2 offset1:3
    ds_read_b128 v[164:167], v13 offset:1344
    ds_read2_b32 v[136:137], v202 offset0:128 offset1:129
    ds_read2_b32 v[138:139], v202 offset0:130 offset1:131
    ds_read_b128 v[168:171], v13 offset:832
    v_mfma_f32_16x16x32_bf16 v[40:43], v[48:51], v[104:107], v[40:43]
    v_mfma_f32_16x16x32_bf16 v[40:43], v[52:55], v[100:103], v[40:43]
    v_mfma_f32_16x16x32_bf16 v[40:43], v[56:59], v[96:99], v[40:43]
    v_mfma_f32_16x16x32_bf16 v[40:43], v[60:63], v[92:95], v[40:43]
    v_mfma_f32_16x16x32_bf16 v[40:43], v[64:67], v[88:91], v[40:43]
    v_mfma_f32_16x16x32_bf16 v[40:43], v[68:71], v[84:87], v[40:43]
    v_mfma_f32_16x16x32_bf16 v[40:43], v[72:75], v[80:83], v[40:43]
    v_mfma_f32_16x16x32_bf16 v[20:23], v[48:51], v[84:87], v[20:23]
    v_mfma_f32_16x16x32_bf16 v[20:23], v[52:55], v[80:83], v[20:23]
    s_waitcnt lgkmcnt(0)
    ds_read2_b32 v[48:49], v11 offset0:96 offset1:97
    ds_read2_b32 v[50:51], v11 offset0:98 offset1:99
    ds_read_b128 v[80:83], v13 offset:3968
    ds_read2_b32 v[52:53], v11 offset0:224 offset1:225
    ds_read2_b32 v[54:55], v11 offset0:226 offset1:227
    ds_read_b128 v[84:87], v13 offset:3456
    ds_read2_b32 v[56:57], v14 offset0:112 offset1:113
    ds_read2_b32 v[58:59], v14 offset0:114 offset1:115
    ds_read_b128 v[88:91], v13 offset:2944
    ds_read2_b32 v[60:61], v15 offset0:0 offset1:1
    ds_read2_b32 v[62:63], v15 offset0:2 offset1:3
    ds_read_b128 v[92:95], v13 offset:2432
    ds_read2_b32 v[64:65], v15 offset0:128 offset1:129
    ds_read2_b32 v[66:67], v15 offset0:130 offset1:131
    ds_read_b128 v[96:99], v13 offset:1920
    ds_read2_b32 v[68:69], v202 offset0:16 offset1:17
    ds_read2_b32 v[70:71], v202 offset0:18 offset1:19
    ds_read_b128 v[100:103], v13 offset:1408
    ds_read2_b32 v[72:73], v202 offset0:144 offset1:145
    ds_read2_b32 v[74:75], v202 offset0:146 offset1:147
    ds_read_b128 v[104:107], v13 offset:896
    v_mfma_f32_16x16x32_bf16 v[40:43], v[112:115], v[168:171], v[40:43]
    v_mfma_f32_16x16x32_bf16 v[40:43], v[116:119], v[164:167], v[40:43]
    v_mfma_f32_16x16x32_bf16 v[40:43], v[120:123], v[160:163], v[40:43]
    v_mfma_f32_16x16x32_bf16 v[40:43], v[124:127], v[156:159], v[40:43]
    v_mfma_f32_16x16x32_bf16 v[40:43], v[128:131], v[152:155], v[40:43]
    v_mfma_f32_16x16x32_bf16 v[40:43], v[132:135], v[148:151], v[40:43]
    v_mfma_f32_16x16x32_bf16 v[40:43], v[136:139], v[144:147], v[40:43]
    v_mfma_f32_16x16x32_bf16 v[20:23], v[112:115], v[148:151], v[20:23]
    v_mfma_f32_16x16x32_bf16 v[20:23], v[116:119], v[144:147], v[20:23]
    s_waitcnt lgkmcnt(0)
    ds_read2_b32 v[112:113], v11 offset0:112 offset1:113
    ds_read2_b32 v[114:115], v11 offset0:114 offset1:115
    ds_read_b128 v[144:147], v13 offset:4032
    ds_read2_b32 v[116:117], v14 offset0:0 offset1:1
    ds_read2_b32 v[118:119], v14 offset0:2 offset1:3
    ds_read_b128 v[148:151], v13 offset:3520
    ds_read2_b32 v[120:121], v14 offset0:128 offset1:129
    ds_read2_b32 v[122:123], v14 offset0:130 offset1:131
    ds_read_b128 v[152:155], v13 offset:3008
    ds_read2_b32 v[124:125], v15 offset0:16 offset1:17
    ds_read2_b32 v[126:127], v15 offset0:18 offset1:19
    ds_read_b128 v[156:159], v13 offset:2496
    ds_read2_b32 v[128:129], v15 offset0:144 offset1:145
    ds_read2_b32 v[130:131], v15 offset0:146 offset1:147
    ds_read_b128 v[160:163], v13 offset:1984
    ds_read2_b32 v[132:133], v202 offset0:32 offset1:33
    ds_read2_b32 v[134:135], v202 offset0:34 offset1:35
    ds_read_b128 v[164:167], v13 offset:1472
    ds_read2_b32 v[136:137], v202 offset0:160 offset1:161
    ds_read2_b32 v[138:139], v202 offset0:162 offset1:163
    ds_read_b128 v[168:171], v13 offset:960
    v_mfma_f32_16x16x32_bf16 v[40:43], v[48:51], v[104:107], v[40:43]
    v_mfma_f32_16x16x32_bf16 v[40:43], v[52:55], v[100:103], v[40:43]
    v_mfma_f32_16x16x32_bf16 v[40:43], v[56:59], v[96:99], v[40:43]
    v_mfma_f32_16x16x32_bf16 v[40:43], v[60:63], v[92:95], v[40:43]
    v_mfma_f32_16x16x32_bf16 v[40:43], v[64:67], v[88:91], v[40:43]
    v_mfma_f32_16x16x32_bf16 v[40:43], v[68:71], v[84:87], v[40:43]
    v_mfma_f32_16x16x32_bf16 v[40:43], v[72:75], v[80:83], v[40:43]
    v_mfma_f32_16x16x32_bf16 v[20:23], v[48:51], v[84:87], v[20:23]
    v_mfma_f32_16x16x32_bf16 v[20:23], v[52:55], v[80:83], v[20:23]
    s_waitcnt lgkmcnt(0)
    v_mfma_f32_16x16x32_bf16 v[40:43], v[112:115], v[168:171], v[40:43]
    v_mfma_f32_16x16x32_bf16 v[40:43], v[116:119], v[164:167], v[40:43]
    v_mfma_f32_16x16x32_bf16 v[40:43], v[120:123], v[160:163], v[40:43]
    v_mfma_f32_16x16x32_bf16 v[40:43], v[124:127], v[156:159], v[40:43]
    v_mfma_f32_16x16x32_bf16 v[40:43], v[128:131], v[152:155], v[40:43]
    v_mfma_f32_16x16x32_bf16 v[40:43], v[132:135], v[148:151], v[40:43]
    v_mfma_f32_16x16x32_bf16 v[40:43], v[136:139], v[144:147], v[40:43]
    v_mfma_f32_16x16x32_bf16 v[20:23], v[112:115], v[148:151], v[20:23]
    v_mfma_f32_16x16x32_bf16 v[20:23], v[116:119], v[144:147], v[20:23]
    v_lshlrev_b32 v3, 16, v3
    v_lshlrev_b32 v14, 5, v9
    v_lshlrev_b32 v15, 3, v10
    v_add_u32 v14, v14, v15
    v_sub_u32 v15, 8952, v14
    v_add_u32 v15, s31, v15
    v_add_u32 v14, s32, v14
    ds_read_b64 v[60:61], v15 offset:512
    ds_read_b64 v[50:51], v15 offset:3072
    s_waitcnt lgkmcnt(0)
    v_and_b32 v64, 0xffff0000, v61
    v_lshlrev_b32 v65, 16, v61
    v_and_b32 v66, 0xffff0000, v60
    v_lshlrev_b32 v67, 16, v60
    v_mul_f32 v64, v64, v3
    v_mul_f32 v65, v65, v3
    v_mul_f32 v66, v66, v3
    v_mul_f32 v67, v67, v3
    v_cvt_pk_bf16_f32 v68, v64, v65
    v_cvt_pk_bf16_f32 v69, v66, v67
    v_cvt_pk_bf16_f32 v70, v40, v41
    v_cvt_pk_bf16_f32 v71, v42, v43
    v_lshlrev_b32 v64, 16, v68
    v_and_b32 v65, 0xffff0000, v68
    v_lshlrev_b32 v66, 16, v69
    v_and_b32 v67, 0xffff0000, v69
    v_lshlrev_b32 v40, 16, v70
    v_and_b32 v41, 0xffff0000, v70
    v_lshlrev_b32 v42, 16, v71
    v_and_b32 v43, 0xffff0000, v71
    v_add_f32 v64, v64, v40
    v_add_f32 v65, v65, v41
    v_add_f32 v66, v66, v42
    v_add_f32 v67, v67, v43
    v_cvt_pk_bf16_f32 v40, v64, v65
    v_cvt_pk_bf16_f32 v41, v66, v67
    buffer_store_dwordx2 v[40:41], v14, s[24:27], 0 offen offset:3072 sc1
    v_and_b32 v72, 0xffff0000, v51
    v_lshlrev_b32 v73, 16, v51
    v_and_b32 v74, 0xffff0000, v50
    v_lshlrev_b32 v75, 16, v50
    v_mul_f32 v72, v72, v3
    v_mul_f32 v73, v73, v3
    v_mul_f32 v74, v74, v3
    v_mul_f32 v75, v75, v3
    v_cvt_pk_bf16_f32 v76, v72, v73
    v_cvt_pk_bf16_f32 v77, v74, v75
    v_cvt_pk_bf16_f32 v78, v20, v21
    v_cvt_pk_bf16_f32 v79, v22, v23
    v_lshlrev_b32 v72, 16, v76
    v_and_b32 v73, 0xffff0000, v76
    v_lshlrev_b32 v74, 16, v77
    v_and_b32 v75, 0xffff0000, v77
    v_lshlrev_b32 v20, 16, v78
    v_and_b32 v21, 0xffff0000, v78
    v_lshlrev_b32 v22, 16, v79
    v_and_b32 v23, 0xffff0000, v79
    v_add_f32 v72, v72, v20
    v_add_f32 v73, v73, v21
    v_add_f32 v74, v74, v22
    v_add_f32 v75, v75, v23
    v_cvt_pk_bf16_f32 v20, v72, v73
    v_cvt_pk_bf16_f32 v21, v74, v75
    buffer_store_dwordx2 v[20:21], v14, s[24:27], 0 offen offset:512 sc1
    s_branch L_g2_pub2
L_g2_q2:
    s_cmp_lg_u32 s40, 2
    s_cbranch_scc1 L_g2_q3
    v_add_u32 v8, s31, v2
    v_lshlrev_b32 v11, 1, v9
    v_add_u32 v11, v11, v12
    v_and_b32 v14, 1, v9
    v_cmp_eq_u32 vcc, 1, v14
    v_mov_b32 v14, 4224
    s_nop 1
    v_cndmask_b32 v14, v14, 2, vcc
    v_add_u32 v11, v11, v14
    v_add_u32 v11, s31, v11
    v_lshlrev_b32 v13, 5, v9
    v_sub_u32 v13, v12, v13
    v_add_u32 v13, 8928, v13
    v_add_u32 v13, s31, v13
    v_add_u32 v14, 960, v11
    v_add_u32 v15, 1920, v11
    v_add_u32 v202, 2880, v11
    v_add_u32 v203, 3840, v11
    v_mov_b32 v4, 0
    v_mov_b32 v5, 0
    v_mov_b32 v6, 0
    v_mov_b32 v7, 0
    s_mov_b32 exec_hi, 0
    ds_write_b128 v8, v[4:7] offset:12544
    s_mov_b32 exec_lo, 3
    ds_write_b128 v8, v[4:7]
    s_mov_b32 exec_lo, 1
    ds_write_b128 v8, v[4:7] offset:4224
    s_mov_b64 exec, -1
    v_mov_b32 v36, 0
    v_mov_b32 v37, 0
    v_mov_b32 v38, 0
    v_mov_b32 v39, 0
    v_mov_b32 v24, 0
    v_mov_b32 v25, 0
    v_mov_b32 v26, 0
    v_mov_b32 v27, 0
    ds_write_b128 v8, v[48:51] offset:32
    v_alignbit_b32 v112, v49, v48, 16
    v_alignbit_b32 v113, v50, v49, 16
    v_alignbit_b32 v114, v51, v50, 16
    v_alignbit_b32 v115, v52, v51, 16
    ds_write_b128 v8, v[112:115] offset:4256
    v_lshlrev_b32 v7, 16, v48
    s_mov_b64 exec, 1
    ds_write_b128 v8, v[4:7] offset:4240
    s_mov_b64 exec, -1
    ds_write_b128 v8, v[54:57] offset:1056
    v_alignbit_b32 v116, v55, v54, 16
    v_alignbit_b32 v117, v56, v55, 16
    v_alignbit_b32 v118, v57, v56, 16
    v_alignbit_b32 v119, v58, v57, 16
    ds_write_b128 v8, v[116:119] offset:5280
    ds_write_b128 v8, v[60:63] offset:2080
    v_alignbit_b32 v112, v61, v60, 16
    v_alignbit_b32 v113, v62, v61, 16
    v_alignbit_b32 v114, v63, v62, 16
    v_alignbit_b32 v115, v64, v63, 16
    ds_write_b128 v8, v[112:115] offset:6304
    ds_write_b128 v8, v[66:69] offset:3104
    v_alignbit_b32 v116, v67, v66, 16
    v_alignbit_b32 v117, v68, v67, 16
    v_alignbit_b32 v118, v69, v68, 16
    v_alignbit_b32 v119, v70, v69, 16
    ds_write_b128 v8, v[116:119] offset:7328
    s_waitcnt lgkmcnt(0)
    ds_read2_b32 v[48:49], v11 offset0:0 offset1:1
    ds_read2_b32 v[50:51], v11 offset0:2 offset1:3
    ds_read_b128 v[80:83], v13 offset:3584
    ds_read2_b32 v[52:53], v11 offset0:128 offset1:129
    ds_read2_b32 v[54:55], v11 offset0:130 offset1:131
    ds_read_b128 v[84:87], v13 offset:3072
    ds_read2_b32 v[56:57], v14 offset0:16 offset1:17
    ds_read2_b32 v[58:59], v14 offset0:18 offset1:19
    ds_read_b128 v[88:91], v13 offset:2560
    ds_read2_b32 v[60:61], v14 offset0:144 offset1:145
    ds_read2_b32 v[62:63], v14 offset0:146 offset1:147
    ds_read_b128 v[92:95], v13 offset:2048
    ds_read2_b32 v[64:65], v15 offset0:32 offset1:33
    ds_read2_b32 v[66:67], v15 offset0:34 offset1:35
    ds_read_b128 v[96:99], v13 offset:1536
    ds_read2_b32 v[68:69], v15 offset0:160 offset1:161
    ds_read2_b32 v[70:71], v15 offset0:162 offset1:163
    ds_read_b128 v[100:103], v13 offset:1024
    s_waitcnt lgkmcnt(0)
    ds_read2_b32 v[112:113], v11 offset0:16 offset1:17
    ds_read2_b32 v[114:115], v11 offset0:18 offset1:19
    ds_read_b128 v[144:147], v13 offset:3648
    ds_read2_b32 v[116:117], v11 offset0:144 offset1:145
    ds_read2_b32 v[118:119], v11 offset0:146 offset1:147
    ds_read_b128 v[148:151], v13 offset:3136
    ds_read2_b32 v[120:121], v14 offset0:32 offset1:33
    ds_read2_b32 v[122:123], v14 offset0:34 offset1:35
    ds_read_b128 v[152:155], v13 offset:2624
    ds_read2_b32 v[124:125], v14 offset0:160 offset1:161
    ds_read2_b32 v[126:127], v14 offset0:162 offset1:163
    ds_read_b128 v[156:159], v13 offset:2112
    ds_read2_b32 v[128:129], v15 offset0:48 offset1:49
    ds_read2_b32 v[130:131], v15 offset0:50 offset1:51
    ds_read_b128 v[160:163], v13 offset:1600
    ds_read2_b32 v[132:133], v15 offset0:176 offset1:177
    ds_read2_b32 v[134:135], v15 offset0:178 offset1:179
    ds_read_b128 v[164:167], v13 offset:1088
    v_mfma_f32_16x16x32_bf16 v[36:39], v[48:51], v[100:103], v[36:39]
    v_mfma_f32_16x16x32_bf16 v[36:39], v[52:55], v[96:99], v[36:39]
    v_mfma_f32_16x16x32_bf16 v[36:39], v[56:59], v[92:95], v[36:39]
    v_mfma_f32_16x16x32_bf16 v[36:39], v[60:63], v[88:91], v[36:39]
    v_mfma_f32_16x16x32_bf16 v[36:39], v[64:67], v[84:87], v[36:39]
    v_mfma_f32_16x16x32_bf16 v[36:39], v[68:71], v[80:83], v[36:39]
    v_mfma_f32_16x16x32_bf16 v[24:27], v[48:51], v[88:91], v[24:27]
    v_mfma_f32_16x16x32_bf16 v[24:27], v[52:55], v[84:87], v[24:27]
    v_mfma_f32_16x16x32_bf16 v[24:27], v[56:59], v[80:83], v[24:27]
    s_waitcnt lgkmcnt(0)
    ds_read2_b32 v[48:49], v11 offset0:32 offset1:33
    ds_read2_b32 v[50:51], v11 offset0:34 offset1:35
    ds_read_b128 v[80:83], v13 offset:3712
    ds_read2_b32 v[52:53], v11 offset0:160 offset1:161
    ds_read2_b32 v[54:55], v11 offset0:162 offset1:163
    ds_read_b128 v[84:87], v13 offset:3200
    ds_read2_b32 v[56:57], v14 offset0:48 offset1:49
    ds_read2_b32 v[58:59], v14 offset0:50 offset1:51
    ds_read_b128 v[88:91], v13 offset:2688
    ds_read2_b32 v[60:61], v14 offset0:176 offset1:177
    ds_read2_b32 v[62:63], v14 offset0:178 offset1:179
    ds_read_b128 v[92:95], v13 offset:2176
    ds_read2_b32 v[64:65], v15 offset0:64 offset1:65
    ds_read2_b32 v[66:67], v15 offset0:66 offset1:67
    ds_read_b128 v[96:99], v13 offset:1664
    ds_read2_b32 v[68:69], v15 offset0:192 offset1:193
    ds_read2_b32 v[70:71], v15 offset0:194 offset1:195
    ds_read_b128 v[100:103], v13 offset:1152
    v_mfma_f32_16x16x32_bf16 v[36:39], v[112:115], v[164:167], v[36:39]
    v_mfma_f32_16x16x32_bf16 v[36:39], v[116:119], v[160:163], v[36:39]
    v_mfma_f32_16x16x32_bf16 v[36:39], v[120:123], v[156:159], v[36:39]
    v_mfma_f32_16x16x32_bf16 v[36:39], v[124:127], v[152:155], v[36:39]
    v_mfma_f32_16x16x32_bf16 v[36:39], v[128:131], v[148:151], v[36:39]
    v_mfma_f32_16x16x32_bf16 v[36:39], v[132:135], v[144:147], v[36:39]
    v_mfma_f32_16x16x32_bf16 v[24:27], v[112:115], v[152:155], v[24:27]
    v_mfma_f32_16x16x32_bf16 v[24:27], v[116:119], v[148:151], v[24:27]
    v_mfma_f32_16x16x32_bf16 v[24:27], v[120:123], v[144:147], v[24:27]
    s_waitcnt lgkmcnt(0)
    ds_read2_b32 v[112:113], v11 offset0:48 offset1:49
    ds_read2_b32 v[114:115], v11 offset0:50 offset1:51
    ds_read_b128 v[144:147], v13 offset:3776
    ds_read2_b32 v[116:117], v11 offset0:176 offset1:177
    ds_read2_b32 v[118:119], v11 offset0:178 offset1:179
    ds_read_b128 v[148:151], v13 offset:3264
    ds_read2_b32 v[120:121], v14 offset0:64 offset1:65
    ds_read2_b32 v[122:123], v14 offset0:66 offset1:67
    ds_read_b128 v[152:155], v13 offset:2752
    ds_read2_b32 v[124:125], v14 offset0:192 offset1:193
    ds_read2_b32 v[126:127], v14 offset0:194 offset1:195
    ds_read_b128 v[156:159], v13 offset:2240
    ds_read2_b32 v[128:129], v15 offset0:80 offset1:81
    ds_read2_b32 v[130:131], v15 offset0:82 offset1:83
    ds_read_b128 v[160:163], v13 offset:1728
    ds_read2_b32 v[132:133], v15 offset0:208 offset1:209
    ds_read2_b32 v[134:135], v15 offset0:210 offset1:211
    ds_read_b128 v[164:167], v13 offset:1216
    v_mfma_f32_16x16x32_bf16 v[36:39], v[48:51], v[100:103], v[36:39]
    v_mfma_f32_16x16x32_bf16 v[36:39], v[52:55], v[96:99], v[36:39]
    v_mfma_f32_16x16x32_bf16 v[36:39], v[56:59], v[92:95], v[36:39]
    v_mfma_f32_16x16x32_bf16 v[36:39], v[60:63], v[88:91], v[36:39]
    v_mfma_f32_16x16x32_bf16 v[36:39], v[64:67], v[84:87], v[36:39]
    v_mfma_f32_16x16x32_bf16 v[36:39], v[68:71], v[80:83], v[36:39]
    v_mfma_f32_16x16x32_bf16 v[24:27], v[48:51], v[88:91], v[24:27]
    v_mfma_f32_16x16x32_bf16 v[24:27], v[52:55], v[84:87], v[24:27]
    v_mfma_f32_16x16x32_bf16 v[24:27], v[56:59], v[80:83], v[24:27]
    s_waitcnt lgkmcnt(0)
    ds_read2_b32 v[48:49], v11 offset0:64 offset1:65
    ds_read2_b32 v[50:51], v11 offset0:66 offset1:67
    ds_read_b128 v[80:83], v13 offset:3840
    ds_read2_b32 v[52:53], v11 offset0:192 offset1:193
    ds_read2_b32 v[54:55], v11 offset0:194 offset1:195
    ds_read_b128 v[84:87], v13 offset:3328
    ds_read2_b32 v[56:57], v14 offset0:80 offset1:81
    ds_read2_b32 v[58:59], v14 offset0:82 offset1:83
    ds_read_b128 v[88:91], v13 offset:2816
    ds_read2_b32 v[60:61], v14 offset0:208 offset1:209
    ds_read2_b32 v[62:63], v14 offset0:210 offset1:211
    ds_read_b128 v[92:95], v13 offset:2304
    ds_read2_b32 v[64:65], v15 offset0:96 offset1:97
    ds_read2_b32 v[66:67], v15 offset0:98 offset1:99
    ds_read_b128 v[96:99], v13 offset:1792
    ds_read2_b32 v[68:69], v15 offset0:224 offset1:225
    ds_read2_b32 v[70:71], v15 offset0:226 offset1:227
    ds_read_b128 v[100:103], v13 offset:1280
    v_mfma_f32_16x16x32_bf16 v[36:39], v[112:115], v[164:167], v[36:39]
    v_mfma_f32_16x16x32_bf16 v[36:39], v[116:119], v[160:163], v[36:39]
    v_mfma_f32_16x16x32_bf16 v[36:39], v[120:123], v[156:159], v[36:39]
    v_mfma_f32_16x16x32_bf16 v[36:39], v[124:127], v[152:155], v[36:39]
    v_mfma_f32_16x16x32_bf16 v[36:39], v[128:131], v[148:151], v[36:39]
    v_mfma_f32_16x16x32_bf16 v[36:39], v[132:135], v[144:147], v[36:39]
    v_mfma_f32_16x16x32_bf16 v[24:27], v[112:115], v[152:155], v[24:27]
    v_mfma_f32_16x16x32_bf16 v[24:27], v[116:119], v[148:151], v[24:27]
    v_mfma_f32_16x16x32_bf16 v[24:27], v[120:123], v[144:147], v[24:27]
    s_waitcnt lgkmcnt(0)
    ds_read2_b32 v[112:113], v11 offset0:80 offset1:81
    ds_read2_b32 v[114:115], v11 offset0:82 offset1:83
    ds_read_b128 v[144:147], v13 offset:3904
    ds_read2_b32 v[116:117], v11 offset0:208 offset1:209
    ds_read2_b32 v[118:119], v11 offset0:210 offset1:211
    ds_read_b128 v[148:151], v13 offset:3392
    ds_read2_b32 v[120:121], v14 offset0:96 offset1:97
    ds_read2_b32 v[122:123], v14 offset0:98 offset1:99
    ds_read_b128 v[152:155], v13 offset:2880
    ds_read2_b32 v[124:125], v14 offset0:224 offset1:225
    ds_read2_b32 v[126:127], v14 offset0:226 offset1:227
    ds_read_b128 v[156:159], v13 offset:2368
    ds_read2_b32 v[128:129], v15 offset0:112 offset1:113
    ds_read2_b32 v[130:131], v15 offset0:114 offset1:115
    ds_read_b128 v[160:163], v13 offset:1856
    ds_read2_b32 v[132:133], v202 offset0:0 offset1:1
    ds_read2_b32 v[134:135], v202 offset0:2 offset1:3
    ds_read_b128 v[164:167], v13 offset:1344
    v_mfma_f32_16x16x32_bf16 v[36:39], v[48:51], v[100:103], v[36:39]
    v_mfma_f32_16x16x32_bf16 v[36:39], v[52:55], v[96:99], v[36:39]
    v_mfma_f32_16x16x32_bf16 v[36:39], v[56:59], v[92:95], v[36:39]
    v_mfma_f32_16x16x32_bf16 v[36:39], v[60:63], v[88:91], v[36:39]
    v_mfma_f32_16x16x32_bf16 v[36:39], v[64:67], v[84:87], v[36:39]
    v_mfma_f32_16x16x32_bf16 v[36:39], v[68:71], v[80:83], v[36:39]
    v_mfma_f32_16x16x32_bf16 v[24:27], v[48:51], v[88:91], v[24:27]
    v_mfma_f32_16x16x32_bf16 v[24:27], v[52:55], v[84:87], v[24:27]
    v_mfma_f32_16x16x32_bf16 v[24:27], v[56:59], v[80:83], v[24:27]
    s_waitcnt lgkmcnt(0)
    ds_read2_b32 v[48:49], v11 offset0:96 offset1:97
    ds_read2_b32 v[50:51], v11 offset0:98 offset1:99
    ds_read_b128 v[80:83], v13 offset:3968
    ds_read2_b32 v[52:53], v11 offset0:224 offset1:225
    ds_read2_b32 v[54:55], v11 offset0:226 offset1:227
    ds_read_b128 v[84:87], v13 offset:3456
    ds_read2_b32 v[56:57], v14 offset0:112 offset1:113
    ds_read2_b32 v[58:59], v14 offset0:114 offset1:115
    ds_read_b128 v[88:91], v13 offset:2944
    ds_read2_b32 v[60:61], v15 offset0:0 offset1:1
    ds_read2_b32 v[62:63], v15 offset0:2 offset1:3
    ds_read_b128 v[92:95], v13 offset:2432
    ds_read2_b32 v[64:65], v15 offset0:128 offset1:129
    ds_read2_b32 v[66:67], v15 offset0:130 offset1:131
    ds_read_b128 v[96:99], v13 offset:1920
    ds_read2_b32 v[68:69], v202 offset0:16 offset1:17
    ds_read2_b32 v[70:71], v202 offset0:18 offset1:19
    ds_read_b128 v[100:103], v13 offset:1408
    v_mfma_f32_16x16x32_bf16 v[36:39], v[112:115], v[164:167], v[36:39]
    v_mfma_f32_16x16x32_bf16 v[36:39], v[116:119], v[160:163], v[36:39]
    v_mfma_f32_16x16x32_bf16 v[36:39], v[120:123], v[156:159], v[36:39]
    v_mfma_f32_16x16x32_bf16 v[36:39], v[124:127], v[152:155], v[36:39]
    v_mfma_f32_16x16x32_bf16 v[36:39], v[128:131], v[148:151], v[36:39]
    v_mfma_f32_16x16x32_bf16 v[36:39], v[132:135], v[144:147], v[36:39]
    v_mfma_f32_16x16x32_bf16 v[24:27], v[112:115], v[152:155], v[24:27]
    v_mfma_f32_16x16x32_bf16 v[24:27], v[116:119], v[148:151], v[24:27]
    v_mfma_f32_16x16x32_bf16 v[24:27], v[120:123], v[144:147], v[24:27]
    s_waitcnt lgkmcnt(0)
    ds_read2_b32 v[112:113], v11 offset0:112 offset1:113
    ds_read2_b32 v[114:115], v11 offset0:114 offset1:115
    ds_read_b128 v[144:147], v13 offset:4032
    ds_read2_b32 v[116:117], v14 offset0:0 offset1:1
    ds_read2_b32 v[118:119], v14 offset0:2 offset1:3
    ds_read_b128 v[148:151], v13 offset:3520
    ds_read2_b32 v[120:121], v14 offset0:128 offset1:129
    ds_read2_b32 v[122:123], v14 offset0:130 offset1:131
    ds_read_b128 v[152:155], v13 offset:3008
    ds_read2_b32 v[124:125], v15 offset0:16 offset1:17
    ds_read2_b32 v[126:127], v15 offset0:18 offset1:19
    ds_read_b128 v[156:159], v13 offset:2496
    ds_read2_b32 v[128:129], v15 offset0:144 offset1:145
    ds_read2_b32 v[130:131], v15 offset0:146 offset1:147
    ds_read_b128 v[160:163], v13 offset:1984
    ds_read2_b32 v[132:133], v202 offset0:32 offset1:33
    ds_read2_b32 v[134:135], v202 offset0:34 offset1:35
    ds_read_b128 v[164:167], v13 offset:1472
    v_mfma_f32_16x16x32_bf16 v[36:39], v[48:51], v[100:103], v[36:39]
    v_mfma_f32_16x16x32_bf16 v[36:39], v[52:55], v[96:99], v[36:39]
    v_mfma_f32_16x16x32_bf16 v[36:39], v[56:59], v[92:95], v[36:39]
    v_mfma_f32_16x16x32_bf16 v[36:39], v[60:63], v[88:91], v[36:39]
    v_mfma_f32_16x16x32_bf16 v[36:39], v[64:67], v[84:87], v[36:39]
    v_mfma_f32_16x16x32_bf16 v[36:39], v[68:71], v[80:83], v[36:39]
    v_mfma_f32_16x16x32_bf16 v[24:27], v[48:51], v[88:91], v[24:27]
    v_mfma_f32_16x16x32_bf16 v[24:27], v[52:55], v[84:87], v[24:27]
    v_mfma_f32_16x16x32_bf16 v[24:27], v[56:59], v[80:83], v[24:27]
    s_waitcnt lgkmcnt(0)
    v_mfma_f32_16x16x32_bf16 v[36:39], v[112:115], v[164:167], v[36:39]
    v_mfma_f32_16x16x32_bf16 v[36:39], v[116:119], v[160:163], v[36:39]
    v_mfma_f32_16x16x32_bf16 v[36:39], v[120:123], v[156:159], v[36:39]
    v_mfma_f32_16x16x32_bf16 v[36:39], v[124:127], v[152:155], v[36:39]
    v_mfma_f32_16x16x32_bf16 v[36:39], v[128:131], v[148:151], v[36:39]
    v_mfma_f32_16x16x32_bf16 v[36:39], v[132:135], v[144:147], v[36:39]
    v_mfma_f32_16x16x32_bf16 v[24:27], v[112:115], v[152:155], v[24:27]
    v_mfma_f32_16x16x32_bf16 v[24:27], v[116:119], v[148:151], v[24:27]
    v_mfma_f32_16x16x32_bf16 v[24:27], v[120:123], v[144:147], v[24:27]
    v_lshlrev_b32 v3, 16, v3
    v_lshlrev_b32 v14, 5, v9
    v_lshlrev_b32 v15, 3, v10
    v_add_u32 v14, v14, v15
    v_sub_u32 v15, 8952, v14
    v_add_u32 v15, s31, v15
    v_add_u32 v14, s32, v14
    ds_read_b64 v[58:59], v15 offset:1024
    ds_read_b64 v[52:53], v15 offset:2560
    s_waitcnt lgkmcnt(0)
    v_and_b32 v64, 0xffff0000, v59
    v_lshlrev_b32 v65, 16, v59
    v_and_b32 v66, 0xffff0000, v58
    v_lshlrev_b32 v67, 16, v58
    v_mul_f32 v64, v64, v3
    v_mul_f32 v65, v65, v3
    v_mul_f32 v66, v66, v3
    v_mul_f32 v67, v67, v3
    v_cvt_pk_bf16_f32 v68, v64, v65
    v_cvt_pk_bf16_f32 v69, v66, v67
    v_cvt_pk_bf16_f32 v70, v36, v37
    v_cvt_pk_bf16_f32 v71, v38, v39
    v_lshlrev_b32 v64, 16, v68
    v_and_b32 v65, 0xffff0000, v68
    v_lshlrev_b32 v66, 16, v69
    v_and_b32 v67, 0xffff0000, v69
    v_lshlrev_b32 v36, 16, v70
    v_and_b32 v37, 0xffff0000, v70
    v_lshlrev_b32 v38, 16, v71
    v_and_b32 v39, 0xffff0000, v71
    v_add_f32 v64, v64, v36
    v_add_f32 v65, v65, v37
    v_add_f32 v66, v66, v38
    v_add_f32 v67, v67, v39
    v_cvt_pk_bf16_f32 v36, v64, v65
    v_cvt_pk_bf16_f32 v37, v66, v67
    buffer_store_dwordx2 v[36:37], v14, s[24:27], 0 offen offset:2560 sc1
    v_and_b32 v72, 0xffff0000, v53
    v_lshlrev_b32 v73, 16, v53
    v_and_b32 v74, 0xffff0000, v52
    v_lshlrev_b32 v75, 16, v52
    v_mul_f32 v72, v72, v3
    v_mul_f32 v73, v73, v3
    v_mul_f32 v74, v74, v3
    v_mul_f32 v75, v75, v3
    v_cvt_pk_bf16_f32 v76, v72, v73
    v_cvt_pk_bf16_f32 v77, v74, v75
    v_cvt_pk_bf16_f32 v78, v24, v25
    v_cvt_pk_bf16_f32 v79, v26, v27
    v_lshlrev_b32 v72, 16, v76
    v_and_b32 v73, 0xffff0000, v76
    v_lshlrev_b32 v74, 16, v77
    v_and_b32 v75, 0xffff0000, v77
    v_lshlrev_b32 v24, 16, v78
    v_and_b32 v25, 0xffff0000, v78
    v_lshlrev_b32 v26, 16, v79
    v_and_b32 v27, 0xffff0000, v79
    v_add_f32 v72, v72, v24
    v_add_f32 v73, v73, v25
    v_add_f32 v74, v74, v26
    v_add_f32 v75, v75, v27
    v_cvt_pk_bf16_f32 v24, v72, v73
    v_cvt_pk_bf16_f32 v25, v74, v75
    buffer_store_dwordx2 v[24:25], v14, s[24:27], 0 offen offset:1024 sc1
    s_branch L_g2_pub2
L_g2_q3:
    v_add_u32 v8, s31, v2
    v_lshlrev_b32 v11, 1, v9
    v_add_u32 v11, v11, v12
    v_and_b32 v14, 1, v9
    v_cmp_eq_u32 vcc, 1, v14
    v_mov_b32 v14, 4224
    s_nop 1
    v_cndmask_b32 v14, v14, 2, vcc
    v_add_u32 v11, v11, v14
    v_add_u32 v11, s31, v11
    v_lshlrev_b32 v13, 5, v9
    v_sub_u32 v13, v12, v13
    v_add_u32 v13, 8928, v13
    v_add_u32 v13, s31, v13
    v_add_u32 v14, 960, v11
    v_add_u32 v15, 1920, v11
    v_add_u32 v202, 2880, v11
    v_add_u32 v203, 3840, v11
    v_mov_b32 v4, 0
    v_mov_b32 v5, 0
    v_mov_b32 v6, 0
    v_mov_b32 v7, 0
    s_mov_b32 exec_hi, 0
    ds_write_b128 v8, v[4:7] offset:12544
    s_mov_b32 exec_lo, 3
    ds_write_b128 v8, v[4:7]
    s_mov_b32 exec_lo, 1
    ds_write_b128 v8, v[4:7] offset:4224
    s_mov_b64 exec, -1
    v_mov_b32 v32, 0
    v_mov_b32 v33, 0
    v_mov_b32 v34, 0
    v_mov_b32 v35, 0
    v_mov_b32 v28, 0
    v_mov_b32 v29, 0
    v_mov_b32 v30, 0
    v_mov_b32 v31, 0
    ds_write_b128 v8, v[48:51] offset:32
    v_alignbit_b32 v112, v49, v48, 16
    v_alignbit_b32 v113, v50, v49, 16
    v_alignbit_b32 v114, v51, v50, 16
    v_alignbit_b32 v115, v52, v51, 16
    ds_write_b128 v8, v[112:115] offset:4256
    v_lshlrev_b32 v7, 16, v48
    s_mov_b64 exec, 1
    ds_write_b128 v8, v[4:7] offset:4240
    s_mov_b64 exec, -1
    ds_write_b128 v8, v[54:57] offset:1056
    v_alignbit_b32 v116, v55, v54, 16
    v_alignbit_b32 v117, v56, v55, 16
    v_alignbit_b32 v118, v57, v56, 16
    v_alignbit_b32 v119, v58, v57, 16
    ds_write_b128 v8, v[116:119] offset:5280
    ds_write_b128 v8, v[60:63] offset:2080
    v_alignbit_b32 v112, v61, v60, 16
    v_alignbit_b32 v113, v62, v61, 16
    v_alignbit_b32 v114, v63, v62, 16
    v_alignbit_b32 v115, v64, v63, 16
    ds_write_b128 v8, v[112:115] offset:6304
    ds_write_b128 v8, v[66:69] offset:3104
    v_alignbit_b32 v116, v67, v66, 16
    v_alignbit_b32 v117, v68, v67, 16
    v_alignbit_b32 v118, v69, v68, 16
    v_alignbit_b32 v119, v70, v69, 16
    ds_write_b128 v8, v[116:119] offset:7328
    s_waitcnt lgkmcnt(0)
    ds_read2_b32 v[48:49], v11 offset0:0 offset1:1
    ds_read2_b32 v[50:51], v11 offset0:2 offset1:3
    ds_read_b128 v[80:83], v13 offset:3584
    ds_read2_b32 v[52:53], v11 offset0:128 offset1:129
    ds_read2_b32 v[54:55], v11 offset0:130 offset1:131
    ds_read_b128 v[84:87], v13 offset:3072
    ds_read2_b32 v[56:57], v14 offset0:16 offset1:17
    ds_read2_b32 v[58:59], v14 offset0:18 offset1:19
    ds_read_b128 v[88:91], v13 offset:2560
    ds_read2_b32 v[60:61], v14 offset0:144 offset1:145
    ds_read2_b32 v[62:63], v14 offset0:146 offset1:147
    ds_read_b128 v[92:95], v13 offset:2048
    ds_read2_b32 v[64:65], v15 offset0:32 offset1:33
    ds_read2_b32 v[66:67], v15 offset0:34 offset1:35
    ds_read_b128 v[96:99], v13 offset:1536
    s_waitcnt lgkmcnt(0)
    ds_read2_b32 v[112:113], v11 offset0:16 offset1:17
    ds_read2_b32 v[114:115], v11 offset0:18 offset1:19
    ds_read_b128 v[144:147], v13 offset:3648
    ds_read2_b32 v[116:117], v11 offset0:144 offset1:145
    ds_read2_b32 v[118:119], v11 offset0:146 offset1:147
    ds_read_b128 v[148:151], v13 offset:3136
    ds_read2_b32 v[120:121], v14 offset0:32 offset1:33
    ds_read2_b32 v[122:123], v14 offset0:34 offset1:35
    ds_read_b128 v[152:155], v13 offset:2624
    ds_read2_b32 v[124:125], v14 offset0:160 offset1:161
    ds_read2_b32 v[126:127], v14 offset0:162 offset1:163
    ds_read_b128 v[156:159], v13 offset:2112
    ds_read2_b32 v[128:129], v15 offset0:48 offset1:49
    ds_read2_b32 v[130:131], v15 offset0:50 offset1:51
    ds_read_b128 v[160:163], v13 offset:1600
    v_mfma_f32_16x16x32_bf16 v[32:35], v[48:51], v[96:99], v[32:35]
    v_mfma_f32_16x16x32_bf16 v[32:35], v[52:55], v[92:95], v[32:35]
    v_mfma_f32_16x16x32_bf16 v[32:35], v[56:59], v[88:91], v[32:35]
    v_mfma_f32_16x16x32_bf16 v[32:35], v[60:63], v[84:87], v[32:35]
    v_mfma_f32_16x16x32_bf16 v[32:35], v[64:67], v[80:83], v[32:35]
    v_mfma_f32_16x16x32_bf16 v[28:31], v[48:51], v[92:95], v[28:31]
    v_mfma_f32_16x16x32_bf16 v[28:31], v[52:55], v[88:91], v[28:31]
    v_mfma_f32_16x16x32_bf16 v[28:31], v[56:59], v[84:87], v[28:31]
    v_mfma_f32_16x16x32_bf16 v[28:31], v[60:63], v[80:83], v[28:31]
    s_waitcnt lgkmcnt(0)
    ds_read2_b32 v[48:49], v11 offset0:32 offset1:33
    ds_read2_b32 v[50:51], v11 offset0:34 offset1:35
    ds_read_b128 v[80:83], v13 offset:3712
    ds_read2_b32 v[52:53], v11 offset0:160 offset1:161
    ds_read2_b32 v[54:55], v11 offset0:162 offset1:163
    ds_read_b128 v[84:87], v13 offset:3200
    ds_read2_b32 v[56:57], v14 offset0:48 offset1:49
    ds_read2_b32 v[58:59], v14 offset0:50 offset1:51
    ds_read_b128 v[88:91], v13 offset:2688
    ds_read2_b32 v[60:61], v14 offset0:176 offset1:177
    ds_read2_b32 v[62:63], v14 offset0:178 offset1:179
    ds_read_b128 v[92:95], v13 offset:2176
    ds_read2_b32 v[64:65], v15 offset0:64 offset1:65
    ds_read2_b32 v[66:67], v15 offset0:66 offset1:67
    ds_read_b128 v[96:99], v13 offset:1664
    v_mfma_f32_16x16x32_bf16 v[32:35], v[112:115], v[160:163], v[32:35]
    v_mfma_f32_16x16x32_bf16 v[32:35], v[116:119], v[156:159], v[32:35]
    v_mfma_f32_16x16x32_bf16 v[32:35], v[120:123], v[152:155], v[32:35]
    v_mfma_f32_16x16x32_bf16 v[32:35], v[124:127], v[148:151], v[32:35]
    v_mfma_f32_16x16x32_bf16 v[32:35], v[128:131], v[144:147], v[32:35]
    v_mfma_f32_16x16x32_bf16 v[28:31], v[112:115], v[156:159], v[28:31]
    v_mfma_f32_16x16x32_bf16 v[28:31], v[116:119], v[152:155], v[28:31]
    v_mfma_f32_16x16x32_bf16 v[28:31], v[120:123], v[148:151], v[28:31]
    v_mfma_f32_16x16x32_bf16 v[28:31], v[124:127], v[144:147], v[28:31]
    s_waitcnt lgkmcnt(0)
    ds_read2_b32 v[112:113], v11 offset0:48 offset1:49
    ds_read2_b32 v[114:115], v11 offset0:50 offset1:51
    ds_read_b128 v[144:147], v13 offset:3776
    ds_read2_b32 v[116:117], v11 offset0:176 offset1:177
    ds_read2_b32 v[118:119], v11 offset0:178 offset1:179
    ds_read_b128 v[148:151], v13 offset:3264
    ds_read2_b32 v[120:121], v14 offset0:64 offset1:65
    ds_read2_b32 v[122:123], v14 offset0:66 offset1:67
    ds_read_b128 v[152:155], v13 offset:2752
    ds_read2_b32 v[124:125], v14 offset0:192 offset1:193
    ds_read2_b32 v[126:127], v14 offset0:194 offset1:195
    ds_read_b128 v[156:159], v13 offset:2240
    ds_read2_b32 v[128:129], v15 offset0:80 offset1:81
    ds_read2_b32 v[130:131], v15 offset0:82 offset1:83
    ds_read_b128 v[160:163], v13 offset:1728
    v_mfma_f32_16x16x32_bf16 v[32:35], v[48:51], v[96:99], v[32:35]
    v_mfma_f32_16x16x32_bf16 v[32:35], v[52:55], v[92:95], v[32:35]
    v_mfma_f32_16x16x32_bf16 v[32:35], v[56:59], v[88:91], v[32:35]
    v_mfma_f32_16x16x32_bf16 v[32:35], v[60:63], v[84:87], v[32:35]
    v_mfma_f32_16x16x32_bf16 v[32:35], v[64:67], v[80:83], v[32:35]
    v_mfma_f32_16x16x32_bf16 v[28:31], v[48:51], v[92:95], v[28:31]
    v_mfma_f32_16x16x32_bf16 v[28:31], v[52:55], v[88:91], v[28:31]
    v_mfma_f32_16x16x32_bf16 v[28:31], v[56:59], v[84:87], v[28:31]
    v_mfma_f32_16x16x32_bf16 v[28:31], v[60:63], v[80:83], v[28:31]
    s_waitcnt lgkmcnt(0)
    ds_read2_b32 v[48:49], v11 offset0:64 offset1:65
    ds_read2_b32 v[50:51], v11 offset0:66 offset1:67
    ds_read_b128 v[80:83], v13 offset:3840
    ds_read2_b32 v[52:53], v11 offset0:192 offset1:193
    ds_read2_b32 v[54:55], v11 offset0:194 offset1:195
    ds_read_b128 v[84:87], v13 offset:3328
    ds_read2_b32 v[56:57], v14 offset0:80 offset1:81
    ds_read2_b32 v[58:59], v14 offset0:82 offset1:83
    ds_read_b128 v[88:91], v13 offset:2816
    ds_read2_b32 v[60:61], v14 offset0:208 offset1:209
    ds_read2_b32 v[62:63], v14 offset0:210 offset1:211
    ds_read_b128 v[92:95], v13 offset:2304
    ds_read2_b32 v[64:65], v15 offset0:96 offset1:97
    ds_read2_b32 v[66:67], v15 offset0:98 offset1:99
    ds_read_b128 v[96:99], v13 offset:1792
    v_mfma_f32_16x16x32_bf16 v[32:35], v[112:115], v[160:163], v[32:35]
    v_mfma_f32_16x16x32_bf16 v[32:35], v[116:119], v[156:159], v[32:35]
    v_mfma_f32_16x16x32_bf16 v[32:35], v[120:123], v[152:155], v[32:35]
    v_mfma_f32_16x16x32_bf16 v[32:35], v[124:127], v[148:151], v[32:35]
    v_mfma_f32_16x16x32_bf16 v[32:35], v[128:131], v[144:147], v[32:35]
    v_mfma_f32_16x16x32_bf16 v[28:31], v[112:115], v[156:159], v[28:31]
    v_mfma_f32_16x16x32_bf16 v[28:31], v[116:119], v[152:155], v[28:31]
    v_mfma_f32_16x16x32_bf16 v[28:31], v[120:123], v[148:151], v[28:31]
    v_mfma_f32_16x16x32_bf16 v[28:31], v[124:127], v[144:147], v[28:31]
    s_waitcnt lgkmcnt(0)
    ds_read2_b32 v[112:113], v11 offset0:80 offset1:81
    ds_read2_b32 v[114:115], v11 offset0:82 offset1:83
    ds_read_b128 v[144:147], v13 offset:3904
    ds_read2_b32 v[116:117], v11 offset0:208 offset1:209
    ds_read2_b32 v[118:119], v11 offset0:210 offset1:211
    ds_read_b128 v[148:151], v13 offset:3392
    ds_read2_b32 v[120:121], v14 offset0:96 offset1:97
    ds_read2_b32 v[122:123], v14 offset0:98 offset1:99
    ds_read_b128 v[152:155], v13 offset:2880
    ds_read2_b32 v[124:125], v14 offset0:224 offset1:225
    ds_read2_b32 v[126:127], v14 offset0:226 offset1:227
    ds_read_b128 v[156:159], v13 offset:2368
    ds_read2_b32 v[128:129], v15 offset0:112 offset1:113
    ds_read2_b32 v[130:131], v15 offset0:114 offset1:115
    ds_read_b128 v[160:163], v13 offset:1856
    v_mfma_f32_16x16x32_bf16 v[32:35], v[48:51], v[96:99], v[32:35]
    v_mfma_f32_16x16x32_bf16 v[32:35], v[52:55], v[92:95], v[32:35]
    v_mfma_f32_16x16x32_bf16 v[32:35], v[56:59], v[88:91], v[32:35]
    v_mfma_f32_16x16x32_bf16 v[32:35], v[60:63], v[84:87], v[32:35]
    v_mfma_f32_16x16x32_bf16 v[32:35], v[64:67], v[80:83], v[32:35]
    v_mfma_f32_16x16x32_bf16 v[28:31], v[48:51], v[92:95], v[28:31]
    v_mfma_f32_16x16x32_bf16 v[28:31], v[52:55], v[88:91], v[28:31]
    v_mfma_f32_16x16x32_bf16 v[28:31], v[56:59], v[84:87], v[28:31]
    v_mfma_f32_16x16x32_bf16 v[28:31], v[60:63], v[80:83], v[28:31]
    s_waitcnt lgkmcnt(0)
    ds_read2_b32 v[48:49], v11 offset0:96 offset1:97
    ds_read2_b32 v[50:51], v11 offset0:98 offset1:99
    ds_read_b128 v[80:83], v13 offset:3968
    ds_read2_b32 v[52:53], v11 offset0:224 offset1:225
    ds_read2_b32 v[54:55], v11 offset0:226 offset1:227
    ds_read_b128 v[84:87], v13 offset:3456
    ds_read2_b32 v[56:57], v14 offset0:112 offset1:113
    ds_read2_b32 v[58:59], v14 offset0:114 offset1:115
    ds_read_b128 v[88:91], v13 offset:2944
    ds_read2_b32 v[60:61], v15 offset0:0 offset1:1
    ds_read2_b32 v[62:63], v15 offset0:2 offset1:3
    ds_read_b128 v[92:95], v13 offset:2432
    ds_read2_b32 v[64:65], v15 offset0:128 offset1:129
    ds_read2_b32 v[66:67], v15 offset0:130 offset1:131
    ds_read_b128 v[96:99], v13 offset:1920
    v_mfma_f32_16x16x32_bf16 v[32:35], v[112:115], v[160:163], v[32:35]
    v_mfma_f32_16x16x32_bf16 v[32:35], v[116:119], v[156:159], v[32:35]
    v_mfma_f32_16x16x32_bf16 v[32:35], v[120:123], v[152:155], v[32:35]
    v_mfma_f32_16x16x32_bf16 v[32:35], v[124:127], v[148:151], v[32:35]
    v_mfma_f32_16x16x32_bf16 v[32:35], v[128:131], v[144:147], v[32:35]
    v_mfma_f32_16x16x32_bf16 v[28:31], v[112:115], v[156:159], v[28:31]
    v_mfma_f32_16x16x32_bf16 v[28:31], v[116:119], v[152:155], v[28:31]
    v_mfma_f32_16x16x32_bf16 v[28:31], v[120:123], v[148:151], v[28:31]
    v_mfma_f32_16x16x32_bf16 v[28:31], v[124:127], v[144:147], v[28:31]
    s_waitcnt lgkmcnt(0)
    ds_read2_b32 v[112:113], v11 offset0:112 offset1:113
    ds_read2_b32 v[114:115], v11 offset0:114 offset1:115
    ds_read_b128 v[144:147], v13 offset:4032
    ds_read2_b32 v[116:117], v14 offset0:0 offset1:1
    ds_read2_b32 v[118:119], v14 offset0:2 offset1:3
    ds_read_b128 v[148:151], v13 offset:3520
    ds_read2_b32 v[120:121], v14 offset0:128 offset1:129
    ds_read2_b32 v[122:123], v14 offset0:130 offset1:131
    ds_read_b128 v[152:155], v13 offset:3008
    ds_read2_b32 v[124:125], v15 offset0:16 offset1:17
    ds_read2_b32 v[126:127], v15 offset0:18 offset1:19
    ds_read_b128 v[156:159], v13 offset:2496
    ds_read2_b32 v[128:129], v15 offset0:144 offset1:145
    ds_read2_b32 v[130:131], v15 offset0:146 offset1:147
    ds_read_b128 v[160:163], v13 offset:1984
    v_mfma_f32_16x16x32_bf16 v[32:35], v[48:51], v[96:99], v[32:35]
    v_mfma_f32_16x16x32_bf16 v[32:35], v[52:55], v[92:95], v[32:35]
    v_mfma_f32_16x16x32_bf16 v[32:35], v[56:59], v[88:91], v[32:35]
    v_mfma_f32_16x16x32_bf16 v[32:35], v[60:63], v[84:87], v[32:35]
    v_mfma_f32_16x16x32_bf16 v[32:35], v[64:67], v[80:83], v[32:35]
    v_mfma_f32_16x16x32_bf16 v[28:31], v[48:51], v[92:95], v[28:31]
    v_mfma_f32_16x16x32_bf16 v[28:31], v[52:55], v[88:91], v[28:31]
    v_mfma_f32_16x16x32_bf16 v[28:31], v[56:59], v[84:87], v[28:31]
    v_mfma_f32_16x16x32_bf16 v[28:31], v[60:63], v[80:83], v[28:31]
    s_waitcnt lgkmcnt(0)
    v_mfma_f32_16x16x32_bf16 v[32:35], v[112:115], v[160:163], v[32:35]
    v_mfma_f32_16x16x32_bf16 v[32:35], v[116:119], v[156:159], v[32:35]
    v_mfma_f32_16x16x32_bf16 v[32:35], v[120:123], v[152:155], v[32:35]
    v_mfma_f32_16x16x32_bf16 v[32:35], v[124:127], v[148:151], v[32:35]
    v_mfma_f32_16x16x32_bf16 v[32:35], v[128:131], v[144:147], v[32:35]
    v_mfma_f32_16x16x32_bf16 v[28:31], v[112:115], v[156:159], v[28:31]
    v_mfma_f32_16x16x32_bf16 v[28:31], v[116:119], v[152:155], v[28:31]
    v_mfma_f32_16x16x32_bf16 v[28:31], v[120:123], v[148:151], v[28:31]
    v_mfma_f32_16x16x32_bf16 v[28:31], v[124:127], v[144:147], v[28:31]
    v_lshlrev_b32 v3, 16, v3
    v_lshlrev_b32 v14, 5, v9
    v_lshlrev_b32 v15, 3, v10
    v_add_u32 v14, v14, v15
    v_sub_u32 v15, 8952, v14
    v_add_u32 v15, s31, v15
    v_add_u32 v14, s32, v14
    ds_read_b64 v[56:57], v15 offset:1536
    ds_read_b64 v[54:55], v15 offset:2048
    s_waitcnt lgkmcnt(0)
    v_and_b32 v64, 0xffff0000, v57
    v_lshlrev_b32 v65, 16, v57
    v_and_b32 v66, 0xffff0000, v56
    v_lshlrev_b32 v67, 16, v56
    v_mul_f32 v64, v64, v3
    v_mul_f32 v65, v65, v3
    v_mul_f32 v66, v66, v3
    v_mul_f32 v67, v67, v3
    v_cvt_pk_bf16_f32 v68, v64, v65
    v_cvt_pk_bf16_f32 v69, v66, v67
    v_cvt_pk_bf16_f32 v70, v32, v33
    v_cvt_pk_bf16_f32 v71, v34, v35
    v_lshlrev_b32 v64, 16, v68
    v_and_b32 v65, 0xffff0000, v68
    v_lshlrev_b32 v66, 16, v69
    v_and_b32 v67, 0xffff0000, v69
    v_lshlrev_b32 v32, 16, v70
    v_and_b32 v33, 0xffff0000, v70
    v_lshlrev_b32 v34, 16, v71
    v_and_b32 v35, 0xffff0000, v71
    v_add_f32 v64, v64, v32
    v_add_f32 v65, v65, v33
    v_add_f32 v66, v66, v34
    v_add_f32 v67, v67, v35
    v_cvt_pk_bf16_f32 v32, v64, v65
    v_cvt_pk_bf16_f32 v33, v66, v67
    buffer_store_dwordx2 v[32:33], v14, s[24:27], 0 offen offset:2048 sc1
    v_and_b32 v72, 0xffff0000, v55
    v_lshlrev_b32 v73, 16, v55
    v_and_b32 v74, 0xffff0000, v54
    v_lshlrev_b32 v75, 16, v54
    v_mul_f32 v72, v72, v3
    v_mul_f32 v73, v73, v3
    v_mul_f32 v74, v74, v3
    v_mul_f32 v75, v75, v3
    v_cvt_pk_bf16_f32 v76, v72, v73
    v_cvt_pk_bf16_f32 v77, v74, v75
    v_cvt_pk_bf16_f32 v78, v28, v29
    v_cvt_pk_bf16_f32 v79, v30, v31
    v_lshlrev_b32 v72, 16, v76
    v_and_b32 v73, 0xffff0000, v76
    v_lshlrev_b32 v74, 16, v77
    v_and_b32 v75, 0xffff0000, v77
    v_lshlrev_b32 v28, 16, v78
    v_and_b32 v29, 0xffff0000, v78
    v_lshlrev_b32 v30, 16, v79
    v_and_b32 v31, 0xffff0000, v79
    v_add_f32 v72, v72, v28
    v_add_f32 v73, v73, v29
    v_add_f32 v74, v74, v30
    v_add_f32 v75, v75, v31
    v_cvt_pk_bf16_f32 v28, v72, v73
    v_cvt_pk_bf16_f32 v29, v74, v75
    buffer_store_dwordx2 v[28:29], v14, s[24:27], 0 offen offset:1536 sc1
L_g2_pub2:
    v_mov_b32 v14, 12928
    v_mov_b32 v15, 1
    s_waitcnt vmcnt(0)
    s_mov_b64 exec, 1
    buffer_atomic_add v15, v14, s[36:39], 0 offen
    s_mov_b64 exec, -1
L_g2_pub:
    v_mov_b32 v14, s33
    v_mov_b32 v15, 4
    s_waitcnt vmcnt(0)
    s_mov_b64 exec, 1
    buffer_atomic_add v15, v14, s[36:39], 0 offen
    s_mov_b64 exec, -1
L_g2_end:
    s_endpgm
.section .rodata,"a"
.p2align 6
.amdhsa_kernel front_kernel
  .amdhsa_next_free_vgpr 128
  .amdhsa_next_free_sgpr 80
  .amdhsa_accum_offset 128
  .amdhsa_group_segment_fixed_size 0
  .amdhsa_kernarg_size 104
  .amdhsa_user_sgpr_count 2
  .amdhsa_user_sgpr_kernarg_segment_ptr 1
  .amdhsa_system_sgpr_workgroup_id_x 1
  .amdhsa_float_denorm_mode_32 3
.end_amdhsa_kernel
.p2align 6
.amdhsa_kernel gemm1_kernel
  .amdhsa_next_free_vgpr 252
  .amdhsa_next_free_sgpr 100
  .amdhsa_accum_offset 252
  .amdhsa_group_segment_fixed_size 0
  .amdhsa_kernarg_size 104
  .amdhsa_user_sgpr_count 2
  .amdhsa_user_sgpr_kernarg_segment_ptr 1
  .amdhsa_system_sgpr_workgroup_id_x 1
  .amdhsa_float_denorm_mode_32 3
.end_amdhsa_kernel
.p2align 6
.amdhsa_kernel gemm2_kernel
  .amdhsa_next_free_vgpr 248
  .amdhsa_next_free_sgpr 100
  .amdhsa_accum_offset 248
  .amdhsa_group_segment_fixed_size 0
  .amdhsa_kernarg_size 104
  .amdhsa_user_sgpr_count 2
  .amdhsa_user_sgpr_kernarg_segment_ptr 1
  .amdhsa_system_sgpr_workgroup_id_x 1
  .amdhsa_float_denorm_mode_32 3
.end_amdhsa_kernel
```
